```python
import torch

def _softmax(x, axis=-1):
    return torch.softmax(x, dim=axis)
def _gelu(x):
    return torch.nn.functional.gelu(x, approximate="tanh")
def _silu(x):
    return torch.nn.functional.silu(x)
def _sigmoid(x):
    return torch.sigmoid(x)
def _layernorm(x, axis=-1, eps=1e-5):
    m = x.mean(dim=axis, keepdim=True)
    v = x.var(dim=axis, keepdim=True, unbiased=False)
    return (x - m) / torch.sqrt(v + eps)
def _scatter_add(tgt, idx, src, axis=0):
    return tgt.clone().index_add_(axis, idx, src)
def _segment_sum(src, seg, n):
    out = torch.zeros((n,) + src.shape[1:], dtype=src.dtype)
    return out.index_add_(0, seg, src)
def _pad(x, pw):
    flat = tuple(v for pair in reversed(pw) for v in pair)
    return torch.nn.functional.pad(x, flat)

kernel_name = 'recurrent_scan__compressed_kv_cla__glu_gated_bilinear__prompt'

def setup_inputs():

    _w = (lambda a: (lambda t: t.to(torch.bfloat16) if t.is_floating_point() else t)(torch.as_tensor(a)))
    def _A_setup():
        B, H, Sq, Sk, D, M = 1, 32, 2048, 2048, 128, 512
        Dc = 4 * D
        return {
            "x": _w((lambda *s: torch.randn(*s, dtype=torch.bfloat16) * 0.05)(B, Sq, M)),
            "c_kv": _w((lambda *s: torch.randn(*s, dtype=torch.bfloat16) * 1.6)(B, Sk, Dc)),
            "w_q": _w((lambda *s: torch.randn(*s, dtype=torch.bfloat16) * 1.6)(M, H, D) * (M ** -0.5)),
            "w_uk": _w((lambda *s: torch.randn(*s, dtype=torch.bfloat16) * 1.6)(Dc, H, D) * (Dc ** -0.5)),
            "w_uv": _w((lambda *s: torch.randn(*s, dtype=torch.bfloat16) * 1.6)(Dc, H, D) * (Dc ** -0.5)),
            "w_o": _w((lambda *s: torch.randn(*s, dtype=torch.bfloat16) * 1.6)(H, D, M) * ((H * D) ** -0.5)),
        }
    _A_in = _A_setup()

    def _B_setup():
        B, S, D, F = 1, 2048, 512, 1792
        return {
            "x": _w((lambda *s: torch.randn(*s, dtype=torch.bfloat16) * 0.05)(B, S, D)),
            "w_gate": _w((lambda *s: torch.randn(*s, dtype=torch.bfloat16) * 0.2)(D, F) * (D ** -0.5)),
            "w_up": _w((lambda *s: torch.randn(*s, dtype=torch.bfloat16) * 0.2)(D, F) * (D ** -0.5)),
            "w_down": _w((lambda *s: torch.randn(*s, dtype=torch.bfloat16) * 0.2)(F, D) * (F ** -0.5)),
        }
    _B_in = _B_setup()

    return {
        "A_x": _A_in["x"],
        "A_c_kv": _A_in["c_kv"],
        "A_w_q": _A_in["w_q"],
        "A_w_uk": _A_in["w_uk"],
        "A_w_uv": _A_in["w_uv"],
        "A_w_o": _A_in["w_o"],
        "B_x": _B_in["x"],
        "B_w_gate": _B_in["w_gate"],
        "B_w_up": _B_in["w_up"],
        "B_w_down": _B_in["w_down"],
    }

def reference(A_x, A_c_kv, A_w_q, A_w_uk, A_w_uv, A_w_o, B_x, B_w_gate, B_w_up, B_w_down):
    def _A_ref(x, c_kv, w_q, w_uk, w_uv, w_o):
        B, Sq, M = x.shape[0], x.shape[1], x.shape[2]
        Sk = c_kv.shape[1]
        H, D = w_q.shape[1], w_q.shape[2]
        q = torch.einsum("bqm,mhd->bhqd", x, w_q)
        k = torch.einsum("bkc,chd->bhkd", c_kv, w_uk)
        v = torch.einsum("bkc,chd->bhkd", c_kv, w_uv)
        scores = torch.einsum("bhqd,bhkd->bhqk", q, k) * (D ** -0.5)
        off = Sk - Sq
        qi = torch.arange(Sq)[:, None]
        kj = torch.arange(Sk)[None, :]
        cmask = kj <= (qi + off)
        scores = torch.where(cmask[None, None], scores, -1e9)
        p = _softmax(scores, axis=-1)
        ctx = torch.einsum("bhqk,bhkd->bhqd", p, v)
        return torch.einsum("bhqd,hdm->bqm", ctx, w_o)

    def _B_ref(x, w_gate, w_up, w_down):
        g = torch.einsum("bsd,df->bsf", x, w_gate)
        u = torch.einsum("bsd,df->bsf", x, w_up)
        h = g * u
        return torch.einsum("bsf,fd->bsd", h, w_down)

    x = A_x
    xn = _layernorm(x, axis=-1)
    s = _A_ref(xn, A_c_kv, A_w_q, A_w_uk, A_w_uv, A_w_o)
    g = _silu(_B_ref(xn, B_w_gate, B_w_up, B_w_down))
    return x + s * g
```

```asm
; @launch grid=(256,1,1) block=(256,1,1) lds=163840
.amdgcn_target "amdgcn-amd-amdhsa--gfx950"
.text
.globl recurrent_scan__compressed_kv_cla__glu_gated_bilinear__prompt_kernel
.p2align 8
.type recurrent_scan__compressed_kv_cla__glu_gated_bilinear__prompt_kernel,@function
recurrent_scan__compressed_kv_cla__glu_gated_bilinear__prompt_kernel:
s_cmp_ge_u32 s2, 256
s_cbranch_scc1 L_end
s_load_dwordx8 s[4:11], s[0:1], 0
s_load_dwordx4 s[12:15], s[0:1], 32
s_load_dwordx4 s[16:19], s[0:1], 56
s_load_dwordx4 s[20:23], s[0:1], 72
s_load_dwordx4 s[24:27], s[0:1], 88
v_lshrrev_b32 v1, 6, v0
v_and_b32 v243, 63, v0
v_readfirstlane_b32 s56, v1
s_nop 3
s_lshr_b32 s58, s2, 3
s_lshl_b32 s59, s58, 2
s_add_u32 s59, s59, s56
s_cmp_lg_u32 s58, 0
s_cbranch_scc1 L_not0
s_getpc_b64 s[96:97]
L_pc0:
s_sub_u32 s96, s96, L_pc0-recurrent_scan__compressed_kv_cla__glu_gated_bilinear__prompt_kernel
s_subb_u32 s97, s97, 0
s_lshl_b32 s3, s59, 13
v_lshl_add_u32 v4, v243, 7, s3
v_min_u32 v4, L_seam-recurrent_scan__compressed_kv_cla__glu_gated_bilinear__prompt_kernel, v4
global_load_dword v5, v4, s[96:97]
L_not0:
s_and_b32 s57, s2, 7
s_lshl_b32 s57, s57, 2
s_add_u32 s3, s58, 0
s_and_b32 s3, s3, 3
s_add_u32 s57, s57, s3
s_lshr_b32 s58, s58, 2
v_lshrrev_b32 v1, 3, v243
v_lshlrev_b32 v2, 10, v1
v_lshrrev_b32 v1, 1, v1
v_and_b32 v3, 7, v243
v_xor_b32 v1, v1, v3
v_xor_b32 v3, 0, v1
v_lshl_add_u32 v224, v3, 4, v2
v_xor_b32 v3, 4, v1
v_lshl_add_u32 v225, v3, 4, v2
v_add_u32 v225, 7168, v225
v_xor_b32 v3, 0, v1
v_lshl_add_u32 v226, v3, 4, v2
v_add_u32 v226, 14336, v226
v_xor_b32 v3, 4, v1
v_lshl_add_u32 v227, v3, 4, v2
v_add_u32 v227, 21504, v227
s_mov_b32 s79, 8192
v_lshrrev_b32 v1, 3, v243
v_mul_lo_u32 v2, v1, s79
v_and_b32 v3, 1, v243
v_lshl_add_u32 v2, v3, 4, v2
v_bfe_u32 v1, v243, 4, 1
v_bfe_u32 v3, v243, 1, 2
v_xor_b32 v1, v1, v3
v_xor_b32 v3, 0, v1
v_lshl_add_u32 v228, v3, 5, v2
v_xor_b32 v3, 2, v1
v_lshl_add_u32 v229, v3, 5, v2
s_mul_i32 s3, s79, 8
s_sub_u32 s3, s3, 1024
v_add_u32 v229, s3, v229
v_xor_b32 v3, 0, v1
v_lshl_add_u32 v230, v3, 5, v2
s_mul_i32 s3, s79, 16
s_sub_u32 s3, s3, 2048
v_add_u32 v230, s3, v230
v_xor_b32 v3, 2, v1
v_lshl_add_u32 v231, v3, 5, v2
s_mul_i32 s3, s79, 24
s_sub_u32 s3, s3, 3072
v_add_u32 v231, s3, v231
s_lshl_b32 s63, s56, 13
s_add_u32 s63, s63, 65536
s_and_b32 s77, s2, 3
s_lshl_b32 s77, s77, 3
s_lshr_b32 s3, s2, 3
s_and_b32 s78, s3, 7
s_add_u32 s77, s77, s78
s_lshr_b32 s78, s3, 3
s_and_b32 s3, s2, 4
s_add_u32 s78, s78, s3
s_lshl_b32 s60, s78, 2
s_add_u32 s60, s60, s56
s_lshl_b32 s60, s60, 16
s_lshl_b32 s61, s56, 17
s_lshl_b32 s62, s77, 8
s_add_u32 s61, s61, s62
s_lshl_b32 s64, s56, 11
s_and_b32 s73, s77, 1
s_lshl_b32 s73, s73, 2
s_lshl_b32 s3, s78, 1
s_add_u32 s73, s73, s3
s_and_b32 s73, s73, 7
v_mov_b32 v222, 0
v_mov_b32 v223, 1
s_lshl_b32 s72, s2, 15
v_lshlrev_b32 v6, 7, v0
s_waitcnt lgkmcnt(0)
s_mov_b32 s28, s6
s_mov_b32 s29, s7
s_mov_b32 s30, 2097152
s_mov_b32 s31, 0x20000
s_mov_b32 s32, s10
s_mov_b32 s33, s11
s_mov_b32 s34, 4194304
s_mov_b32 s35, 0x20000
s_add_u32 s48, s26, 77594624
s_addc_u32 s49, s27, 0
s_mov_b32 s50, 27648
s_mov_b32 s51, 0x20000
buffer_store_dword v222, v6, s[48:51], s72 offen sc1
s_add_u32 s3, s73, 0
s_and_b32 s3, s3, 7
s_lshl_b32 s76, s3, 19
s_lshl_b32 s75, s3, 7
s_add_u32 s75, s75, s60
s_add_u32 m0, s64, 0
s_add_u32 s74, s61, s76
buffer_load_dwordx4 v228, s[32:35], s74 offen offset:0 lds
buffer_load_dwordx4 v229, s[32:35], s74 offen offset:1024 lds
s_add_u32 m0, s63, 0
s_add_u32 s74, s75, 0
buffer_load_dwordx4 v224, s[28:31], s74 offen offset:0 lds
buffer_load_dwordx4 v225, s[28:31], s74 offen offset:1024 lds
buffer_load_dwordx4 v226, s[28:31], s74 offen offset:2048 lds
buffer_load_dwordx4 v227, s[28:31], s74 offen offset:3072 lds
s_add_u32 m0, s63, 4096
s_add_u32 s74, s75, 32768
buffer_load_dwordx4 v224, s[28:31], s74 offen offset:0 lds
buffer_load_dwordx4 v225, s[28:31], s74 offen offset:1024 lds
buffer_load_dwordx4 v226, s[28:31], s74 offen offset:2048 lds
buffer_load_dwordx4 v227, s[28:31], s74 offen offset:3072 lds
s_add_u32 s3, s73, 1
s_and_b32 s3, s3, 7
s_lshl_b32 s76, s3, 19
s_lshl_b32 s75, s3, 7
s_add_u32 s75, s75, s60
s_add_u32 m0, s64, 8192
s_add_u32 s74, s61, s76
buffer_load_dwordx4 v228, s[32:35], s74 offen offset:0 lds
buffer_load_dwordx4 v229, s[32:35], s74 offen offset:1024 lds
s_add_u32 m0, s63, 32768
s_add_u32 s74, s75, 0
buffer_load_dwordx4 v224, s[28:31], s74 offen offset:0 lds
buffer_load_dwordx4 v225, s[28:31], s74 offen offset:1024 lds
buffer_load_dwordx4 v226, s[28:31], s74 offen offset:2048 lds
buffer_load_dwordx4 v227, s[28:31], s74 offen offset:3072 lds
s_add_u32 m0, s63, 36864
s_add_u32 s74, s75, 32768
buffer_load_dwordx4 v224, s[28:31], s74 offen offset:0 lds
buffer_load_dwordx4 v225, s[28:31], s74 offen offset:1024 lds
buffer_load_dwordx4 v226, s[28:31], s74 offen offset:2048 lds
buffer_load_dwordx4 v227, s[28:31], s74 offen offset:3072 lds
s_mov_b32 s36, s12
s_mov_b32 s37, s13
s_mov_b32 s38, 4194304
s_mov_b32 s39, 0x20000
s_mov_b32 s44, s4
s_mov_b32 s45, s5
s_mov_b32 s46, 2097152
s_mov_b32 s47, 0x20000
v_and_b32 v1, 7, v243
v_lshrrev_b32 v2, 3, v243
v_lshlrev_b32 v3, 10, v1
v_lshl_add_u32 v244, v2, 4, v3
s_lshl_b32 s69, s2, 13
s_lshl_b32 s3, s56, 8
s_add_u32 s69, s69, s3
v_lshrrev_b32 v3, 2, v2
v_lshlrev_b32 v3, 10, v3
v_and_b32 v2, 3, v2
v_lshl_add_u32 v3, v2, 8, v3
v_lshl_add_u32 v245, v1, 4, v3
s_lshr_b32 s70, s2, 1
s_lshl_b32 s70, s70, 14
s_and_b32 s3, s2, 1
s_lshl_b32 s3, s3, 7
s_add_u32 s70, s70, s3
s_lshl_b32 s3, s56, 12
s_add_u32 s70, s70, s3
s_add_u32 s71, s70, 2048
v_lshlrev_b32 v97, 4, v1
v_add_u32 v97, 0x8000, v97
s_lshl_b32 s3, s56, 2
v_add_u32 v96, s3, v97
v_lshrrev_b32 v1, 4, v243
v_lshlrev_b32 v1, 10, v1
v_bfe_u32 v2, v243, 2, 2
v_lshl_add_u32 v1, v2, 7, v1
v_and_b32 v2, 3, v243
v_lshl_add_u32 v1, v2, 3, v1
v_bfe_u32 v2, v243, 3, 2
v_xor_b32 v3, 0, v2
v_lshl_add_u32 v236, v3, 5, v1
v_xor_b32 v3, 1, v2
v_lshl_add_u32 v237, v3, 5, v1
v_xor_b32 v3, 2, v2
v_lshl_add_u32 v238, v3, 5, v1
v_xor_b32 v3, 3, v2
v_lshl_add_u32 v239, v3, 5, v1
v_and_b32 v1, 15, v243
v_lshlrev_b32 v2, 7, v1
v_lshrrev_b32 v1, 1, v1
v_lshrrev_b32 v3, 4, v243
v_xor_b32 v1, v1, v3
v_add_u32 v2, s63, v2
v_xor_b32 v3, 0, v1
v_lshl_add_u32 v232, v3, 4, v2
v_add_u32 v234, 0x10000, v232
v_xor_b32 v3, 4, v1
v_lshl_add_u32 v233, v3, 4, v2
v_add_u32 v235, 0x10000, v233
v_lshlrev_b32 v242, 4, v243
s_lshl_b32 s3, s59, 15
s_and_b32 s79, s2, 7
s_lshl_b32 s79, s79, 10
s_add_u32 s3, s3, s79
v_add_u32 v220, s3, v242
v_lshrrev_b32 v221, 5, v243
v_mul_u32_u24 v221, 3584, v221
v_and_b32 v1, 31, v243
v_lshl_add_u32 v221, v1, 4, v221
s_mul_i32 s3, s59, 14336
s_lshr_b32 s79, s79, 1
s_min_u32 s79, s79, 3072
s_add_u32 s3, s3, s79
v_add_u32 v221, s3, v221
s_and_b32 s3, s2, 3
s_lshl_b32 s3, s3, 11
s_and_b32 s79, s2, 4
s_lshl_b32 s79, s79, 8
s_add_u32 s3, s3, s79
s_add_u32 s12, s12, s3
s_addc_u32 s13, s13, 0
s_and_b32 s3, s2, 7
s_lshl_b32 s3, s3, 10
s_sub_u32 s12, s12, s3
s_subb_u32 s13, s13, 0
s_lshl_b32 s65, s73, 1
s_add_u32 s65, s65, s56
s_lshl_b32 s66, s56, 12
s_lshl_b32 s67, s78, 3
s_lshl_b32 s3, s56, 1
s_add_u32 s67, s67, s3
s_mul_i32 s67, s67, 16384
s_mov_b32 s68, 0x3e0293ee
s_mul_i32 s3, s77, 1048576
s_add_u32 s3, s3, 2097152
s_add_u32 s40, s26, s3
s_addc_u32 s41, s27, 0
s_mov_b32 s42, 1048576
s_mov_b32 s43, 0x20000
s_mov_b32 s52, s24
s_mov_b32 s53, s25
s_mov_b32 s54, 256
s_mov_b32 s55, 0x20000
s_add_u32 s3, s73, 2
s_and_b32 s3, s3, 7
s_lshl_b32 s76, s3, 19
s_lshl_b32 s75, s3, 7
s_add_u32 s75, s75, s60
s_add_u32 m0, s64, 16384
s_add_u32 s74, s61, s76
buffer_load_dwordx4 v228, s[32:35], s74 offen offset:0 lds
buffer_load_dwordx4 v229, s[32:35], s74 offen offset:1024 lds
s_add_u32 m0, s63, 65536
s_add_u32 s74, s75, 0
buffer_load_dwordx4 v224, s[28:31], s74 offen offset:0 lds
buffer_load_dwordx4 v225, s[28:31], s74 offen offset:1024 lds
buffer_load_dwordx4 v226, s[28:31], s74 offen offset:2048 lds
buffer_load_dwordx4 v227, s[28:31], s74 offen offset:3072 lds
s_add_u32 m0, s63, 69632
s_add_u32 s74, s75, 32768
buffer_load_dwordx4 v224, s[28:31], s74 offen offset:0 lds
buffer_load_dwordx4 v225, s[28:31], s74 offen offset:1024 lds
buffer_load_dwordx4 v226, s[28:31], s74 offen offset:2048 lds
buffer_load_dwordx4 v227, s[28:31], s74 offen offset:3072 lds
s_lshr_b32 s0, s2, 3
s_cmp_lg_u32 s0, 1
s_cbranch_scc1 L_ct0
s_lshl_b32 s0, s56, 13
v_lshl_add_u32 v6, v243, 7, s0
v_min_u32 v6, L_p1-L_seam-4, v6
s_getpc_b64 s[0:1]
L_cp0:
s_add_u32 s0, s0, L_seam-L_cp0
s_addc_u32 s1, s1, 0
global_load_dword v219, v6, s[0:1]
L_ct0:
s_lshr_b32 s0, s2, 3
s_cmp_lg_u32 s0, 2
s_cbranch_scc1 L_ct1
s_lshl_b32 s0, s56, 13
v_lshl_add_u32 v6, v243, 7, s0
v_min_u32 v6, L_k3-L_p1-4, v6
s_getpc_b64 s[0:1]
L_cp1:
s_add_u32 s0, s0, L_p1-L_cp1
s_addc_u32 s1, s1, 0
global_load_dword v219, v6, s[0:1]
L_ct1:
s_lshr_b32 s0, s2, 3
s_cmp_lg_u32 s0, 3
s_cbranch_scc1 L_ct2
s_lshl_b32 s0, s56, 13
v_lshl_add_u32 v6, v243, 7, s0
v_min_u32 v6, L_end-L_k3-4, v6
s_getpc_b64 s[0:1]
L_cp2:
s_add_u32 s0, s0, L_k3-L_cp2
s_addc_u32 s1, s1, 0
global_load_dword v219, v6, s[0:1]
L_ct2:
buffer_load_dwordx4 v[208:211], v244, s[44:47], s69 offen
buffer_load_dwordx4 v[212:215], v244, s[44:47], s69 offen offset:128
s_add_u32 s44, s26, 0
s_addc_u32 s45, s27, 0
s_mov_b32 s46, 2097152
s_mov_b32 s47, 0x20000
s_waitcnt vmcnt(22)
s_barrier
ds_read_b64_tr_b16 v[160:161], v236 offset:0
ds_read_b64_tr_b16 v[162:163], v236 offset:512
ds_read_b64_tr_b16 v[164:165], v236 offset:4096
ds_read_b64_tr_b16 v[166:167], v236 offset:4608
ds_read_b64_tr_b16 v[168:169], v237 offset:0
ds_read_b64_tr_b16 v[170:171], v237 offset:512
ds_read_b64_tr_b16 v[172:173], v237 offset:4096
ds_read_b64_tr_b16 v[174:175], v237 offset:4608
ds_read_b128 a[0:3], v232 offset:0
ds_read_b128 a[4:7], v233 offset:0
ds_read_b128 a[64:67], v232 offset:2048
ds_read_b128 a[68:71], v233 offset:2048
ds_read_b128 a[128:131], v232 offset:4096
ds_read_b128 a[132:135], v233 offset:4096
ds_read_b128 a[192:195], v232 offset:6144
ds_read_b128 a[196:199], v233 offset:6144
s_waitcnt lgkmcnt(7)
v_mfma_f32_16x16x32_bf16 v[0:3], v[160:163], a[0:3], 0
ds_read_b64_tr_b16 v[176:177], v238 offset:0
s_waitcnt lgkmcnt(7)
v_mfma_f32_16x16x32_bf16 v[0:3], v[164:167], a[4:7], v[0:3]
ds_read_b64_tr_b16 v[178:179], v238 offset:512
s_waitcnt lgkmcnt(7)
v_mfma_f32_16x16x32_bf16 v[16:19], v[160:163], a[64:67], 0
ds_read_b64_tr_b16 v[180:181], v238 offset:4096
s_waitcnt lgkmcnt(7)
v_mfma_f32_16x16x32_bf16 v[16:19], v[164:167], a[68:71], v[16:19]
ds_read_b64_tr_b16 v[182:183], v238 offset:4608
s_waitcnt lgkmcnt(7)
v_mfma_f32_16x16x32_bf16 v[32:35], v[160:163], a[128:131], 0
s_waitcnt lgkmcnt(6)
v_mfma_f32_16x16x32_bf16 v[32:35], v[164:167], a[132:135], v[32:35]
s_waitcnt lgkmcnt(5)
v_mfma_f32_16x16x32_bf16 v[48:51], v[160:163], a[192:195], 0
s_waitcnt lgkmcnt(4)
ds_read_b64_tr_b16 v[184:185], v239 offset:0
v_mfma_f32_16x16x32_bf16 v[48:51], v[164:167], a[196:199], v[48:51]
global_load_dwordx4 v[248:251], v220, s[12:13]
v_mfma_f32_16x16x32_bf16 v[4:7], v[168:171], a[0:3], 0
ds_read_b64_tr_b16 v[186:187], v239 offset:512
v_mfma_f32_16x16x32_bf16 v[4:7], v[172:175], a[4:7], v[4:7]
ds_read_b64_tr_b16 v[188:189], v239 offset:4096
v_mfma_f32_16x16x32_bf16 v[20:23], v[168:171], a[64:67], 0
ds_read_b64_tr_b16 v[190:191], v239 offset:4608
v_mfma_f32_16x16x32_bf16 v[20:23], v[172:175], a[68:71], v[20:23]
v_add_u32 v220, 8192, v220
v_mfma_f32_16x16x32_bf16 v[36:39], v[168:171], a[128:131], 0
v_mfma_f32_16x16x32_bf16 v[36:39], v[172:175], a[132:135], v[36:39]
v_mfma_f32_16x16x32_bf16 v[52:55], v[168:171], a[192:195], 0
v_mfma_f32_16x16x32_bf16 v[52:55], v[172:175], a[196:199], v[52:55]
s_waitcnt lgkmcnt(2)
s_waitcnt vmcnt(13)
s_barrier
s_cmp_lg_u32 s2, 0
s_cbranch_scc1 L_nozs
s_cmp_lg_u32 s56, 0
s_cbranch_scc1 L_sig3
s_mov_b64 exec, 1
buffer_atomic_add v223, v222, s[52:55], 0 offen sc1
s_mov_b64 exec, -1
L_sig3:
L_nozs:
v_mfma_f32_16x16x32_bf16 v[8:11], v[176:179], a[0:3], 0
ds_read_b64_tr_b16 v[192:193], v236 offset:8192
s_add_u32 s3, s73, 3
v_mfma_f32_16x16x32_bf16 v[8:11], v[180:183], a[4:7], v[8:11]
ds_read_b128 a[8:11], v232 offset:32768
s_and_b32 s3, s3, 7
v_mfma_f32_16x16x32_bf16 v[24:27], v[176:179], a[64:67], 0
ds_read_b64_tr_b16 v[194:195], v236 offset:8704
s_waitcnt vmcnt(1)
v_mfma_f32_16x16x32_bf16 v[24:27], v[180:183], a[68:71], v[24:27]
ds_read_b64_tr_b16 v[196:197], v236 offset:12288
s_lshl_b32 s76, s3, 19
v_mfma_f32_16x16x32_bf16 v[40:43], v[176:179], a[128:131], 0
global_load_dwordx4 v[248:251], v220, s[12:13]
v_mfma_f32_16x16x32_bf16 v[40:43], v[180:183], a[132:135], v[40:43]
ds_read_b64_tr_b16 v[198:199], v236 offset:12800
v_lshlrev_b32 v128, 16, v208
s_lshl_b32 s75, s3, 7
v_mfma_f32_16x16x32_bf16 v[56:59], v[176:179], a[192:195], 0
ds_read_b128 a[12:15], v233 offset:32768
s_add_u32 s75, s75, s60
s_add_u32 m0, s64, 24576
v_mfma_f32_16x16x32_bf16 v[56:59], v[180:183], a[196:199], v[56:59]
ds_read_b128 a[72:75], v232 offset:34816
v_and_b32 v129, 0xffff0000, v208
s_add_u32 s74, s61, s76
v_mfma_f32_16x16x32_bf16 v[12:15], v[184:187], a[0:3], 0
s_waitcnt lgkmcnt(5)
v_lshlrev_b32 v130, 16, v209
v_and_b32 v131, 0xffff0000, v209
v_mfma_f32_16x16x32_bf16 v[12:15], v[188:191], a[4:7], v[12:15]
buffer_load_dwordx4 v228, s[32:35], s74 offen offset:0 lds
v_mfma_f32_16x16x32_bf16 v[28:31], v[184:187], a[64:67], 0
ds_read_b128 a[76:79], v233 offset:34816
v_lshlrev_b32 v132, 16, v210
v_mfma_f32_16x16x32_bf16 v[28:31], v[188:191], a[68:71], v[28:31]
ds_read_b128 a[136:139], v232 offset:36864
v_and_b32 v133, 0xffff0000, v210
v_mfma_f32_16x16x32_bf16 v[44:47], v[184:187], a[128:131], 0
buffer_load_dwordx4 v229, s[32:35], s74 offen offset:1024 lds
s_add_u32 m0, s63, 0
v_mfma_f32_16x16x32_bf16 v[44:47], v[188:191], a[132:135], v[44:47]
ds_read_b128 a[140:143], v233 offset:36864
s_add_u32 s74, s75, 0
v_lshlrev_b32 v134, 16, v211
v_mfma_f32_16x16x32_bf16 v[60:63], v[184:187], a[192:195], 0
ds_read_b64_tr_b16 v[200:201], v237 offset:8192
v_add_u32 v220, 8192, v220
v_mfma_f32_16x16x32_bf16 v[60:63], v[188:191], a[196:199], v[60:63]
s_waitcnt lgkmcnt(4)
ds_read_b64_tr_b16 v[202:203], v237 offset:8704
v_and_b32 v135, 0xffff0000, v211
v_mfma_f32_16x16x32_bf16 v[0:3], v[192:195], a[8:11], v[0:3]
ds_read_b128 a[200:203], v232 offset:38912
v_lshlrev_b32 v136, 16, v212
v_mfma_f32_16x16x32_bf16 v[0:3], v[196:199], a[12:15], v[0:3]
ds_read_b128 a[204:207], v233 offset:38912
v_and_b32 v137, 0xffff0000, v212
v_mfma_f32_16x16x32_bf16 v[16:19], v[192:195], a[72:75], v[16:19]
s_waitcnt lgkmcnt(5)
ds_read_b64_tr_b16 v[204:205], v237 offset:12288
v_mfma_f32_16x16x32_bf16 v[16:19], v[196:199], a[76:79], v[16:19]
ds_read_b64_tr_b16 v[206:207], v237 offset:12800
buffer_load_dwordx4 v224, s[28:31], s74 offen offset:0 lds
v_lshlrev_b32 v138, 16, v213
v_mfma_f32_16x16x32_bf16 v[32:35], v[192:195], a[136:139], v[32:35]
s_waitcnt lgkmcnt(6)
ds_read_b64_tr_b16 v[160:161], v238 offset:8192
v_and_b32 v139, 0xffff0000, v213
v_mfma_f32_16x16x32_bf16 v[32:35], v[196:199], a[140:143], v[32:35]
s_waitcnt lgkmcnt(4)
ds_read_b64_tr_b16 v[162:163], v238 offset:8704
buffer_load_dwordx4 v225, s[28:31], s74 offen offset:1024 lds
v_mfma_f32_16x16x32_bf16 v[48:51], v[192:195], a[200:203], v[48:51]
s_waitcnt lgkmcnt(4)
ds_read_b64_tr_b16 v[164:165], v238 offset:12288
v_lshlrev_b32 v140, 16, v214
v_mfma_f32_16x16x32_bf16 v[48:51], v[196:199], a[204:207], v[48:51]
buffer_load_dwordx4 v226, s[28:31], s74 offen offset:2048 lds
v_and_b32 v141, 0xffff0000, v214
v_mfma_f32_16x16x32_bf16 v[4:7], v[200:203], a[8:11], v[4:7]
s_waitcnt lgkmcnt(3)
ds_read_b64_tr_b16 v[166:167], v238 offset:12800
global_load_dwordx4 v[248:251], v220, s[12:13]
v_lshlrev_b32 v142, 16, v215
v_mfma_f32_16x16x32_bf16 v[4:7], v[204:207], a[12:15], v[4:7]
buffer_load_dwordx4 v227, s[28:31], s74 offen offset:3072 lds
s_add_u32 m0, s63, 4096
s_add_u32 s74, s75, 32768
v_mfma_f32_16x16x32_bf16 v[20:23], v[200:203], a[72:75], v[20:23]
buffer_load_dwordx4 v224, s[28:31], s74 offen offset:0 lds
v_and_b32 v143, 0xffff0000, v215
v_mfma_f32_16x16x32_bf16 v[20:23], v[204:207], a[76:79], v[20:23]
buffer_load_dwordx4 v225, s[28:31], s74 offen offset:1024 lds
v_add_f32 v216, v128, v129
v_add_u32 v220, 8192, v220
v_mfma_f32_16x16x32_bf16 v[36:39], v[200:203], a[136:139], v[36:39]
ds_read_b64_tr_b16 v[168:169], v239 offset:8192
v_add_f32 v217, v130, v131
v_mfma_f32_16x16x32_bf16 v[36:39], v[204:207], a[140:143], v[36:39]
buffer_load_dwordx4 v226, s[28:31], s74 offen offset:2048 lds
v_mfma_f32_16x16x32_bf16 v[52:55], v[200:203], a[200:203], v[52:55]
ds_read_b64_tr_b16 v[170:171], v239 offset:8704
v_add_f32 v216, v216, v132
v_mfma_f32_16x16x32_bf16 v[52:55], v[204:207], a[204:207], v[52:55]
s_waitcnt lgkmcnt(2)
s_waitcnt vmcnt(14)
s_barrier
v_add_f32 v217, v217, v133
v_mfma_f32_16x16x32_bf16 v[8:11], v[160:163], a[8:11], v[8:11]
ds_read_b64_tr_b16 v[172:173], v239 offset:12288
v_mfma_f32_16x16x32_bf16 v[8:11], v[164:167], a[12:15], v[8:11]
ds_read_b64_tr_b16 v[174:175], v239 offset:12800
v_add_f32 v216, v216, v134
v_mfma_f32_16x16x32_bf16 v[24:27], v[160:163], a[72:75], v[24:27]
buffer_load_dwordx4 v227, s[28:31], s74 offen offset:3072 lds
v_add_f32 v217, v217, v135
v_mfma_f32_16x16x32_bf16 v[24:27], v[164:167], a[76:79], v[24:27]
global_load_dwordx4 v[248:251], v220, s[12:13]
v_add_f32 v216, v216, v136
s_add_u32 s3, s73, 4
v_mfma_f32_16x16x32_bf16 v[40:43], v[160:163], a[136:139], v[40:43]
ds_read_b64_tr_b16 v[176:177], v236 offset:16384
s_and_b32 s3, s3, 7
v_mfma_f32_16x16x32_bf16 v[40:43], v[164:167], a[140:143], v[40:43]
ds_read_b128 a[16:19], v234 offset:0
s_lshl_b32 s76, s3, 19
v_add_f32 v217, v217, v137
s_lshl_b32 s75, s3, 7
v_mfma_f32_16x16x32_bf16 v[56:59], v[160:163], a[200:203], v[56:59]
ds_read_b64_tr_b16 v[178:179], v236 offset:16896
s_add_u32 s75, s75, s60
v_add_f32 v216, v216, v138
s_add_u32 m0, s64, 0
v_mfma_f32_16x16x32_bf16 v[56:59], v[164:167], a[204:207], v[56:59]
s_waitcnt lgkmcnt(4)
ds_read_b64_tr_b16 v[180:181], v236 offset:20480
s_add_u32 s74, s61, s76
v_add_f32 v217, v217, v139
v_mfma_f32_16x16x32_bf16 v[12:15], v[168:171], a[8:11], v[12:15]
s_waitcnt lgkmcnt(4)
ds_read_b64_tr_b16 v[182:183], v236 offset:20992
v_mfma_f32_16x16x32_bf16 v[12:15], v[172:175], a[12:15], v[12:15]
ds_read_b128 a[20:23], v235 offset:0
v_add_u32 v220, 4294942720, v220
v_add_f32 v216, v216, v140
v_mfma_f32_16x16x32_bf16 v[28:31], v[168:171], a[72:75], v[28:31]
ds_read_b128 a[80:83], v234 offset:2048
v_add_f32 v217, v217, v141
v_mfma_f32_16x16x32_bf16 v[28:31], v[172:175], a[76:79], v[28:31]
buffer_load_dwordx4 v228, s[32:35], s74 offen offset:0 lds
v_mfma_f32_16x16x32_bf16 v[44:47], v[168:171], a[136:139], v[44:47]
ds_read_b128 a[84:87], v235 offset:2048
v_add_f32 v216, v216, v142
v_mfma_f32_16x16x32_bf16 v[44:47], v[172:175], a[140:143], v[44:47]
ds_read_b128 a[144:147], v234 offset:4096
v_add_f32 v217, v217, v143
v_mfma_f32_16x16x32_bf16 v[60:63], v[168:171], a[200:203], v[60:63]
buffer_load_dwordx4 v229, s[32:35], s74 offen offset:1024 lds
s_add_u32 m0, s63, 32768
s_add_u32 s74, s75, 0
v_add_f32 v216, v216, v217
v_mfma_f32_16x16x32_bf16 v[60:63], v[172:175], a[204:207], v[60:63]
s_waitcnt lgkmcnt(4)
ds_read_b128 a[148:151], v235 offset:4096
v_mfma_f32_16x16x32_bf16 v[0:3], v[176:179], a[16:19], v[0:3]
s_waitcnt lgkmcnt(4)
ds_read_b128 a[208:211], v234 offset:6144
v_mfma_f32_16x16x32_bf16 v[0:3], v[180:183], a[20:23], v[0:3]
s_waitcnt lgkmcnt(4)
ds_read_b128 a[212:215], v235 offset:6144
ds_read_b64_tr_b16 v[184:185], v237 offset:16384
v_mfma_f32_16x16x32_bf16 v[16:19], v[176:179], a[80:83], v[16:19]
s_waitcnt lgkmcnt(5)
ds_read_b64_tr_b16 v[186:187], v237 offset:16896
ds_read_b64_tr_b16 v[188:189], v237 offset:20480
v_mfma_f32_16x16x32_bf16 v[16:19], v[180:183], a[84:87], v[16:19]
s_waitcnt lgkmcnt(6)
ds_read_b64_tr_b16 v[190:191], v237 offset:20992
buffer_load_dwordx4 v224, s[28:31], s74 offen offset:0 lds
global_load_dwordx4 v[248:251], v220, s[8:9]
v_mfma_f32_16x16x32_bf16 v[32:35], v[176:179], a[144:147], v[32:35]
s_waitcnt lgkmcnt(6)
s_nop 1
v_add_f32_dpp v216, v216, v216 row_ror:8 row_mask:0xf bank_mask:0xf
v_mov_b32 v218, v216
v_mfma_f32_16x16x32_bf16 v[32:35], v[180:183], a[148:151], v[32:35]
s_waitcnt lgkmcnt(5)
buffer_load_dwordx4 v225, s[28:31], s74 offen offset:1024 lds
s_nop 1
v_permlane16_swap_b32 v216, v218
v_mfma_f32_16x16x32_bf16 v[48:51], v[176:179], a[208:211], v[48:51]
s_waitcnt lgkmcnt(4)
ds_read_b64_tr_b16 v[192:193], v238 offset:16384
v_add_u32 v220, 8192, v220
v_mfma_f32_16x16x32_bf16 v[48:51], v[180:183], a[212:215], v[48:51]
s_waitcnt lgkmcnt(3)
ds_read_b64_tr_b16 v[194:195], v238 offset:16896
v_mfma_f32_16x16x32_bf16 v[4:7], v[184:187], a[16:19], v[4:7]
s_waitcnt lgkmcnt(2)
ds_read_b64_tr_b16 v[196:197], v238 offset:20480
buffer_load_dwordx4 v226, s[28:31], s74 offen offset:2048 lds
v_mfma_f32_16x16x32_bf16 v[4:7], v[188:191], a[20:23], v[4:7]
buffer_load_dwordx4 v227, s[28:31], s74 offen offset:3072 lds
s_add_u32 m0, s63, 36864
s_add_u32 s74, s75, 32768
v_mfma_f32_16x16x32_bf16 v[20:23], v[184:187], a[80:83], v[20:23]
ds_read_b64_tr_b16 v[198:199], v238 offset:20992
s_nop 1
v_add_f32 v216, v216, v218
v_mov_b32 v218, v216
v_mfma_f32_16x16x32_bf16 v[20:23], v[188:191], a[84:87], v[20:23]
buffer_load_dwordx4 v224, s[28:31], s74 offen offset:0 lds
v_mfma_f32_16x16x32_bf16 v[36:39], v[184:187], a[144:147], v[36:39]
s_nop 1
v_permlane32_swap_b32 v216, v218
s_nop 1
v_add_f32 v216, v216, v218
v_mfma_f32_16x16x32_bf16 v[36:39], v[188:191], a[148:151], v[36:39]
buffer_load_dwordx4 v225, s[28:31], s74 offen offset:1024 lds
v_mfma_f32_16x16x32_bf16 v[52:55], v[184:187], a[208:211], v[52:55]
ds_write_b32 v96, v216 offset:0
s_waitcnt lgkmcnt(0)
v_mfma_f32_16x16x32_bf16 v[52:55], v[188:191], a[212:215], v[52:55]
s_waitcnt vmcnt(10)
s_barrier
ds_read_b64_tr_b16 v[200:201], v239 offset:16384
v_mfma_f32_16x16x32_bf16 v[8:11], v[192:195], a[16:19], v[8:11]
global_load_dwordx4 v[248:251], v220, s[8:9]
v_mfma_f32_16x16x32_bf16 v[8:11], v[196:199], a[20:23], v[8:11]
buffer_load_dwordx4 v226, s[28:31], s74 offen offset:2048 lds
v_mfma_f32_16x16x32_bf16 v[24:27], v[192:195], a[80:83], v[24:27]
ds_read_b64_tr_b16 v[202:203], v239 offset:16896
ds_read_b64_tr_b16 v[204:205], v239 offset:20480
v_add_u32 v220, 8192, v220
v_mfma_f32_16x16x32_bf16 v[24:27], v[196:199], a[84:87], v[24:27]
ds_read_b64_tr_b16 v[206:207], v239 offset:20992
ds_read_b64_tr_b16 v[160:161], v236 offset:24576
v_mfma_f32_16x16x32_bf16 v[40:43], v[192:195], a[144:147], v[40:43]
buffer_load_dwordx4 v227, s[28:31], s74 offen offset:3072 lds
s_add_u32 s3, s73, 5
s_and_b32 s3, s3, 7
v_mfma_f32_16x16x32_bf16 v[40:43], v[196:199], a[148:151], v[40:43]
ds_read_b128 a[24:27], v232 offset:0
s_lshl_b32 s76, s3, 19
s_lshl_b32 s75, s3, 7
v_mfma_f32_16x16x32_bf16 v[56:59], v[192:195], a[208:211], v[56:59]
ds_read_b128 v[100:103], v97 offset:0
s_waitcnt lgkmcnt(0)
v_add_f32 v100, v100, v101
s_add_u32 s75, s75, s60
s_add_u32 m0, s64, 8192
v_add_f32 v102, v102, v103
v_mfma_f32_16x16x32_bf16 v[56:59], v[196:199], a[212:215], v[56:59]
ds_read_b64_tr_b16 v[162:163], v236 offset:25088
s_add_u32 s74, s61, s76
v_mfma_f32_16x16x32_bf16 v[12:15], v[200:203], a[16:19], v[12:15]
ds_read_b64_tr_b16 v[164:165], v236 offset:28672
v_add_f32 v216, v100, v102
v_mfma_f32_16x16x32_bf16 v[12:15], v[204:207], a[20:23], v[12:15]
ds_read_b64_tr_b16 v[166:167], v236 offset:29184
v_mul_f32 v216, 0x3b000000, v216
v_mfma_f32_16x16x32_bf16 v[28:31], v[200:203], a[80:83], v[28:31]
ds_read_b128 a[28:31], v233 offset:0
v_sub_f32 v144, v128, v216
v_mfma_f32_16x16x32_bf16 v[28:31], v[204:207], a[84:87], v[28:31]
ds_read_b128 a[88:91], v232 offset:2048
v_sub_f32 v145, v129, v216
v_mfma_f32_16x16x32_bf16 v[44:47], v[200:203], a[144:147], v[44:47]
buffer_load_dwordx4 v228, s[32:35], s74 offen offset:0 lds
v_sub_f32 v146, v130, v216
v_mfma_f32_16x16x32_bf16 v[44:47], v[204:207], a[148:151], v[44:47]
ds_read_b128 a[92:95], v233 offset:2048
v_sub_f32 v147, v131, v216
v_mfma_f32_16x16x32_bf16 v[60:63], v[200:203], a[208:211], v[60:63]
ds_read_b128 a[152:155], v232 offset:4096
global_load_dwordx4 v[248:251], v220, s[8:9]
v_sub_f32 v148, v132, v216
v_mfma_f32_16x16x32_bf16 v[60:63], v[204:207], a[212:215], v[60:63]
s_waitcnt lgkmcnt(5)
ds_read_b128 a[156:159], v233 offset:4096
v_mfma_f32_16x16x32_bf16 v[0:3], v[160:163], a[24:27], v[0:3]
s_waitcnt lgkmcnt(4)
ds_read_b128 a[216:219], v232 offset:6144
buffer_load_dwordx4 v229, s[32:35], s74 offen offset:1024 lds
s_add_u32 m0, s63, 65536
s_add_u32 s74, s75, 0
v_sub_f32 v149, v133, v216
v_mfma_f32_16x16x32_bf16 v[0:3], v[164:167], a[28:31], v[0:3]
s_waitcnt lgkmcnt(4)
ds_read_b128 a[220:223], v233 offset:6144
ds_read_b64_tr_b16 v[168:169], v237 offset:24576
v_add_u32 v220, 8192, v220
v_sub_f32 v150, v134, v216
v_mfma_f32_16x16x32_bf16 v[16:19], v[160:163], a[88:91], v[16:19]
s_waitcnt lgkmcnt(5)
ds_read_b64_tr_b16 v[170:171], v237 offset:25088
ds_read_b64_tr_b16 v[172:173], v237 offset:28672
v_sub_f32 v151, v135, v216
v_mfma_f32_16x16x32_bf16 v[16:19], v[164:167], a[92:95], v[16:19]
s_waitcnt lgkmcnt(6)
ds_read_b64_tr_b16 v[174:175], v237 offset:29184
buffer_load_dwordx4 v224, s[28:31], s74 offen offset:0 lds
v_mfma_f32_16x16x32_bf16 v[32:35], v[160:163], a[152:155], v[32:35]
s_waitcnt lgkmcnt(6)
ds_read_b64_tr_b16 v[176:177], v238 offset:24576
v_sub_f32 v152, v136, v216
v_mfma_f32_16x16x32_bf16 v[32:35], v[164:167], a[156:159], v[32:35]
s_waitcnt lgkmcnt(6)
ds_read_b64_tr_b16 v[178:179], v238 offset:25088
buffer_load_dwordx4 v225, s[28:31], s74 offen offset:1024 lds
v_sub_f32 v153, v137, v216
v_mfma_f32_16x16x32_bf16 v[48:51], v[160:163], a[216:219], v[48:51]
s_waitcnt lgkmcnt(6)
ds_read_b64_tr_b16 v[180:181], v238 offset:28672
v_sub_f32 v154, v138, v216
v_mfma_f32_16x16x32_bf16 v[48:51], v[164:167], a[220:223], v[48:51]
s_waitcnt lgkmcnt(5)
ds_read_b64_tr_b16 v[182:183], v238 offset:29184
v_sub_f32 v155, v139, v216
v_mfma_f32_16x16x32_bf16 v[4:7], v[168:171], a[24:27], v[4:7]
s_waitcnt lgkmcnt(4)
buffer_load_dwordx4 v226, s[28:31], s74 offen offset:2048 lds
v_sub_f32 v156, v140, v216
v_sub_f32 v157, v141, v216
v_mfma_f32_16x16x32_bf16 v[4:7], v[172:175], a[28:31], v[4:7]
buffer_load_dwordx4 v227, s[28:31], s74 offen offset:3072 lds
s_add_u32 m0, s63, 69632
s_add_u32 s74, s75, 32768
v_mfma_f32_16x16x32_bf16 v[20:23], v[168:171], a[88:91], v[20:23]
global_load_dwordx4 v[248:251], v220, s[8:9]
v_mfma_f32_16x16x32_bf16 v[20:23], v[172:175], a[92:95], v[20:23]
buffer_load_dwordx4 v224, s[28:31], s74 offen offset:0 lds
v_sub_f32 v158, v142, v216
v_mfma_f32_16x16x32_bf16 v[36:39], v[168:171], a[152:155], v[36:39]
buffer_load_dwordx4 v225, s[28:31], s74 offen offset:1024 lds
v_sub_f32 v159, v143, v216
v_mfma_f32_16x16x32_bf16 v[36:39], v[172:175], a[156:159], v[36:39]
ds_read_b64_tr_b16 v[184:185], v239 offset:24576
v_mul_f32 v217, v144, v144
s_lshr_b32 s0, s2, 3
s_cmp_lg_u32 s0, 4
s_cbranch_scc1 L_ct10
s_lshl_b32 s0, s56, 13
v_lshl_add_u32 v246, v243, 7, s0
v_min_u32 v246, 8192-4, v246
s_getpc_b64 s[0:1]
L_cp10:
s_add_u32 s0, s0, L_c250-L_cp10
s_addc_u32 s1, s1, 0
global_load_dword v247, v246, s[0:1]
L_ct10:
v_mfma_f32_16x16x32_bf16 v[52:55], v[168:171], a[216:219], v[52:55]
buffer_load_dwordx4 v226, s[28:31], s74 offen offset:2048 lds
v_add_u32 v220, 4294942720, v220
v_mul_f32 v218, v145, v145
v_mfma_f32_16x16x32_bf16 v[52:55], v[172:175], a[220:223], v[52:55]
s_waitcnt lgkmcnt(1)
s_waitcnt vmcnt(11)
s_barrier
v_mfma_f32_16x16x32_bf16 v[8:11], v[176:179], a[24:27], v[8:11]
ds_read_b64_tr_b16 v[186:187], v239 offset:25088
v_fmac_f32 v217, v146, v146
v_mfma_f32_16x16x32_bf16 v[8:11], v[180:183], a[28:31], v[8:11]
ds_read_b64_tr_b16 v[188:189], v239 offset:28672
v_fmac_f32 v218, v147, v147
v_mfma_f32_16x16x32_bf16 v[24:27], v[176:179], a[88:91], v[24:27]
ds_read_b64_tr_b16 v[190:191], v239 offset:29184
v_fmac_f32 v217, v148, v148
v_mfma_f32_16x16x32_bf16 v[24:27], v[180:183], a[92:95], v[24:27]
buffer_load_dwordx4 v227, s[28:31], s74 offen offset:3072 lds
v_fmac_f32 v218, v149, v149
s_add_u32 s3, s73, 6
v_mfma_f32_16x16x32_bf16 v[40:43], v[176:179], a[152:155], v[40:43]
global_load_dwordx4 v[248:251], v221, s[16:17]
s_and_b32 s3, s3, 7
v_fmac_f32 v217, v150, v150
v_mfma_f32_16x16x32_bf16 v[40:43], v[180:183], a[156:159], v[40:43]
ds_read_b64_tr_b16 v[192:193], v236 offset:0
s_lshl_b32 s76, s3, 19
s_lshl_b32 s75, s3, 7
v_mfma_f32_16x16x32_bf16 v[56:59], v[176:179], a[216:219], v[56:59]
ds_read_b128 a[32:35], v232 offset:32768
v_fmac_f32 v218, v151, v151
s_add_u32 s75, s75, s60
s_add_u32 m0, s64, 16384
v_mfma_f32_16x16x32_bf16 v[56:59], v[180:183], a[220:223], v[56:59]
s_waitcnt lgkmcnt(4)
ds_read_b64_tr_b16 v[194:195], v236 offset:512
v_fmac_f32 v217, v152, v152
s_add_u32 s74, s61, s76
v_mfma_f32_16x16x32_bf16 v[12:15], v[184:187], a[24:27], v[12:15]
s_waitcnt lgkmcnt(3)
ds_read_b64_tr_b16 v[196:197], v236 offset:4096
v_fmac_f32 v218, v153, v153
v_mfma_f32_16x16x32_bf16 v[12:15], v[188:191], a[28:31], v[12:15]
ds_read_b64_tr_b16 v[198:199], v236 offset:4608
v_fmac_f32 v217, v154, v154
v_mfma_f32_16x16x32_bf16 v[28:31], v[184:187], a[88:91], v[28:31]
ds_read_b128 a[36:39], v233 offset:32768
v_fmac_f32 v218, v155, v155
v_mfma_f32_16x16x32_bf16 v[28:31], v[188:191], a[92:95], v[28:31]
ds_read_b128 a[96:99], v232 offset:34816
v_fmac_f32 v217, v156, v156
v_mfma_f32_16x16x32_bf16 v[44:47], v[184:187], a[152:155], v[44:47]
buffer_load_dwordx4 v228, s[32:35], s74 offen offset:0 lds
v_add_u32 v221, 7168, v221
v_mfma_f32_16x16x32_bf16 v[44:47], v[188:191], a[156:159], v[44:47]
ds_read_b128 a[100:103], v233 offset:34816
v_fmac_f32 v218, v157, v157
v_mfma_f32_16x16x32_bf16 v[60:63], v[184:187], a[216:219], v[60:63]
ds_read_b128 a[160:163], v232 offset:36864
v_fmac_f32 v217, v158, v158
v_mfma_f32_16x16x32_bf16 v[60:63], v[188:191], a[220:223], v[60:63]
s_waitcnt lgkmcnt(5)
ds_read_b128 a[164:167], v233 offset:36864
v_fmac_f32 v218, v159, v159
v_mfma_f32_16x16x32_bf16 v[0:3], v[192:195], a[32:35], v[0:3]
s_waitcnt lgkmcnt(4)
ds_read_b128 a[224:227], v232 offset:38912
buffer_load_dwordx4 v229, s[32:35], s74 offen offset:1024 lds
s_add_u32 m0, s63, 0
s_add_u32 s74, s75, 0
v_add_f32 v217, v217, v218
v_mfma_f32_16x16x32_bf16 v[0:3], v[196:199], a[36:39], v[0:3]
s_waitcnt lgkmcnt(4)
ds_read_b128 a[228:231], v233 offset:38912
ds_read_b64_tr_b16 v[200:201], v237 offset:0
v_mfma_f32_16x16x32_bf16 v[16:19], v[192:195], a[96:99], v[16:19]
s_waitcnt lgkmcnt(5)
ds_read_b64_tr_b16 v[202:203], v237 offset:512
ds_read_b64_tr_b16 v[204:205], v237 offset:4096
v_mfma_f32_16x16x32_bf16 v[16:19], v[196:199], a[100:103], v[16:19]
s_waitcnt lgkmcnt(6)
ds_read_b64_tr_b16 v[206:207], v237 offset:4608
buffer_load_dwordx4 v224, s[28:31], s74 offen offset:0 lds
v_mfma_f32_16x16x32_bf16 v[32:35], v[192:195], a[160:163], v[32:35]
s_waitcnt lgkmcnt(6)
s_nop 1
v_add_f32_dpp v217, v217, v217 row_ror:8 row_mask:0xf bank_mask:0xf
v_mov_b32 v218, v217
v_mfma_f32_16x16x32_bf16 v[32:35], v[196:199], a[164:167], v[32:35]
s_waitcnt lgkmcnt(5)
ds_read_b64_tr_b16 v[160:161], v238 offset:0
buffer_load_dwordx4 v225, s[28:31], s74 offen offset:1024 lds
v_mfma_f32_16x16x32_bf16 v[48:51], v[192:195], a[224:227], v[48:51]
s_waitcnt lgkmcnt(5)
ds_read_b64_tr_b16 v[162:163], v238 offset:512
global_load_dwordx4 v[248:251], v221, s[16:17]
v_mfma_f32_16x16x32_bf16 v[48:51], v[196:199], a[228:231], v[48:51]
s_waitcnt lgkmcnt(4)
ds_read_b64_tr_b16 v[164:165], v238 offset:4096
v_mfma_f32_16x16x32_bf16 v[4:7], v[200:203], a[32:35], v[4:7]
s_waitcnt lgkmcnt(3)
buffer_load_dwordx4 v226, s[28:31], s74 offen offset:2048 lds
s_nop 1
v_permlane16_swap_b32 v217, v218
v_mfma_f32_16x16x32_bf16 v[4:7], v[204:207], a[36:39], v[4:7]
buffer_load_dwordx4 v227, s[28:31], s74 offen offset:3072 lds
s_add_u32 m0, s63, 4096
s_add_u32 s74, s75, 32768
v_add_u32 v221, 4294960128, v221
v_mfma_f32_16x16x32_bf16 v[20:23], v[200:203], a[96:99], v[20:23]
ds_read_b64_tr_b16 v[166:167], v238 offset:4608
s_nop 1
v_add_f32 v217, v217, v218
v_mov_b32 v218, v217
v_mfma_f32_16x16x32_bf16 v[20:23], v[204:207], a[100:103], v[20:23]
buffer_load_dwordx4 v224, s[28:31], s74 offen offset:0 lds
v_mfma_f32_16x16x32_bf16 v[36:39], v[200:203], a[160:163], v[36:39]
s_nop 1
v_permlane32_swap_b32 v217, v218
s_nop 1
v_add_f32 v217, v217, v218
v_mfma_f32_16x16x32_bf16 v[36:39], v[204:207], a[164:167], v[36:39]
buffer_load_dwordx4 v225, s[28:31], s74 offen offset:1024 lds
v_mfma_f32_16x16x32_bf16 v[52:55], v[200:203], a[224:227], v[52:55]
ds_write_b32 v96, v217 offset:128
s_waitcnt lgkmcnt(0)
v_mfma_f32_16x16x32_bf16 v[52:55], v[204:207], a[228:231], v[52:55]
s_waitcnt vmcnt(10)
s_barrier
ds_read_b64_tr_b16 v[168:169], v239 offset:0
v_mfma_f32_16x16x32_bf16 v[8:11], v[160:163], a[32:35], v[8:11]
buffer_load_dwordx4 v226, s[28:31], s74 offen offset:2048 lds
v_mfma_f32_16x16x32_bf16 v[8:11], v[164:167], a[36:39], v[8:11]
ds_read_b64_tr_b16 v[170:171], v239 offset:512
ds_read_b64_tr_b16 v[172:173], v239 offset:4096
v_mfma_f32_16x16x32_bf16 v[24:27], v[160:163], a[96:99], v[24:27]
ds_read_b64_tr_b16 v[174:175], v239 offset:4608
v_mfma_f32_16x16x32_bf16 v[24:27], v[164:167], a[100:103], v[24:27]
global_load_dwordx4 v[248:251], v221, s[18:19]
v_mfma_f32_16x16x32_bf16 v[40:43], v[160:163], a[160:163], v[40:43]
buffer_load_dwordx4 v227, s[28:31], s74 offen offset:3072 lds
s_add_u32 s3, s73, 7
s_and_b32 s3, s3, 7
v_mfma_f32_16x16x32_bf16 v[40:43], v[164:167], a[164:167], v[40:43]
ds_read_b64_tr_b16 v[176:177], v236 offset:8192
s_lshl_b32 s76, s3, 19
s_lshl_b32 s75, s3, 7
v_mfma_f32_16x16x32_bf16 v[56:59], v[160:163], a[224:227], v[56:59]
ds_read_b128 a[40:43], v234 offset:0
s_add_u32 s75, s75, s60
s_add_u32 m0, s64, 24576
v_mfma_f32_16x16x32_bf16 v[56:59], v[164:167], a[228:231], v[56:59]
s_waitcnt lgkmcnt(4)
ds_read_b128 v[100:103], v97 offset:128
v_add_u32 v221, 7168, v221
s_add_u32 s74, s61, s76
v_mfma_f32_16x16x32_bf16 v[12:15], v[168:171], a[32:35], v[12:15]
s_waitcnt lgkmcnt(3)
s_waitcnt lgkmcnt(0)
v_add_f32 v100, v100, v101
v_mfma_f32_16x16x32_bf16 v[12:15], v[172:175], a[36:39], v[12:15]
ds_read_b64_tr_b16 v[178:179], v236 offset:8704
ds_read_b64_tr_b16 v[180:181], v236 offset:12288
v_mfma_f32_16x16x32_bf16 v[28:31], v[168:171], a[96:99], v[28:31]
ds_read_b64_tr_b16 v[182:183], v236 offset:12800
ds_read_b128 a[44:47], v235 offset:0
v_mfma_f32_16x16x32_bf16 v[28:31], v[172:175], a[100:103], v[28:31]
ds_read_b128 a[104:107], v234 offset:2048
ds_read_b128 a[108:111], v235 offset:2048
v_mfma_f32_16x16x32_bf16 v[44:47], v[168:171], a[160:163], v[44:47]
buffer_load_dwordx4 v228, s[32:35], s74 offen offset:0 lds
v_mfma_f32_16x16x32_bf16 v[44:47], v[172:175], a[164:167], v[44:47]
ds_read_b128 a[168:171], v234 offset:4096
ds_read_b128 a[172:175], v235 offset:4096
v_mfma_f32_16x16x32_bf16 v[60:63], v[168:171], a[224:227], v[60:63]
buffer_load_dwordx4 v229, s[32:35], s74 offen offset:1024 lds
s_add_u32 m0, s63, 32768
s_add_u32 s74, s75, 0
v_mfma_f32_16x16x32_bf16 v[60:63], v[172:175], a[228:231], v[60:63]
s_waitcnt lgkmcnt(7)
ds_read_b64_tr_b16 v[184:185], v237 offset:8192
v_mfma_f32_16x16x32_bf16 v[0:3], v[176:179], a[40:43], v[0:3]
s_waitcnt lgkmcnt(5)
ds_read_b128 a[232:235], v234 offset:6144
v_mfma_f32_16x16x32_bf16 v[0:3], v[180:183], a[44:47], v[0:3]
s_waitcnt lgkmcnt(5)
ds_read_b128 a[236:239], v235 offset:6144
global_load_dwordx4 v[248:251], v221, s[18:19]
v_mfma_f32_16x16x32_bf16 v[16:19], v[176:179], a[104:107], v[16:19]
s_waitcnt lgkmcnt(5)
ds_read_b64_tr_b16 v[186:187], v237 offset:8704
ds_read_b64_tr_b16 v[188:189], v237 offset:12288
v_mfma_f32_16x16x32_bf16 v[16:19], v[180:183], a[108:111], v[16:19]
s_waitcnt lgkmcnt(6)
ds_read_b64_tr_b16 v[190:191], v237 offset:12800
buffer_load_dwordx4 v224, s[28:31], s74 offen offset:0 lds
v_add_f32 v102, v102, v103
v_mfma_f32_16x16x32_bf16 v[32:35], v[176:179], a[168:171], v[32:35]
s_waitcnt lgkmcnt(6)
ds_read_b64_tr_b16 v[192:193], v238 offset:8192
v_add_u32 v221, 4294960128, v221
v_mfma_f32_16x16x32_bf16 v[32:35], v[180:183], a[172:175], v[32:35]
s_waitcnt lgkmcnt(5)
ds_read_b64_tr_b16 v[194:195], v238 offset:8704
buffer_load_dwordx4 v225, s[28:31], s74 offen offset:1024 lds
v_mfma_f32_16x16x32_bf16 v[48:51], v[176:179], a[232:235], v[48:51]
s_waitcnt lgkmcnt(5)
ds_read_b64_tr_b16 v[196:197], v238 offset:12288
v_mfma_f32_16x16x32_bf16 v[48:51], v[180:183], a[236:239], v[48:51]
s_waitcnt lgkmcnt(5)
ds_read_b64_tr_b16 v[198:199], v238 offset:12800
v_mfma_f32_16x16x32_bf16 v[4:7], v[184:187], a[40:43], v[4:7]
s_waitcnt lgkmcnt(4)
buffer_load_dwordx4 v226, s[28:31], s74 offen offset:2048 lds
v_add_f32 v217, v100, v102
v_mfma_f32_16x16x32_bf16 v[4:7], v[188:191], a[44:47], v[4:7]
buffer_load_dwordx4 v227, s[28:31], s74 offen offset:3072 lds
s_add_u32 m0, s63, 36864
s_add_u32 s74, s75, 32768
v_mfma_f32_16x16x32_bf16 v[20:23], v[184:187], a[104:107], v[20:23]
buffer_load_dwordx4 v224, s[28:31], s74 offen offset:0 lds
v_mfma_f32_16x16x32_bf16 v[20:23], v[188:191], a[108:111], v[20:23]
buffer_load_dwordx4 v225, s[28:31], s74 offen offset:1024 lds
v_mfma_f32_16x16x32_bf16 v[36:39], v[184:187], a[168:171], v[36:39]
ds_read_b64_tr_b16 v[200:201], v239 offset:8192
ds_read_b64_tr_b16 v[202:203], v239 offset:8704
v_mfma_f32_16x16x32_bf16 v[36:39], v[188:191], a[172:175], v[36:39]
buffer_load_dwordx4 v226, s[28:31], s74 offen offset:2048 lds
v_mfma_f32_16x16x32_bf16 v[52:55], v[184:187], a[232:235], v[52:55]
ds_read_b64_tr_b16 v[204:205], v239 offset:12288
v_mul_f32 v217, 0x3b000000, v217
v_mfma_f32_16x16x32_bf16 v[52:55], v[188:191], a[236:239], v[52:55]
s_waitcnt lgkmcnt(3)
s_waitcnt vmcnt(10)
s_barrier
v_mfma_f32_16x16x32_bf16 v[8:11], v[192:195], a[40:43], v[8:11]
ds_read_b64_tr_b16 v[206:207], v239 offset:12800
v_mfma_f32_16x16x32_bf16 v[8:11], v[196:199], a[44:47], v[8:11]
buffer_load_dwordx4 v227, s[28:31], s74 offen offset:3072 lds
v_mfma_f32_16x16x32_bf16 v[24:27], v[192:195], a[104:107], v[24:27]
ds_read_b64_tr_b16 v[160:161], v236 offset:16384
s_add_u32 s3, s65, 0
v_mfma_f32_16x16x32_bf16 v[24:27], v[196:199], a[108:111], v[24:27]
ds_read_b128 a[48:51], v232 offset:0
s_and_b32 s3, s3, 15
v_mfma_f32_16x16x32_bf16 v[40:43], v[192:195], a[168:171], v[40:43]
ds_read_b64_tr_b16 v[162:163], v236 offset:16896
v_cvt_pk_bf16_f32 v218, v216, v217
s_lshl_b32 s3, s3, 18
s_add_u32 s3, s3, s62
v_mfma_f32_16x16x32_bf16 v[40:43], v[196:199], a[172:175], v[40:43]
ds_read_b64_tr_b16 v[164:165], v236 offset:20480
s_add_u32 m0, s66, 32768
s_add_u32 s74, s3, 128
v_lshlrev_b32 v216, 16, v218
v_mfma_f32_16x16x32_bf16 v[56:59], v[192:195], a[232:235], v[56:59]
ds_read_b64_tr_b16 v[166:167], v236 offset:20992
v_and_b32 v217, 0xffff0000, v218
v_mfma_f32_16x16x32_bf16 v[56:59], v[196:199], a[236:239], v[56:59]
s_waitcnt lgkmcnt(5)
ds_read_b128 a[52:55], v233 offset:0
v_mfma_f32_16x16x32_bf16 v[12:15], v[200:203], a[40:43], v[12:15]
buffer_load_dwordx4 v228, s[32:35], s74 offen offset:0 lds
v_add_f32 v217, 0x3727c5ac, v217
v_mfma_f32_16x16x32_bf16 v[12:15], v[204:207], a[44:47], v[12:15]
ds_read_b128 a[112:115], v232 offset:2048
v_cvt_pk_bf16_f32 v217, v217, v217
v_mfma_f32_16x16x32_bf16 v[28:31], v[200:203], a[104:107], v[28:31]
buffer_load_dwordx4 v229, s[32:35], s74 offen offset:1024 lds
v_mfma_f32_16x16x32_bf16 v[28:31], v[204:207], a[108:111], v[28:31]
ds_read_b128 a[116:119], v233 offset:2048
v_lshlrev_b32 v217, 16, v217
v_mfma_f32_16x16x32_bf16 v[44:47], v[200:203], a[168:171], v[44:47]
buffer_load_dwordx4 v230, s[32:35], s74 offen offset:2048 lds
v_mfma_f32_16x16x32_bf16 v[44:47], v[204:207], a[172:175], v[44:47]
buffer_load_dwordx4 v231, s[32:35], s74 offen offset:3072 lds
s_add_u32 s3, s65, 4
s_and_b32 s3, s3, 15
s_lshl_b32 s3, s3, 18
s_add_u32 s3, s3, s62
s_add_u32 m0, s66, 49152
s_add_u32 s74, s3, 128
v_mfma_f32_16x16x32_bf16 v[60:63], v[200:203], a[232:235], v[60:63]
ds_read_b128 a[176:179], v232 offset:4096
ds_read_b128 a[180:183], v233 offset:4096
v_mfma_f32_16x16x32_bf16 v[60:63], v[204:207], a[236:239], v[60:63]
s_waitcnt lgkmcnt(4)
ds_read_b64_tr_b16 v[168:169], v237 offset:16384
v_mfma_f32_16x16x32_bf16 v[0:3], v[160:163], a[48:51], v[0:3]
ds_read_b128 a[240:243], v232 offset:6144
ds_read_b64_tr_b16 v[170:171], v237 offset:16896
v_mfma_f32_16x16x32_bf16 v[0:3], v[164:167], a[52:55], v[0:3]
s_waitcnt lgkmcnt(6)
ds_read_b128 a[244:247], v233 offset:6144
v_mfma_f32_16x16x32_bf16 v[16:19], v[160:163], a[112:115], v[16:19]
s_waitcnt lgkmcnt(6)
ds_read_b64_tr_b16 v[172:173], v237 offset:20480
v_sqrt_f32 v217, v217
v_mfma_f32_16x16x32_bf16 v[16:19], v[164:167], a[116:119], v[16:19]
s_waitcnt lgkmcnt(6)
ds_read_b64_tr_b16 v[174:175], v237 offset:20992
buffer_load_dwordx4 v228, s[32:35], s74 offen offset:0 lds
v_mfma_f32_16x16x32_bf16 v[32:35], v[160:163], a[176:179], v[32:35]
s_waitcnt lgkmcnt(6)
buffer_load_dwordx4 v229, s[32:35], s74 offen offset:1024 lds
s_nop 0
v_cvt_pk_bf16_f32 v217, v217, v217
v_lshlrev_b32 v217, 16, v217
v_mfma_f32_16x16x32_bf16 v[32:35], v[164:167], a[180:183], v[32:35]
s_waitcnt lgkmcnt(4)
buffer_load_dwordx4 v230, s[32:35], s74 offen offset:2048 lds
v_rcp_f32 v217, v217
v_mfma_f32_16x16x32_bf16 v[48:51], v[160:163], a[240:243], v[48:51]
s_waitcnt lgkmcnt(2)
ds_read_b64_tr_b16 v[176:177], v238 offset:16384
v_mfma_f32_16x16x32_bf16 v[48:51], v[164:167], a[244:247], v[48:51]
buffer_load_dwordx4 v231, s[32:35], s74 offen offset:3072 lds
s_add_u32 s3, s65, 8
s_and_b32 s3, s3, 15
s_lshl_b32 s3, s3, 18
s_add_u32 s3, s3, s62
s_add_u32 m0, s66, 131072
s_add_u32 s74, s3, 128
v_mfma_f32_16x16x32_bf16 v[4:7], v[168:171], a[48:51], v[4:7]
s_waitcnt lgkmcnt(1)
ds_read_b64_tr_b16 v[178:179], v238 offset:16896
v_mfma_f32_16x16x32_bf16 v[4:7], v[172:175], a[52:55], v[4:7]
buffer_load_dwordx4 v228, s[32:35], s74 offen offset:0 lds
v_mfma_f32_16x16x32_bf16 v[20:23], v[168:171], a[112:115], v[20:23]
ds_read_b64_tr_b16 v[180:181], v238 offset:20480
ds_read_b64_tr_b16 v[182:183], v238 offset:20992
v_mfma_f32_16x16x32_bf16 v[20:23], v[172:175], a[116:119], v[20:23]
buffer_load_dwordx4 v229, s[32:35], s74 offen offset:1024 lds
s_cmp_lg_u32 s56, 0
s_cbranch_scc1 L_nozp
buffer_load_dword v219, v222, s[52:55], 0 offen sc1
L_nozp:
v_sub_f32 v128, v128, v216
v_sub_f32 v129, v129, v216
v_mfma_f32_16x16x32_bf16 v[36:39], v[168:171], a[176:179], v[36:39]
buffer_load_dwordx4 v230, s[32:35], s74 offen offset:2048 lds
v_sub_f32 v130, v130, v216
v_mfma_f32_16x16x32_bf16 v[36:39], v[172:175], a[180:183], v[36:39]
buffer_load_dwordx4 v231, s[32:35], s74 offen offset:3072 lds
s_add_u32 s3, s65, 12
s_and_b32 s3, s3, 15
s_lshl_b32 s3, s3, 18
s_add_u32 s3, s3, s62
s_add_u32 m0, s66, 147456
s_add_u32 s74, s3, 128
v_mfma_f32_16x16x32_bf16 v[52:55], v[168:171], a[240:243], v[52:55]
buffer_load_dwordx4 v228, s[32:35], s74 offen offset:0 lds
v_sub_f32 v131, v131, v216
v_mfma_f32_16x16x32_bf16 v[52:55], v[172:175], a[244:247], v[52:55]
s_waitcnt lgkmcnt(2)
s_waitcnt vmcnt(13)
s_barrier
v_sub_f32 v132, v132, v216
v_mfma_f32_16x16x32_bf16 v[8:11], v[176:179], a[48:51], v[8:11]
s_waitcnt lgkmcnt(0)
ds_read_b64_tr_b16 v[184:185], v239 offset:16384
v_mfma_f32_16x16x32_bf16 v[8:11], v[180:183], a[52:55], v[8:11]
ds_read_b64_tr_b16 v[186:187], v239 offset:16896
v_sub_f32 v133, v133, v216
v_mfma_f32_16x16x32_bf16 v[24:27], v[176:179], a[112:115], v[24:27]
ds_read_b64_tr_b16 v[188:189], v239 offset:20480
v_sub_f32 v134, v134, v216
v_mfma_f32_16x16x32_bf16 v[24:27], v[180:183], a[116:119], v[24:27]
ds_read_b64_tr_b16 v[190:191], v239 offset:20992
buffer_load_dwordx4 v229, s[32:35], s74 offen offset:1024 lds
v_sub_f32 v135, v135, v216
v_mfma_f32_16x16x32_bf16 v[40:43], v[176:179], a[176:179], v[40:43]
buffer_load_dwordx4 v230, s[32:35], s74 offen offset:2048 lds
v_mfma_f32_16x16x32_bf16 v[40:43], v[180:183], a[180:183], v[40:43]
buffer_load_dwordx4 v231, s[32:35], s74 offen offset:3072 lds
s_add_u32 s3, s65, 0
s_and_b32 s3, s3, 15
v_sub_f32 v136, v136, v216
s_lshl_b32 s3, s3, 18
s_add_u32 s3, s3, s62
v_mfma_f32_16x16x32_bf16 v[56:59], v[176:179], a[240:243], v[56:59]
ds_read_b64_tr_b16 v[192:193], v236 offset:24576
v_sub_f32 v137, v137, v216
s_add_u32 m0, s66, 65536
v_mfma_f32_16x16x32_bf16 v[56:59], v[180:183], a[244:247], v[56:59]
s_waitcnt lgkmcnt(3)
ds_read_b128 a[56:59], v232 offset:32768
s_add_u32 s74, s3, 0
v_mfma_f32_16x16x32_bf16 v[12:15], v[184:187], a[48:51], v[12:15]
s_waitcnt lgkmcnt(2)
ds_read_b64_tr_b16 v[194:195], v236 offset:25088
v_sub_f32 v138, v138, v216
v_mfma_f32_16x16x32_bf16 v[12:15], v[188:191], a[52:55], v[12:15]
ds_read_b64_tr_b16 v[196:197], v236 offset:28672
v_sub_f32 v139, v139, v216
v_mfma_f32_16x16x32_bf16 v[28:31], v[184:187], a[112:115], v[28:31]
ds_read_b64_tr_b16 v[198:199], v236 offset:29184
v_sub_f32 v140, v140, v216
v_mfma_f32_16x16x32_bf16 v[28:31], v[188:191], a[116:119], v[28:31]
ds_read_b128 a[60:63], v233 offset:32768
v_sub_f32 v141, v141, v216
v_mfma_f32_16x16x32_bf16 v[44:47], v[184:187], a[176:179], v[44:47]
ds_read_b128 a[120:123], v232 offset:34816
v_sub_f32 v142, v142, v216
v_mfma_f32_16x16x32_bf16 v[44:47], v[188:191], a[180:183], v[44:47]
ds_read_b128 a[124:127], v233 offset:34816
buffer_load_dwordx4 v228, s[36:39], s74 offen offset:0 lds
v_sub_f32 v143, v143, v216
v_mfma_f32_16x16x32_bf16 v[60:63], v[184:187], a[240:243], v[60:63]
ds_read_b128 a[184:187], v232 offset:36864
v_cvt_pk_bf16_f32 v208, v128, v129
v_mfma_f32_16x16x32_bf16 v[60:63], v[188:191], a[244:247], v[60:63]
s_waitcnt lgkmcnt(6)
ds_read_b128 a[188:191], v233 offset:36864
v_mfma_f32_16x16x32_bf16 v[0:3], v[192:195], a[56:59], v[0:3]
s_waitcnt lgkmcnt(4)
ds_read_b128 a[248:251], v232 offset:38912
buffer_load_dwordx4 v229, s[36:39], s74 offen offset:1024 lds
v_mfma_f32_16x16x32_bf16 v[0:3], v[196:199], a[60:63], v[0:3]
s_waitcnt lgkmcnt(4)
ds_read_b128 a[252:255], v233 offset:38912
ds_read_b64_tr_b16 v[200:201], v237 offset:24576
v_cvt_pk_bf16_f32 v209, v130, v131
v_mfma_f32_16x16x32_bf16 v[16:19], v[192:195], a[120:123], v[16:19]
s_waitcnt lgkmcnt(5)
ds_read_b64_tr_b16 v[202:203], v237 offset:25088
ds_read_b64_tr_b16 v[204:205], v237 offset:28672
v_mfma_f32_16x16x32_bf16 v[16:19], v[196:199], a[124:127], v[16:19]
s_waitcnt lgkmcnt(6)
ds_read_b64_tr_b16 v[206:207], v237 offset:29184
buffer_load_dwordx4 v230, s[36:39], s74 offen offset:2048 lds
v_cvt_pk_bf16_f32 v210, v132, v133
v_mfma_f32_16x16x32_bf16 v[32:35], v[192:195], a[184:187], v[32:35]
s_waitcnt lgkmcnt(6)
ds_read_b64_tr_b16 v[160:161], v238 offset:24576
v_cvt_pk_bf16_f32 v211, v134, v135
v_mfma_f32_16x16x32_bf16 v[32:35], v[196:199], a[188:191], v[32:35]
s_waitcnt lgkmcnt(6)
ds_read_b64_tr_b16 v[162:163], v238 offset:25088
buffer_load_dwordx4 v231, s[36:39], s74 offen offset:3072 lds
s_add_u32 s3, s65, 4
s_and_b32 s3, s3, 15
s_lshl_b32 s3, s3, 18
s_add_u32 s3, s3, s62
s_add_u32 m0, s66, 81920
s_add_u32 s74, s3, 0
v_cvt_pk_bf16_f32 v212, v136, v137
v_mfma_f32_16x16x32_bf16 v[48:51], v[192:195], a[248:251], v[48:51]
s_waitcnt lgkmcnt(6)
ds_read_b64_tr_b16 v[164:165], v238 offset:28672
v_mfma_f32_16x16x32_bf16 v[48:51], v[196:199], a[252:255], v[48:51]
s_waitcnt lgkmcnt(5)
ds_read_b64_tr_b16 v[166:167], v238 offset:29184
v_cvt_pk_bf16_f32 v213, v138, v139
v_mfma_f32_16x16x32_bf16 v[4:7], v[200:203], a[56:59], v[4:7]
s_waitcnt lgkmcnt(4)
v_cvt_pk_bf16_f32 v214, v140, v141
v_cvt_pk_bf16_f32 v215, v142, v143
v_mfma_f32_16x16x32_bf16 v[4:7], v[204:207], a[60:63], v[4:7]
buffer_load_dwordx4 v228, s[36:39], s74 offen offset:0 lds
v_mfma_f32_16x16x32_bf16 v[20:23], v[200:203], a[120:123], v[20:23]
buffer_load_dwordx4 v229, s[36:39], s74 offen offset:1024 lds
v_mfma_f32_16x16x32_bf16 v[20:23], v[204:207], a[124:127], v[20:23]
ds_read_b64_tr_b16 v[168:169], v239 offset:24576
v_lshlrev_b32 v128, 16, v208
v_mfma_f32_16x16x32_bf16 v[36:39], v[200:203], a[184:187], v[36:39]
buffer_load_dwordx4 v230, s[36:39], s74 offen offset:2048 lds
v_and_b32 v129, 0xffff0000, v208
v_mfma_f32_16x16x32_bf16 v[36:39], v[204:207], a[188:191], v[36:39]
ds_read_b64_tr_b16 v[170:171], v239 offset:25088
v_lshlrev_b32 v130, 16, v209
v_mfma_f32_16x16x32_bf16 v[52:55], v[200:203], a[248:251], v[52:55]
ds_read_b64_tr_b16 v[172:173], v239 offset:28672
v_and_b32 v131, 0xffff0000, v209
v_mfma_f32_16x16x32_bf16 v[52:55], v[204:207], a[252:255], v[52:55]
s_waitcnt lgkmcnt(3)
s_waitcnt vmcnt(15)
s_barrier
v_mfma_f32_16x16x32_bf16 v[8:11], v[160:163], a[56:59], v[8:11]
ds_read_b64_tr_b16 v[174:175], v239 offset:29184
v_lshlrev_b32 v132, 16, v210
v_mfma_f32_16x16x32_bf16 v[8:11], v[164:167], a[60:63], v[8:11]
buffer_load_dwordx4 v231, s[36:39], s74 offen offset:3072 lds
v_mfma_f32_16x16x32_bf16 v[24:27], v[160:163], a[120:123], v[24:27]
s_add_u32 s3, s65, 8
v_and_b32 v133, 0xffff0000, v210
v_lshlrev_b32 v134, 16, v211
v_mfma_f32_16x16x32_bf16 v[24:27], v[164:167], a[124:127], v[24:27]
ds_read_b64_tr_b16 v[176:177], v236 offset:32768
v_and_b32 v135, 0xffff0000, v211
v_mfma_f32_16x16x32_bf16 v[40:43], v[160:163], a[184:187], v[40:43]
ds_read_b64_tr_b16 v[178:179], v236 offset:33280
s_and_b32 s3, s3, 15
v_mfma_f32_16x16x32_bf16 v[40:43], v[164:167], a[188:191], v[40:43]
ds_read_b64_tr_b16 v[180:181], v236 offset:36864
s_lshl_b32 s3, s3, 18
v_mfma_f32_16x16x32_bf16 v[56:59], v[160:163], a[248:251], v[56:59]
ds_read_b64_tr_b16 v[182:183], v236 offset:37376
v_lshlrev_b32 v136, 16, v212
v_mfma_f32_16x16x32_bf16 v[56:59], v[164:167], a[252:255], v[56:59]
s_waitcnt lgkmcnt(4)
ds_read_b64_tr_b16 v[184:185], v236 offset:40960
v_mfma_f32_16x16x32_bf16 v[12:15], v[168:171], a[56:59], v[12:15]
ds_read_b64_tr_b16 v[186:187], v236 offset:41472
s_add_u32 s3, s3, s62
v_and_b32 v137, 0xffff0000, v212
v_mfma_f32_16x16x32_bf16 v[12:15], v[172:175], a[60:63], v[12:15]
ds_read_b64_tr_b16 v[188:189], v236 offset:45056
s_add_u32 m0, s66, 98304
v_lshlrev_b32 v138, 16, v213
L_c250:
v_mfma_f32_16x16x32_bf16 v[28:31], v[168:171], a[120:123], v[28:31]
ds_read_b64_tr_b16 v[190:191], v236 offset:45568
s_add_u32 s74, s3, 0
v_and_b32 v139, 0xffff0000, v213
v_mfma_f32_16x16x32_bf16 v[28:31], v[172:175], a[124:127], v[28:31]
ds_read_b64_tr_b16 v[192:193], v237 offset:32768
v_lshlrev_b32 v140, 16, v214
v_mfma_f32_16x16x32_bf16 v[44:47], v[168:171], a[184:187], v[44:47]
buffer_load_dwordx4 v228, s[36:39], s74 offen offset:0 lds
v_mfma_f32_16x16x32_bf16 v[44:47], v[172:175], a[188:191], v[44:47]
ds_read_b64_tr_b16 v[194:195], v237 offset:33280
v_and_b32 v141, 0xffff0000, v214
v_mfma_f32_16x16x32_bf16 v[60:63], v[168:171], a[248:251], v[60:63]
ds_read_b64_tr_b16 v[196:197], v237 offset:36864
v_lshlrev_b32 v142, 16, v215
v_mfma_f32_16x16x32_bf16 v[60:63], v[172:175], a[252:255], v[60:63]
s_waitcnt lgkmcnt(5)
ds_read_b64_tr_b16 v[198:199], v237 offset:37376
v_mfma_f32_16x16x32_bf16 v[64:67], v[176:179], a[0:3], 0
ds_read_b64_tr_b16 v[200:201], v237 offset:40960
v_and_b32 v143, 0xffff0000, v215
v_mfma_f32_16x16x32_bf16 v[64:67], v[180:183], a[4:7], v[64:67]
ds_read_b64_tr_b16 v[202:203], v237 offset:41472
v_mul_f32 v128, v128, v217
v_mfma_f32_16x16x32_bf16 v[64:67], v[184:187], a[8:11], v[64:67]
s_waitcnt lgkmcnt(5)
ds_read_b64_tr_b16 v[204:205], v237 offset:45056
v_mfma_f32_16x16x32_bf16 v[64:67], v[188:191], a[12:15], v[64:67]
ds_read_b64_tr_b16 v[206:207], v237 offset:45568
v_mul_f32 v129, v129, v217
v_mfma_f32_16x16x32_bf16 v[72:75], v[176:179], a[64:67], 0
buffer_load_dwordx4 v229, s[36:39], s74 offen offset:1024 lds
v_mul_f32 v130, v130, v217
v_mfma_f32_16x16x32_bf16 v[72:75], v[180:183], a[68:71], v[72:75]
v_mul_f32 v131, v131, v217
v_mul_f32 v132, v132, v217
v_mfma_f32_16x16x32_bf16 v[72:75], v[184:187], a[72:75], v[72:75]
buffer_load_dwordx4 v230, s[36:39], s74 offen offset:2048 lds
v_mfma_f32_16x16x32_bf16 v[72:75], v[188:191], a[76:79], v[72:75]
v_mul_f32 v133, v133, v217
v_mul_f32 v0, s68, v0
v_mfma_f32_16x16x32_bf16 v[80:83], v[176:179], a[128:131], 0
ds_read_b64_tr_b16 v[160:161], v236 offset:49152
v_mul_f32 v134, v134, v217
v_mfma_f32_16x16x32_bf16 v[80:83], v[180:183], a[132:135], v[80:83]
v_mul_f32 v135, v135, v217
v_mul_f32 v1, s68, v1
v_mfma_f32_16x16x32_bf16 v[80:83], v[184:187], a[136:139], v[80:83]
buffer_load_dwordx4 v231, s[36:39], s74 offen offset:3072 lds
v_mfma_f32_16x16x32_bf16 v[80:83], v[188:191], a[140:143], v[80:83]
ds_read_b64_tr_b16 v[162:163], v236 offset:49664
v_mul_f32 v136, v136, v217
v_mfma_f32_16x16x32_bf16 v[88:91], v[176:179], a[192:195], 0
ds_read_b64_tr_b16 v[164:165], v236 offset:53248
v_mul_f32 v2, s68, v2
v_mfma_f32_16x16x32_bf16 v[88:91], v[180:183], a[196:199], v[88:91]
ds_read_b64_tr_b16 v[166:167], v236 offset:53760
v_mul_f32 v137, v137, v217
v_mfma_f32_16x16x32_bf16 v[88:91], v[184:187], a[200:203], v[88:91]
ds_read_b64_tr_b16 v[168:169], v236 offset:57344
v_mul_f32 v3, s68, v3
v_mfma_f32_16x16x32_bf16 v[88:91], v[188:191], a[204:207], v[88:91]
s_waitcnt lgkmcnt(4)
ds_read_b64_tr_b16 v[170:171], v236 offset:57856
v_mul_f32 v138, v138, v217
v_mfma_f32_16x16x32_bf16 v[68:71], v[192:195], a[0:3], 0
ds_read_b64_tr_b16 v[172:173], v236 offset:61440
v_cvt_pk_bf16_f32 v248, v0, v1
v_mfma_f32_16x16x32_bf16 v[68:71], v[196:199], a[4:7], v[68:71]
ds_read_b64_tr_b16 v[174:175], v236 offset:61952
v_mul_f32 v139, v139, v217
s_add_u32 s3, s65, 12
v_mfma_f32_16x16x32_bf16 v[68:71], v[200:203], a[8:11], v[68:71]
s_and_b32 s3, s3, 15
v_mul_f32 v140, v140, v217
v_cvt_pk_bf16_f32 v249, v2, v3
v_mfma_f32_16x16x32_bf16 v[68:71], v[204:207], a[12:15], v[68:71]
s_lshl_b32 s3, s3, 18
v_mul_f32 v141, v141, v217
v_mul_f32 v4, s68, v4
v_mfma_f32_16x16x32_bf16 v[76:79], v[192:195], a[64:67], 0
s_add_u32 s3, s3, s62
v_mul_f32 v142, v142, v217
v_mul_f32 v5, s68, v5
v_mfma_f32_16x16x32_bf16 v[76:79], v[196:199], a[68:71], v[76:79]
s_add_u32 m0, s66, 114688
v_mul_f32 v143, v143, v217
s_add_u32 s74, s3, 0
v_mfma_f32_16x16x32_bf16 v[76:79], v[200:203], a[72:75], v[76:79]
v_cvt_pk_bf16_f32 v144, v128, v129
v_mul_f32 v6, s68, v6
v_mfma_f32_16x16x32_bf16 v[76:79], v[204:207], a[76:79], v[76:79]
buffer_load_dwordx4 v228, s[36:39], s74 offen offset:0 lds
v_mfma_f32_16x16x32_bf16 v[84:87], v[192:195], a[128:131], 0
v_cvt_pk_bf16_f32 v145, v130, v131
v_mul_f32 v7, s68, v7
v_mfma_f32_16x16x32_bf16 v[84:87], v[196:199], a[132:135], v[84:87]
ds_read_b64_tr_b16 v[176:177], v237 offset:49152
v_cvt_pk_bf16_f32 v146, v132, v133
v_mfma_f32_16x16x32_bf16 v[84:87], v[200:203], a[136:139], v[84:87]
v_cvt_pk_bf16_f32 v250, v4, v5
v_cvt_pk_bf16_f32 v147, v134, v135
v_mfma_f32_16x16x32_bf16 v[84:87], v[204:207], a[140:143], v[84:87]
ds_read_b64_tr_b16 v[178:179], v237 offset:49664
v_cvt_pk_bf16_f32 v148, v136, v137
v_mfma_f32_16x16x32_bf16 v[92:95], v[192:195], a[192:195], 0
ds_read_b64_tr_b16 v[180:181], v237 offset:53248
v_cvt_pk_bf16_f32 v251, v6, v7
v_mfma_f32_16x16x32_bf16 v[92:95], v[196:199], a[196:199], v[92:95]
ds_read_b64_tr_b16 v[182:183], v237 offset:53760
v_cvt_pk_bf16_f32 v149, v138, v139
v_mfma_f32_16x16x32_bf16 v[92:95], v[200:203], a[200:203], v[92:95]
ds_read_b64_tr_b16 v[184:185], v237 offset:57344
s_add_u32 s72, s67, 0
v_mfma_f32_16x16x32_bf16 v[92:95], v[204:207], a[204:207], v[92:95]
s_waitcnt lgkmcnt(5)
ds_read_b64_tr_b16 v[186:187], v237 offset:57856
v_mfma_f32_16x16x32_bf16 v[64:67], v[160:163], a[16:19], v[64:67]
ds_read_b64_tr_b16 v[188:189], v237 offset:61440
v_cvt_pk_bf16_f32 v150, v140, v141
v_mfma_f32_16x16x32_bf16 v[64:67], v[164:167], a[20:23], v[64:67]
buffer_load_dwordx4 v229, s[36:39], s74 offen offset:1024 lds
v_mfma_f32_16x16x32_bf16 v[64:67], v[168:171], a[24:27], v[64:67]
ds_read_b64_tr_b16 v[190:191], v237 offset:61952
v_cvt_pk_bf16_f32 v151, v142, v143
v_mfma_f32_16x16x32_bf16 v[64:67], v[172:175], a[28:31], v[64:67]
buffer_store_dwordx4 v[248:251], v242, s[40:43], s72 offen offset:0 sc1
v_mfma_f32_16x16x32_bf16 v[72:75], v[160:163], a[80:83], v[72:75]
buffer_store_dwordx4 v[144:147], v245, s[44:47], s70 offen sc1
v_mul_f32 v8, s68, v8
v_mfma_f32_16x16x32_bf16 v[72:75], v[164:167], a[84:87], v[72:75]
buffer_load_dwordx4 v230, s[36:39], s74 offen offset:2048 lds
v_mul_f32 v9, s68, v9
v_mfma_f32_16x16x32_bf16 v[72:75], v[168:171], a[88:91], v[72:75]
buffer_store_dwordx4 v[148:151], v245, s[44:47], s71 offen sc1
v_mfma_f32_16x16x32_bf16 v[72:75], v[172:175], a[92:95], v[72:75]
v_mul_f32 v10, s68, v10
v_mul_f32 v11, s68, v11
v_mfma_f32_16x16x32_bf16 v[80:83], v[160:163], a[144:147], v[80:83]
buffer_load_dwordx4 v231, s[36:39], s74 offen offset:3072 lds
v_mfma_f32_16x16x32_bf16 v[80:83], v[164:167], a[148:151], v[80:83]
v_cvt_pk_bf16_f32 v252, v8, v9
v_mfma_f32_16x16x32_bf16 v[80:83], v[168:171], a[152:155], v[80:83]
v_cvt_pk_bf16_f32 v253, v10, v11
v_mfma_f32_16x16x32_bf16 v[80:83], v[172:175], a[156:159], v[80:83]
v_mul_f32 v12, s68, v12
v_mfma_f32_16x16x32_bf16 v[88:91], v[160:163], a[208:211], v[88:91]
v_mul_f32 v13, s68, v13
v_mfma_f32_16x16x32_bf16 v[88:91], v[164:167], a[212:215], v[88:91]
v_mul_f32 v14, s68, v14
v_mfma_f32_16x16x32_bf16 v[88:91], v[168:171], a[216:219], v[88:91]
v_mul_f32 v15, s68, v15
v_mfma_f32_16x16x32_bf16 v[88:91], v[172:175], a[220:223], v[88:91]
s_waitcnt lgkmcnt(0)
s_waitcnt vmcnt(19)
s_barrier
s_cmp_lg_u32 s56, 0
s_cbranch_scc1 L_nozc
s_waitcnt vmcnt(25)
v_readfirstlane_b32 s79, v219
s_nop 2
s_cmp_ge_u32 s79, 1
s_cbranch_scc0 L_spin5
L_got5:
L_nozc:
s_lshr_b32 s69, s2, 4
s_lshl_b32 s69, s69, 7
v_mfma_f32_16x16x32_bf16 v[68:71], v[176:179], a[16:19], v[68:71]
v_add_u32 v240, 131072, v236
v_add_u32 v241, 131072, v237
v_mfma_f32_16x16x32_bf16 v[68:71], v[180:183], a[20:23], v[68:71]
ds_read_b64_tr_b16 v[192:193], v240 offset:0
s_add_u32 s3, s65, 0
v_mfma_f32_16x16x32_bf16 v[68:71], v[184:187], a[24:27], v[68:71]
ds_read_b64_tr_b16 v[194:195], v240 offset:512
s_and_b32 s3, s3, 15
v_mfma_f32_16x16x32_bf16 v[68:71], v[188:191], a[28:31], v[68:71]
ds_read_b64_tr_b16 v[196:197], v240 offset:4096
v_cvt_pk_bf16_f32 v254, v12, v13
v_mfma_f32_16x16x32_bf16 v[76:79], v[176:179], a[80:83], v[76:79]
ds_read_b64_tr_b16 v[198:199], v240 offset:4608
s_lshl_b32 s3, s3, 18
v_mfma_f32_16x16x32_bf16 v[76:79], v[180:183], a[84:87], v[76:79]
ds_read_b64_tr_b16 v[200:201], v240 offset:8192
v_cvt_pk_bf16_f32 v255, v14, v15
v_mfma_f32_16x16x32_bf16 v[76:79], v[184:187], a[88:91], v[76:79]
ds_read_b64_tr_b16 v[202:203], v240 offset:8704
s_add_u32 s3, s3, s62
v_mfma_f32_16x16x32_bf16 v[76:79], v[188:191], a[92:95], v[76:79]
ds_read_b64_tr_b16 v[204:205], v240 offset:12288
s_add_u32 m0, s66, 0
v_mfma_f32_16x16x32_bf16 v[84:87], v[176:179], a[144:147], v[84:87]
ds_read_b64_tr_b16 v[206:207], v240 offset:12800
s_add_u32 s72, s67, 0
v_mfma_f32_16x16x32_bf16 v[84:87], v[180:183], a[148:151], v[84:87]
s_add_u32 s74, s3, 128
ds_read_b64_tr_b16 v[160:161], v241 offset:0
v_mfma_f32_16x16x32_bf16 v[84:87], v[184:187], a[152:155], v[84:87]
buffer_store_dwordx4 v[252:255], v242, s[40:43], s72 offen offset:1024 sc1
v_mfma_f32_16x16x32_bf16 v[84:87], v[188:191], a[156:159], v[84:87]
buffer_load_dwordx4 v228, s[36:39], s74 offen offset:0 lds
v_mfma_f32_16x16x32_bf16 v[92:95], v[176:179], a[208:211], v[92:95]
ds_read_b64_tr_b16 v[162:163], v241 offset:512
v_mul_f32 v16, s68, v16
v_mfma_f32_16x16x32_bf16 v[92:95], v[180:183], a[212:215], v[92:95]
ds_read_b64_tr_b16 v[164:165], v241 offset:4096
v_mul_f32 v17, s68, v17
v_mfma_f32_16x16x32_bf16 v[92:95], v[184:187], a[216:219], v[92:95]
ds_read_b64_tr_b16 v[166:167], v241 offset:4608
v_mul_f32 v18, s68, v18
v_mfma_f32_16x16x32_bf16 v[92:95], v[188:191], a[220:223], v[92:95]
s_waitcnt lgkmcnt(4)
ds_read_b64_tr_b16 v[168:169], v241 offset:8192
v_mfma_f32_16x16x32_bf16 v[64:67], v[192:195], a[32:35], v[64:67]
ds_read_b64_tr_b16 v[170:171], v241 offset:8704
v_mul_f32 v19, s68, v19
v_mfma_f32_16x16x32_bf16 v[64:67], v[196:199], a[36:39], v[64:67]
ds_read_b64_tr_b16 v[172:173], v241 offset:12288
v_cvt_pk_bf16_f32 v248, v16, v17
v_mfma_f32_16x16x32_bf16 v[64:67], v[200:203], a[40:43], v[64:67]
ds_read_b64_tr_b16 v[174:175], v241 offset:12800
v_cvt_pk_bf16_f32 v249, v18, v19
v_mfma_f32_16x16x32_bf16 v[64:67], v[204:207], a[44:47], v[64:67]
buffer_load_dwordx4 v229, s[36:39], s74 offen offset:1024 lds
v_mfma_f32_16x16x32_bf16 v[72:75], v[192:195], a[96:99], v[72:75]
buffer_load_dwordx4 v230, s[36:39], s74 offen offset:2048 lds
v_mfma_f32_16x16x32_bf16 v[72:75], v[196:199], a[100:103], v[72:75]
v_mul_f32 v20, s68, v20
v_mfma_f32_16x16x32_bf16 v[72:75], v[200:203], a[104:107], v[72:75]
ds_read_b64_tr_b16 v[176:177], v240 offset:16384
v_mul_f32 v21, s68, v21
v_mfma_f32_16x16x32_bf16 v[72:75], v[204:207], a[108:111], v[72:75]
buffer_load_dwordx4 v231, s[36:39], s74 offen offset:3072 lds
v_mfma_f32_16x16x32_bf16 v[80:83], v[192:195], a[160:163], v[80:83]
ds_read_b64_tr_b16 v[178:179], v240 offset:16896
v_mul_f32 v22, s68, v22
v_mfma_f32_16x16x32_bf16 v[80:83], v[196:199], a[164:167], v[80:83]
ds_read_b64_tr_b16 v[180:181], v240 offset:20480
v_mul_f32 v23, s68, v23
v_mfma_f32_16x16x32_bf16 v[80:83], v[200:203], a[168:171], v[80:83]
ds_read_b64_tr_b16 v[182:183], v240 offset:20992
v_cvt_pk_bf16_f32 v250, v20, v21
v_mfma_f32_16x16x32_bf16 v[80:83], v[204:207], a[172:175], v[80:83]
ds_read_b64_tr_b16 v[184:185], v240 offset:24576
s_add_u32 s3, s65, 4
v_mfma_f32_16x16x32_bf16 v[88:91], v[192:195], a[224:227], v[88:91]
ds_read_b64_tr_b16 v[186:187], v240 offset:25088
v_cvt_pk_bf16_f32 v251, v22, v23
v_mfma_f32_16x16x32_bf16 v[88:91], v[196:199], a[228:231], v[88:91]
ds_read_b64_tr_b16 v[188:189], v240 offset:28672
s_and_b32 s3, s3, 15
v_mfma_f32_16x16x32_bf16 v[88:91], v[200:203], a[232:235], v[88:91]
ds_read_b64_tr_b16 v[190:191], v240 offset:29184
s_add_u32 s72, s67, 4096
v_mfma_f32_16x16x32_bf16 v[88:91], v[204:207], a[236:239], v[88:91]
s_waitcnt lgkmcnt(6)
s_lshl_b32 s3, s3, 18
v_mfma_f32_16x16x32_bf16 v[68:71], v[160:163], a[32:35], v[68:71]
buffer_store_dwordx4 v[248:251], v242, s[40:43], s72 offen offset:0 sc1
v_mfma_f32_16x16x32_bf16 v[68:71], v[164:167], a[36:39], v[68:71]
s_add_u32 s3, s3, s62
s_add_u32 m0, s66, 16384
v_mfma_f32_16x16x32_bf16 v[68:71], v[168:171], a[40:43], v[68:71]
s_add_u32 s74, s3, 128
v_mul_f32 v24, s68, v24
v_mfma_f32_16x16x32_bf16 v[68:71], v[172:175], a[44:47], v[68:71]
s_lshr_b32 s0, s2, 3
s_cmp_lg_u32 s0, 5
s_cbranch_scc1 L_ct11
s_lshl_b32 s0, s56, 13
v_lshl_add_u32 v246, v243, 7, s0
v_min_u32 v246, 8192-4, v246
s_getpc_b64 s[0:1]
L_cp11:
s_add_u32 s0, s0, L_c560-L_cp11
s_addc_u32 s1, s1, 0
global_load_dword v247, v246, s[0:1]
L_ct11:
v_mfma_f32_16x16x32_bf16 v[76:79], v[160:163], a[96:99], v[76:79]
buffer_load_dwordx4 v228, s[36:39], s74 offen offset:0 lds
v_mfma_f32_16x16x32_bf16 v[76:79], v[164:167], a[100:103], v[76:79]
v_mul_f32 v25, s68, v25
v_mfma_f32_16x16x32_bf16 v[76:79], v[168:171], a[104:107], v[76:79]
ds_read_b64_tr_b16 v[192:193], v241 offset:16384
v_mul_f32 v26, s68, v26
v_mfma_f32_16x16x32_bf16 v[76:79], v[172:175], a[108:111], v[76:79]
ds_read_b64_tr_b16 v[194:195], v241 offset:16896
v_mfma_f32_16x16x32_bf16 v[84:87], v[160:163], a[160:163], v[84:87]
ds_read_b64_tr_b16 v[196:197], v241 offset:20480
v_mul_f32 v27, s68, v27
v_mfma_f32_16x16x32_bf16 v[84:87], v[164:167], a[164:167], v[84:87]
ds_read_b64_tr_b16 v[198:199], v241 offset:20992
v_mfma_f32_16x16x32_bf16 v[84:87], v[168:171], a[168:171], v[84:87]
ds_read_b64_tr_b16 v[200:201], v241 offset:24576
v_cvt_pk_bf16_f32 v252, v24, v25
v_mfma_f32_16x16x32_bf16 v[84:87], v[172:175], a[172:175], v[84:87]
ds_read_b64_tr_b16 v[202:203], v241 offset:25088
v_mfma_f32_16x16x32_bf16 v[92:95], v[160:163], a[224:227], v[92:95]
buffer_load_dwordx4 v229, s[36:39], s74 offen offset:1024 lds
v_mfma_f32_16x16x32_bf16 v[92:95], v[164:167], a[228:231], v[92:95]
ds_read_b64_tr_b16 v[204:205], v241 offset:28672
v_cvt_pk_bf16_f32 v253, v26, v27
v_mfma_f32_16x16x32_bf16 v[92:95], v[168:171], a[232:235], v[92:95]
ds_read_b64_tr_b16 v[206:207], v241 offset:29184
v_mul_f32 v28, s68, v28
v_mfma_f32_16x16x32_bf16 v[92:95], v[172:175], a[236:239], v[92:95]
buffer_load_dwordx4 v230, s[36:39], s74 offen offset:2048 lds
v_mfma_f32_16x16x32_bf16 v[64:67], v[176:179], a[48:51], v[64:67]
s_waitcnt lgkmcnt(4)
v_mul_f32 v29, s68, v29
v_mfma_f32_16x16x32_bf16 v[64:67], v[180:183], a[52:55], v[64:67]
v_mul_f32 v30, s68, v30
v_mfma_f32_16x16x32_bf16 v[64:67], v[184:187], a[56:59], v[64:67]
v_mfma_f32_16x16x32_bf16 v[64:67], v[188:191], a[60:63], v[64:67]
v_mul_f32 v31, s68, v31
v_mfma_f32_16x16x32_bf16 v[72:75], v[176:179], a[112:115], v[72:75]
buffer_load_dwordx4 v231, s[36:39], s74 offen offset:3072 lds
v_mfma_f32_16x16x32_bf16 v[72:75], v[180:183], a[116:119], v[72:75]
v_cvt_pk_bf16_f32 v254, v28, v29
v_mfma_f32_16x16x32_bf16 v[72:75], v[184:187], a[120:123], v[72:75]
ds_read_b64_tr_b16 v[160:161], v238 offset:32768
v_cvt_pk_bf16_f32 v255, v30, v31
v_mfma_f32_16x16x32_bf16 v[72:75], v[188:191], a[124:127], v[72:75]
ds_read_b64_tr_b16 v[162:163], v238 offset:33280
v_mfma_f32_16x16x32_bf16 v[80:83], v[176:179], a[176:179], v[80:83]
ds_read_b64_tr_b16 v[164:165], v238 offset:36864
s_add_u32 s72, s67, 4096
v_mfma_f32_16x16x32_bf16 v[80:83], v[180:183], a[180:183], v[80:83]
ds_read_b64_tr_b16 v[166:167], v238 offset:37376
v_mfma_f32_16x16x32_bf16 v[80:83], v[184:187], a[184:187], v[80:83]
ds_read_b64_tr_b16 v[168:169], v238 offset:40960
v_mfma_f32_16x16x32_bf16 v[80:83], v[188:191], a[188:191], v[80:83]
ds_read_b64_tr_b16 v[170:171], v238 offset:41472
v_mfma_f32_16x16x32_bf16 v[88:91], v[176:179], a[240:243], v[88:91]
ds_read_b64_tr_b16 v[172:173], v238 offset:45056
v_mfma_f32_16x16x32_bf16 v[88:91], v[180:183], a[244:247], v[88:91]
buffer_store_dwordx4 v[252:255], v242, s[40:43], s72 offen offset:1024 sc1
v_mfma_f32_16x16x32_bf16 v[88:91], v[184:187], a[248:251], v[88:91]
ds_read_b64_tr_b16 v[174:175], v238 offset:45568
v_mul_f32 v32, s68, v32
v_mfma_f32_16x16x32_bf16 v[88:91], v[188:191], a[252:255], v[88:91]
v_mul_f32 v33, s68, v33
v_mfma_f32_16x16x32_bf16 v[68:71], v[192:195], a[48:51], v[68:71]
v_mul_f32 v34, s68, v34
v_mfma_f32_16x16x32_bf16 v[68:71], v[196:199], a[52:55], v[68:71]
s_waitcnt lgkmcnt(3)
v_mfma_f32_16x16x32_bf16 v[68:71], v[200:203], a[56:59], v[68:71]
v_mul_f32 v35, s68, v35
v_mfma_f32_16x16x32_bf16 v[68:71], v[204:207], a[60:63], v[68:71]
v_mfma_f32_16x16x32_bf16 v[76:79], v[192:195], a[112:115], v[76:79]
v_cvt_pk_bf16_f32 v248, v32, v33
v_mfma_f32_16x16x32_bf16 v[76:79], v[196:199], a[116:119], v[76:79]
v_mfma_f32_16x16x32_bf16 v[76:79], v[200:203], a[120:123], v[76:79]
ds_read_b64_tr_b16 v[176:177], v239 offset:32768
v_cvt_pk_bf16_f32 v249, v34, v35
v_mfma_f32_16x16x32_bf16 v[76:79], v[204:207], a[124:127], v[76:79]
ds_read_b64_tr_b16 v[178:179], v239 offset:33280
v_mul_f32 v36, s68, v36
v_mfma_f32_16x16x32_bf16 v[84:87], v[192:195], a[176:179], v[84:87]
ds_read_b64_tr_b16 v[180:181], v239 offset:36864
v_mfma_f32_16x16x32_bf16 v[84:87], v[196:199], a[180:183], v[84:87]
ds_read_b64_tr_b16 v[182:183], v239 offset:37376
v_mul_f32 v37, s68, v37
v_mfma_f32_16x16x32_bf16 v[84:87], v[200:203], a[184:187], v[84:87]
ds_read_b64_tr_b16 v[184:185], v239 offset:40960
v_mfma_f32_16x16x32_bf16 v[84:87], v[204:207], a[188:191], v[84:87]
ds_read_b64_tr_b16 v[186:187], v239 offset:41472
v_mul_f32 v38, s68, v38
v_mfma_f32_16x16x32_bf16 v[92:95], v[192:195], a[240:243], v[92:95]
ds_read_b64_tr_b16 v[188:189], v239 offset:45056
v_mfma_f32_16x16x32_bf16 v[92:95], v[196:199], a[244:247], v[92:95]
ds_read_b64_tr_b16 v[190:191], v239 offset:45568
v_mul_f32 v39, s68, v39
v_mfma_f32_16x16x32_bf16 v[92:95], v[200:203], a[248:251], v[92:95]
v_mfma_f32_16x16x32_bf16 v[92:95], v[204:207], a[252:255], v[92:95]
v_cvt_pk_bf16_f32 v250, v36, v37
v_mfma_f32_16x16x32_bf16 v[96:99], v[160:163], a[0:3], 0
v_mfma_f32_16x16x32_bf16 v[96:99], v[164:167], a[4:7], v[96:99]
s_waitcnt lgkmcnt(3)
v_cvt_pk_bf16_f32 v251, v38, v39
v_mfma_f32_16x16x32_bf16 v[96:99], v[168:171], a[8:11], v[96:99]
s_add_u32 s72, s67, 16384
v_mfma_f32_16x16x32_bf16 v[96:99], v[172:175], a[12:15], v[96:99]
buffer_store_dwordx4 v[248:251], v242, s[40:43], s72 offen offset:0 sc1
v_mfma_f32_16x16x32_bf16 v[104:107], v[160:163], a[64:67], 0
v_mfma_f32_16x16x32_bf16 v[104:107], v[164:167], a[68:71], v[104:107]
v_mfma_f32_16x16x32_bf16 v[104:107], v[168:171], a[72:75], v[104:107]
ds_read_b64_tr_b16 v[192:193], v238 offset:49152
v_mfma_f32_16x16x32_bf16 v[104:107], v[172:175], a[76:79], v[104:107]
ds_read_b64_tr_b16 v[194:195], v238 offset:49664
v_mul_f32 v40, s68, v40
v_mfma_f32_16x16x32_bf16 v[112:115], v[160:163], a[128:131], 0
ds_read_b64_tr_b16 v[196:197], v238 offset:53248
v_mfma_f32_16x16x32_bf16 v[112:115], v[164:167], a[132:135], v[112:115]
ds_read_b64_tr_b16 v[198:199], v238 offset:53760
v_mul_f32 v41, s68, v41
v_mfma_f32_16x16x32_bf16 v[112:115], v[168:171], a[136:139], v[112:115]
ds_read_b64_tr_b16 v[200:201], v238 offset:57344
v_mul_f32 v42, s68, v42
v_mfma_f32_16x16x32_bf16 v[112:115], v[172:175], a[140:143], v[112:115]
ds_read_b64_tr_b16 v[202:203], v238 offset:57856
v_mfma_f32_16x16x32_bf16 v[120:123], v[160:163], a[192:195], 0
ds_read_b64_tr_b16 v[204:205], v238 offset:61440
v_mul_f32 v43, s68, v43
v_mfma_f32_16x16x32_bf16 v[120:123], v[164:167], a[196:199], v[120:123]
ds_read_b64_tr_b16 v[206:207], v238 offset:61952
v_mfma_f32_16x16x32_bf16 v[120:123], v[168:171], a[200:203], v[120:123]
v_cvt_pk_bf16_f32 v252, v40, v41
v_mfma_f32_16x16x32_bf16 v[120:123], v[172:175], a[204:207], v[120:123]
v_mfma_f32_16x16x32_bf16 v[100:103], v[176:179], a[0:3], 0
v_cvt_pk_bf16_f32 v253, v42, v43
v_mfma_f32_16x16x32_bf16 v[100:103], v[180:183], a[4:7], v[100:103]
s_waitcnt lgkmcnt(3)
v_mfma_f32_16x16x32_bf16 v[100:103], v[184:187], a[8:11], v[100:103]
v_mul_f32 v44, s68, v44
v_mfma_f32_16x16x32_bf16 v[100:103], v[188:191], a[12:15], v[100:103]
v_mul_f32 v45, s68, v45
v_mfma_f32_16x16x32_bf16 v[108:111], v[176:179], a[64:67], 0
v_mfma_f32_16x16x32_bf16 v[108:111], v[180:183], a[68:71], v[108:111]
v_mul_f32 v46, s68, v46
v_mfma_f32_16x16x32_bf16 v[108:111], v[184:187], a[72:75], v[108:111]
ds_read_b64_tr_b16 v[160:161], v239 offset:49152
v_mfma_f32_16x16x32_bf16 v[108:111], v[188:191], a[76:79], v[108:111]
ds_read_b64_tr_b16 v[162:163], v239 offset:49664
v_mul_f32 v47, s68, v47
v_mfma_f32_16x16x32_bf16 v[116:119], v[176:179], a[128:131], 0
ds_read_b64_tr_b16 v[164:165], v239 offset:53248
v_mfma_f32_16x16x32_bf16 v[116:119], v[180:183], a[132:135], v[116:119]
ds_read_b64_tr_b16 v[166:167], v239 offset:53760
v_cvt_pk_bf16_f32 v254, v44, v45
v_mfma_f32_16x16x32_bf16 v[116:119], v[184:187], a[136:139], v[116:119]
ds_read_b64_tr_b16 v[168:169], v239 offset:57344
v_mfma_f32_16x16x32_bf16 v[116:119], v[188:191], a[140:143], v[116:119]
ds_read_b64_tr_b16 v[170:171], v239 offset:57856
v_cvt_pk_bf16_f32 v255, v46, v47
v_mfma_f32_16x16x32_bf16 v[124:127], v[176:179], a[192:195], 0
ds_read_b64_tr_b16 v[172:173], v239 offset:61440
s_add_u32 s72, s67, 16384
v_mfma_f32_16x16x32_bf16 v[124:127], v[180:183], a[196:199], v[124:127]
ds_read_b64_tr_b16 v[174:175], v239 offset:61952
v_mfma_f32_16x16x32_bf16 v[124:127], v[184:187], a[200:203], v[124:127]
buffer_store_dwordx4 v[252:255], v242, s[40:43], s72 offen offset:1024 sc1
v_mfma_f32_16x16x32_bf16 v[124:127], v[188:191], a[204:207], v[124:127]
v_mfma_f32_16x16x32_bf16 v[96:99], v[192:195], a[16:19], v[96:99]
v_mfma_f32_16x16x32_bf16 v[96:99], v[196:199], a[20:23], v[96:99]
s_waitcnt lgkmcnt(3)
v_mul_f32 v48, s68, v48
v_mfma_f32_16x16x32_bf16 v[96:99], v[200:203], a[24:27], v[96:99]
v_mfma_f32_16x16x32_bf16 v[96:99], v[204:207], a[28:31], v[96:99]
v_mul_f32 v49, s68, v49
v_mfma_f32_16x16x32_bf16 v[104:107], v[192:195], a[80:83], v[104:107]
v_mfma_f32_16x16x32_bf16 v[104:107], v[196:199], a[84:87], v[104:107]
v_mul_f32 v50, s68, v50
v_mfma_f32_16x16x32_bf16 v[104:107], v[200:203], a[88:91], v[104:107]
v_add_u32 v240, 131072, v238
v_mfma_f32_16x16x32_bf16 v[104:107], v[204:207], a[92:95], v[104:107]
v_add_u32 v241, 131072, v239
v_mfma_f32_16x16x32_bf16 v[112:115], v[192:195], a[144:147], v[112:115]
ds_read_b64_tr_b16 v[176:177], v240 offset:0
v_mul_f32 v51, s68, v51
v_mfma_f32_16x16x32_bf16 v[112:115], v[196:199], a[148:151], v[112:115]
ds_read_b64_tr_b16 v[178:179], v240 offset:512
v_cvt_pk_bf16_f32 v248, v48, v49
v_mfma_f32_16x16x32_bf16 v[112:115], v[200:203], a[152:155], v[112:115]
ds_read_b64_tr_b16 v[180:181], v240 offset:4096
v_cvt_pk_bf16_f32 v249, v50, v51
v_mfma_f32_16x16x32_bf16 v[112:115], v[204:207], a[156:159], v[112:115]
ds_read_b64_tr_b16 v[182:183], v240 offset:4608
v_mfma_f32_16x16x32_bf16 v[120:123], v[192:195], a[208:211], v[120:123]
ds_read_b64_tr_b16 v[184:185], v240 offset:8192
v_mul_f32 v52, s68, v52
v_mfma_f32_16x16x32_bf16 v[120:123], v[196:199], a[212:215], v[120:123]
ds_read_b64_tr_b16 v[186:187], v240 offset:8704
v_mfma_f32_16x16x32_bf16 v[120:123], v[200:203], a[216:219], v[120:123]
ds_read_b64_tr_b16 v[188:189], v240 offset:12288
v_mul_f32 v53, s68, v53
v_mfma_f32_16x16x32_bf16 v[120:123], v[204:207], a[220:223], v[120:123]
ds_read_b64_tr_b16 v[190:191], v240 offset:12800
v_mul_f32 v54, s68, v54
v_mfma_f32_16x16x32_bf16 v[100:103], v[160:163], a[16:19], v[100:103]
v_mfma_f32_16x16x32_bf16 v[100:103], v[164:167], a[20:23], v[100:103]
s_waitcnt lgkmcnt(5)
v_mul_f32 v55, s68, v55
v_mfma_f32_16x16x32_bf16 v[100:103], v[168:171], a[24:27], v[100:103]
v_mfma_f32_16x16x32_bf16 v[100:103], v[172:175], a[28:31], v[100:103]
v_cvt_pk_bf16_f32 v250, v52, v53
v_mfma_f32_16x16x32_bf16 v[108:111], v[160:163], a[80:83], v[108:111]
v_mfma_f32_16x16x32_bf16 v[108:111], v[164:167], a[84:87], v[108:111]
v_cvt_pk_bf16_f32 v251, v54, v55
v_mfma_f32_16x16x32_bf16 v[108:111], v[168:171], a[88:91], v[108:111]
ds_read_b64_tr_b16 v[192:193], v241 offset:0
v_mfma_f32_16x16x32_bf16 v[108:111], v[172:175], a[92:95], v[108:111]
ds_read_b64_tr_b16 v[194:195], v241 offset:512
s_add_u32 s72, s67, 20480
v_mfma_f32_16x16x32_bf16 v[116:119], v[160:163], a[144:147], v[116:119]
ds_read_b64_tr_b16 v[196:197], v241 offset:4096
v_mfma_f32_16x16x32_bf16 v[116:119], v[164:167], a[148:151], v[116:119]
ds_read_b64_tr_b16 v[198:199], v241 offset:4608
v_mfma_f32_16x16x32_bf16 v[116:119], v[168:171], a[152:155], v[116:119]
buffer_store_dwordx4 v[248:251], v242, s[40:43], s72 offen offset:0 sc1
v_mfma_f32_16x16x32_bf16 v[116:119], v[172:175], a[156:159], v[116:119]
ds_read_b64_tr_b16 v[200:201], v241 offset:8192
v_mul_f32 v56, s68, v56
v_mfma_f32_16x16x32_bf16 v[124:127], v[160:163], a[208:211], v[124:127]
ds_read_b64_tr_b16 v[202:203], v241 offset:8704
v_mfma_f32_16x16x32_bf16 v[124:127], v[164:167], a[212:215], v[124:127]
ds_read_b64_tr_b16 v[204:205], v241 offset:12288
v_mul_f32 v57, s68, v57
v_mfma_f32_16x16x32_bf16 v[124:127], v[168:171], a[216:219], v[124:127]
ds_read_b64_tr_b16 v[206:207], v241 offset:12800
v_mfma_f32_16x16x32_bf16 v[124:127], v[172:175], a[220:223], v[124:127]
v_mul_f32 v58, s68, v58
v_mfma_f32_16x16x32_bf16 v[96:99], v[176:179], a[32:35], v[96:99]
s_waitcnt lgkmcnt(4)
v_mfma_f32_16x16x32_bf16 v[96:99], v[180:183], a[36:39], v[96:99]
v_mul_f32 v59, s68, v59
v_mfma_f32_16x16x32_bf16 v[96:99], v[184:187], a[40:43], v[96:99]
v_cvt_pk_bf16_f32 v252, v56, v57
v_mfma_f32_16x16x32_bf16 v[96:99], v[188:191], a[44:47], v[96:99]
v_mfma_f32_16x16x32_bf16 v[104:107], v[176:179], a[96:99], v[104:107]
v_cvt_pk_bf16_f32 v253, v58, v59
v_mfma_f32_16x16x32_bf16 v[104:107], v[180:183], a[100:103], v[104:107]
v_mfma_f32_16x16x32_bf16 v[104:107], v[184:187], a[104:107], v[104:107]
ds_read_b64_tr_b16 v[160:161], v240 offset:16384
v_mul_f32 v60, s68, v60
v_mfma_f32_16x16x32_bf16 v[104:107], v[188:191], a[108:111], v[104:107]
ds_read_b64_tr_b16 v[162:163], v240 offset:16896
v_mfma_f32_16x16x32_bf16 v[112:115], v[176:179], a[160:163], v[112:115]
ds_read_b64_tr_b16 v[164:165], v240 offset:20480
v_mul_f32 v61, s68, v61
v_mfma_f32_16x16x32_bf16 v[112:115], v[180:183], a[164:167], v[112:115]
ds_read_b64_tr_b16 v[166:167], v240 offset:20992
v_mfma_f32_16x16x32_bf16 v[112:115], v[184:187], a[168:171], v[112:115]
ds_read_b64_tr_b16 v[168:169], v240 offset:24576
v_mul_f32 v62, s68, v62
v_mfma_f32_16x16x32_bf16 v[112:115], v[188:191], a[172:175], v[112:115]
ds_read_b64_tr_b16 v[170:171], v240 offset:25088
v_mul_f32 v63, s68, v63
v_mfma_f32_16x16x32_bf16 v[120:123], v[176:179], a[224:227], v[120:123]
ds_read_b64_tr_b16 v[172:173], v240 offset:28672
v_mfma_f32_16x16x32_bf16 v[120:123], v[180:183], a[228:231], v[120:123]
ds_read_b64_tr_b16 v[174:175], v240 offset:29184
v_cvt_pk_bf16_f32 v254, v60, v61
v_mfma_f32_16x16x32_bf16 v[120:123], v[184:187], a[232:235], v[120:123]
v_mfma_f32_16x16x32_bf16 v[120:123], v[188:191], a[236:239], v[120:123]
v_cvt_pk_bf16_f32 v255, v62, v63
v_mfma_f32_16x16x32_bf16 v[100:103], v[192:195], a[32:35], v[100:103]
v_mfma_f32_16x16x32_bf16 v[100:103], v[196:199], a[36:39], v[100:103]
s_waitcnt lgkmcnt(3)
s_add_u32 s72, s67, 20480
v_mfma_f32_16x16x32_bf16 v[100:103], v[200:203], a[40:43], v[100:103]
buffer_store_dwordx4 v[252:255], v242, s[40:43], s72 offen offset:1024 sc1
v_mfma_f32_16x16x32_bf16 v[100:103], v[204:207], a[44:47], v[100:103]
v_mfma_f32_16x16x32_bf16 v[108:111], v[192:195], a[96:99], v[108:111]
v_mfma_f32_16x16x32_bf16 v[108:111], v[196:199], a[100:103], v[108:111]
v_mul_f32 v64, s68, v64
v_mfma_f32_16x16x32_bf16 v[108:111], v[200:203], a[104:107], v[108:111]
ds_read_b64_tr_b16 v[176:177], v241 offset:16384
v_mfma_f32_16x16x32_bf16 v[108:111], v[204:207], a[108:111], v[108:111]
ds_read_b64_tr_b16 v[178:179], v241 offset:16896
v_mul_f32 v65, s68, v65
v_mfma_f32_16x16x32_bf16 v[116:119], v[192:195], a[160:163], v[116:119]
ds_read_b64_tr_b16 v[180:181], v241 offset:20480
v_mfma_f32_16x16x32_bf16 v[116:119], v[196:199], a[164:167], v[116:119]
ds_read_b64_tr_b16 v[182:183], v241 offset:20992
v_mul_f32 v66, s68, v66
v_mfma_f32_16x16x32_bf16 v[116:119], v[200:203], a[168:171], v[116:119]
ds_read_b64_tr_b16 v[184:185], v241 offset:24576
v_mfma_f32_16x16x32_bf16 v[116:119], v[204:207], a[172:175], v[116:119]
ds_read_b64_tr_b16 v[186:187], v241 offset:25088
v_mul_f32 v67, s68, v67
v_mfma_f32_16x16x32_bf16 v[124:127], v[192:195], a[224:227], v[124:127]
ds_read_b64_tr_b16 v[188:189], v241 offset:28672
v_mfma_f32_16x16x32_bf16 v[124:127], v[196:199], a[228:231], v[124:127]
ds_read_b64_tr_b16 v[190:191], v241 offset:29184
v_cvt_pk_bf16_f32 v248, v64, v65
v_mfma_f32_16x16x32_bf16 v[124:127], v[200:203], a[232:235], v[124:127]
v_cvt_pk_bf16_f32 v249, v66, v67
v_mfma_f32_16x16x32_bf16 v[124:127], v[204:207], a[236:239], v[124:127]
v_mfma_f32_16x16x32_bf16 v[96:99], v[160:163], a[48:51], v[96:99]
v_mul_f32 v68, s68, v68
v_mfma_f32_16x16x32_bf16 v[96:99], v[164:167], a[52:55], v[96:99]
s_waitcnt lgkmcnt(3)
v_mfma_f32_16x16x32_bf16 v[96:99], v[168:171], a[56:59], v[96:99]
v_mul_f32 v69, s68, v69
v_mfma_f32_16x16x32_bf16 v[96:99], v[172:175], a[60:63], v[96:99]
v_mfma_f32_16x16x32_bf16 v[104:107], v[160:163], a[112:115], v[104:107]
v_mul_f32 v70, s68, v70
v_mfma_f32_16x16x32_bf16 v[104:107], v[164:167], a[116:119], v[104:107]
v_mfma_f32_16x16x32_bf16 v[104:107], v[168:171], a[120:123], v[104:107]
v_mul_f32 v71, s68, v71
v_mfma_f32_16x16x32_bf16 v[104:107], v[172:175], a[124:127], v[104:107]
v_cvt_pk_bf16_f32 v250, v68, v69
v_mfma_f32_16x16x32_bf16 v[112:115], v[160:163], a[176:179], v[112:115]
v_mfma_f32_16x16x32_bf16 v[112:115], v[164:167], a[180:183], v[112:115]
v_cvt_pk_bf16_f32 v251, v70, v71
v_mfma_f32_16x16x32_bf16 v[112:115], v[168:171], a[184:187], v[112:115]
v_mfma_f32_16x16x32_bf16 v[112:115], v[172:175], a[188:191], v[112:115]
s_add_u32 s72, s67, 0
v_mfma_f32_16x16x32_bf16 v[120:123], v[160:163], a[240:243], v[120:123]
buffer_store_dwordx4 v[248:251], v242, s[40:43], s72 offen offset:2048 sc1
v_mfma_f32_16x16x32_bf16 v[120:123], v[164:167], a[244:247], v[120:123]
v_mfma_f32_16x16x32_bf16 v[120:123], v[168:171], a[248:251], v[120:123]
v_mfma_f32_16x16x32_bf16 v[120:123], v[172:175], a[252:255], v[120:123]
s_waitcnt vmcnt(16)
s_barrier
s_cmp_lg_u32 s56, 0
s_cbranch_scc1 L_sig4
s_mov_b64 exec, 1
buffer_atomic_add v223, v222, s[48:51], s69 offen sc1
s_mov_b64 exec, -1
L_sig4:
v_mfma_f32_16x16x32_bf16 v[100:103], v[176:179], a[48:51], v[100:103]
s_add_u32 s3, s65, 8
v_add_u32 v240, 65536, v236
v_add_u32 v241, 65536, v237
v_mfma_f32_16x16x32_bf16 v[100:103], v[180:183], a[52:55], v[100:103]
s_waitcnt lgkmcnt(0)
ds_read_b64_tr_b16 v[192:193], v240 offset:0
v_mfma_f32_16x16x32_bf16 v[100:103], v[184:187], a[56:59], v[100:103]
ds_read_b64_tr_b16 v[194:195], v240 offset:512
s_and_b32 s3, s3, 15
v_mfma_f32_16x16x32_bf16 v[100:103], v[188:191], a[60:63], v[100:103]
ds_read_b64_tr_b16 v[196:197], v240 offset:4096
v_mul_f32 v72, s68, v72
v_mfma_f32_16x16x32_bf16 v[108:111], v[176:179], a[112:115], v[108:111]
ds_read_b64_tr_b16 v[198:199], v240 offset:4608
s_lshl_b32 s3, s3, 18
v_mfma_f32_16x16x32_bf16 v[108:111], v[180:183], a[116:119], v[108:111]
ds_read_b64_tr_b16 v[200:201], v240 offset:8192
v_mul_f32 v73, s68, v73
v_mfma_f32_16x16x32_bf16 v[108:111], v[184:187], a[120:123], v[108:111]
ds_read_b64_tr_b16 v[202:203], v240 offset:8704
s_add_u32 s3, s3, s62
v_mfma_f32_16x16x32_bf16 v[108:111], v[188:191], a[124:127], v[108:111]
ds_read_b64_tr_b16 v[204:205], v240 offset:12288
v_mul_f32 v74, s68, v74
v_mfma_f32_16x16x32_bf16 v[116:119], v[176:179], a[176:179], v[116:119]
ds_read_b64_tr_b16 v[206:207], v240 offset:12800
s_add_u32 m0, s66, 32768
v_mfma_f32_16x16x32_bf16 v[116:119], v[180:183], a[180:183], v[116:119]
s_add_u32 s74, s3, 128
v_mul_f32 v75, s68, v75
v_mfma_f32_16x16x32_bf16 v[116:119], v[184:187], a[184:187], v[116:119]
ds_read_b64_tr_b16 v[160:161], v241 offset:0
v_cvt_pk_bf16_f32 v252, v72, v73
v_mfma_f32_16x16x32_bf16 v[116:119], v[188:191], a[188:191], v[116:119]
buffer_load_dwordx4 v228, s[36:39], s74 offen offset:0 lds
v_mfma_f32_16x16x32_bf16 v[124:127], v[176:179], a[240:243], v[124:127]
ds_read_b64_tr_b16 v[162:163], v241 offset:512
v_cvt_pk_bf16_f32 v253, v74, v75
v_mfma_f32_16x16x32_bf16 v[124:127], v[180:183], a[244:247], v[124:127]
ds_read_b64_tr_b16 v[164:165], v241 offset:4096
v_mul_f32 v76, s68, v76
v_mfma_f32_16x16x32_bf16 v[124:127], v[184:187], a[248:251], v[124:127]
ds_read_b64_tr_b16 v[166:167], v241 offset:4608
v_mul_f32 v77, s68, v77
v_mfma_f32_16x16x32_bf16 v[124:127], v[188:191], a[252:255], v[124:127]
s_waitcnt lgkmcnt(4)
ds_read_b64_tr_b16 v[168:169], v241 offset:8192
v_mfma_f32_16x16x32_bf16 v[128:131], a[0:3], v[192:195], 0
ds_read_b64_tr_b16 v[170:171], v241 offset:8704
v_mul_f32 v78, s68, v78
v_mfma_f32_16x16x32_bf16 v[128:131], a[4:7], v[196:199], v[128:131]
ds_read_b64_tr_b16 v[172:173], v241 offset:12288
v_mul_f32 v79, s68, v79
v_mfma_f32_16x16x32_bf16 v[128:131], a[8:11], v[200:203], v[128:131]
ds_read_b64_tr_b16 v[174:175], v241 offset:12800
v_cvt_pk_bf16_f32 v254, v76, v77
v_mfma_f32_16x16x32_bf16 v[128:131], a[12:15], v[204:207], v[128:131]
buffer_load_dwordx4 v229, s[36:39], s74 offen offset:1024 lds
v_mfma_f32_16x16x32_bf16 v[136:139], a[64:67], v[192:195], 0
buffer_load_dwordx4 v230, s[36:39], s74 offen offset:2048 lds
v_mfma_f32_16x16x32_bf16 v[136:139], a[68:71], v[196:199], v[136:139]
v_cvt_pk_bf16_f32 v255, v78, v79
s_add_u32 s72, s67, 4096
v_mfma_f32_16x16x32_bf16 v[136:139], a[72:75], v[200:203], v[136:139]
ds_read_b64_tr_b16 v[176:177], v240 offset:16384
v_mfma_f32_16x16x32_bf16 v[136:139], a[76:79], v[204:207], v[136:139]
buffer_store_dwordx4 v[252:255], v242, s[40:43], s72 offen offset:2048 sc1
v_mfma_f32_16x16x32_bf16 v[144:147], a[128:131], v[192:195], 0
buffer_load_dwordx4 v231, s[36:39], s74 offen offset:3072 lds
v_mfma_f32_16x16x32_bf16 v[144:147], a[132:135], v[196:199], v[144:147]
ds_read_b64_tr_b16 v[178:179], v240 offset:16896
v_mfma_f32_16x16x32_bf16 v[144:147], a[136:139], v[200:203], v[144:147]
ds_read_b64_tr_b16 v[180:181], v240 offset:20480
v_mul_f32 v80, s68, v80
v_mfma_f32_16x16x32_bf16 v[144:147], a[140:143], v[204:207], v[144:147]
ds_read_b64_tr_b16 v[182:183], v240 offset:20992
v_mul_f32 v81, s68, v81
v_mfma_f32_16x16x32_bf16 v[152:155], a[192:195], v[192:195], 0
ds_read_b64_tr_b16 v[184:185], v240 offset:24576
s_add_u32 s3, s65, 12
v_mfma_f32_16x16x32_bf16 v[152:155], a[196:199], v[196:199], v[152:155]
ds_read_b64_tr_b16 v[186:187], v240 offset:25088
s_and_b32 s3, s3, 15
v_mfma_f32_16x16x32_bf16 v[152:155], a[200:203], v[200:203], v[152:155]
ds_read_b64_tr_b16 v[188:189], v240 offset:28672
v_mul_f32 v82, s68, v82
v_mfma_f32_16x16x32_bf16 v[152:155], a[204:207], v[204:207], v[152:155]
s_waitcnt lgkmcnt(6)
ds_read_b64_tr_b16 v[190:191], v240 offset:29184
v_mfma_f32_16x16x32_bf16 v[132:135], a[0:3], v[160:163], 0
s_lshl_b32 s3, s3, 18
v_mul_f32 v83, s68, v83
s_add_u32 s3, s3, s62
v_mfma_f32_16x16x32_bf16 v[132:135], a[4:7], v[164:167], v[132:135]
s_add_u32 m0, s66, 49152
v_cvt_pk_bf16_f32 v248, v80, v81
v_mfma_f32_16x16x32_bf16 v[132:135], a[8:11], v[168:171], v[132:135]
s_add_u32 s74, s3, 128
v_mfma_f32_16x16x32_bf16 v[132:135], a[12:15], v[172:175], v[132:135]
v_cvt_pk_bf16_f32 v249, v82, v83
v_mfma_f32_16x16x32_bf16 v[140:143], a[64:67], v[160:163], 0
buffer_load_dwordx4 v228, s[36:39], s74 offen offset:0 lds
v_mfma_f32_16x16x32_bf16 v[140:143], a[68:71], v[164:167], v[140:143]
v_mul_f32 v84, s68, v84
v_mfma_f32_16x16x32_bf16 v[140:143], a[72:75], v[168:171], v[140:143]
ds_read_b64_tr_b16 v[192:193], v241 offset:16384
v_mul_f32 v85, s68, v85
v_mfma_f32_16x16x32_bf16 v[140:143], a[76:79], v[172:175], v[140:143]
ds_read_b64_tr_b16 v[194:195], v241 offset:16896
v_mfma_f32_16x16x32_bf16 v[148:151], a[128:131], v[160:163], 0
s_barrier
ds_read_b64_tr_b16 v[196:197], v241 offset:20480
v_mfma_f32_16x16x32_bf16 v[148:151], a[132:135], v[164:167], v[148:151]
ds_read_b64_tr_b16 v[198:199], v241 offset:20992
v_mul_f32 v86, s68, v86
v_mfma_f32_16x16x32_bf16 v[148:151], a[136:139], v[168:171], v[148:151]
ds_read_b64_tr_b16 v[200:201], v241 offset:24576
v_mul_f32 v87, s68, v87
v_mfma_f32_16x16x32_bf16 v[148:151], a[140:143], v[172:175], v[148:151]
ds_read_b64_tr_b16 v[202:203], v241 offset:25088
v_mfma_f32_16x16x32_bf16 v[156:159], a[192:195], v[160:163], 0
buffer_load_dwordx4 v229, s[36:39], s74 offen offset:1024 lds
v_mfma_f32_16x16x32_bf16 v[156:159], a[196:199], v[164:167], v[156:159]
ds_read_b64_tr_b16 v[204:205], v241 offset:28672
v_cvt_pk_bf16_f32 v250, v84, v85
v_mfma_f32_16x16x32_bf16 v[156:159], a[200:203], v[168:171], v[156:159]
ds_read_b64_tr_b16 v[206:207], v241 offset:29184
v_cvt_pk_bf16_f32 v251, v86, v87
v_mfma_f32_16x16x32_bf16 v[156:159], a[204:207], v[172:175], v[156:159]
s_waitcnt lgkmcnt(5)
s_add_u32 s72, s67, 16384
v_mfma_f32_16x16x32_bf16 v[128:131], a[16:19], v[176:179], v[128:131]
buffer_load_dwordx4 v230, s[36:39], s74 offen offset:2048 lds
v_mfma_f32_16x16x32_bf16 v[128:131], a[20:23], v[180:183], v[128:131]
buffer_store_dwordx4 v[248:251], v242, s[40:43], s72 offen offset:2048 sc1
v_mfma_f32_16x16x32_bf16 v[128:131], a[24:27], v[184:187], v[128:131]
v_mfma_f32_16x16x32_bf16 v[128:131], a[28:31], v[188:191], v[128:131]
v_mfma_f32_16x16x32_bf16 v[136:139], a[80:83], v[176:179], v[136:139]
buffer_load_dwordx4 v231, s[36:39], s74 offen offset:3072 lds
v_mfma_f32_16x16x32_bf16 v[136:139], a[84:87], v[180:183], v[136:139]
v_mul_f32 v88, s68, v88
v_mfma_f32_16x16x32_bf16 v[136:139], a[88:91], v[184:187], v[136:139]
ds_read_b64_tr_b16 v[160:161], v240 offset:32768
v_mul_f32 v89, s68, v89
v_mfma_f32_16x16x32_bf16 v[136:139], a[92:95], v[188:191], v[136:139]
ds_read_b64_tr_b16 v[162:163], v240 offset:33280
v_mul_f32 v90, s68, v90
v_mfma_f32_16x16x32_bf16 v[144:147], a[144:147], v[176:179], v[144:147]
ds_read_b64_tr_b16 v[164:165], v240 offset:36864
v_mfma_f32_16x16x32_bf16 v[144:147], a[148:151], v[180:183], v[144:147]
ds_read_b64_tr_b16 v[166:167], v240 offset:37376
v_mul_f32 v91, s68, v91
v_mfma_f32_16x16x32_bf16 v[144:147], a[152:155], v[184:187], v[144:147]
ds_read_b64_tr_b16 v[168:169], v240 offset:40960
v_mfma_f32_16x16x32_bf16 v[144:147], a[156:159], v[188:191], v[144:147]
ds_read_b64_tr_b16 v[170:171], v240 offset:41472
v_cvt_pk_bf16_f32 v252, v88, v89
v_mfma_f32_16x16x32_bf16 v[152:155], a[208:211], v[176:179], v[152:155]
ds_read_b64_tr_b16 v[172:173], v240 offset:45056
v_mfma_f32_16x16x32_bf16 v[152:155], a[212:215], v[180:183], v[152:155]
ds_read_b64_tr_b16 v[174:175], v240 offset:45568
v_cvt_pk_bf16_f32 v253, v90, v91
v_mfma_f32_16x16x32_bf16 v[152:155], a[216:219], v[184:187], v[152:155]
v_mfma_f32_16x16x32_bf16 v[152:155], a[220:223], v[188:191], v[152:155]
v_mul_f32 v92, s68, v92
L_c560:
v_mfma_f32_16x16x32_bf16 v[132:135], a[16:19], v[192:195], v[132:135]
s_waitcnt lgkmcnt(4)
v_mul_f32 v93, s68, v93
v_mfma_f32_16x16x32_bf16 v[132:135], a[20:23], v[196:199], v[132:135]
s_mov_b32 s70, s56
s_lshl_b32 s71, s58, 3
s_sub_u32 s77, 120, s71
v_mfma_f32_16x16x32_bf16 v[132:135], a[24:27], v[200:203], v[132:135]
s_add_u32 s71, s71, s70
s_add_u32 s77, s77, s70
v_mul_f32 v94, s68, v94
v_mfma_f32_16x16x32_bf16 v[132:135], a[28:31], v[204:207], v[132:135]
s_add_u32 s79, s71, 0
s_lshl_b32 s79, s79, 14
v_mfma_f32_16x16x32_bf16 v[140:143], a[80:83], v[192:195], v[140:143]
v_add_u32 v224, s79, v242
v_mfma_f32_16x16x32_bf16 v[140:143], a[84:87], v[196:199], v[140:143]
v_mul_f32 v95, s68, v95
s_add_u32 s79, s71, 4
v_mfma_f32_16x16x32_bf16 v[140:143], a[88:91], v[200:203], v[140:143]
s_lshl_b32 s79, s79, 14
v_cvt_pk_bf16_f32 v254, v92, v93
v_mfma_f32_16x16x32_bf16 v[140:143], a[92:95], v[204:207], v[140:143]
ds_read_b64_tr_b16 v[176:177], v241 offset:32768
v_add_u32 v225, s79, v242
v_mfma_f32_16x16x32_bf16 v[148:151], a[144:147], v[192:195], v[148:151]
ds_read_b64_tr_b16 v[178:179], v241 offset:33280
v_cvt_pk_bf16_f32 v255, v94, v95
v_mfma_f32_16x16x32_bf16 v[148:151], a[148:151], v[196:199], v[148:151]
ds_read_b64_tr_b16 v[180:181], v241 offset:36864
s_add_u32 s79, s77, 0
v_mfma_f32_16x16x32_bf16 v[148:151], a[152:155], v[200:203], v[148:151]
ds_read_b64_tr_b16 v[182:183], v241 offset:37376
s_lshl_b32 s79, s79, 14
v_mfma_f32_16x16x32_bf16 v[148:151], a[156:159], v[204:207], v[148:151]
ds_read_b64_tr_b16 v[184:185], v241 offset:40960
v_add_u32 v226, s79, v242
v_mfma_f32_16x16x32_bf16 v[156:159], a[208:211], v[192:195], v[156:159]
ds_read_b64_tr_b16 v[186:187], v241 offset:41472
s_add_u32 s72, s67, 20480
v_mfma_f32_16x16x32_bf16 v[156:159], a[212:215], v[196:199], v[156:159]
ds_read_b64_tr_b16 v[188:189], v241 offset:45056
s_add_u32 s79, s77, 4
v_mfma_f32_16x16x32_bf16 v[156:159], a[216:219], v[200:203], v[156:159]
ds_read_b64_tr_b16 v[190:191], v241 offset:45568
s_lshl_b32 s79, s79, 14
v_mfma_f32_16x16x32_bf16 v[156:159], a[220:223], v[204:207], v[156:159]
buffer_store_dwordx4 v[252:255], v242, s[40:43], s72 offen offset:2048 sc1
v_mfma_f32_16x16x32_bf16 v[128:131], a[32:35], v[160:163], v[128:131]
v_add_u32 v227, s79, v242
s_mov_b32 s78, 8192
v_mfma_f32_16x16x32_bf16 v[128:131], a[36:39], v[164:167], v[128:131]
s_waitcnt lgkmcnt(4)
s_cmp_lt_u32 s56, 2
s_cselect_b32 s78, s78, 3584
v_mfma_f32_16x16x32_bf16 v[128:131], a[40:43], v[168:171], v[128:131]
s_lshl_b32 s79, s56, 7
v_mul_f32 v96, s68, v96
s_lshl_b32 s98, s57, 8
v_mfma_f32_16x16x32_bf16 v[128:131], a[44:47], v[172:175], v[128:131]
s_add_u32 s98, s98, s79
v_mul_f32 v97, s68, v97
s_lshl_b32 s79, s57, 7
v_mfma_f32_16x16x32_bf16 v[136:139], a[96:99], v[160:163], v[136:139]
s_cmp_lt_u32 s56, 2
s_cselect_b32 s98, s98, s79
v_mul_f32 v98, s68, v98
v_mfma_f32_16x16x32_bf16 v[136:139], a[100:103], v[164:167], v[136:139]
s_lshl_b32 s99, s78, 5
v_mul_f32 v99, s68, v99
s_lshl_b32 s100, s56, 13
v_mfma_f32_16x16x32_bf16 v[136:139], a[104:107], v[168:171], v[136:139]
ds_read_b64_tr_b16 v[192:193], v240 offset:49152
v_lshrrev_b32 v212, 3, v243
v_mfma_f32_16x16x32_bf16 v[136:139], a[108:111], v[172:175], v[136:139]
ds_read_b64_tr_b16 v[194:195], v240 offset:49664
v_cvt_pk_bf16_f32 v248, v96, v97
v_mfma_f32_16x16x32_bf16 v[144:147], a[160:163], v[160:163], v[144:147]
ds_read_b64_tr_b16 v[196:197], v240 offset:53248
v_mul_lo_u32 v213, v212, s78
v_mfma_f32_16x16x32_bf16 v[144:147], a[164:167], v[164:167], v[144:147]
ds_read_b64_tr_b16 v[198:199], v240 offset:53760
v_cvt_pk_bf16_f32 v249, v98, v99
v_mfma_f32_16x16x32_bf16 v[144:147], a[168:171], v[168:171], v[144:147]
ds_read_b64_tr_b16 v[200:201], v240 offset:57344
v_and_b32 v214, 1, v243
v_mfma_f32_16x16x32_bf16 v[144:147], a[172:175], v[172:175], v[144:147]
ds_read_b64_tr_b16 v[202:203], v240 offset:57856
v_lshl_add_u32 v213, v214, 4, v213
v_mfma_f32_16x16x32_bf16 v[152:155], a[224:227], v[160:163], v[152:155]
ds_read_b64_tr_b16 v[204:205], v240 offset:61440
v_mul_f32 v100, s68, v100
v_mfma_f32_16x16x32_bf16 v[152:155], a[228:231], v[164:167], v[152:155]
ds_read_b64_tr_b16 v[206:207], v240 offset:61952
v_bfe_u32 v212, v243, 4, 1
v_mfma_f32_16x16x32_bf16 v[152:155], a[232:235], v[168:171], v[152:155]
v_mul_f32 v101, s68, v101
v_mfma_f32_16x16x32_bf16 v[152:155], a[236:239], v[172:175], v[152:155]
v_bfe_u32 v214, v243, 1, 2
v_mfma_f32_16x16x32_bf16 v[132:135], a[32:35], v[176:179], v[132:135]
v_mul_f32 v102, s68, v102
v_xor_b32 v212, v212, v214
v_mfma_f32_16x16x32_bf16 v[132:135], a[36:39], v[180:183], v[132:135]
s_waitcnt lgkmcnt(3)
v_xor_b32 v214, 0, v212
v_mfma_f32_16x16x32_bf16 v[132:135], a[40:43], v[184:187], v[132:135]
v_mul_f32 v103, s68, v103
v_mfma_f32_16x16x32_bf16 v[132:135], a[44:47], v[188:191], v[132:135]
v_lshl_add_u32 v228, v214, 5, v213
v_mfma_f32_16x16x32_bf16 v[140:143], a[96:99], v[176:179], v[140:143]
v_cvt_pk_bf16_f32 v250, v100, v101
v_xor_b32 v214, 2, v212
v_mfma_f32_16x16x32_bf16 v[140:143], a[100:103], v[180:183], v[140:143]
v_cvt_pk_bf16_f32 v251, v102, v103
v_lshl_add_u32 v229, v214, 5, v213
v_mfma_f32_16x16x32_bf16 v[140:143], a[104:107], v[184:187], v[140:143]
s_mul_i32 s79, s78, 8
s_add_u32 s72, s67, 0
s_sub_u32 s79, s79, 1024
v_mfma_f32_16x16x32_bf16 v[140:143], a[108:111], v[188:191], v[140:143]
buffer_store_dwordx4 v[248:251], v242, s[40:43], s72 offen offset:3072 sc1
v_mfma_f32_16x16x32_bf16 v[148:151], a[160:163], v[176:179], v[148:151]
ds_read_b64_tr_b16 v[160:161], v241 offset:49152
v_add_u32 v229, s79, v229
v_mfma_f32_16x16x32_bf16 v[148:151], a[164:167], v[180:183], v[148:151]
ds_read_b64_tr_b16 v[162:163], v241 offset:49664
v_xor_b32 v214, 0, v212
v_mfma_f32_16x16x32_bf16 v[148:151], a[168:171], v[184:187], v[148:151]
ds_read_b64_tr_b16 v[164:165], v241 offset:53248
v_lshl_add_u32 v230, v214, 5, v213
v_mfma_f32_16x16x32_bf16 v[148:151], a[172:175], v[188:191], v[148:151]
ds_read_b64_tr_b16 v[166:167], v241 offset:53760
v_mul_f32 v104, s68, v104
v_mfma_f32_16x16x32_bf16 v[156:159], a[224:227], v[176:179], v[156:159]
ds_read_b64_tr_b16 v[168:169], v241 offset:57344
s_mul_i32 s79, s78, 16
v_mfma_f32_16x16x32_bf16 v[156:159], a[228:231], v[180:183], v[156:159]
ds_read_b64_tr_b16 v[170:171], v241 offset:57856
s_sub_u32 s79, s79, 2048
v_mfma_f32_16x16x32_bf16 v[156:159], a[232:235], v[184:187], v[156:159]
ds_read_b64_tr_b16 v[172:173], v241 offset:61440
v_mul_f32 v105, s68, v105
v_mfma_f32_16x16x32_bf16 v[156:159], a[236:239], v[188:191], v[156:159]
ds_read_b64_tr_b16 v[174:175], v241 offset:61952
v_add_u32 v230, s79, v230
v_mfma_f32_16x16x32_bf16 v[128:131], a[48:51], v[192:195], v[128:131]
v_xor_b32 v214, 2, v212
v_mul_f32 v106, s68, v106
v_mfma_f32_16x16x32_bf16 v[128:131], a[52:55], v[196:199], v[128:131]
s_waitcnt lgkmcnt(5)
v_lshl_add_u32 v231, v214, 5, v213
v_mul_f32 v107, s68, v107
s_lshr_b32 s0, s2, 3
s_cmp_lg_u32 s0, 6
s_cbranch_scc1 L_ct12
s_lshl_b32 s0, s56, 13
v_lshl_add_u32 v246, v243, 7, s0
v_min_u32 v246, 8192-4, v246
s_getpc_b64 s[0:1]
L_cp12:
s_add_u32 s0, s0, L_c860-L_cp12
s_addc_u32 s1, s1, 0
global_load_dword v247, v246, s[0:1]
L_ct12:
v_mfma_f32_16x16x32_bf16 v[128:131], a[56:59], v[200:203], v[128:131]
s_mul_i32 s79, s78, 24
s_sub_u32 s79, s79, 3072
v_cvt_pk_bf16_f32 v252, v104, v105
v_mfma_f32_16x16x32_bf16 v[128:131], a[60:63], v[204:207], v[128:131]
v_add_u32 v231, s79, v231
v_mfma_f32_16x16x32_bf16 v[136:139], a[112:115], v[192:195], v[136:139]
v_add_u32 v232, 0x10000, v236
v_mfma_f32_16x16x32_bf16 v[136:139], a[116:119], v[196:199], v[136:139]
v_cvt_pk_bf16_f32 v253, v106, v107
v_mfma_f32_16x16x32_bf16 v[136:139], a[120:123], v[200:203], v[136:139]
v_add_u32 v208, 0x20000, v236
v_mul_f32 v108, s68, v108
v_mfma_f32_16x16x32_bf16 v[136:139], a[124:127], v[204:207], v[136:139]
v_add_u32 v233, 0x10000, v237
v_mfma_f32_16x16x32_bf16 v[144:147], a[176:179], v[192:195], v[144:147]
v_mul_f32 v109, s68, v109
v_add_u32 v209, 0x20000, v237
v_mfma_f32_16x16x32_bf16 v[144:147], a[180:183], v[196:199], v[144:147]
v_add_u32 v240, 65536, v238
v_add_u32 v241, 65536, v239
v_mfma_f32_16x16x32_bf16 v[144:147], a[184:187], v[200:203], v[144:147]
ds_read_b64_tr_b16 v[176:177], v240 offset:0
v_add_u32 v234, 0x10000, v238
v_mfma_f32_16x16x32_bf16 v[144:147], a[188:191], v[204:207], v[144:147]
ds_read_b64_tr_b16 v[178:179], v240 offset:512
v_mul_f32 v110, s68, v110
v_mfma_f32_16x16x32_bf16 v[152:155], a[240:243], v[192:195], v[152:155]
ds_read_b64_tr_b16 v[180:181], v240 offset:4096
v_add_u32 v210, 0x20000, v238
v_mfma_f32_16x16x32_bf16 v[152:155], a[244:247], v[196:199], v[152:155]
ds_read_b64_tr_b16 v[182:183], v240 offset:4608
v_mul_f32 v111, s68, v111
v_mfma_f32_16x16x32_bf16 v[152:155], a[248:251], v[200:203], v[152:155]
ds_read_b64_tr_b16 v[184:185], v240 offset:8192
v_add_u32 v235, 0x10000, v239
v_mfma_f32_16x16x32_bf16 v[152:155], a[252:255], v[204:207], v[152:155]
ds_read_b64_tr_b16 v[186:187], v240 offset:8704
v_cvt_pk_bf16_f32 v254, v108, v109
v_mfma_f32_16x16x32_bf16 v[132:135], a[48:51], v[160:163], v[132:135]
s_waitcnt lgkmcnt(6)
ds_read_b64_tr_b16 v[188:189], v240 offset:12288
v_add_u32 v211, 0x20000, v239
v_mfma_f32_16x16x32_bf16 v[132:135], a[52:55], v[164:167], v[132:135]
ds_read_b64_tr_b16 v[190:191], v240 offset:12800
v_cvt_pk_bf16_f32 v255, v110, v111
v_mfma_f32_16x16x32_bf16 v[132:135], a[56:59], v[168:171], v[132:135]
s_cmp_eq_u32 s56, 2
s_cselect_b64 s[28:29], s[16:17], s[18:19]
s_add_u32 s72, s67, 4096
v_mfma_f32_16x16x32_bf16 v[132:135], a[60:63], v[172:175], v[132:135]
s_cmp_lt_u32 s56, 2
s_cselect_b64 s[28:29], s[8:9], s[28:29]
v_mfma_f32_16x16x32_bf16 v[140:143], a[112:115], v[160:163], v[140:143]
s_cmp_lt_u32 s57, 28
s_cselect_b32 s30, 1835008, 0
v_mfma_f32_16x16x32_bf16 v[140:143], a[116:119], v[164:167], v[140:143]
buffer_store_dwordx4 v[252:255], v242, s[40:43], s72 offen offset:3072 sc1
v_mfma_f32_16x16x32_bf16 v[140:143], a[120:123], v[168:171], v[140:143]
s_cmp_lt_u32 s56, 2
s_cselect_b32 s30, 4194304, s30
v_mul_f32 v112, s68, v112
v_mfma_f32_16x16x32_bf16 v[140:143], a[124:127], v[172:175], v[140:143]
s_add_u32 s32, s26, 0
s_addc_u32 s33, s27, 0
s_mov_b32 s34, 2097152
v_mfma_f32_16x16x32_bf16 v[148:151], a[176:179], v[160:163], v[148:151]
s_mov_b32 s35, 0x20000
s_lshl_b32 s70, s58, 7
v_mul_f32 v113, s68, v113
v_mfma_f32_16x16x32_bf16 v[148:151], a[180:183], v[164:167], v[148:151]
s_sub_u32 s71, 1920, s70
v_mul_f32 v114, s68, v114
v_mfma_f32_16x16x32_bf16 v[148:151], a[184:187], v[168:171], v[148:151]
ds_read_b64_tr_b16 v[192:193], v241 offset:0
v_mul_f32 v115, s68, v115
v_mfma_f32_16x16x32_bf16 v[148:151], a[188:191], v[172:175], v[148:151]
ds_read_b64_tr_b16 v[194:195], v241 offset:512
v_cvt_pk_bf16_f32 v248, v112, v113
v_mfma_f32_16x16x32_bf16 v[156:159], a[240:243], v[160:163], v[156:159]
ds_read_b64_tr_b16 v[196:197], v241 offset:4096
v_cvt_pk_bf16_f32 v249, v114, v115
v_mfma_f32_16x16x32_bf16 v[156:159], a[244:247], v[164:167], v[156:159]
ds_read_b64_tr_b16 v[198:199], v241 offset:4608
v_mul_f32 v116, s68, v116
v_mfma_f32_16x16x32_bf16 v[156:159], a[248:251], v[168:171], v[156:159]
ds_read_b64_tr_b16 v[200:201], v241 offset:8192
ds_read_b64_tr_b16 v[202:203], v241 offset:8704
v_mfma_f32_16x16x32_bf16 v[156:159], a[252:255], v[172:175], v[156:159]
s_waitcnt lgkmcnt(6)
ds_read_b64_tr_b16 v[204:205], v241 offset:12288
v_mfma_f32_16x16x32_bf16 v[64:67], a[0:3], v[176:179], 0
ds_read_b64_tr_b16 v[206:207], v241 offset:12800
v_mul_f32 v117, s68, v117
v_mfma_f32_16x16x32_bf16 v[64:67], a[4:7], v[180:183], v[64:67]
s_add_u32 m0, s100, 131072
s_nop 0
v_mul_f32 v118, s68, v118
v_mfma_f32_16x16x32_bf16 v[64:67], a[8:11], v[184:187], v[64:67]
buffer_load_dwordx4 v228, s[28:31], s98 offen offset:0 lds
v_mfma_f32_16x16x32_bf16 v[64:67], a[12:15], v[188:191], v[64:67]
v_mul_f32 v119, s68, v119
v_mfma_f32_16x16x32_bf16 v[72:75], a[64:67], v[176:179], 0
buffer_load_dwordx4 v229, s[28:31], s98 offen offset:1024 lds
v_mfma_f32_16x16x32_bf16 v[72:75], a[68:71], v[180:183], v[72:75]
v_cvt_pk_bf16_f32 v250, v116, v117
v_mfma_f32_16x16x32_bf16 v[72:75], a[72:75], v[184:187], v[72:75]
ds_read_b64_tr_b16 v[160:161], v240 offset:16384
v_cvt_pk_bf16_f32 v251, v118, v119
v_mfma_f32_16x16x32_bf16 v[72:75], a[76:79], v[188:191], v[72:75]
ds_read_b64_tr_b16 v[162:163], v240 offset:16896
v_mfma_f32_16x16x32_bf16 v[80:83], a[128:131], v[176:179], 0
ds_read_b64_tr_b16 v[164:165], v240 offset:20480
s_add_u32 s72, s67, 16384
v_mfma_f32_16x16x32_bf16 v[80:83], a[132:135], v[180:183], v[80:83]
buffer_load_dwordx4 v230, s[28:31], s98 offen offset:2048 lds
v_mfma_f32_16x16x32_bf16 v[80:83], a[136:139], v[184:187], v[80:83]
ds_read_b64_tr_b16 v[166:167], v240 offset:20992
v_mfma_f32_16x16x32_bf16 v[80:83], a[140:143], v[188:191], v[80:83]
ds_read_b64_tr_b16 v[168:169], v240 offset:24576
v_mfma_f32_16x16x32_bf16 v[88:91], a[192:195], v[176:179], 0
ds_read_b64_tr_b16 v[170:171], v240 offset:25088
v_mfma_f32_16x16x32_bf16 v[88:91], a[196:199], v[180:183], v[88:91]
buffer_store_dwordx4 v[248:251], v242, s[40:43], s72 offen offset:3072 sc1
v_mfma_f32_16x16x32_bf16 v[88:91], a[200:203], v[184:187], v[88:91]
ds_read_b64_tr_b16 v[172:173], v240 offset:28672
v_mul_f32 v120, s68, v120
v_mfma_f32_16x16x32_bf16 v[88:91], a[204:207], v[188:191], v[88:91]
s_waitcnt lgkmcnt(4)
ds_read_b64_tr_b16 v[174:175], v240 offset:29184
v_mfma_f32_16x16x32_bf16 v[68:71], a[0:3], v[192:195], 0
buffer_load_dwordx4 v231, s[28:31], s98 offen offset:3072 lds
v_mfma_f32_16x16x32_bf16 v[68:71], a[4:7], v[196:199], v[68:71]
s_add_u32 m0, s100, 135168
v_mul_f32 v121, s68, v121
s_add_u32 s98, s98, s99
v_mfma_f32_16x16x32_bf16 v[68:71], a[8:11], v[200:203], v[68:71]
buffer_load_dwordx4 v228, s[28:31], s98 offen offset:0 lds
v_mfma_f32_16x16x32_bf16 v[68:71], a[12:15], v[204:207], v[68:71]
v_mul_f32 v122, s68, v122
v_mfma_f32_16x16x32_bf16 v[76:79], a[64:67], v[192:195], 0
v_mul_f32 v123, s68, v123
v_mfma_f32_16x16x32_bf16 v[76:79], a[68:71], v[196:199], v[76:79]
buffer_load_dwordx4 v229, s[28:31], s98 offen offset:1024 lds
v_mfma_f32_16x16x32_bf16 v[76:79], a[72:75], v[200:203], v[76:79]
ds_read_b64_tr_b16 v[176:177], v241 offset:16384
v_cvt_pk_bf16_f32 v252, v120, v121
v_mfma_f32_16x16x32_bf16 v[76:79], a[76:79], v[204:207], v[76:79]
ds_read_b64_tr_b16 v[178:179], v241 offset:16896
v_cvt_pk_bf16_f32 v253, v122, v123
v_mfma_f32_16x16x32_bf16 v[84:87], a[128:131], v[192:195], 0
buffer_load_dwordx4 v230, s[28:31], s98 offen offset:2048 lds
v_mfma_f32_16x16x32_bf16 v[84:87], a[132:135], v[196:199], v[84:87]
ds_read_b64_tr_b16 v[180:181], v241 offset:20480
v_mul_f32 v124, s68, v124
v_mfma_f32_16x16x32_bf16 v[84:87], a[136:139], v[200:203], v[84:87]
ds_read_b64_tr_b16 v[182:183], v241 offset:20992
v_mul_f32 v125, s68, v125
v_mfma_f32_16x16x32_bf16 v[84:87], a[140:143], v[204:207], v[84:87]
ds_read_b64_tr_b16 v[184:185], v241 offset:24576
v_mul_f32 v126, s68, v126
v_mfma_f32_16x16x32_bf16 v[92:95], a[192:195], v[192:195], 0
ds_read_b64_tr_b16 v[186:187], v241 offset:25088
v_mfma_f32_16x16x32_bf16 v[92:95], a[196:199], v[196:199], v[92:95]
ds_read_b64_tr_b16 v[188:189], v241 offset:28672
v_mul_f32 v127, s68, v127
v_mfma_f32_16x16x32_bf16 v[92:95], a[200:203], v[200:203], v[92:95]
ds_read_b64_tr_b16 v[190:191], v241 offset:29184
v_mfma_f32_16x16x32_bf16 v[92:95], a[204:207], v[204:207], v[92:95]
buffer_load_dwordx4 v231, s[28:31], s98 offen offset:3072 lds
v_mfma_f32_16x16x32_bf16 v[64:67], a[16:19], v[160:163], v[64:67]
s_waitcnt lgkmcnt(5)
v_cvt_pk_bf16_f32 v254, v124, v125
v_mfma_f32_16x16x32_bf16 v[64:67], a[20:23], v[164:167], v[64:67]
v_cvt_pk_bf16_f32 v255, v126, v127
v_mfma_f32_16x16x32_bf16 v[64:67], a[24:27], v[168:171], v[64:67]
s_add_u32 s72, s67, 20480
v_mfma_f32_16x16x32_bf16 v[64:67], a[28:31], v[172:175], v[64:67]
buffer_store_dwordx4 v[252:255], v242, s[40:43], s72 offen offset:3072 sc1
v_mfma_f32_16x16x32_bf16 v[72:75], a[80:83], v[160:163], v[72:75]
v_mfma_f32_16x16x32_bf16 v[72:75], a[84:87], v[164:167], v[72:75]
v_mfma_f32_16x16x32_bf16 v[72:75], a[88:91], v[168:171], v[72:75]
ds_read_b64_tr_b16 v[192:193], v240 offset:32768
v_mfma_f32_16x16x32_bf16 v[72:75], a[92:95], v[172:175], v[72:75]
ds_read_b64_tr_b16 v[194:195], v240 offset:33280
s_add_u32 s72, s67, 8192
v_mfma_f32_16x16x32_bf16 v[80:83], a[144:147], v[160:163], v[80:83]
ds_read_b64_tr_b16 v[196:197], v240 offset:36864
v_mfma_f32_16x16x32_bf16 v[80:83], a[148:151], v[164:167], v[80:83]
ds_read_b64_tr_b16 v[198:199], v240 offset:37376
v_cvt_pk_bf16_f32 v248, v128, v129
v_mfma_f32_16x16x32_bf16 v[80:83], a[152:155], v[168:171], v[80:83]
ds_read_b64_tr_b16 v[200:201], v240 offset:40960
v_mfma_f32_16x16x32_bf16 v[80:83], a[156:159], v[172:175], v[80:83]
ds_read_b64_tr_b16 v[202:203], v240 offset:41472
v_mfma_f32_16x16x32_bf16 v[88:91], a[208:211], v[160:163], v[88:91]
ds_read_b64_tr_b16 v[204:205], v240 offset:45056
v_mfma_f32_16x16x32_bf16 v[88:91], a[212:215], v[164:167], v[88:91]
ds_read_b64_tr_b16 v[206:207], v240 offset:45568
v_cvt_pk_bf16_f32 v249, v130, v131
v_mfma_f32_16x16x32_bf16 v[88:91], a[216:219], v[168:171], v[88:91]
v_mfma_f32_16x16x32_bf16 v[88:91], a[220:223], v[172:175], v[88:91]
v_mfma_f32_16x16x32_bf16 v[68:71], a[16:19], v[176:179], v[68:71]
s_waitcnt lgkmcnt(4)
v_mfma_f32_16x16x32_bf16 v[68:71], a[20:23], v[180:183], v[68:71]
v_cvt_pk_bf16_f32 v250, v136, v137
v_mfma_f32_16x16x32_bf16 v[68:71], a[24:27], v[184:187], v[68:71]
v_mfma_f32_16x16x32_bf16 v[68:71], a[28:31], v[188:191], v[68:71]
v_mfma_f32_16x16x32_bf16 v[76:79], a[80:83], v[176:179], v[76:79]
v_mfma_f32_16x16x32_bf16 v[76:79], a[84:87], v[180:183], v[76:79]
v_cvt_pk_bf16_f32 v251, v138, v139
v_mfma_f32_16x16x32_bf16 v[76:79], a[88:91], v[184:187], v[76:79]
ds_read_b64_tr_b16 v[160:161], v241 offset:32768
v_mfma_f32_16x16x32_bf16 v[76:79], a[92:95], v[188:191], v[76:79]
ds_read_b64_tr_b16 v[162:163], v241 offset:33280
v_mfma_f32_16x16x32_bf16 v[84:87], a[144:147], v[176:179], v[84:87]
ds_read_b64_tr_b16 v[164:165], v241 offset:36864
v_mfma_f32_16x16x32_bf16 v[84:87], a[148:151], v[180:183], v[84:87]
ds_read_b64_tr_b16 v[166:167], v241 offset:37376
v_mfma_f32_16x16x32_bf16 v[84:87], a[152:155], v[184:187], v[84:87]
ds_read_b64_tr_b16 v[168:169], v241 offset:40960
v_mfma_f32_16x16x32_bf16 v[84:87], a[156:159], v[188:191], v[84:87]
ds_read_b64_tr_b16 v[170:171], v241 offset:41472
v_mfma_f32_16x16x32_bf16 v[92:95], a[208:211], v[176:179], v[92:95]
ds_read_b64_tr_b16 v[172:173], v241 offset:45056
v_mfma_f32_16x16x32_bf16 v[92:95], a[212:215], v[180:183], v[92:95]
ds_read_b64_tr_b16 v[174:175], v241 offset:45568
v_mfma_f32_16x16x32_bf16 v[92:95], a[216:219], v[184:187], v[92:95]
buffer_store_dwordx4 v[248:251], v242, s[40:43], s72 offen offset:0 sc1
v_mfma_f32_16x16x32_bf16 v[92:95], a[220:223], v[188:191], v[92:95]
v_mfma_f32_16x16x32_bf16 v[64:67], a[32:35], v[192:195], v[64:67]
v_mfma_f32_16x16x32_bf16 v[64:67], a[36:39], v[196:199], v[64:67]
s_waitcnt lgkmcnt(3)
v_mfma_f32_16x16x32_bf16 v[64:67], a[40:43], v[200:203], v[64:67]
v_cvt_pk_bf16_f32 v252, v132, v133
v_mfma_f32_16x16x32_bf16 v[64:67], a[44:47], v[204:207], v[64:67]
v_mfma_f32_16x16x32_bf16 v[72:75], a[96:99], v[192:195], v[72:75]
v_mfma_f32_16x16x32_bf16 v[72:75], a[100:103], v[196:199], v[72:75]
v_mfma_f32_16x16x32_bf16 v[72:75], a[104:107], v[200:203], v[72:75]
ds_read_b64_tr_b16 v[176:177], v240 offset:49152
v_cvt_pk_bf16_f32 v253, v134, v135
v_mfma_f32_16x16x32_bf16 v[72:75], a[108:111], v[204:207], v[72:75]
ds_read_b64_tr_b16 v[178:179], v240 offset:49664
v_mfma_f32_16x16x32_bf16 v[80:83], a[160:163], v[192:195], v[80:83]
ds_read_b64_tr_b16 v[180:181], v240 offset:53248
v_mfma_f32_16x16x32_bf16 v[80:83], a[164:167], v[196:199], v[80:83]
ds_read_b64_tr_b16 v[182:183], v240 offset:53760
v_mfma_f32_16x16x32_bf16 v[80:83], a[168:171], v[200:203], v[80:83]
ds_read_b64_tr_b16 v[184:185], v240 offset:57344
v_cvt_pk_bf16_f32 v254, v140, v141
v_mfma_f32_16x16x32_bf16 v[80:83], a[172:175], v[204:207], v[80:83]
ds_read_b64_tr_b16 v[186:187], v240 offset:57856
v_mfma_f32_16x16x32_bf16 v[88:91], a[224:227], v[192:195], v[88:91]
ds_read_b64_tr_b16 v[188:189], v240 offset:61440
v_mfma_f32_16x16x32_bf16 v[88:91], a[228:231], v[196:199], v[88:91]
ds_read_b64_tr_b16 v[190:191], v240 offset:61952
v_mfma_f32_16x16x32_bf16 v[88:91], a[232:235], v[200:203], v[88:91]
v_cvt_pk_bf16_f32 v255, v142, v143
v_mfma_f32_16x16x32_bf16 v[88:91], a[236:239], v[204:207], v[88:91]
v_mfma_f32_16x16x32_bf16 v[68:71], a[32:35], v[160:163], v[68:71]
v_mfma_f32_16x16x32_bf16 v[68:71], a[36:39], v[164:167], v[68:71]
s_waitcnt lgkmcnt(3)
v_mfma_f32_16x16x32_bf16 v[68:71], a[40:43], v[168:171], v[68:71]
v_mfma_f32_16x16x32_bf16 v[68:71], a[44:47], v[172:175], v[68:71]
buffer_store_dwordx4 v[252:255], v242, s[40:43], s72 offen offset:1024 sc1
v_mfma_f32_16x16x32_bf16 v[76:79], a[96:99], v[160:163], v[76:79]
v_mfma_f32_16x16x32_bf16 v[76:79], a[100:103], v[164:167], v[76:79]
v_mfma_f32_16x16x32_bf16 v[76:79], a[104:107], v[168:171], v[76:79]
ds_read_b64_tr_b16 v[192:193], v241 offset:49152
v_mfma_f32_16x16x32_bf16 v[76:79], a[108:111], v[172:175], v[76:79]
ds_read_b64_tr_b16 v[194:195], v241 offset:49664
v_mfma_f32_16x16x32_bf16 v[84:87], a[160:163], v[160:163], v[84:87]
ds_read_b64_tr_b16 v[196:197], v241 offset:53248
v_mfma_f32_16x16x32_bf16 v[84:87], a[164:167], v[164:167], v[84:87]
ds_read_b64_tr_b16 v[198:199], v241 offset:53760
v_mfma_f32_16x16x32_bf16 v[84:87], a[168:171], v[168:171], v[84:87]
ds_read_b64_tr_b16 v[200:201], v241 offset:57344
v_mfma_f32_16x16x32_bf16 v[84:87], a[172:175], v[172:175], v[84:87]
ds_read_b64_tr_b16 v[202:203], v241 offset:57856
s_add_u32 s72, s67, 24576
v_mfma_f32_16x16x32_bf16 v[92:95], a[224:227], v[160:163], v[92:95]
ds_read_b64_tr_b16 v[204:205], v241 offset:61440
v_mfma_f32_16x16x32_bf16 v[92:95], a[228:231], v[164:167], v[92:95]
ds_read_b64_tr_b16 v[206:207], v241 offset:61952
v_cvt_pk_bf16_f32 v248, v144, v145
v_mfma_f32_16x16x32_bf16 v[92:95], a[232:235], v[168:171], v[92:95]
v_mfma_f32_16x16x32_bf16 v[92:95], a[236:239], v[172:175], v[92:95]
v_mfma_f32_16x16x32_bf16 v[64:67], a[48:51], v[176:179], v[64:67]
v_mfma_f32_16x16x32_bf16 v[64:67], a[52:55], v[180:183], v[64:67]
s_waitcnt lgkmcnt(3)
v_cvt_pk_bf16_f32 v249, v146, v147
v_mfma_f32_16x16x32_bf16 v[64:67], a[56:59], v[184:187], v[64:67]
v_mfma_f32_16x16x32_bf16 v[64:67], a[60:63], v[188:191], v[64:67]
v_mfma_f32_16x16x32_bf16 v[72:75], a[112:115], v[176:179], v[72:75]
v_mfma_f32_16x16x32_bf16 v[72:75], a[116:119], v[180:183], v[72:75]
v_cvt_pk_bf16_f32 v250, v152, v153
v_mfma_f32_16x16x32_bf16 v[72:75], a[120:123], v[184:187], v[72:75]
v_mfma_f32_16x16x32_bf16 v[72:75], a[124:127], v[188:191], v[72:75]
v_mfma_f32_16x16x32_bf16 v[80:83], a[176:179], v[176:179], v[80:83]
v_mfma_f32_16x16x32_bf16 v[80:83], a[180:183], v[180:183], v[80:83]
v_mfma_f32_16x16x32_bf16 v[80:83], a[184:187], v[184:187], v[80:83]
v_cvt_pk_bf16_f32 v251, v154, v155
v_mfma_f32_16x16x32_bf16 v[80:83], a[188:191], v[188:191], v[80:83]
v_mfma_f32_16x16x32_bf16 v[88:91], a[240:243], v[176:179], v[88:91]
v_mfma_f32_16x16x32_bf16 v[88:91], a[244:247], v[180:183], v[88:91]
v_mfma_f32_16x16x32_bf16 v[88:91], a[248:251], v[184:187], v[88:91]
buffer_store_dwordx4 v[248:251], v242, s[40:43], s72 offen offset:0 sc1
v_mfma_f32_16x16x32_bf16 v[88:91], a[252:255], v[188:191], v[88:91]
s_waitcnt vmcnt(16)
s_barrier
v_mfma_f32_16x16x32_bf16 v[68:71], a[48:51], v[192:195], v[68:71]
ds_read_b64_tr_b16 v[160:161], v236 offset:0
v_mfma_f32_16x16x32_bf16 v[68:71], a[52:55], v[196:199], v[68:71]
s_waitcnt lgkmcnt(1)
ds_read_b64_tr_b16 v[162:163], v236 offset:512
v_mfma_f32_16x16x32_bf16 v[68:71], a[56:59], v[200:203], v[68:71]
ds_read_b64_tr_b16 v[164:165], v236 offset:4096
ds_read_b64_tr_b16 v[166:167], v236 offset:4608
v_mfma_f32_16x16x32_bf16 v[68:71], a[60:63], v[204:207], v[68:71]
ds_read_b64_tr_b16 v[168:169], v236 offset:8192
ds_read_b64_tr_b16 v[170:171], v236 offset:8704
v_mfma_f32_16x16x32_bf16 v[76:79], a[112:115], v[192:195], v[76:79]
ds_read_b64_tr_b16 v[172:173], v236 offset:12288
ds_read_b64_tr_b16 v[174:175], v236 offset:12800
v_mfma_f32_16x16x32_bf16 v[76:79], a[116:119], v[196:199], v[76:79]
v_mfma_f32_16x16x32_bf16 v[76:79], a[120:123], v[200:203], v[76:79]
ds_read_b64_tr_b16 v[176:177], v237 offset:0
v_cvt_pk_bf16_f32 v252, v148, v149
v_mfma_f32_16x16x32_bf16 v[76:79], a[124:127], v[204:207], v[76:79]
ds_read_b64_tr_b16 v[178:179], v237 offset:512
v_mfma_f32_16x16x32_bf16 v[84:87], a[176:179], v[192:195], v[84:87]
ds_read_b64_tr_b16 v[180:181], v237 offset:4096
v_mfma_f32_16x16x32_bf16 v[84:87], a[180:183], v[196:199], v[84:87]
ds_read_b64_tr_b16 v[182:183], v237 offset:4608
v_mfma_f32_16x16x32_bf16 v[84:87], a[184:187], v[200:203], v[84:87]
ds_read_b64_tr_b16 v[184:185], v237 offset:8192
v_cvt_pk_bf16_f32 v253, v150, v151
v_mfma_f32_16x16x32_bf16 v[84:87], a[188:191], v[204:207], v[84:87]
ds_read_b64_tr_b16 v[186:187], v237 offset:8704
v_mfma_f32_16x16x32_bf16 v[92:95], a[240:243], v[192:195], v[92:95]
ds_read_b64_tr_b16 v[188:189], v237 offset:12288
v_mfma_f32_16x16x32_bf16 v[92:95], a[244:247], v[196:199], v[92:95]
ds_read_b64_tr_b16 v[190:191], v237 offset:12800
v_mfma_f32_16x16x32_bf16 v[92:95], a[248:251], v[200:203], v[92:95]
v_mfma_f32_16x16x32_bf16 v[92:95], a[252:255], v[204:207], v[92:95]
s_waitcnt lgkmcnt(5)
v_cvt_pk_bf16_f32 v254, v156, v157
v_mfma_f32_16x16x32_bf16 v[96:99], a[0:3], v[160:163], 0
v_mfma_f32_16x16x32_bf16 v[96:99], a[4:7], v[164:167], v[96:99]
v_mfma_f32_16x16x32_bf16 v[96:99], a[8:11], v[168:171], v[96:99]
v_mfma_f32_16x16x32_bf16 v[96:99], a[12:15], v[172:175], v[96:99]
v_cvt_pk_bf16_f32 v255, v158, v159
v_mfma_f32_16x16x32_bf16 v[104:107], a[64:67], v[160:163], 0
v_mfma_f32_16x16x32_bf16 v[104:107], a[68:71], v[164:167], v[104:107]
v_mfma_f32_16x16x32_bf16 v[104:107], a[72:75], v[168:171], v[104:107]
ds_read_b64_tr_b16 v[192:193], v236 offset:16384
v_mfma_f32_16x16x32_bf16 v[104:107], a[76:79], v[172:175], v[104:107]
ds_read_b64_tr_b16 v[194:195], v236 offset:16896
v_mfma_f32_16x16x32_bf16 v[112:115], a[128:131], v[160:163], 0
buffer_store_dwordx4 v[252:255], v242, s[40:43], s72 offen offset:1024 sc1
v_mfma_f32_16x16x32_bf16 v[112:115], a[132:135], v[164:167], v[112:115]
ds_read_b64_tr_b16 v[196:197], v236 offset:20480
v_mfma_f32_16x16x32_bf16 v[112:115], a[136:139], v[168:171], v[112:115]
ds_read_b64_tr_b16 v[198:199], v236 offset:20992
v_mfma_f32_16x16x32_bf16 v[112:115], a[140:143], v[172:175], v[112:115]
ds_read_b64_tr_b16 v[200:201], v236 offset:24576
v_mfma_f32_16x16x32_bf16 v[120:123], a[192:195], v[160:163], 0
ds_read_b64_tr_b16 v[202:203], v236 offset:25088
v_mfma_f32_16x16x32_bf16 v[120:123], a[196:199], v[164:167], v[120:123]
ds_read_b64_tr_b16 v[204:205], v236 offset:28672
v_mfma_f32_16x16x32_bf16 v[120:123], a[200:203], v[168:171], v[120:123]
ds_read_b64_tr_b16 v[206:207], v236 offset:29184
v_mfma_f32_16x16x32_bf16 v[120:123], a[204:207], v[172:175], v[120:123]
s_add_u32 s72, s67, 8192
v_mfma_f32_16x16x32_bf16 v[100:103], a[0:3], v[176:179], 0
s_waitcnt lgkmcnt(5)
v_mfma_f32_16x16x32_bf16 v[100:103], a[4:7], v[180:183], v[100:103]
v_cvt_pk_bf16_f32 v248, v64, v65
v_mfma_f32_16x16x32_bf16 v[100:103], a[8:11], v[184:187], v[100:103]
v_mfma_f32_16x16x32_bf16 v[100:103], a[12:15], v[188:191], v[100:103]
v_mfma_f32_16x16x32_bf16 v[108:111], a[64:67], v[176:179], 0
v_mfma_f32_16x16x32_bf16 v[108:111], a[68:71], v[180:183], v[108:111]
v_mfma_f32_16x16x32_bf16 v[108:111], a[72:75], v[184:187], v[108:111]
ds_read_b64_tr_b16 v[160:161], v237 offset:16384
v_cvt_pk_bf16_f32 v249, v66, v67
v_mfma_f32_16x16x32_bf16 v[108:111], a[76:79], v[188:191], v[108:111]
ds_read_b64_tr_b16 v[162:163], v237 offset:16896
v_mfma_f32_16x16x32_bf16 v[116:119], a[128:131], v[176:179], 0
ds_read_b64_tr_b16 v[164:165], v237 offset:20480
v_mfma_f32_16x16x32_bf16 v[116:119], a[132:135], v[180:183], v[116:119]
ds_read_b64_tr_b16 v[166:167], v237 offset:20992
v_mfma_f32_16x16x32_bf16 v[116:119], a[136:139], v[184:187], v[116:119]
ds_read_b64_tr_b16 v[168:169], v237 offset:24576
v_cvt_pk_bf16_f32 v250, v72, v73
v_mfma_f32_16x16x32_bf16 v[116:119], a[140:143], v[188:191], v[116:119]
ds_read_b64_tr_b16 v[170:171], v237 offset:25088
v_mfma_f32_16x16x32_bf16 v[124:127], a[192:195], v[176:179], 0
ds_read_b64_tr_b16 v[172:173], v237 offset:28672
v_mfma_f32_16x16x32_bf16 v[124:127], a[196:199], v[180:183], v[124:127]
ds_read_b64_tr_b16 v[174:175], v237 offset:29184
v_mfma_f32_16x16x32_bf16 v[124:127], a[200:203], v[184:187], v[124:127]
s_barrier
v_cvt_pk_bf16_f32 v251, v74, v75
s_add_u32 m0, s100, 98304
v_mfma_f32_16x16x32_bf16 v[124:127], a[204:207], v[188:191], v[124:127]
s_add_u32 s98, s98, s99
v_mfma_f32_16x16x32_bf16 v[96:99], a[16:19], v[192:195], v[96:99]
s_waitcnt lgkmcnt(4)
v_mfma_f32_16x16x32_bf16 v[96:99], a[20:23], v[196:199], v[96:99]
buffer_load_dwordx4 v228, s[28:31], s98 offen offset:0 lds
v_mfma_f32_16x16x32_bf16 v[96:99], a[24:27], v[200:203], v[96:99]
buffer_store_dwordx4 v[248:251], v242, s[40:43], s72 offen offset:2048 sc1
v_mfma_f32_16x16x32_bf16 v[96:99], a[28:31], v[204:207], v[96:99]
buffer_load_dwordx4 v229, s[28:31], s98 offen offset:1024 lds
v_mfma_f32_16x16x32_bf16 v[104:107], a[80:83], v[192:195], v[104:107]
v_mfma_f32_16x16x32_bf16 v[104:107], a[84:87], v[196:199], v[104:107]
v_mfma_f32_16x16x32_bf16 v[104:107], a[88:91], v[200:203], v[104:107]
ds_read_b64_tr_b16 v[176:177], v236 offset:32768
v_mfma_f32_16x16x32_bf16 v[104:107], a[92:95], v[204:207], v[104:107]
buffer_load_dwordx4 v230, s[28:31], s98 offen offset:2048 lds
v_mfma_f32_16x16x32_bf16 v[112:115], a[144:147], v[192:195], v[112:115]
ds_read_b64_tr_b16 v[178:179], v236 offset:33280
v_mfma_f32_16x16x32_bf16 v[112:115], a[148:151], v[196:199], v[112:115]
ds_read_b64_tr_b16 v[180:181], v236 offset:36864
v_mfma_f32_16x16x32_bf16 v[112:115], a[152:155], v[200:203], v[112:115]
ds_read_b64_tr_b16 v[182:183], v236 offset:37376
v_mfma_f32_16x16x32_bf16 v[112:115], a[156:159], v[204:207], v[112:115]
ds_read_b64_tr_b16 v[184:185], v236 offset:40960
v_cvt_pk_bf16_f32 v252, v68, v69
v_mfma_f32_16x16x32_bf16 v[120:123], a[208:211], v[192:195], v[120:123]
ds_read_b64_tr_b16 v[186:187], v236 offset:41472
v_mfma_f32_16x16x32_bf16 v[120:123], a[212:215], v[196:199], v[120:123]
ds_read_b64_tr_b16 v[188:189], v236 offset:45056
v_mfma_f32_16x16x32_bf16 v[120:123], a[216:219], v[200:203], v[120:123]
ds_read_b64_tr_b16 v[190:191], v236 offset:45568
v_mfma_f32_16x16x32_bf16 v[120:123], a[220:223], v[204:207], v[120:123]
buffer_load_dwordx4 v231, s[28:31], s98 offen offset:3072 lds
v_mfma_f32_16x16x32_bf16 v[100:103], a[16:19], v[160:163], v[100:103]
s_add_u32 m0, s100, 102400
s_add_u32 s98, s98, s99
v_cvt_pk_bf16_f32 v253, v70, v71
v_mfma_f32_16x16x32_bf16 v[100:103], a[20:23], v[164:167], v[100:103]
s_waitcnt lgkmcnt(4)
v_mfma_f32_16x16x32_bf16 v[100:103], a[24:27], v[168:171], v[100:103]
buffer_load_dwordx4 v228, s[28:31], s98 offen offset:0 lds
v_mfma_f32_16x16x32_bf16 v[100:103], a[28:31], v[172:175], v[100:103]
buffer_load_dwordx4 v229, s[28:31], s98 offen offset:1024 lds
v_mfma_f32_16x16x32_bf16 v[108:111], a[80:83], v[160:163], v[108:111]
v_cvt_pk_bf16_f32 v254, v76, v77
v_mfma_f32_16x16x32_bf16 v[108:111], a[84:87], v[164:167], v[108:111]
buffer_load_dwordx4 v230, s[28:31], s98 offen offset:2048 lds
v_mfma_f32_16x16x32_bf16 v[108:111], a[88:91], v[168:171], v[108:111]
ds_read_b64_tr_b16 v[192:193], v237 offset:32768
v_mfma_f32_16x16x32_bf16 v[108:111], a[92:95], v[172:175], v[108:111]
ds_read_b64_tr_b16 v[194:195], v237 offset:33280
v_cvt_pk_bf16_f32 v255, v78, v79
v_mfma_f32_16x16x32_bf16 v[116:119], a[144:147], v[160:163], v[116:119]
ds_read_b64_tr_b16 v[196:197], v237 offset:36864
v_mfma_f32_16x16x32_bf16 v[116:119], a[148:151], v[164:167], v[116:119]
ds_read_b64_tr_b16 v[198:199], v237 offset:37376
v_mfma_f32_16x16x32_bf16 v[116:119], a[152:155], v[168:171], v[116:119]
ds_read_b64_tr_b16 v[200:201], v237 offset:40960
v_mfma_f32_16x16x32_bf16 v[116:119], a[156:159], v[172:175], v[116:119]
ds_read_b64_tr_b16 v[202:203], v237 offset:41472
v_mfma_f32_16x16x32_bf16 v[124:127], a[208:211], v[160:163], v[124:127]
buffer_load_dwordx4 v231, s[28:31], s98 offen offset:3072 lds
v_mfma_f32_16x16x32_bf16 v[124:127], a[212:215], v[164:167], v[124:127]
ds_read_b64_tr_b16 v[204:205], v237 offset:45056
s_add_u32 m0, s100, 65536
v_mfma_f32_16x16x32_bf16 v[124:127], a[216:219], v[168:171], v[124:127]
ds_read_b64_tr_b16 v[206:207], v237 offset:45568
s_add_u32 s98, s98, s99
v_mfma_f32_16x16x32_bf16 v[124:127], a[220:223], v[172:175], v[124:127]
buffer_store_dwordx4 v[252:255], v242, s[40:43], s72 offen offset:3072 sc1
v_mfma_f32_16x16x32_bf16 v[96:99], a[32:35], v[176:179], v[96:99]
buffer_load_dwordx4 v228, s[28:31], s98 offen offset:0 lds
v_mfma_f32_16x16x32_bf16 v[96:99], a[36:39], v[180:183], v[96:99]
s_waitcnt lgkmcnt(3)
v_mfma_f32_16x16x32_bf16 v[96:99], a[40:43], v[184:187], v[96:99]
buffer_load_dwordx4 v229, s[28:31], s98 offen offset:1024 lds
v_mfma_f32_16x16x32_bf16 v[96:99], a[44:47], v[188:191], v[96:99]
v_mfma_f32_16x16x32_bf16 v[104:107], a[96:99], v[176:179], v[104:107]
s_add_u32 s72, s67, 24576
v_mfma_f32_16x16x32_bf16 v[104:107], a[100:103], v[180:183], v[104:107]
buffer_load_dwordx4 v230, s[28:31], s98 offen offset:2048 lds
v_mfma_f32_16x16x32_bf16 v[104:107], a[104:107], v[184:187], v[104:107]
ds_read_b64_tr_b16 v[160:161], v236 offset:49152
v_cvt_pk_bf16_f32 v248, v80, v81
v_mfma_f32_16x16x32_bf16 v[104:107], a[108:111], v[188:191], v[104:107]
ds_read_b64_tr_b16 v[162:163], v236 offset:49664
v_mfma_f32_16x16x32_bf16 v[112:115], a[160:163], v[176:179], v[112:115]
ds_read_b64_tr_b16 v[164:165], v236 offset:53248
v_mfma_f32_16x16x32_bf16 v[112:115], a[164:167], v[180:183], v[112:115]
ds_read_b64_tr_b16 v[166:167], v236 offset:53760
v_mfma_f32_16x16x32_bf16 v[112:115], a[168:171], v[184:187], v[112:115]
buffer_load_dwordx4 v231, s[28:31], s98 offen offset:3072 lds
v_mfma_f32_16x16x32_bf16 v[112:115], a[172:175], v[188:191], v[112:115]
ds_read_b64_tr_b16 v[168:169], v236 offset:57344
v_cvt_pk_bf16_f32 v249, v82, v83
v_mfma_f32_16x16x32_bf16 v[120:123], a[224:227], v[176:179], v[120:123]
ds_read_b64_tr_b16 v[170:171], v236 offset:57856
s_add_u32 m0, s100, 69632
v_mfma_f32_16x16x32_bf16 v[120:123], a[228:231], v[180:183], v[120:123]
ds_read_b64_tr_b16 v[172:173], v236 offset:61440
s_add_u32 s98, s98, s99
v_mfma_f32_16x16x32_bf16 v[120:123], a[232:235], v[184:187], v[120:123]
ds_read_b64_tr_b16 v[174:175], v236 offset:61952
v_cvt_pk_bf16_f32 v250, v88, v89
v_mfma_f32_16x16x32_bf16 v[120:123], a[236:239], v[188:191], v[120:123]
buffer_load_dwordx4 v228, s[28:31], s98 offen offset:0 lds
v_mfma_f32_16x16x32_bf16 v[100:103], a[32:35], v[192:195], v[100:103]
buffer_load_dwordx4 v229, s[28:31], s98 offen offset:1024 lds
v_mfma_f32_16x16x32_bf16 v[100:103], a[36:39], v[196:199], v[100:103]
s_waitcnt lgkmcnt(4)
v_mfma_f32_16x16x32_bf16 v[100:103], a[40:43], v[200:203], v[100:103]
v_cvt_pk_bf16_f32 v251, v90, v91
v_mfma_f32_16x16x32_bf16 v[100:103], a[44:47], v[204:207], v[100:103]
buffer_load_dwordx4 v230, s[28:31], s98 offen offset:2048 lds
v_mfma_f32_16x16x32_bf16 v[108:111], a[96:99], v[192:195], v[108:111]
v_mfma_f32_16x16x32_bf16 v[108:111], a[100:103], v[196:199], v[108:111]
v_mfma_f32_16x16x32_bf16 v[108:111], a[104:107], v[200:203], v[108:111]
ds_read_b64_tr_b16 v[176:177], v237 offset:49152
v_mfma_f32_16x16x32_bf16 v[108:111], a[108:111], v[204:207], v[108:111]
ds_read_b64_tr_b16 v[178:179], v237 offset:49664
v_mfma_f32_16x16x32_bf16 v[116:119], a[160:163], v[192:195], v[116:119]
buffer_store_dwordx4 v[248:251], v242, s[40:43], s72 offen offset:2048 sc1
v_mfma_f32_16x16x32_bf16 v[116:119], a[164:167], v[196:199], v[116:119]
buffer_load_dwordx4 v231, s[28:31], s98 offen offset:3072 lds
v_mfma_f32_16x16x32_bf16 v[116:119], a[168:171], v[200:203], v[116:119]
ds_read_b64_tr_b16 v[180:181], v237 offset:53248
v_mfma_f32_16x16x32_bf16 v[116:119], a[172:175], v[204:207], v[116:119]
ds_read_b64_tr_b16 v[182:183], v237 offset:53760
L_c860:
v_mfma_f32_16x16x32_bf16 v[124:127], a[224:227], v[192:195], v[124:127]
ds_read_b64_tr_b16 v[184:185], v237 offset:57344
v_mfma_f32_16x16x32_bf16 v[124:127], a[228:231], v[196:199], v[124:127]
ds_read_b64_tr_b16 v[186:187], v237 offset:57856
v_mfma_f32_16x16x32_bf16 v[124:127], a[232:235], v[200:203], v[124:127]
ds_read_b64_tr_b16 v[188:189], v237 offset:61440
v_mfma_f32_16x16x32_bf16 v[124:127], a[236:239], v[204:207], v[124:127]
ds_read_b64_tr_b16 v[190:191], v237 offset:61952
v_cvt_pk_bf16_f32 v252, v84, v85
v_mfma_f32_16x16x32_bf16 v[96:99], a[48:51], v[160:163], v[96:99]
buffer_load_dword v245, v222, s[48:51], s70 offen sc1
v_mfma_f32_16x16x32_bf16 v[96:99], a[52:55], v[164:167], v[96:99]
s_waitcnt lgkmcnt(5)
v_mfma_f32_16x16x32_bf16 v[96:99], a[56:59], v[168:171], v[96:99]
buffer_load_dword v244, v222, s[48:51], s71 offen sc1
v_mfma_f32_16x16x32_bf16 v[96:99], a[60:63], v[172:175], v[96:99]
v_cvt_pk_bf16_f32 v253, v86, v87
v_mfma_f32_16x16x32_bf16 v[104:107], a[112:115], v[160:163], v[104:107]
v_mfma_f32_16x16x32_bf16 v[104:107], a[116:119], v[164:167], v[104:107]
v_mfma_f32_16x16x32_bf16 v[104:107], a[120:123], v[168:171], v[104:107]
ds_read_b64_tr_b16 v[192:193], v238 offset:0
v_mfma_f32_16x16x32_bf16 v[104:107], a[124:127], v[172:175], v[104:107]
ds_read_b64_tr_b16 v[194:195], v238 offset:512
v_cvt_pk_bf16_f32 v254, v92, v93
v_mfma_f32_16x16x32_bf16 v[112:115], a[176:179], v[160:163], v[112:115]
ds_read_b64_tr_b16 v[196:197], v238 offset:4096
v_mfma_f32_16x16x32_bf16 v[112:115], a[180:183], v[164:167], v[112:115]
ds_read_b64_tr_b16 v[198:199], v238 offset:4608
v_mfma_f32_16x16x32_bf16 v[112:115], a[184:187], v[168:171], v[112:115]
ds_read_b64_tr_b16 v[200:201], v238 offset:8192
v_mfma_f32_16x16x32_bf16 v[112:115], a[188:191], v[172:175], v[112:115]
ds_read_b64_tr_b16 v[202:203], v238 offset:8704
v_cvt_pk_bf16_f32 v255, v94, v95
v_mfma_f32_16x16x32_bf16 v[120:123], a[240:243], v[160:163], v[120:123]
ds_read_b64_tr_b16 v[204:205], v238 offset:12288
v_mfma_f32_16x16x32_bf16 v[120:123], a[244:247], v[164:167], v[120:123]
ds_read_b64_tr_b16 v[206:207], v238 offset:12800
v_mfma_f32_16x16x32_bf16 v[120:123], a[248:251], v[168:171], v[120:123]
v_mfma_f32_16x16x32_bf16 v[120:123], a[252:255], v[172:175], v[120:123]
v_mfma_f32_16x16x32_bf16 v[100:103], a[48:51], v[176:179], v[100:103]
s_waitcnt lgkmcnt(4)
v_mfma_f32_16x16x32_bf16 v[100:103], a[52:55], v[180:183], v[100:103]
buffer_store_dwordx4 v[252:255], v242, s[40:43], s72 offen offset:3072 sc1
v_mfma_f32_16x16x32_bf16 v[100:103], a[56:59], v[184:187], v[100:103]
v_mfma_f32_16x16x32_bf16 v[100:103], a[60:63], v[188:191], v[100:103]
v_mfma_f32_16x16x32_bf16 v[108:111], a[112:115], v[176:179], v[108:111]
v_mfma_f32_16x16x32_bf16 v[108:111], a[116:119], v[180:183], v[108:111]
v_mfma_f32_16x16x32_bf16 v[108:111], a[120:123], v[184:187], v[108:111]
ds_read_b64_tr_b16 v[160:161], v239 offset:0
v_mfma_f32_16x16x32_bf16 v[108:111], a[124:127], v[188:191], v[108:111]
ds_read_b64_tr_b16 v[162:163], v239 offset:512
v_mfma_f32_16x16x32_bf16 v[116:119], a[176:179], v[176:179], v[116:119]
ds_read_b64_tr_b16 v[164:165], v239 offset:4096
v_mfma_f32_16x16x32_bf16 v[116:119], a[180:183], v[180:183], v[116:119]
ds_read_b64_tr_b16 v[166:167], v239 offset:4608
v_mfma_f32_16x16x32_bf16 v[116:119], a[184:187], v[184:187], v[116:119]
ds_read_b64_tr_b16 v[168:169], v239 offset:8192
v_mfma_f32_16x16x32_bf16 v[116:119], a[188:191], v[188:191], v[116:119]
ds_read_b64_tr_b16 v[170:171], v239 offset:8704
v_mfma_f32_16x16x32_bf16 v[124:127], a[240:243], v[176:179], v[124:127]
ds_read_b64_tr_b16 v[172:173], v239 offset:12288
v_mfma_f32_16x16x32_bf16 v[124:127], a[244:247], v[180:183], v[124:127]
ds_read_b64_tr_b16 v[174:175], v239 offset:12800
v_mfma_f32_16x16x32_bf16 v[124:127], a[248:251], v[184:187], v[124:127]
v_mfma_f32_16x16x32_bf16 v[124:127], a[252:255], v[188:191], v[124:127]
v_mfma_f32_16x16x32_bf16 v[128:131], a[0:3], v[192:195], 0
v_mfma_f32_16x16x32_bf16 v[128:131], a[4:7], v[196:199], v[128:131]
s_waitcnt lgkmcnt(3)
v_mfma_f32_16x16x32_bf16 v[128:131], a[8:11], v[200:203], v[128:131]
v_mfma_f32_16x16x32_bf16 v[128:131], a[12:15], v[204:207], v[128:131]
v_mfma_f32_16x16x32_bf16 v[136:139], a[64:67], v[192:195], 0
v_mfma_f32_16x16x32_bf16 v[136:139], a[68:71], v[196:199], v[136:139]
v_mfma_f32_16x16x32_bf16 v[136:139], a[72:75], v[200:203], v[136:139]
ds_read_b64_tr_b16 v[176:177], v238 offset:16384
v_mfma_f32_16x16x32_bf16 v[136:139], a[76:79], v[204:207], v[136:139]
ds_read_b64_tr_b16 v[178:179], v238 offset:16896
v_mfma_f32_16x16x32_bf16 v[144:147], a[128:131], v[192:195], 0
ds_read_b64_tr_b16 v[180:181], v238 offset:20480
v_mfma_f32_16x16x32_bf16 v[144:147], a[132:135], v[196:199], v[144:147]
ds_read_b64_tr_b16 v[182:183], v238 offset:20992
v_mfma_f32_16x16x32_bf16 v[144:147], a[136:139], v[200:203], v[144:147]
ds_read_b64_tr_b16 v[184:185], v238 offset:24576
v_mfma_f32_16x16x32_bf16 v[144:147], a[140:143], v[204:207], v[144:147]
ds_read_b64_tr_b16 v[186:187], v238 offset:25088
v_mfma_f32_16x16x32_bf16 v[152:155], a[192:195], v[192:195], 0
ds_read_b64_tr_b16 v[188:189], v238 offset:28672
v_mfma_f32_16x16x32_bf16 v[152:155], a[196:199], v[196:199], v[152:155]
ds_read_b64_tr_b16 v[190:191], v238 offset:29184
s_lshr_b32 s0, s2, 3
s_cmp_lg_u32 s0, 7
s_cbranch_scc1 L_ct13
s_lshl_b32 s0, s56, 13
v_lshl_add_u32 v246, v243, 7, s0
v_min_u32 v246, 8192-4, v246
s_getpc_b64 s[0:1]
L_cp13:
s_add_u32 s0, s0, L_c1200-L_cp13
s_addc_u32 s1, s1, 0
global_load_dword v247, v246, s[0:1]
L_ct13:
v_mfma_f32_16x16x32_bf16 v[152:155], a[200:203], v[200:203], v[152:155]
v_mfma_f32_16x16x32_bf16 v[152:155], a[204:207], v[204:207], v[152:155]
v_mfma_f32_16x16x32_bf16 v[132:135], a[0:3], v[160:163], 0
v_mfma_f32_16x16x32_bf16 v[132:135], a[4:7], v[164:167], v[132:135]
s_waitcnt lgkmcnt(3)
v_mfma_f32_16x16x32_bf16 v[132:135], a[8:11], v[168:171], v[132:135]
v_mfma_f32_16x16x32_bf16 v[132:135], a[12:15], v[172:175], v[132:135]
v_mfma_f32_16x16x32_bf16 v[140:143], a[64:67], v[160:163], 0
v_mfma_f32_16x16x32_bf16 v[140:143], a[68:71], v[164:167], v[140:143]
v_mfma_f32_16x16x32_bf16 v[140:143], a[72:75], v[168:171], v[140:143]
ds_read_b64_tr_b16 v[192:193], v239 offset:16384
v_mfma_f32_16x16x32_bf16 v[140:143], a[76:79], v[172:175], v[140:143]
ds_read_b64_tr_b16 v[194:195], v239 offset:16896
v_mfma_f32_16x16x32_bf16 v[148:151], a[128:131], v[160:163], 0
ds_read_b64_tr_b16 v[196:197], v239 offset:20480
v_mfma_f32_16x16x32_bf16 v[148:151], a[132:135], v[164:167], v[148:151]
ds_read_b64_tr_b16 v[198:199], v239 offset:20992
v_mfma_f32_16x16x32_bf16 v[148:151], a[136:139], v[168:171], v[148:151]
ds_read_b64_tr_b16 v[200:201], v239 offset:24576
v_mfma_f32_16x16x32_bf16 v[148:151], a[140:143], v[172:175], v[148:151]
ds_read_b64_tr_b16 v[202:203], v239 offset:25088
v_mfma_f32_16x16x32_bf16 v[156:159], a[192:195], v[160:163], 0
ds_read_b64_tr_b16 v[204:205], v239 offset:28672
v_mfma_f32_16x16x32_bf16 v[156:159], a[196:199], v[164:167], v[156:159]
ds_read_b64_tr_b16 v[206:207], v239 offset:29184
v_mfma_f32_16x16x32_bf16 v[156:159], a[200:203], v[168:171], v[156:159]
v_mfma_f32_16x16x32_bf16 v[156:159], a[204:207], v[172:175], v[156:159]
v_mfma_f32_16x16x32_bf16 v[128:131], a[16:19], v[176:179], v[128:131]
v_mfma_f32_16x16x32_bf16 v[128:131], a[20:23], v[180:183], v[128:131]
s_waitcnt lgkmcnt(3)
v_mfma_f32_16x16x32_bf16 v[128:131], a[24:27], v[184:187], v[128:131]
v_mfma_f32_16x16x32_bf16 v[128:131], a[28:31], v[188:191], v[128:131]
v_mfma_f32_16x16x32_bf16 v[136:139], a[80:83], v[176:179], v[136:139]
v_mfma_f32_16x16x32_bf16 v[136:139], a[84:87], v[180:183], v[136:139]
v_mfma_f32_16x16x32_bf16 v[136:139], a[88:91], v[184:187], v[136:139]
ds_read_b64_tr_b16 v[160:161], v238 offset:32768
v_mfma_f32_16x16x32_bf16 v[136:139], a[92:95], v[188:191], v[136:139]
ds_read_b64_tr_b16 v[162:163], v238 offset:33280
v_mfma_f32_16x16x32_bf16 v[144:147], a[144:147], v[176:179], v[144:147]
ds_read_b64_tr_b16 v[164:165], v238 offset:36864
v_mfma_f32_16x16x32_bf16 v[144:147], a[148:151], v[180:183], v[144:147]
ds_read_b64_tr_b16 v[166:167], v238 offset:37376
v_mfma_f32_16x16x32_bf16 v[144:147], a[152:155], v[184:187], v[144:147]
ds_read_b64_tr_b16 v[168:169], v238 offset:40960
v_mfma_f32_16x16x32_bf16 v[144:147], a[156:159], v[188:191], v[144:147]
ds_read_b64_tr_b16 v[170:171], v238 offset:41472
v_mfma_f32_16x16x32_bf16 v[152:155], a[208:211], v[176:179], v[152:155]
ds_read_b64_tr_b16 v[172:173], v238 offset:45056
v_mfma_f32_16x16x32_bf16 v[152:155], a[212:215], v[180:183], v[152:155]
ds_read_b64_tr_b16 v[174:175], v238 offset:45568
v_mfma_f32_16x16x32_bf16 v[152:155], a[216:219], v[184:187], v[152:155]
v_mfma_f32_16x16x32_bf16 v[152:155], a[220:223], v[188:191], v[152:155]
v_mfma_f32_16x16x32_bf16 v[132:135], a[16:19], v[192:195], v[132:135]
v_mfma_f32_16x16x32_bf16 v[132:135], a[20:23], v[196:199], v[132:135]
s_waitcnt lgkmcnt(3)
s_waitcnt vmcnt(1)
v_readfirstlane_b32 s79, v245
s_nop 2
s_cmp_ge_u32 s79, 16
s_cbranch_scc0 L_spin6
L_got6:
v_mfma_f32_16x16x32_bf16 v[132:135], a[24:27], v[200:203], v[132:135]
v_mfma_f32_16x16x32_bf16 v[132:135], a[28:31], v[204:207], v[132:135]
s_waitcnt vmcnt(1)
v_readfirstlane_b32 s79, v244
s_nop 2
s_cmp_ge_u32 s79, 16
s_cbranch_scc0 L_spin7
L_got7:
v_mfma_f32_16x16x32_bf16 v[140:143], a[80:83], v[192:195], v[140:143]
v_mfma_f32_16x16x32_bf16 v[140:143], a[84:87], v[196:199], v[140:143]
v_mfma_f32_16x16x32_bf16 v[140:143], a[88:91], v[200:203], v[140:143]
ds_read_b64_tr_b16 v[176:177], v239 offset:32768
v_mfma_f32_16x16x32_bf16 v[140:143], a[92:95], v[204:207], v[140:143]
ds_read_b64_tr_b16 v[178:179], v239 offset:33280
v_mfma_f32_16x16x32_bf16 v[148:151], a[144:147], v[192:195], v[148:151]
ds_read_b64_tr_b16 v[180:181], v239 offset:36864
v_mfma_f32_16x16x32_bf16 v[148:151], a[148:151], v[196:199], v[148:151]
ds_read_b64_tr_b16 v[182:183], v239 offset:37376
v_mfma_f32_16x16x32_bf16 v[148:151], a[152:155], v[200:203], v[148:151]
ds_read_b64_tr_b16 v[184:185], v239 offset:40960
v_mfma_f32_16x16x32_bf16 v[148:151], a[156:159], v[204:207], v[148:151]
ds_read_b64_tr_b16 v[186:187], v239 offset:41472
v_mfma_f32_16x16x32_bf16 v[156:159], a[208:211], v[192:195], v[156:159]
ds_read_b64_tr_b16 v[188:189], v239 offset:45056
v_mfma_f32_16x16x32_bf16 v[156:159], a[212:215], v[196:199], v[156:159]
ds_read_b64_tr_b16 v[190:191], v239 offset:45568
v_mfma_f32_16x16x32_bf16 v[156:159], a[216:219], v[200:203], v[156:159]
v_mfma_f32_16x16x32_bf16 v[156:159], a[220:223], v[204:207], v[156:159]
v_mfma_f32_16x16x32_bf16 v[128:131], a[32:35], v[160:163], v[128:131]
s_mov_b32 s101, 0
v_mfma_f32_16x16x32_bf16 v[128:131], a[36:39], v[164:167], v[128:131]
s_waitcnt lgkmcnt(3)
v_mfma_f32_16x16x32_bf16 v[128:131], a[40:43], v[168:171], v[128:131]
buffer_load_dwordx4 a[64:67], v224, s[32:35], s101 offen offset:0 sc1
v_mfma_f32_16x16x32_bf16 v[128:131], a[44:47], v[172:175], v[128:131]
buffer_load_dwordx4 a[68:71], v225, s[32:35], s101 offen offset:0 sc1
v_mfma_f32_16x16x32_bf16 v[136:139], a[96:99], v[160:163], v[136:139]
buffer_load_dwordx4 a[72:75], v226, s[32:35], s101 offen offset:0 sc1
v_mfma_f32_16x16x32_bf16 v[136:139], a[100:103], v[164:167], v[136:139]
buffer_load_dwordx4 a[76:79], v227, s[32:35], s101 offen offset:0 sc1
v_mfma_f32_16x16x32_bf16 v[136:139], a[104:107], v[168:171], v[136:139]
buffer_load_dwordx4 a[80:83], v224, s[32:35], s101 offen offset:1024 sc1
v_mfma_f32_16x16x32_bf16 v[136:139], a[108:111], v[172:175], v[136:139]
ds_read_b64_tr_b16 v[192:193], v238 offset:49152
v_mfma_f32_16x16x32_bf16 v[144:147], a[160:163], v[160:163], v[144:147]
ds_read_b64_tr_b16 v[194:195], v238 offset:49664
v_mfma_f32_16x16x32_bf16 v[144:147], a[164:167], v[164:167], v[144:147]
buffer_load_dwordx4 a[84:87], v225, s[32:35], s101 offen offset:1024 sc1
v_mfma_f32_16x16x32_bf16 v[144:147], a[168:171], v[168:171], v[144:147]
ds_read_b64_tr_b16 v[196:197], v238 offset:53248
v_mfma_f32_16x16x32_bf16 v[144:147], a[172:175], v[172:175], v[144:147]
ds_read_b64_tr_b16 v[198:199], v238 offset:53760
v_mfma_f32_16x16x32_bf16 v[152:155], a[224:227], v[160:163], v[152:155]
ds_read_b64_tr_b16 v[200:201], v238 offset:57344
v_mfma_f32_16x16x32_bf16 v[152:155], a[228:231], v[164:167], v[152:155]
ds_read_b64_tr_b16 v[202:203], v238 offset:57856
v_mfma_f32_16x16x32_bf16 v[152:155], a[232:235], v[168:171], v[152:155]
buffer_load_dwordx4 a[88:91], v226, s[32:35], s101 offen offset:1024 sc1
v_mfma_f32_16x16x32_bf16 v[152:155], a[236:239], v[172:175], v[152:155]
ds_read_b64_tr_b16 v[204:205], v238 offset:61440
ds_read_b64_tr_b16 v[206:207], v238 offset:61952
v_mfma_f32_16x16x32_bf16 v[132:135], a[32:35], v[176:179], v[132:135]
buffer_load_dwordx4 a[92:95], v227, s[32:35], s101 offen offset:1024 sc1
v_mfma_f32_16x16x32_bf16 v[132:135], a[36:39], v[180:183], v[132:135]
s_waitcnt lgkmcnt(5)
buffer_load_dwordx4 a[192:195], v224, s[32:35], s101 offen offset:2048 sc1
v_mfma_f32_16x16x32_bf16 v[132:135], a[40:43], v[184:187], v[132:135]
buffer_load_dwordx4 a[196:199], v225, s[32:35], s101 offen offset:2048 sc1
v_mfma_f32_16x16x32_bf16 v[132:135], a[44:47], v[188:191], v[132:135]
buffer_load_dwordx4 a[200:203], v226, s[32:35], s101 offen offset:2048 sc1
v_mfma_f32_16x16x32_bf16 v[140:143], a[96:99], v[176:179], v[140:143]
buffer_load_dwordx4 a[204:207], v227, s[32:35], s101 offen offset:2048 sc1
v_mfma_f32_16x16x32_bf16 v[140:143], a[100:103], v[180:183], v[140:143]
buffer_load_dwordx4 a[208:211], v224, s[32:35], s101 offen offset:3072 sc1
v_mfma_f32_16x16x32_bf16 v[140:143], a[104:107], v[184:187], v[140:143]
buffer_load_dwordx4 a[212:215], v225, s[32:35], s101 offen offset:3072 sc1
v_mfma_f32_16x16x32_bf16 v[140:143], a[108:111], v[188:191], v[140:143]
ds_read_b64_tr_b16 v[160:161], v239 offset:49152
v_mfma_f32_16x16x32_bf16 v[148:151], a[160:163], v[176:179], v[148:151]
ds_read_b64_tr_b16 v[162:163], v239 offset:49664
v_mfma_f32_16x16x32_bf16 v[148:151], a[164:167], v[180:183], v[148:151]
buffer_load_dwordx4 a[216:219], v226, s[32:35], s101 offen offset:3072 sc1
v_mfma_f32_16x16x32_bf16 v[148:151], a[168:171], v[184:187], v[148:151]
ds_read_b64_tr_b16 v[164:165], v239 offset:53248
v_mfma_f32_16x16x32_bf16 v[148:151], a[172:175], v[188:191], v[148:151]
ds_read_b64_tr_b16 v[166:167], v239 offset:53760
v_mfma_f32_16x16x32_bf16 v[156:159], a[224:227], v[176:179], v[156:159]
buffer_load_dwordx4 a[220:223], v227, s[32:35], s101 offen offset:3072 sc1
v_mfma_f32_16x16x32_bf16 v[156:159], a[228:231], v[180:183], v[156:159]
ds_read_b64_tr_b16 v[168:169], v239 offset:57344
v_mfma_f32_16x16x32_bf16 v[156:159], a[232:235], v[184:187], v[156:159]
ds_read_b64_tr_b16 v[170:171], v239 offset:57856
s_add_u32 s72, s67, 12288
v_mfma_f32_16x16x32_bf16 v[156:159], a[236:239], v[188:191], v[156:159]
ds_read_b64_tr_b16 v[172:173], v239 offset:61440
v_cvt_pk_bf16_f32 v248, v96, v97
v_mfma_f32_16x16x32_bf16 v[128:131], a[48:51], v[192:195], v[128:131]
s_waitcnt lgkmcnt(5)
ds_read_b64_tr_b16 v[174:175], v239 offset:61952
v_mfma_f32_16x16x32_bf16 v[128:131], a[52:55], v[196:199], v[128:131]
v_cvt_pk_bf16_f32 v249, v98, v99
v_mfma_f32_16x16x32_bf16 v[128:131], a[56:59], v[200:203], v[128:131]
v_cvt_pk_bf16_f32 v250, v104, v105
v_mfma_f32_16x16x32_bf16 v[128:131], a[60:63], v[204:207], v[128:131]
v_cvt_pk_bf16_f32 v251, v106, v107
v_mfma_f32_16x16x32_bf16 v[136:139], a[112:115], v[192:195], v[136:139]
buffer_store_dwordx4 v[248:251], v242, s[40:43], s72 offen offset:0 sc1
v_mfma_f32_16x16x32_bf16 v[136:139], a[116:119], v[196:199], v[136:139]
v_mfma_f32_16x16x32_bf16 v[136:139], a[120:123], v[200:203], v[136:139]
v_cvt_pk_bf16_f32 v252, v100, v101
v_mfma_f32_16x16x32_bf16 v[136:139], a[124:127], v[204:207], v[136:139]
s_waitcnt vmcnt(44)
s_barrier
v_mfma_f32_16x16x32_bf16 v[144:147], a[176:179], v[192:195], v[144:147]
ds_read_b64_tr_b16 a[96:97], v208 offset:0
v_cvt_pk_bf16_f32 v253, v102, v103
v_mfma_f32_16x16x32_bf16 v[144:147], a[180:183], v[196:199], v[144:147]
ds_read_b64_tr_b16 a[98:99], v208 offset:512
v_mfma_f32_16x16x32_bf16 v[144:147], a[184:187], v[200:203], v[144:147]
ds_read_b64_tr_b16 a[100:101], v208 offset:4096
v_cvt_pk_bf16_f32 v254, v108, v109
v_mfma_f32_16x16x32_bf16 v[144:147], a[188:191], v[204:207], v[144:147]
ds_read_b64_tr_b16 a[102:103], v208 offset:4608
v_cvt_pk_bf16_f32 v255, v110, v111
v_mfma_f32_16x16x32_bf16 v[152:155], a[240:243], v[192:195], v[152:155]
v_mfma_f32_16x16x32_bf16 v[152:155], a[244:247], v[196:199], v[152:155]
buffer_store_dwordx4 v[252:255], v242, s[40:43], s72 offen offset:1024 sc1
v_mfma_f32_16x16x32_bf16 v[152:155], a[248:251], v[200:203], v[152:155]
ds_read_b64_tr_b16 a[104:105], v209 offset:0
v_mfma_f32_16x16x32_bf16 v[152:155], a[252:255], v[204:207], v[152:155]
ds_read_b64_tr_b16 a[106:107], v209 offset:512
v_mfma_f32_16x16x32_bf16 v[132:135], a[48:51], v[160:163], v[132:135]
s_waitcnt lgkmcnt(4)
ds_read_b64_tr_b16 a[108:109], v209 offset:4096
v_mfma_f32_16x16x32_bf16 v[132:135], a[52:55], v[164:167], v[132:135]
ds_read_b64_tr_b16 a[110:111], v209 offset:4608
s_add_u32 s72, s67, 28672
v_mfma_f32_16x16x32_bf16 v[132:135], a[56:59], v[168:171], v[132:135]
v_cvt_pk_bf16_f32 v248, v112, v113
v_mfma_f32_16x16x32_bf16 v[132:135], a[60:63], v[172:175], v[132:135]
v_cvt_pk_bf16_f32 v249, v114, v115
v_mfma_f32_16x16x32_bf16 v[140:143], a[112:115], v[160:163], v[140:143]
v_cvt_pk_bf16_f32 v250, v120, v121
v_mfma_f32_16x16x32_bf16 v[140:143], a[116:119], v[164:167], v[140:143]
v_mfma_f32_16x16x32_bf16 v[140:143], a[120:123], v[168:171], v[140:143]
ds_read_b64_tr_b16 a[224:225], v210 offset:0
v_cvt_pk_bf16_f32 v251, v122, v123
v_mfma_f32_16x16x32_bf16 v[140:143], a[124:127], v[172:175], v[140:143]
ds_read_b64_tr_b16 a[226:227], v210 offset:512
v_mfma_f32_16x16x32_bf16 v[148:151], a[176:179], v[160:163], v[148:151]
ds_read_b64_tr_b16 a[228:229], v210 offset:4096
v_mfma_f32_16x16x32_bf16 v[148:151], a[180:183], v[164:167], v[148:151]
buffer_store_dwordx4 v[248:251], v242, s[40:43], s72 offen offset:0 sc1
v_mfma_f32_16x16x32_bf16 v[148:151], a[184:187], v[168:171], v[148:151]
ds_read_b64_tr_b16 a[230:231], v210 offset:4608
v_cvt_pk_bf16_f32 v252, v116, v117
v_mfma_f32_16x16x32_bf16 v[148:151], a[188:191], v[172:175], v[148:151]
v_mfma_f32_16x16x32_bf16 v[156:159], a[240:243], v[160:163], v[156:159]
v_cvt_pk_bf16_f32 v253, v118, v119
v_mfma_f32_16x16x32_bf16 v[156:159], a[244:247], v[164:167], v[156:159]
v_mfma_f32_16x16x32_bf16 v[156:159], a[248:251], v[168:171], v[156:159]
s_waitcnt vmcnt(11)
v_cvt_pk_bf16_f32 v254, v124, v125
v_mfma_f32_16x16x32_bf16 v[156:159], a[252:255], v[172:175], v[156:159]
ds_read_b64_tr_b16 a[232:233], v211 offset:0
v_cvt_pk_bf16_f32 v255, v126, v127
L_seam:
v_mfma_f32_16x16x32_bf16 v[0:3], a[96:99], a[64:67], 0
s_waitcnt lgkmcnt(2)
ds_read_b64_tr_b16 a[234:235], v211 offset:512
v_mfma_f32_16x16x32_bf16 v[0:3], a[100:103], a[80:83], v[0:3]
ds_read_b64_tr_b16 a[236:237], v211 offset:4096
v_mfma_f32_16x16x32_bf16 v[4:7], a[96:99], a[68:71], 0
ds_read_b64_tr_b16 a[238:239], v211 offset:4608
v_mfma_f32_16x16x32_bf16 v[4:7], a[100:103], a[84:87], v[4:7]
buffer_store_dwordx4 v[252:255], v242, s[40:43], s72 offen offset:1024 sc1
v_mfma_f32_16x16x32_bf16 v[8:11], a[96:99], a[72:75], 0
v_mfma_f32_16x16x32_bf16 v[8:11], a[100:103], a[88:91], v[8:11]
v_mfma_f32_16x16x32_bf16 v[12:15], a[96:99], a[76:79], 0
ds_read_b64_tr_b16 a[240:241], v210 offset:8192
v_mfma_f32_16x16x32_bf16 v[12:15], a[100:103], a[92:95], v[12:15]
ds_read_b64_tr_b16 a[242:243], v210 offset:8704
v_mfma_f32_16x16x32_bf16 v[16:19], a[104:107], a[64:67], 0
s_add_u32 s72, s67, 12288
v_cvt_pk_bf16_f32 v248, v128, v129
v_mfma_f32_16x16x32_bf16 v[16:19], a[108:111], a[80:83], v[16:19]
ds_read_b64_tr_b16 a[244:245], v210 offset:12288
v_cvt_pk_bf16_f32 v249, v130, v131
v_mfma_f32_16x16x32_bf16 v[20:23], a[104:107], a[68:71], 0
ds_read_b64_tr_b16 a[246:247], v210 offset:12800
v_cvt_pk_bf16_f32 v250, v136, v137
v_mfma_f32_16x16x32_bf16 v[20:23], a[108:111], a[84:87], v[20:23]
v_mfma_f32_16x16x32_bf16 v[24:27], a[104:107], a[72:75], 0
v_cvt_pk_bf16_f32 v251, v138, v139
v_mfma_f32_16x16x32_bf16 v[24:27], a[108:111], a[88:91], v[24:27]
buffer_store_dwordx4 v[248:251], v242, s[40:43], s72 offen offset:2048 sc1
v_mfma_f32_16x16x32_bf16 v[28:31], a[104:107], a[76:79], 0
ds_read_b64_tr_b16 a[248:249], v211 offset:8192
v_mfma_f32_16x16x32_bf16 v[28:31], a[108:111], a[92:95], v[28:31]
ds_read_b64_tr_b16 a[250:251], v211 offset:8704
v_mfma_f32_16x16x32_bf16 v[32:35], a[224:227], a[64:67], 0
s_waitcnt lgkmcnt(3)
ds_read_b64_tr_b16 a[252:253], v211 offset:12288
v_mfma_f32_16x16x32_bf16 v[32:35], a[228:231], a[80:83], v[32:35]
ds_read_b64_tr_b16 a[254:255], v211 offset:12800
v_cvt_pk_bf16_f32 v252, v132, v133
v_mfma_f32_16x16x32_bf16 v[36:39], a[224:227], a[68:71], 0
v_cvt_pk_bf16_f32 v253, v134, v135
v_mfma_f32_16x16x32_bf16 v[36:39], a[228:231], a[84:87], v[36:39]
v_mfma_f32_16x16x32_bf16 v[40:43], a[224:227], a[72:75], 0
v_cvt_pk_bf16_f32 v254, v140, v141
v_mfma_f32_16x16x32_bf16 v[40:43], a[228:231], a[88:91], v[40:43]
v_cvt_pk_bf16_f32 v255, v142, v143
v_mfma_f32_16x16x32_bf16 v[44:47], a[224:227], a[76:79], 0
ds_read_b64_tr_b16 a[96:97], v208 offset:24576
v_mfma_f32_16x16x32_bf16 v[44:47], a[228:231], a[92:95], v[44:47]
ds_read_b64_tr_b16 a[98:99], v208 offset:25088
v_mfma_f32_16x16x32_bf16 v[48:51], a[232:235], a[64:67], 0
buffer_store_dwordx4 v[252:255], v242, s[40:43], s72 offen offset:3072 sc1
v_mfma_f32_16x16x32_bf16 v[48:51], a[236:239], a[80:83], v[48:51]
ds_read_b64_tr_b16 a[100:101], v208 offset:28672
v_mfma_f32_16x16x32_bf16 v[52:55], a[232:235], a[68:71], 0
ds_read_b64_tr_b16 a[102:103], v208 offset:29184
s_add_u32 s72, s67, 28672
v_mfma_f32_16x16x32_bf16 v[52:55], a[236:239], a[84:87], v[52:55]
v_cvt_pk_bf16_f32 v248, v144, v145
v_mfma_f32_16x16x32_bf16 v[56:59], a[232:235], a[72:75], 0
v_cvt_pk_bf16_f32 v249, v146, v147
v_mfma_f32_16x16x32_bf16 v[56:59], a[236:239], a[88:91], v[56:59]
v_mfma_f32_16x16x32_bf16 v[60:63], a[232:235], a[76:79], 0
ds_read_b64_tr_b16 a[104:105], v209 offset:24576
v_cvt_pk_bf16_f32 v250, v152, v153
v_mfma_f32_16x16x32_bf16 v[60:63], a[236:239], a[92:95], v[60:63]
ds_read_b64_tr_b16 a[106:107], v209 offset:25088
v_mfma_f32_16x16x32_bf16 v[160:163], a[240:243], a[64:67], 0
s_waitcnt lgkmcnt(3)
ds_read_b64_tr_b16 a[108:109], v209 offset:28672
v_mfma_f32_16x16x32_bf16 v[160:163], a[244:247], a[80:83], v[160:163]
ds_read_b64_tr_b16 a[110:111], v209 offset:29184
v_cvt_pk_bf16_f32 v251, v154, v155
v_mfma_f32_16x16x32_bf16 v[164:167], a[240:243], a[68:71], 0
buffer_store_dwordx4 v[248:251], v242, s[40:43], s72 offen offset:2048 sc1
v_mfma_f32_16x16x32_bf16 v[164:167], a[244:247], a[84:87], v[164:167]
v_mfma_f32_16x16x32_bf16 v[168:171], a[240:243], a[72:75], 0
v_cvt_pk_bf16_f32 v252, v148, v149
v_mfma_f32_16x16x32_bf16 v[168:171], a[244:247], a[88:91], v[168:171]
v_mfma_f32_16x16x32_bf16 v[172:175], a[240:243], a[76:79], 0
ds_read_b64_tr_b16 a[224:225], v210 offset:24576
s_mov_b32 s101, 4096
v_mfma_f32_16x16x32_bf16 v[172:175], a[244:247], a[92:95], v[172:175]
ds_read_b64_tr_b16 a[226:227], v210 offset:25088
v_cvt_pk_bf16_f32 v253, v150, v151
v_mfma_f32_16x16x32_bf16 v[176:179], a[248:251], a[64:67], 0
ds_read_b64_tr_b16 a[228:229], v210 offset:28672
v_cvt_pk_bf16_f32 v254, v156, v157
v_mfma_f32_16x16x32_bf16 v[176:179], a[252:255], a[80:83], v[176:179]
ds_read_b64_tr_b16 a[230:231], v210 offset:29184
v_cvt_pk_bf16_f32 v255, v158, v159
v_mfma_f32_16x16x32_bf16 v[180:183], a[248:251], a[68:71], 0
buffer_load_dwordx4 a[128:131], v224, s[32:35], s101 offen offset:0 sc1
v_mfma_f32_16x16x32_bf16 v[180:183], a[252:255], a[84:87], v[180:183]
buffer_store_dwordx4 v[252:255], v242, s[40:43], s72 offen offset:3072 sc1
v_mfma_f32_16x16x32_bf16 v[184:187], a[248:251], a[72:75], 0
v_mfma_f32_16x16x32_bf16 v[184:187], a[252:255], a[88:91], v[184:187]
v_mfma_f32_16x16x32_bf16 v[188:191], a[248:251], a[76:79], 0
buffer_load_dwordx4 a[132:135], v225, s[32:35], s101 offen offset:0 sc1
v_mfma_f32_16x16x32_bf16 v[188:191], a[252:255], a[92:95], v[188:191]
ds_read_b64_tr_b16 a[232:233], v211 offset:24576
v_mfma_f32_16x16x32_bf16 a[0:3], a[96:99], a[64:67], 0
s_waitcnt lgkmcnt(1)
ds_read_b64_tr_b16 a[234:235], v211 offset:25088
v_mfma_f32_16x16x32_bf16 a[0:3], a[100:103], a[80:83], a[0:3]
ds_read_b64_tr_b16 a[236:237], v211 offset:28672
v_mfma_f32_16x16x32_bf16 a[4:7], a[96:99], a[68:71], 0
ds_read_b64_tr_b16 a[238:239], v211 offset:29184
v_mfma_f32_16x16x32_bf16 a[4:7], a[100:103], a[84:87], a[4:7]
v_mfma_f32_16x16x32_bf16 a[8:11], a[96:99], a[72:75], 0
buffer_load_dwordx4 a[136:139], v226, s[32:35], s101 offen offset:0 sc1
v_mfma_f32_16x16x32_bf16 a[8:11], a[100:103], a[88:91], a[8:11]
v_mfma_f32_16x16x32_bf16 a[12:15], a[96:99], a[76:79], 0
ds_read_b64_tr_b16 a[240:241], v208 offset:8192
v_mfma_f32_16x16x32_bf16 a[12:15], a[100:103], a[92:95], a[12:15]
ds_read_b64_tr_b16 a[242:243], v208 offset:8704
v_mfma_f32_16x16x32_bf16 a[16:19], a[104:107], a[64:67], 0
ds_read_b64_tr_b16 a[244:245], v208 offset:12288
v_mfma_f32_16x16x32_bf16 a[16:19], a[108:111], a[80:83], a[16:19]
ds_read_b64_tr_b16 a[246:247], v208 offset:12800
v_mfma_f32_16x16x32_bf16 a[20:23], a[104:107], a[68:71], 0
buffer_load_dwordx4 a[140:143], v227, s[32:35], s101 offen offset:0 sc1
v_mfma_f32_16x16x32_bf16 a[20:23], a[108:111], a[84:87], a[20:23]
s_lshr_b32 s97, s62, 1
s_add_u32 s97, s97, 2048
v_mfma_f32_16x16x32_bf16 a[24:27], a[104:107], a[72:75], 0
s_mov_b32 s60, s56
v_mfma_f32_16x16x32_bf16 a[24:27], a[108:111], a[88:91], a[24:27]
v_mfma_f32_16x16x32_bf16 a[28:31], a[104:107], a[76:79], 0
s_lshl_b32 s61, s58, 3
ds_read_b64_tr_b16 a[248:249], v209 offset:8192
v_mfma_f32_16x16x32_bf16 a[28:31], a[108:111], a[92:95], a[28:31]
ds_read_b64_tr_b16 a[250:251], v209 offset:8704
s_sub_u32 s62, 120, s61
v_mfma_f32_16x16x32_bf16 a[32:35], a[224:227], a[64:67], 0
ds_read_b64_tr_b16 a[252:253], v209 offset:12288
s_add_u32 s61, s61, s60
v_mfma_f32_16x16x32_bf16 a[32:35], a[228:231], a[80:83], a[32:35]
ds_read_b64_tr_b16 a[254:255], v209 offset:12800
s_add_u32 s62, s62, s60
v_mfma_f32_16x16x32_bf16 a[36:39], a[224:227], a[68:71], 0
buffer_load_dwordx4 a[144:147], v224, s[32:35], s101 offen offset:1024 sc1
v_mfma_f32_16x16x32_bf16 a[36:39], a[228:231], a[84:87], a[36:39]
s_add_u32 s65, s61, 0
v_mfma_f32_16x16x32_bf16 a[40:43], a[224:227], a[72:75], 0
s_lshl_b32 s76, s65, 17
v_mfma_f32_16x16x32_bf16 a[40:43], a[228:231], a[88:91], a[40:43]
s_lshl_b32 s67, s57, 12
v_mfma_f32_16x16x32_bf16 a[44:47], a[224:227], a[76:79], 0
buffer_load_dwordx4 a[148:151], v225, s[32:35], s101 offen offset:1024 sc1
v_mfma_f32_16x16x32_bf16 a[44:47], a[228:231], a[92:95], a[44:47]
s_waitcnt lgkmcnt(1)
ds_read_b64_tr_b16 a[96:97], v208 offset:16384
v_mfma_f32_16x16x32_bf16 a[48:51], a[232:235], a[64:67], 0
s_add_u32 s76, s76, s67
ds_read_b64_tr_b16 a[98:99], v208 offset:16896
v_mfma_f32_16x16x32_bf16 a[48:51], a[236:239], a[80:83], a[48:51]
ds_read_b64_tr_b16 a[100:101], v208 offset:20480
s_mul_i32 s10, s65, 57344
v_mfma_f32_16x16x32_bf16 a[52:55], a[232:235], a[68:71], 0
ds_read_b64_tr_b16 a[102:103], v208 offset:20992
s_lshl_b32 s67, s57, 11
v_mfma_f32_16x16x32_bf16 a[52:55], a[236:239], a[84:87], a[52:55]
s_add_u32 s10, s10, s67
s_add_u32 s65, s61, 4
v_mfma_f32_16x16x32_bf16 a[56:59], a[232:235], a[72:75], 0
buffer_load_dwordx4 a[152:155], v226, s[32:35], s101 offen offset:1024 sc1
v_mfma_f32_16x16x32_bf16 a[56:59], a[236:239], a[88:91], a[56:59]
s_lshl_b32 s77, s65, 17
v_mfma_f32_16x16x32_bf16 a[60:63], a[232:235], a[76:79], 0
s_lshl_b32 s67, s57, 12
ds_read_b64_tr_b16 a[104:105], v209 offset:16384
v_mfma_f32_16x16x32_bf16 a[60:63], a[236:239], a[92:95], a[60:63]
ds_read_b64_tr_b16 a[106:107], v209 offset:16896
s_add_u32 s77, s77, s67
v_mfma_f32_16x16x32_bf16 v[64:67], a[240:243], a[64:67], 0
ds_read_b64_tr_b16 a[108:109], v209 offset:20480
s_mul_i32 s11, s65, 57344
v_mfma_f32_16x16x32_bf16 v[64:67], a[244:247], a[80:83], v[64:67]
ds_read_b64_tr_b16 a[110:111], v209 offset:20992
s_lshl_b32 s67, s57, 11
v_mfma_f32_16x16x32_bf16 v[68:71], a[240:243], a[68:71], 0
buffer_load_dwordx4 a[156:159], v227, s[32:35], s101 offen offset:1024 sc1
v_mfma_f32_16x16x32_bf16 v[68:71], a[244:247], a[84:87], v[68:71]
s_add_u32 s11, s11, s67
v_mfma_f32_16x16x32_bf16 v[72:75], a[240:243], a[72:75], 0
s_add_u32 s65, s62, 0
v_mfma_f32_16x16x32_bf16 v[72:75], a[244:247], a[88:91], v[72:75]
s_lshl_b32 s78, s65, 17
v_mfma_f32_16x16x32_bf16 v[76:79], a[240:243], a[76:79], 0
ds_read_b64_tr_b16 a[224:225], v210 offset:16384
s_lshl_b32 s67, s57, 12
v_mfma_f32_16x16x32_bf16 v[76:79], a[244:247], a[92:95], v[76:79]
ds_read_b64_tr_b16 a[226:227], v210 offset:16896
v_mfma_f32_16x16x32_bf16 v[80:83], a[248:251], a[64:67], 0
s_waitcnt lgkmcnt(2)
ds_read_b64_tr_b16 a[228:229], v210 offset:20480
v_mfma_f32_16x16x32_bf16 v[80:83], a[252:255], a[80:83], v[80:83]
ds_read_b64_tr_b16 a[230:231], v210 offset:20992
s_add_u32 s78, s78, s67
v_mfma_f32_16x16x32_bf16 v[84:87], a[248:251], a[68:71], 0
s_mul_i32 s12, s65, 57344
s_lshl_b32 s67, s57, 11
v_mfma_f32_16x16x32_bf16 v[84:87], a[252:255], a[84:87], v[84:87]
s_add_u32 s12, s12, s67
v_mfma_f32_16x16x32_bf16 v[88:91], a[248:251], a[72:75], 0
s_add_u32 s65, s62, 4
v_mfma_f32_16x16x32_bf16 v[88:91], a[252:255], a[88:91], v[88:91]
v_mfma_f32_16x16x32_bf16 v[92:95], a[248:251], a[76:79], 0
s_lshl_b32 s79, s65, 17
ds_read_b64_tr_b16 a[232:233], v211 offset:16384
v_mfma_f32_16x16x32_bf16 v[92:95], a[252:255], a[92:95], v[92:95]
ds_read_b64_tr_b16 a[234:235], v211 offset:16896
s_lshl_b32 s67, s57, 12
v_mfma_f32_16x16x32_bf16 v[96:99], a[96:99], a[64:67], 0
ds_read_b64_tr_b16 a[236:237], v211 offset:20480
s_add_u32 s79, s79, s67
v_mfma_f32_16x16x32_bf16 v[96:99], a[100:103], a[80:83], v[96:99]
ds_read_b64_tr_b16 a[238:239], v211 offset:20992
s_mul_i32 s13, s65, 57344
v_mfma_f32_16x16x32_bf16 v[100:103], a[96:99], a[68:71], 0
v_mfma_f32_16x16x32_bf16 v[100:103], a[100:103], a[84:87], v[100:103]
s_lshl_b32 s67, s57, 11
v_mfma_f32_16x16x32_bf16 v[104:107], a[96:99], a[72:75], 0
s_add_u32 s13, s13, s67
v_mfma_f32_16x16x32_bf16 v[104:107], a[100:103], a[88:91], v[104:107]
v_and_b32 v212, 15, v243
v_mfma_f32_16x16x32_bf16 v[108:111], a[96:99], a[76:79], 0
v_mfma_f32_16x16x32_bf16 v[108:111], a[100:103], a[92:95], v[108:111]
s_waitcnt vmcnt(16)
s_barrier
s_add_u32 m0, s100, 0
v_mfma_f32_16x16x32_bf16 v[112:115], a[104:107], a[64:67], 0
ds_read_b64_tr_b16 a[240:241], v232 offset:32768
v_lshrrev_b32 v213, 4, v243
v_mfma_f32_16x16x32_bf16 v[112:115], a[108:111], a[80:83], v[112:115]
ds_read_b64_tr_b16 a[242:243], v232 offset:33280
s_add_u32 s98, s98, s99
v_mfma_f32_16x16x32_bf16 v[116:119], a[104:107], a[68:71], 0
ds_read_b64_tr_b16 a[244:245], v232 offset:36864
v_lshlrev_b32 v213, 2, v213
v_mfma_f32_16x16x32_bf16 v[116:119], a[108:111], a[84:87], v[116:119]
ds_read_b64_tr_b16 a[246:247], v232 offset:37376
v_mfma_f32_16x16x32_bf16 v[120:123], a[104:107], a[72:75], 0
buffer_load_dwordx4 v228, s[28:31], s98 offen offset:0 lds
v_mfma_f32_16x16x32_bf16 v[120:123], a[108:111], a[88:91], v[120:123]
v_sub_u32 v212, v212, v213
v_mfma_f32_16x16x32_bf16 v[124:127], a[104:107], a[76:79], 0
ds_read_b64_tr_b16 a[248:249], v233 offset:32768
v_mfma_f32_16x16x32_bf16 v[124:127], a[108:111], a[92:95], v[124:127]
s_waitcnt lgkmcnt(4)
ds_read_b64_tr_b16 a[250:251], v233 offset:33280
v_mfma_f32_16x16x32_bf16 v[128:131], a[224:227], a[64:67], 0
ds_read_b64_tr_b16 a[252:253], v233 offset:36864
v_mov_b32 v213, 0xf149f2ca
v_mfma_f32_16x16x32_bf16 v[128:131], a[228:231], a[80:83], v[128:131]
ds_read_b64_tr_b16 a[254:255], v233 offset:37376
v_mfma_f32_16x16x32_bf16 v[132:135], a[224:227], a[68:71], 0
buffer_load_dwordx4 v229, s[28:31], s98 offen offset:1024 lds
v_mfma_f32_16x16x32_bf16 v[132:135], a[228:231], a[84:87], v[132:135]
v_mfma_f32_16x16x32_bf16 v[136:139], a[224:227], a[72:75], 0
v_mfma_f32_16x16x32_bf16 v[136:139], a[228:231], a[88:91], v[136:139]
v_mfma_f32_16x16x32_bf16 v[140:143], a[224:227], a[76:79], 0
ds_read_b64_tr_b16 a[96:97], v234 offset:32768
v_mfma_f32_16x16x32_bf16 v[140:143], a[228:231], a[92:95], v[140:143]
buffer_load_dwordx4 v230, s[28:31], s98 offen offset:2048 lds
v_mfma_f32_16x16x32_bf16 v[144:147], a[232:235], a[64:67], 0
ds_read_b64_tr_b16 a[98:99], v234 offset:33280
v_mfma_f32_16x16x32_bf16 v[144:147], a[236:239], a[80:83], v[144:147]
ds_read_b64_tr_b16 a[100:101], v234 offset:36864
v_mfma_f32_16x16x32_bf16 v[148:151], a[232:235], a[68:71], 0
ds_read_b64_tr_b16 a[102:103], v234 offset:37376
v_mfma_f32_16x16x32_bf16 v[148:151], a[236:239], a[84:87], v[148:151]
v_mfma_f32_16x16x32_bf16 v[152:155], a[232:235], a[72:75], 0
v_mfma_f32_16x16x32_bf16 v[152:155], a[236:239], a[88:91], v[152:155]
buffer_load_dwordx4 v231, s[28:31], s98 offen offset:3072 lds
v_cmp_gt_i32 vcc, 0, v212
v_mov_b32 v244, v213
v_mov_b32 v248, 0x3f803f80
v_cndmask_b32 v252, 0, v213, vcc
v_mfma_f32_16x16x32_bf16 v[156:159], a[232:235], a[76:79], 0
ds_read_b64_tr_b16 a[104:105], v235 offset:32768
v_mfma_f32_16x16x32_bf16 v[156:159], a[236:239], a[92:95], v[156:159]
s_waitcnt lgkmcnt(3)
ds_read_b64_tr_b16 a[106:107], v235 offset:33280
v_mfma_f32_16x16x32_bf16 v[0:3], a[240:243], a[192:195], v[0:3]
ds_read_b64_tr_b16 a[108:109], v235 offset:36864
v_mfma_f32_16x16x32_bf16 v[0:3], a[244:247], a[208:211], v[0:3]
ds_read_b64_tr_b16 a[110:111], v235 offset:37376
v_mfma_f32_16x16x32_bf16 v[4:7], a[240:243], a[196:199], v[4:7]
v_mfma_f32_16x16x32_bf16 v[4:7], a[244:247], a[212:215], v[4:7]
s_add_u32 m0, s100, 4096
v_mfma_f32_16x16x32_bf16 v[8:11], a[240:243], a[200:203], v[8:11]
v_mfma_f32_16x16x32_bf16 v[8:11], a[244:247], a[216:219], v[8:11]
s_add_u32 s98, s98, s99
v_mfma_f32_16x16x32_bf16 v[12:15], a[240:243], a[204:207], v[12:15]
ds_read_b64_tr_b16 a[224:225], v232 offset:40960
v_mfma_f32_16x16x32_bf16 v[12:15], a[244:247], a[220:223], v[12:15]
ds_read_b64_tr_b16 a[226:227], v232 offset:41472
v_cmp_gt_i32 vcc, 1, v212
v_mov_b32 v245, v213
v_mov_b32 v249, 0x3f803f80
v_cndmask_b32 v253, 0, v213, vcc
v_mfma_f32_16x16x32_bf16 v[16:19], a[248:251], a[192:195], v[16:19]
buffer_load_dwordx4 v228, s[28:31], s98 offen offset:0 lds
v_mfma_f32_16x16x32_bf16 v[16:19], a[252:255], a[208:211], v[16:19]
ds_read_b64_tr_b16 a[228:229], v232 offset:45056
v_mfma_f32_16x16x32_bf16 v[20:23], a[248:251], a[196:199], v[20:23]
ds_read_b64_tr_b16 a[230:231], v232 offset:45568
v_mfma_f32_16x16x32_bf16 v[20:23], a[252:255], a[212:215], v[20:23]
v_mfma_f32_16x16x32_bf16 v[24:27], a[248:251], a[200:203], v[24:27]
v_mfma_f32_16x16x32_bf16 v[24:27], a[252:255], a[216:219], v[24:27]
buffer_load_dwordx4 v229, s[28:31], s98 offen offset:1024 lds
v_mfma_f32_16x16x32_bf16 v[28:31], a[248:251], a[204:207], v[28:31]
ds_read_b64_tr_b16 a[232:233], v233 offset:40960
v_mfma_f32_16x16x32_bf16 v[28:31], a[252:255], a[220:223], v[28:31]
ds_read_b64_tr_b16 a[234:235], v233 offset:41472
v_mfma_f32_16x16x32_bf16 v[32:35], a[96:99], a[192:195], v[32:35]
s_waitcnt lgkmcnt(3)
ds_read_b64_tr_b16 a[236:237], v233 offset:45056
v_cmp_gt_i32 vcc, 2, v212
v_mov_b32 v246, v213
v_mov_b32 v250, 0x3f803f80
v_cndmask_b32 v254, 0, v213, vcc
v_mfma_f32_16x16x32_bf16 v[32:35], a[100:103], a[208:211], v[32:35]
ds_read_b64_tr_b16 a[238:239], v233 offset:45568
v_mfma_f32_16x16x32_bf16 v[36:39], a[96:99], a[196:199], v[36:39]
v_mfma_f32_16x16x32_bf16 v[36:39], a[100:103], a[212:215], v[36:39]
v_mfma_f32_16x16x32_bf16 v[40:43], a[96:99], a[200:203], v[40:43]
buffer_load_dwordx4 v230, s[28:31], s98 offen offset:2048 lds
v_mfma_f32_16x16x32_bf16 v[40:43], a[100:103], a[216:219], v[40:43]
v_mfma_f32_16x16x32_bf16 v[44:47], a[96:99], a[204:207], v[44:47]
ds_read_b64_tr_b16 a[240:241], v234 offset:40960
v_mfma_f32_16x16x32_bf16 v[44:47], a[100:103], a[220:223], v[44:47]
ds_read_b64_tr_b16 a[242:243], v234 offset:41472
v_mfma_f32_16x16x32_bf16 v[48:51], a[104:107], a[192:195], v[48:51]
ds_read_b64_tr_b16 a[244:245], v234 offset:45056
v_mfma_f32_16x16x32_bf16 v[48:51], a[108:111], a[208:211], v[48:51]
ds_read_b64_tr_b16 a[246:247], v234 offset:45568
v_mfma_f32_16x16x32_bf16 v[52:55], a[104:107], a[196:199], v[52:55]
buffer_load_dwordx4 v231, s[28:31], s98 offen offset:3072 lds
v_cmp_gt_i32 vcc, 3, v212
v_mov_b32 v247, v213
v_mov_b32 v251, 0x3f803f80
v_cndmask_b32 v255, 0, v213, vcc
v_mfma_f32_16x16x32_bf16 v[52:55], a[108:111], a[212:215], v[52:55]
s_lshl_b32 s67, s58, 2
s_cmp_eq_u32 s58, 0
s_cselect_b32 s60, s56, 64
v_mfma_f32_16x16x32_bf16 v[56:59], a[104:107], a[200:203], v[56:59]
s_cmp_eq_u32 s58, 7
s_cselect_b32 s61, s56, 64
v_mfma_f32_16x16x32_bf16 v[56:59], a[108:111], a[216:219], v[56:59]
v_mfma_f32_16x16x32_bf16 v[60:63], a[104:107], a[204:207], v[60:63]
ds_read_b64_tr_b16 a[248:249], v235 offset:40960
v_mfma_f32_16x16x32_bf16 v[60:63], a[108:111], a[220:223], v[60:63]
ds_read_b64_tr_b16 a[250:251], v235 offset:41472
s_sub_u32 s62, 64, s67
v_mfma_f32_16x16x32_bf16 v[64:67], a[224:227], a[192:195], v[64:67]
s_waitcnt lgkmcnt(2)
ds_read_b64_tr_b16 a[252:253], v235 offset:45056
v_mfma_f32_16x16x32_bf16 v[64:67], a[228:231], a[208:211], v[64:67]
ds_read_b64_tr_b16 a[254:255], v235 offset:45568
s_lshl_b32 s63, s56, 12
v_mfma_f32_16x16x32_bf16 v[68:71], a[224:227], a[196:199], v[68:71]
s_and_b32 s67, s56, 1
v_mfma_f32_16x16x32_bf16 v[68:71], a[228:231], a[212:215], v[68:71]
s_lshl_b32 s67, s67, 12
v_mfma_f32_16x16x32_bf16 v[72:75], a[224:227], a[200:203], v[72:75]
s_mov_b32 s66, 98304
v_mfma_f32_16x16x32_bf16 v[72:75], a[228:231], a[216:219], v[72:75]
s_mov_b32 s64, 131072
v_mfma_f32_16x16x32_bf16 v[76:79], a[224:227], a[204:207], v[76:79]
ds_read_b64_tr_b16 a[96:97], v232 offset:57344
v_mfma_f32_16x16x32_bf16 v[76:79], a[228:231], a[220:223], v[76:79]
buffer_load_dwordx4 a[64:67], v224, s[32:35], s101 offen offset:2048 sc1
v_mfma_f32_16x16x32_bf16 v[80:83], a[232:235], a[192:195], v[80:83]
ds_read_b64_tr_b16 a[98:99], v232 offset:57856
v_mfma_f32_16x16x32_bf16 v[80:83], a[236:239], a[208:211], v[80:83]
ds_read_b64_tr_b16 a[100:101], v232 offset:61440
v_mfma_f32_16x16x32_bf16 v[84:87], a[232:235], a[196:199], v[84:87]
ds_read_b64_tr_b16 a[102:103], v232 offset:61952
v_mfma_f32_16x16x32_bf16 v[84:87], a[236:239], a[212:215], v[84:87]
v_mfma_f32_16x16x32_bf16 v[88:91], a[232:235], a[200:203], v[88:91]
buffer_load_dwordx4 a[68:71], v225, s[32:35], s101 offen offset:2048 sc1
v_mfma_f32_16x16x32_bf16 v[88:91], a[236:239], a[216:219], v[88:91]
s_cmp_lt_u32 s56, 2
s_cselect_b32 s66, s66, 32768
s_cselect_b32 s64, s64, 65536
s_cselect_b32 s6, 32768, 0
v_mfma_f32_16x16x32_bf16 v[92:95], a[232:235], a[204:207], v[92:95]
s_add_u32 s66, s66, s67
s_add_u32 s64, s64, s63
s_add_u32 s6, s6, s66
v_mfma_f32_16x16x32_bf16 v[92:95], a[236:239], a[220:223], v[92:95]
ds_read_b64_tr_b16 a[104:105], v232 offset:49152
s_mov_b32 s74, 0x1f800000
L_c1200:
v_mfma_f32_16x16x32_bf16 v[160:163], a[240:243], a[192:195], v[160:163]
ds_read_b64_tr_b16 a[106:107], v232 offset:49664
s_mov_b32 s75, 0x5f800000
v_mfma_f32_16x16x32_bf16 v[160:163], a[244:247], a[208:211], v[160:163]
ds_read_b64_tr_b16 a[108:109], v232 offset:53248
s_mov_b64 s[72:73], 0
v_mfma_f32_16x16x32_bf16 v[164:167], a[240:243], a[196:199], v[164:167]
ds_read_b64_tr_b16 a[110:111], v232 offset:53760
s_mov_b32 s7, 0
v_mfma_f32_16x16x32_bf16 v[164:167], a[244:247], a[212:215], v[164:167]
buffer_load_dwordx4 a[72:75], v226, s[32:35], s101 offen offset:2048 sc1
v_mfma_f32_16x16x32_bf16 v[168:171], a[240:243], a[200:203], v[168:171]
s_mov_b32 s65, s64
v_mfma_f32_16x16x32_bf16 v[168:171], a[244:247], a[216:219], v[168:171]
s_mov_b32 s68, 32768
v_mfma_f32_16x16x32_bf16 v[172:175], a[240:243], a[204:207], v[172:175]
ds_read_b64_tr_b16 a[224:225], v233 offset:57344
v_mfma_f32_16x16x32_bf16 v[172:175], a[244:247], a[220:223], v[172:175]
s_waitcnt lgkmcnt(3)
s_cmp_lt_u32 s56, 2
s_cselect_b32 s67, s68, 32768
v_mfma_f32_16x16x32_bf16 v[176:179], a[248:251], a[192:195], v[176:179]
ds_read_b64_tr_b16 a[226:227], v233 offset:57856
v_mfma_f32_16x16x32_bf16 v[176:179], a[252:255], a[208:211], v[176:179]
ds_read_b64_tr_b16 a[228:229], v233 offset:61440
s_mov_b32 s70, 0
v_mfma_f32_16x16x32_bf16 v[180:183], a[248:251], a[196:199], v[180:183]
ds_read_b64_tr_b16 a[230:231], v233 offset:61952
v_add_u32 v240, 131072, v242
v_mfma_f32_16x16x32_bf16 v[180:183], a[252:255], a[212:215], v[180:183]
buffer_load_dwordx4 a[76:79], v227, s[32:35], s101 offen offset:2048 sc1
v_mfma_f32_16x16x32_bf16 v[184:187], a[248:251], a[200:203], v[184:187]
v_add_u32 v241, 32768, v242
v_mfma_f32_16x16x32_bf16 v[184:187], a[252:255], a[216:219], v[184:187]
v_mfma_f32_16x16x32_bf16 v[188:191], a[248:251], a[204:207], v[188:191]
ds_read_b64_tr_b16 a[232:233], v233 offset:49152
v_mfma_f32_16x16x32_bf16 v[188:191], a[252:255], a[220:223], v[188:191]
ds_read_b64_tr_b16 a[234:235], v233 offset:49664
s_mul_i32 s8, s57, 1048576
v_mfma_f32_16x16x32_bf16 a[0:3], a[96:99], a[192:195], a[0:3]
ds_read_b64_tr_b16 a[236:237], v233 offset:53248
s_add_u32 s8, s8, 2097152
v_mfma_f32_16x16x32_bf16 a[0:3], a[100:103], a[208:211], a[0:3]
buffer_load_dwordx4 a[80:83], v224, s[32:35], s101 offen offset:3072 sc1
v_mfma_f32_16x16x32_bf16 a[4:7], a[96:99], a[196:199], a[4:7]
ds_read_b64_tr_b16 a[238:239], v233 offset:53760
v_mfma_f32_16x16x32_bf16 a[4:7], a[100:103], a[212:215], a[4:7]
s_add_u32 s40, s26, s8
s_addc_u32 s41, s27, 0
v_mfma_f32_16x16x32_bf16 a[8:11], a[96:99], a[200:203], a[8:11]
s_add_u32 s36, s26, 35651584
s_addc_u32 s37, s27, 0
v_mfma_f32_16x16x32_bf16 a[8:11], a[100:103], a[216:219], a[8:11]
buffer_load_dwordx4 a[84:87], v225, s[32:35], s101 offen offset:3072 sc1
v_mfma_f32_16x16x32_bf16 a[12:15], a[96:99], a[204:207], a[12:15]
ds_read_b64_tr_b16 a[240:241], v234 offset:57344
s_mov_b32 s38, 7340032
v_mfma_f32_16x16x32_bf16 a[12:15], a[100:103], a[220:223], a[12:15]
ds_read_b64_tr_b16 a[242:243], v234 offset:57856
s_mov_b32 s39, 0x20000
v_mfma_f32_16x16x32_bf16 v[96:99], a[104:107], a[192:195], v[96:99]
s_waitcnt lgkmcnt(3)
ds_read_b64_tr_b16 a[244:245], v234 offset:61440
v_mfma_f32_16x16x32_bf16 v[96:99], a[108:111], a[208:211], v[96:99]
ds_read_b64_tr_b16 a[246:247], v234 offset:61952
v_mfma_f32_16x16x32_bf16 v[100:103], a[104:107], a[196:199], v[100:103]
s_cmp_lt_u32 s57, 28
s_cselect_b32 s38, s38, 0
v_mfma_f32_16x16x32_bf16 v[100:103], a[108:111], a[212:215], v[100:103]
s_add_u32 s44, s26, 44040192
s_addc_u32 s45, s27, 0
v_mfma_f32_16x16x32_bf16 v[104:107], a[104:107], a[200:203], v[104:107]
buffer_load_dwordx4 a[88:91], v226, s[32:35], s101 offen offset:3072 sc1
v_mfma_f32_16x16x32_bf16 v[104:107], a[108:111], a[216:219], v[104:107]
v_mfma_f32_16x16x32_bf16 v[108:111], a[104:107], a[204:207], v[108:111]
s_mov_b32 s46, 16777216
ds_read_b64_tr_b16 a[248:249], v234 offset:49152
v_mfma_f32_16x16x32_bf16 v[108:111], a[108:111], a[220:223], v[108:111]
ds_read_b64_tr_b16 a[250:251], v234 offset:49664
s_mov_b32 s47, 0x20000
v_mfma_f32_16x16x32_bf16 a[16:19], a[224:227], a[192:195], a[16:19]
ds_read_b64_tr_b16 a[252:253], v234 offset:53248
v_mfma_f32_16x16x32_bf16 a[16:19], a[228:231], a[208:211], a[16:19]
ds_read_b64_tr_b16 a[254:255], v234 offset:53760
v_mfma_f32_16x16x32_bf16 a[20:23], a[224:227], a[196:199], a[20:23]
buffer_load_dwordx4 a[92:95], v227, s[32:35], s101 offen offset:3072 sc1
v_mfma_f32_16x16x32_bf16 a[20:23], a[228:231], a[212:215], a[20:23]
v_mfma_f32_16x16x32_bf16 a[24:27], a[224:227], a[200:203], a[24:27]
v_mfma_f32_16x16x32_bf16 a[24:27], a[228:231], a[216:219], a[24:27]
v_mfma_f32_16x16x32_bf16 a[28:31], a[224:227], a[204:207], a[28:31]
ds_read_b64_tr_b16 a[96:97], v235 offset:57344
v_mfma_f32_16x16x32_bf16 a[28:31], a[228:231], a[220:223], a[28:31]
ds_read_b64_tr_b16 a[98:99], v235 offset:57856
v_mfma_f32_16x16x32_bf16 v[112:115], a[232:235], a[192:195], v[112:115]
s_waitcnt lgkmcnt(2)
ds_read_b64_tr_b16 a[100:101], v235 offset:61440
v_mfma_f32_16x16x32_bf16 v[112:115], a[236:239], a[208:211], v[112:115]
ds_read_b64_tr_b16 a[102:103], v235 offset:61952
v_mfma_f32_16x16x32_bf16 v[116:119], a[232:235], a[196:199], v[116:119]
v_mfma_f32_16x16x32_bf16 v[116:119], a[236:239], a[212:215], v[116:119]
v_mfma_f32_16x16x32_bf16 v[120:123], a[232:235], a[200:203], v[120:123]
v_mfma_f32_16x16x32_bf16 v[120:123], a[236:239], a[216:219], v[120:123]
v_mfma_f32_16x16x32_bf16 v[124:127], a[232:235], a[204:207], v[124:127]
ds_read_b64_tr_b16 a[104:105], v235 offset:49152
v_mfma_f32_16x16x32_bf16 v[124:127], a[236:239], a[220:223], v[124:127]
ds_read_b64_tr_b16 a[106:107], v235 offset:49664
v_mfma_f32_16x16x32_bf16 a[32:35], a[240:243], a[192:195], a[32:35]
ds_read_b64_tr_b16 a[108:109], v235 offset:53248
v_mfma_f32_16x16x32_bf16 a[32:35], a[244:247], a[208:211], a[32:35]
ds_read_b64_tr_b16 a[110:111], v235 offset:53760
v_mfma_f32_16x16x32_bf16 a[36:39], a[240:243], a[196:199], a[36:39]
v_mfma_f32_16x16x32_bf16 a[36:39], a[244:247], a[212:215], a[36:39]
v_mfma_f32_16x16x32_bf16 a[40:43], a[240:243], a[200:203], a[40:43]
s_lshl_b32 s8, s2, 2
v_mfma_f32_16x16x32_bf16 a[40:43], a[244:247], a[216:219], a[40:43]
v_mfma_f32_16x16x32_bf16 a[44:47], a[240:243], a[204:207], a[44:47]
s_add_u32 s8, s8, s56
v_mfma_f32_16x16x32_bf16 a[44:47], a[244:247], a[220:223], a[44:47]
s_waitcnt vmcnt(16)
s_barrier
s_cmp_lg_u32 s56, 0
s_cbranch_scc1 L_sig8
s_mov_b64 exec, 1
buffer_atomic_add v223, v222, s[48:51], s97 offen sc1
s_mov_b64 exec, -1
L_sig8:
v_mfma_f32_16x16x32_bf16 v[128:131], a[248:251], a[192:195], v[128:131]
ds_read_b64_tr_b16 a[224:225], v232 offset:0
s_add_u32 m0, s100, 32768
v_mfma_f32_16x16x32_bf16 v[128:131], a[252:255], a[208:211], v[128:131]
ds_read_b64_tr_b16 a[226:227], v232 offset:512
s_add_u32 s98, s98, s99
v_mfma_f32_16x16x32_bf16 v[132:135], a[248:251], a[196:199], v[132:135]
ds_read_b64_tr_b16 a[228:229], v232 offset:4096
s_mul_i32 s9, s8, 1792
v_mfma_f32_16x16x32_bf16 v[132:135], a[252:255], a[212:215], v[132:135]
ds_read_b64_tr_b16 a[230:231], v232 offset:4608
s_lshl_b32 s8, s8, 12
s_lshr_b32 s0, s2, 3
s_cmp_lg_u32 s0, 8
s_cbranch_scc1 L_ct14
s_lshl_b32 s0, s56, 13
v_lshl_add_u32 v221, v243, 7, s0
v_min_u32 v221, 8192-4, v221
s_getpc_b64 s[0:1]
L_cp14:
s_add_u32 s0, s0, L_c1600-L_cp14
s_addc_u32 s1, s1, 0
global_load_dword v213, v221, s[0:1]
L_ct14:
v_mfma_f32_16x16x32_bf16 v[136:139], a[248:251], a[200:203], v[136:139]
buffer_load_dwordx4 v228, s[28:31], s98 offen offset:0 lds
v_mfma_f32_16x16x32_bf16 v[136:139], a[252:255], a[216:219], v[136:139]
v_add_u32 v214, s8, v242
v_mfma_f32_16x16x32_bf16 v[140:143], a[248:251], a[204:207], v[140:143]
ds_read_b64_tr_b16 a[232:233], v233 offset:0
v_mfma_f32_16x16x32_bf16 v[140:143], a[252:255], a[220:223], v[140:143]
s_waitcnt lgkmcnt(4)
ds_read_b64_tr_b16 a[234:235], v233 offset:512
v_mfma_f32_16x16x32_bf16 a[48:51], a[96:99], a[192:195], a[48:51]
ds_read_b64_tr_b16 a[236:237], v233 offset:4096
v_add_u32 v215, s9, v242
v_mfma_f32_16x16x32_bf16 a[48:51], a[100:103], a[208:211], a[48:51]
ds_read_b64_tr_b16 a[238:239], v233 offset:4608
v_mfma_f32_16x16x32_bf16 a[52:55], a[96:99], a[196:199], a[52:55]
buffer_load_dwordx4 v229, s[28:31], s98 offen offset:1024 lds
v_mfma_f32_16x16x32_bf16 a[52:55], a[100:103], a[212:215], a[52:55]
v_mfma_f32_16x16x32_bf16 a[56:59], a[96:99], a[200:203], a[56:59]
v_min_u32 v215, 1833968, v215
v_mfma_f32_16x16x32_bf16 a[56:59], a[100:103], a[216:219], a[56:59]
v_mfma_f32_16x16x32_bf16 a[60:63], a[96:99], a[204:207], a[60:63]
ds_read_b64_tr_b16 a[240:241], v234 offset:0
v_mfma_f32_16x16x32_bf16 a[60:63], a[100:103], a[220:223], a[60:63]
buffer_load_dwordx4 v230, s[28:31], s98 offen offset:2048 lds
v_mfma_f32_16x16x32_bf16 v[144:147], a[104:107], a[192:195], v[144:147]
ds_read_b64_tr_b16 a[242:243], v234 offset:512
v_mfma_f32_16x16x32_bf16 v[144:147], a[108:111], a[208:211], v[144:147]
ds_read_b64_tr_b16 a[244:245], v234 offset:4096
v_mfma_f32_16x16x32_bf16 v[148:151], a[104:107], a[196:199], v[148:151]
ds_read_b64_tr_b16 a[246:247], v234 offset:4608
v_mfma_f32_16x16x32_bf16 v[148:151], a[108:111], a[212:215], v[148:151]
v_mfma_f32_16x16x32_bf16 v[152:155], a[104:107], a[200:203], v[152:155]
v_mfma_f32_16x16x32_bf16 v[152:155], a[108:111], a[216:219], v[152:155]
buffer_load_dwordx4 v231, s[28:31], s98 offen offset:3072 lds
v_mfma_f32_16x16x32_bf16 v[156:159], a[104:107], a[204:207], v[156:159]
ds_read_b64_tr_b16 a[248:249], v235 offset:0
v_mfma_f32_16x16x32_bf16 v[156:159], a[108:111], a[220:223], v[156:159]
s_waitcnt lgkmcnt(3)
ds_read_b64_tr_b16 a[250:251], v235 offset:512
v_mfma_f32_16x16x32_bf16 v[0:3], a[224:227], a[128:131], v[0:3]
ds_read_b64_tr_b16 a[252:253], v235 offset:4096
v_mfma_f32_16x16x32_bf16 v[0:3], a[228:231], a[144:147], v[0:3]
ds_read_b64_tr_b16 a[254:255], v235 offset:4608
v_mfma_f32_16x16x32_bf16 v[4:7], a[224:227], a[132:135], v[4:7]
global_load_dwordx4 v[216:219], v214, s[14:15] offset:0
v_mfma_f32_16x16x32_bf16 v[4:7], a[228:231], a[148:151], v[4:7]
s_add_u32 m0, s100, 36864
v_mfma_f32_16x16x32_bf16 v[8:11], a[224:227], a[136:139], v[8:11]
v_mfma_f32_16x16x32_bf16 v[8:11], a[228:231], a[152:155], v[8:11]
s_add_u32 s98, s98, s99
v_mfma_f32_16x16x32_bf16 v[12:15], a[224:227], a[140:143], v[12:15]
ds_read_b64_tr_b16 a[96:97], v232 offset:8192
v_mfma_f32_16x16x32_bf16 v[12:15], a[228:231], a[156:159], v[12:15]
ds_read_b64_tr_b16 a[98:99], v232 offset:8704
v_mfma_f32_16x16x32_bf16 v[16:19], a[232:235], a[128:131], v[16:19]
buffer_load_dwordx4 v228, s[28:31], s98 offen offset:0 lds
v_mfma_f32_16x16x32_bf16 v[16:19], a[236:239], a[144:147], v[16:19]
ds_read_b64_tr_b16 a[100:101], v232 offset:12288
v_mfma_f32_16x16x32_bf16 v[20:23], a[232:235], a[132:135], v[20:23]
ds_read_b64_tr_b16 a[102:103], v232 offset:12800
v_mfma_f32_16x16x32_bf16 v[20:23], a[236:239], a[148:151], v[20:23]
v_mfma_f32_16x16x32_bf16 v[24:27], a[232:235], a[136:139], v[24:27]
v_mfma_f32_16x16x32_bf16 v[24:27], a[236:239], a[152:155], v[24:27]
buffer_load_dwordx4 v229, s[28:31], s98 offen offset:1024 lds
v_mfma_f32_16x16x32_bf16 v[28:31], a[232:235], a[140:143], v[28:31]
ds_read_b64_tr_b16 a[104:105], v233 offset:8192
v_mfma_f32_16x16x32_bf16 v[28:31], a[236:239], a[156:159], v[28:31]
ds_read_b64_tr_b16 a[106:107], v233 offset:8704
v_mfma_f32_16x16x32_bf16 v[32:35], a[240:243], a[128:131], v[32:35]
s_waitcnt lgkmcnt(3)
ds_read_b64_tr_b16 a[108:109], v233 offset:12288
v_mfma_f32_16x16x32_bf16 v[32:35], a[244:247], a[144:147], v[32:35]
ds_read_b64_tr_b16 a[110:111], v233 offset:12800
v_mfma_f32_16x16x32_bf16 v[36:39], a[240:243], a[132:135], v[36:39]
v_mfma_f32_16x16x32_bf16 v[36:39], a[244:247], a[148:151], v[36:39]
v_mfma_f32_16x16x32_bf16 v[40:43], a[240:243], a[136:139], v[40:43]
buffer_load_dwordx4 v230, s[28:31], s98 offen offset:2048 lds
v_mfma_f32_16x16x32_bf16 v[40:43], a[244:247], a[152:155], v[40:43]
v_mfma_f32_16x16x32_bf16 v[44:47], a[240:243], a[140:143], v[44:47]
ds_read_b64_tr_b16 a[224:225], v234 offset:8192
v_mfma_f32_16x16x32_bf16 v[44:47], a[244:247], a[156:159], v[44:47]
ds_read_b64_tr_b16 a[226:227], v234 offset:8704
v_mfma_f32_16x16x32_bf16 v[48:51], a[248:251], a[128:131], v[48:51]
ds_read_b64_tr_b16 a[228:229], v234 offset:12288
v_mfma_f32_16x16x32_bf16 v[48:51], a[252:255], a[144:147], v[48:51]
ds_read_b64_tr_b16 a[230:231], v234 offset:12800
v_mfma_f32_16x16x32_bf16 v[52:55], a[248:251], a[132:135], v[52:55]
buffer_load_dwordx4 v231, s[28:31], s98 offen offset:3072 lds
v_mfma_f32_16x16x32_bf16 v[52:55], a[252:255], a[148:151], v[52:55]
v_mfma_f32_16x16x32_bf16 v[56:59], a[248:251], a[136:139], v[56:59]
v_mfma_f32_16x16x32_bf16 v[56:59], a[252:255], a[152:155], v[56:59]
v_mfma_f32_16x16x32_bf16 v[60:63], a[248:251], a[140:143], v[60:63]
ds_read_b64_tr_b16 a[232:233], v235 offset:8192
v_mfma_f32_16x16x32_bf16 v[60:63], a[252:255], a[156:159], v[60:63]
ds_read_b64_tr_b16 a[234:235], v235 offset:8704
v_mfma_f32_16x16x32_bf16 v[64:67], a[96:99], a[128:131], v[64:67]
s_waitcnt lgkmcnt(2)
ds_read_b64_tr_b16 a[236:237], v235 offset:12288
v_mfma_f32_16x16x32_bf16 v[64:67], a[100:103], a[144:147], v[64:67]
ds_read_b64_tr_b16 a[238:239], v235 offset:12800
v_mfma_f32_16x16x32_bf16 v[68:71], a[96:99], a[132:135], v[68:71]
v_mfma_f32_16x16x32_bf16 v[68:71], a[100:103], a[148:151], v[68:71]
v_mfma_f32_16x16x32_bf16 v[72:75], a[96:99], a[136:139], v[72:75]
v_mfma_f32_16x16x32_bf16 v[72:75], a[100:103], a[152:155], v[72:75]
v_mfma_f32_16x16x32_bf16 v[76:79], a[96:99], a[140:143], v[76:79]
ds_read_b64_tr_b16 a[240:241], v232 offset:24576
s_mov_b32 s101, 8192
v_mfma_f32_16x16x32_bf16 v[76:79], a[100:103], a[156:159], v[76:79]
ds_read_b64_tr_b16 a[242:243], v232 offset:25088
v_mfma_f32_16x16x32_bf16 v[80:83], a[104:107], a[128:131], v[80:83]
ds_read_b64_tr_b16 a[244:245], v232 offset:28672
v_mfma_f32_16x16x32_bf16 v[80:83], a[108:111], a[144:147], v[80:83]
ds_read_b64_tr_b16 a[246:247], v232 offset:29184
v_mfma_f32_16x16x32_bf16 v[84:87], a[104:107], a[132:135], v[84:87]
buffer_load_dwordx4 a[192:195], v224, s[32:35], s101 offen offset:0 sc1
v_mfma_f32_16x16x32_bf16 v[84:87], a[108:111], a[148:151], v[84:87]
global_load_dwordx4 v[216:219], v214, s[14:15] offset:1024
v_mfma_f32_16x16x32_bf16 v[88:91], a[104:107], a[136:139], v[88:91]
v_mfma_f32_16x16x32_bf16 v[88:91], a[108:111], a[152:155], v[88:91]
v_mfma_f32_16x16x32_bf16 v[92:95], a[104:107], a[140:143], v[92:95]
buffer_load_dwordx4 a[196:199], v225, s[32:35], s101 offen offset:0 sc1
v_mfma_f32_16x16x32_bf16 v[92:95], a[108:111], a[156:159], v[92:95]
ds_read_b64_tr_b16 a[248:249], v232 offset:16384
v_mfma_f32_16x16x32_bf16 v[160:163], a[224:227], a[128:131], v[160:163]
ds_read_b64_tr_b16 a[250:251], v232 offset:16896
v_mfma_f32_16x16x32_bf16 v[160:163], a[228:231], a[144:147], v[160:163]
ds_read_b64_tr_b16 a[252:253], v232 offset:20480
v_mfma_f32_16x16x32_bf16 v[164:167], a[224:227], a[132:135], v[164:167]
ds_read_b64_tr_b16 a[254:255], v232 offset:20992
v_mfma_f32_16x16x32_bf16 v[164:167], a[228:231], a[148:151], v[164:167]
v_mfma_f32_16x16x32_bf16 v[168:171], a[224:227], a[136:139], v[168:171]
buffer_load_dwordx4 a[200:203], v226, s[32:35], s101 offen offset:0 sc1
v_mfma_f32_16x16x32_bf16 v[168:171], a[228:231], a[152:155], v[168:171]
v_mfma_f32_16x16x32_bf16 v[172:175], a[224:227], a[140:143], v[172:175]
ds_read_b64_tr_b16 a[96:97], v233 offset:24576
v_mfma_f32_16x16x32_bf16 v[172:175], a[228:231], a[156:159], v[172:175]
s_waitcnt lgkmcnt(3)
ds_read_b64_tr_b16 a[98:99], v233 offset:25088
v_mfma_f32_16x16x32_bf16 v[176:179], a[232:235], a[128:131], v[176:179]
ds_read_b64_tr_b16 a[100:101], v233 offset:28672
v_mfma_f32_16x16x32_bf16 v[176:179], a[236:239], a[144:147], v[176:179]
ds_read_b64_tr_b16 a[102:103], v233 offset:29184
v_mfma_f32_16x16x32_bf16 v[180:183], a[232:235], a[132:135], v[180:183]
buffer_load_dwordx4 a[204:207], v227, s[32:35], s101 offen offset:0 sc1
v_mfma_f32_16x16x32_bf16 v[180:183], a[236:239], a[148:151], v[180:183]
v_mfma_f32_16x16x32_bf16 v[184:187], a[232:235], a[136:139], v[184:187]
v_mfma_f32_16x16x32_bf16 v[184:187], a[236:239], a[152:155], v[184:187]
v_mfma_f32_16x16x32_bf16 v[188:191], a[232:235], a[140:143], v[188:191]
ds_read_b64_tr_b16 a[104:105], v233 offset:16384
v_mfma_f32_16x16x32_bf16 v[188:191], a[236:239], a[156:159], v[188:191]
ds_read_b64_tr_b16 a[106:107], v233 offset:16896
v_mfma_f32_16x16x32_bf16 a[0:3], a[240:243], a[128:131], a[0:3]
ds_read_b64_tr_b16 a[108:109], v233 offset:20480
v_mfma_f32_16x16x32_bf16 a[0:3], a[244:247], a[144:147], a[0:3]
ds_read_b64_tr_b16 a[110:111], v233 offset:20992
v_mfma_f32_16x16x32_bf16 a[4:7], a[240:243], a[132:135], a[4:7]
buffer_load_dwordx4 a[208:211], v224, s[32:35], s101 offen offset:1024 sc1
v_mfma_f32_16x16x32_bf16 a[4:7], a[244:247], a[148:151], a[4:7]
v_mfma_f32_16x16x32_bf16 a[8:11], a[240:243], a[136:139], a[8:11]
v_mfma_f32_16x16x32_bf16 a[8:11], a[244:247], a[152:155], a[8:11]
v_mfma_f32_16x16x32_bf16 a[12:15], a[240:243], a[140:143], a[12:15]
buffer_load_dwordx4 a[212:215], v225, s[32:35], s101 offen offset:1024 sc1
v_mfma_f32_16x16x32_bf16 a[12:15], a[244:247], a[156:159], a[12:15]
ds_read_b64_tr_b16 a[224:225], v234 offset:24576
v_mfma_f32_16x16x32_bf16 v[96:99], a[248:251], a[128:131], v[96:99]
s_waitcnt lgkmcnt(1)
ds_read_b64_tr_b16 a[226:227], v234 offset:25088
v_mfma_f32_16x16x32_bf16 v[96:99], a[252:255], a[144:147], v[96:99]
ds_read_b64_tr_b16 a[228:229], v234 offset:28672
v_mfma_f32_16x16x32_bf16 v[100:103], a[248:251], a[132:135], v[100:103]
ds_read_b64_tr_b16 a[230:231], v234 offset:29184
v_mfma_f32_16x16x32_bf16 v[100:103], a[252:255], a[148:151], v[100:103]
v_mfma_f32_16x16x32_bf16 v[104:107], a[248:251], a[136:139], v[104:107]
buffer_load_dwordx4 a[216:219], v226, s[32:35], s101 offen offset:1024 sc1
v_mfma_f32_16x16x32_bf16 v[104:107], a[252:255], a[152:155], v[104:107]
v_mfma_f32_16x16x32_bf16 v[108:111], a[248:251], a[140:143], v[108:111]
ds_read_b64_tr_b16 a[232:233], v234 offset:16384
v_mfma_f32_16x16x32_bf16 v[108:111], a[252:255], a[156:159], v[108:111]
ds_read_b64_tr_b16 a[234:235], v234 offset:16896
v_mfma_f32_16x16x32_bf16 a[16:19], a[96:99], a[128:131], a[16:19]
ds_read_b64_tr_b16 a[236:237], v234 offset:20480
v_mfma_f32_16x16x32_bf16 a[16:19], a[100:103], a[144:147], a[16:19]
ds_read_b64_tr_b16 a[238:239], v234 offset:20992
v_mfma_f32_16x16x32_bf16 a[20:23], a[96:99], a[132:135], a[20:23]
buffer_load_dwordx4 a[220:223], v227, s[32:35], s101 offen offset:1024 sc1
v_mfma_f32_16x16x32_bf16 a[20:23], a[100:103], a[148:151], a[20:23]
v_mfma_f32_16x16x32_bf16 a[24:27], a[96:99], a[136:139], a[24:27]
global_load_dwordx4 v[216:219], v214, s[14:15] offset:2048
v_mfma_f32_16x16x32_bf16 a[24:27], a[100:103], a[152:155], a[24:27]
v_mfma_f32_16x16x32_bf16 a[28:31], a[96:99], a[140:143], a[28:31]
ds_read_b64_tr_b16 a[240:241], v235 offset:24576
v_mfma_f32_16x16x32_bf16 a[28:31], a[100:103], a[156:159], a[28:31]
ds_read_b64_tr_b16 a[242:243], v235 offset:25088
v_mfma_f32_16x16x32_bf16 v[112:115], a[104:107], a[128:131], v[112:115]
ds_read_b64_tr_b16 a[244:245], v235 offset:28672
v_mfma_f32_16x16x32_bf16 v[112:115], a[108:111], a[144:147], v[112:115]
ds_read_b64_tr_b16 a[246:247], v235 offset:29184
v_mfma_f32_16x16x32_bf16 v[116:119], a[104:107], a[132:135], v[116:119]
v_mfma_f32_16x16x32_bf16 v[116:119], a[108:111], a[148:151], v[116:119]
v_mfma_f32_16x16x32_bf16 v[120:123], a[104:107], a[136:139], v[120:123]
v_mfma_f32_16x16x32_bf16 v[120:123], a[108:111], a[152:155], v[120:123]
v_mfma_f32_16x16x32_bf16 v[124:127], a[104:107], a[140:143], v[124:127]
ds_read_b64_tr_b16 a[248:249], v235 offset:16384
v_mfma_f32_16x16x32_bf16 v[124:127], a[108:111], a[156:159], v[124:127]
s_waitcnt lgkmcnt(2)
ds_read_b64_tr_b16 a[250:251], v235 offset:16896
v_mfma_f32_16x16x32_bf16 a[32:35], a[224:227], a[128:131], a[32:35]
ds_read_b64_tr_b16 a[252:253], v235 offset:20480
v_mfma_f32_16x16x32_bf16 a[32:35], a[228:231], a[144:147], a[32:35]
ds_read_b64_tr_b16 a[254:255], v235 offset:20992
v_mfma_f32_16x16x32_bf16 a[36:39], a[224:227], a[132:135], a[36:39]
v_mfma_f32_16x16x32_bf16 a[36:39], a[228:231], a[148:151], a[36:39]
v_mfma_f32_16x16x32_bf16 a[40:43], a[224:227], a[136:139], a[40:43]
v_mfma_f32_16x16x32_bf16 a[40:43], a[228:231], a[152:155], a[40:43]
v_mfma_f32_16x16x32_bf16 a[44:47], a[224:227], a[140:143], a[44:47]
v_mfma_f32_16x16x32_bf16 a[44:47], a[228:231], a[156:159], a[44:47]
s_waitcnt vmcnt(19)
s_barrier
s_add_u32 m0, s100, 98304
v_mfma_f32_16x16x32_bf16 v[128:131], a[232:235], a[128:131], v[128:131]
ds_read_b64_tr_b16 a[96:97], v236 offset:0
s_add_u32 s98, s98, s99
v_mfma_f32_16x16x32_bf16 v[128:131], a[236:239], a[144:147], v[128:131]
ds_read_b64_tr_b16 a[98:99], v236 offset:512
v_mfma_f32_16x16x32_bf16 v[132:135], a[232:235], a[132:135], v[132:135]
ds_read_b64_tr_b16 a[100:101], v236 offset:4096
v_mfma_f32_16x16x32_bf16 v[132:135], a[236:239], a[148:151], v[132:135]
ds_read_b64_tr_b16 a[102:103], v236 offset:4608
v_mfma_f32_16x16x32_bf16 v[136:139], a[232:235], a[136:139], v[136:139]
buffer_load_dwordx4 v228, s[28:31], s98 offen offset:0 lds
v_mfma_f32_16x16x32_bf16 v[136:139], a[236:239], a[152:155], v[136:139]
v_mfma_f32_16x16x32_bf16 v[140:143], a[232:235], a[140:143], v[140:143]
ds_read_b64_tr_b16 a[104:105], v237 offset:0
v_mfma_f32_16x16x32_bf16 v[140:143], a[236:239], a[156:159], v[140:143]
ds_read_b64_tr_b16 a[106:107], v237 offset:512
v_mfma_f32_16x16x32_bf16 a[48:51], a[240:243], a[128:131], a[48:51]
s_waitcnt lgkmcnt(4)
ds_read_b64_tr_b16 a[108:109], v237 offset:4096
v_mfma_f32_16x16x32_bf16 a[48:51], a[244:247], a[144:147], a[48:51]
ds_read_b64_tr_b16 a[110:111], v237 offset:4608
v_mfma_f32_16x16x32_bf16 a[52:55], a[240:243], a[132:135], a[52:55]
buffer_load_dwordx4 v229, s[28:31], s98 offen offset:1024 lds
v_mfma_f32_16x16x32_bf16 a[52:55], a[244:247], a[148:151], a[52:55]
v_mfma_f32_16x16x32_bf16 a[56:59], a[240:243], a[136:139], a[56:59]
v_mfma_f32_16x16x32_bf16 a[56:59], a[244:247], a[152:155], a[56:59]
v_mfma_f32_16x16x32_bf16 a[60:63], a[240:243], a[140:143], a[60:63]
ds_read_b64_tr_b16 a[224:225], v238 offset:0
v_mfma_f32_16x16x32_bf16 a[60:63], a[244:247], a[156:159], a[60:63]
buffer_load_dwordx4 v230, s[28:31], s98 offen offset:2048 lds
v_mfma_f32_16x16x32_bf16 v[144:147], a[248:251], a[128:131], v[144:147]
ds_read_b64_tr_b16 a[226:227], v238 offset:512
v_mfma_f32_16x16x32_bf16 v[144:147], a[252:255], a[144:147], v[144:147]
ds_read_b64_tr_b16 a[228:229], v238 offset:4096
v_mfma_f32_16x16x32_bf16 v[148:151], a[248:251], a[132:135], v[148:151]
ds_read_b64_tr_b16 a[230:231], v238 offset:4608
v_mfma_f32_16x16x32_bf16 v[148:151], a[252:255], a[148:151], v[148:151]
v_mfma_f32_16x16x32_bf16 v[152:155], a[248:251], a[136:139], v[152:155]
v_mfma_f32_16x16x32_bf16 v[152:155], a[252:255], a[152:155], v[152:155]
buffer_load_dwordx4 v231, s[28:31], s98 offen offset:3072 lds
v_mfma_f32_16x16x32_bf16 v[156:159], a[248:251], a[140:143], v[156:159]
global_load_dwordx4 v[216:219], v214, s[14:15] offset:3072
v_mfma_f32_16x16x32_bf16 v[156:159], a[252:255], a[156:159], v[156:159]
ds_read_b64_tr_b16 a[232:233], v239 offset:0
v_mfma_f32_16x16x32_bf16 v[0:3], a[96:99], a[64:67], v[0:3]
s_waitcnt lgkmcnt(2)
ds_read_b64_tr_b16 a[234:235], v239 offset:512
v_mfma_f32_16x16x32_bf16 v[0:3], a[100:103], a[80:83], v[0:3]
ds_read_b64_tr_b16 a[236:237], v239 offset:4096
v_mfma_f32_16x16x32_bf16 v[4:7], a[96:99], a[68:71], v[4:7]
ds_read_b64_tr_b16 a[238:239], v239 offset:4608
v_mfma_f32_16x16x32_bf16 v[4:7], a[100:103], a[84:87], v[4:7]
s_add_u32 m0, s100, 102400
v_mfma_f32_16x16x32_bf16 v[8:11], a[96:99], a[72:75], v[8:11]
v_mfma_f32_16x16x32_bf16 v[8:11], a[100:103], a[88:91], v[8:11]
s_add_u32 s98, s98, s99
v_mfma_f32_16x16x32_bf16 v[12:15], a[96:99], a[76:79], v[12:15]
ds_read_b64_tr_b16 a[240:241], v236 offset:8192
v_mfma_f32_16x16x32_bf16 v[12:15], a[100:103], a[92:95], v[12:15]
ds_read_b64_tr_b16 a[242:243], v236 offset:8704
v_mfma_f32_16x16x32_bf16 v[16:19], a[104:107], a[64:67], v[16:19]
buffer_load_dwordx4 v228, s[28:31], s98 offen offset:0 lds
v_mfma_f32_16x16x32_bf16 v[16:19], a[108:111], a[80:83], v[16:19]
ds_read_b64_tr_b16 a[244:245], v236 offset:12288
v_mfma_f32_16x16x32_bf16 v[20:23], a[104:107], a[68:71], v[20:23]
ds_read_b64_tr_b16 a[246:247], v236 offset:12800
v_mfma_f32_16x16x32_bf16 v[20:23], a[108:111], a[84:87], v[20:23]
v_mfma_f32_16x16x32_bf16 v[24:27], a[104:107], a[72:75], v[24:27]
v_mfma_f32_16x16x32_bf16 v[24:27], a[108:111], a[88:91], v[24:27]
buffer_load_dwordx4 v229, s[28:31], s98 offen offset:1024 lds
v_mfma_f32_16x16x32_bf16 v[28:31], a[104:107], a[76:79], v[28:31]
ds_read_b64_tr_b16 a[248:249], v237 offset:8192
v_mfma_f32_16x16x32_bf16 v[28:31], a[108:111], a[92:95], v[28:31]
ds_read_b64_tr_b16 a[250:251], v237 offset:8704
v_mfma_f32_16x16x32_bf16 v[32:35], a[224:227], a[64:67], v[32:35]
s_waitcnt lgkmcnt(3)
ds_read_b64_tr_b16 a[252:253], v237 offset:12288
v_mfma_f32_16x16x32_bf16 v[32:35], a[228:231], a[80:83], v[32:35]
ds_read_b64_tr_b16 a[254:255], v237 offset:12800
v_mfma_f32_16x16x32_bf16 v[36:39], a[224:227], a[68:71], v[36:39]
v_mfma_f32_16x16x32_bf16 v[36:39], a[228:231], a[84:87], v[36:39]
v_mfma_f32_16x16x32_bf16 v[40:43], a[224:227], a[72:75], v[40:43]
buffer_load_dwordx4 v230, s[28:31], s98 offen offset:2048 lds
v_mfma_f32_16x16x32_bf16 v[40:43], a[228:231], a[88:91], v[40:43]
v_mfma_f32_16x16x32_bf16 v[44:47], a[224:227], a[76:79], v[44:47]
ds_read_b64_tr_b16 a[96:97], v238 offset:8192
v_mfma_f32_16x16x32_bf16 v[44:47], a[228:231], a[92:95], v[44:47]
ds_read_b64_tr_b16 a[98:99], v238 offset:8704
v_mfma_f32_16x16x32_bf16 v[48:51], a[232:235], a[64:67], v[48:51]
ds_read_b64_tr_b16 a[100:101], v238 offset:12288
v_mfma_f32_16x16x32_bf16 v[48:51], a[236:239], a[80:83], v[48:51]
ds_read_b64_tr_b16 a[102:103], v238 offset:12800
v_mfma_f32_16x16x32_bf16 v[52:55], a[232:235], a[68:71], v[52:55]
buffer_load_dwordx4 v231, s[28:31], s98 offen offset:3072 lds
v_mfma_f32_16x16x32_bf16 v[52:55], a[236:239], a[84:87], v[52:55]
v_mfma_f32_16x16x32_bf16 v[56:59], a[232:235], a[72:75], v[56:59]
v_mfma_f32_16x16x32_bf16 v[56:59], a[236:239], a[88:91], v[56:59]
v_mfma_f32_16x16x32_bf16 v[60:63], a[232:235], a[76:79], v[60:63]
ds_read_b64_tr_b16 a[104:105], v239 offset:8192
v_mfma_f32_16x16x32_bf16 v[60:63], a[236:239], a[92:95], v[60:63]
ds_read_b64_tr_b16 a[106:107], v239 offset:8704
v_mfma_f32_16x16x32_bf16 v[64:67], a[240:243], a[64:67], v[64:67]
s_waitcnt lgkmcnt(2)
ds_read_b64_tr_b16 a[108:109], v239 offset:12288
v_mfma_f32_16x16x32_bf16 v[64:67], a[244:247], a[80:83], v[64:67]
ds_read_b64_tr_b16 a[110:111], v239 offset:12800
v_mfma_f32_16x16x32_bf16 v[68:71], a[240:243], a[68:71], v[68:71]
v_mfma_f32_16x16x32_bf16 v[68:71], a[244:247], a[84:87], v[68:71]
v_mfma_f32_16x16x32_bf16 v[72:75], a[240:243], a[72:75], v[72:75]
v_mfma_f32_16x16x32_bf16 v[72:75], a[244:247], a[88:91], v[72:75]
v_mfma_f32_16x16x32_bf16 v[76:79], a[240:243], a[76:79], v[76:79]
ds_read_b64_tr_b16 a[224:225], v236 offset:24576
v_mfma_f32_16x16x32_bf16 v[76:79], a[244:247], a[92:95], v[76:79]
buffer_load_dwordx4 a[128:131], v224, s[32:35], s101 offen offset:2048 sc1
v_mfma_f32_16x16x32_bf16 v[80:83], a[248:251], a[64:67], v[80:83]
ds_read_b64_tr_b16 a[226:227], v236 offset:25088
v_mfma_f32_16x16x32_bf16 v[80:83], a[252:255], a[80:83], v[80:83]
global_load_dwordx4 v[216:219], v215, s[20:21] offset:0
v_mfma_f32_16x16x32_bf16 v[84:87], a[248:251], a[68:71], v[84:87]
ds_read_b64_tr_b16 a[228:229], v236 offset:28672
v_mfma_f32_16x16x32_bf16 v[84:87], a[252:255], a[84:87], v[84:87]
ds_read_b64_tr_b16 a[230:231], v236 offset:29184
v_mfma_f32_16x16x32_bf16 v[88:91], a[248:251], a[72:75], v[88:91]
buffer_load_dwordx4 a[132:135], v225, s[32:35], s101 offen offset:2048 sc1
v_mfma_f32_16x16x32_bf16 v[88:91], a[252:255], a[88:91], v[88:91]
v_mfma_f32_16x16x32_bf16 v[92:95], a[248:251], a[76:79], v[92:95]
ds_read_b64_tr_b16 a[232:233], v236 offset:16384
v_mfma_f32_16x16x32_bf16 v[92:95], a[252:255], a[92:95], v[92:95]
ds_read_b64_tr_b16 a[234:235], v236 offset:16896
v_mfma_f32_16x16x32_bf16 v[160:163], a[96:99], a[64:67], v[160:163]
ds_read_b64_tr_b16 a[236:237], v236 offset:20480
v_mfma_f32_16x16x32_bf16 v[160:163], a[100:103], a[80:83], v[160:163]
ds_read_b64_tr_b16 a[238:239], v236 offset:20992
v_mfma_f32_16x16x32_bf16 v[164:167], a[96:99], a[68:71], v[164:167]
buffer_load_dwordx4 a[136:139], v226, s[32:35], s101 offen offset:2048 sc1
v_mfma_f32_16x16x32_bf16 v[164:167], a[100:103], a[84:87], v[164:167]
v_mfma_f32_16x16x32_bf16 v[168:171], a[96:99], a[72:75], v[168:171]
v_mfma_f32_16x16x32_bf16 v[168:171], a[100:103], a[88:91], v[168:171]
v_mfma_f32_16x16x32_bf16 v[172:175], a[96:99], a[76:79], v[172:175]
ds_read_b64_tr_b16 a[240:241], v237 offset:24576
v_mfma_f32_16x16x32_bf16 v[172:175], a[100:103], a[92:95], v[172:175]
s_waitcnt lgkmcnt(2)
ds_read_b64_tr_b16 a[242:243], v237 offset:25088
v_mfma_f32_16x16x32_bf16 v[176:179], a[104:107], a[64:67], v[176:179]
ds_read_b64_tr_b16 a[244:245], v237 offset:28672
v_mfma_f32_16x16x32_bf16 v[176:179], a[108:111], a[80:83], v[176:179]
ds_read_b64_tr_b16 a[246:247], v237 offset:29184
v_mfma_f32_16x16x32_bf16 v[180:183], a[104:107], a[68:71], v[180:183]
buffer_load_dwordx4 a[140:143], v227, s[32:35], s101 offen offset:2048 sc1
v_mfma_f32_16x16x32_bf16 v[180:183], a[108:111], a[84:87], v[180:183]
v_mfma_f32_16x16x32_bf16 v[184:187], a[104:107], a[72:75], v[184:187]
v_mfma_f32_16x16x32_bf16 v[184:187], a[108:111], a[88:91], v[184:187]
v_mfma_f32_16x16x32_bf16 v[188:191], a[104:107], a[76:79], v[188:191]
ds_read_b64_tr_b16 a[248:249], v237 offset:16384
v_mfma_f32_16x16x32_bf16 v[188:191], a[108:111], a[92:95], v[188:191]
ds_read_b64_tr_b16 a[250:251], v237 offset:16896
v_mfma_f32_16x16x32_bf16 a[0:3], a[224:227], a[64:67], a[0:3]
ds_read_b64_tr_b16 a[252:253], v237 offset:20480
v_mfma_f32_16x16x32_bf16 a[0:3], a[228:231], a[80:83], a[0:3]
buffer_load_dwordx4 a[144:147], v224, s[32:35], s101 offen offset:3072 sc1
v_mfma_f32_16x16x32_bf16 a[4:7], a[224:227], a[68:71], a[4:7]
ds_read_b64_tr_b16 a[254:255], v237 offset:20992
v_mfma_f32_16x16x32_bf16 a[4:7], a[228:231], a[84:87], a[4:7]
v_mfma_f32_16x16x32_bf16 a[8:11], a[224:227], a[72:75], a[8:11]
v_mfma_f32_16x16x32_bf16 a[8:11], a[228:231], a[88:91], a[8:11]
buffer_load_dwordx4 a[148:151], v225, s[32:35], s101 offen offset:3072 sc1
v_mfma_f32_16x16x32_bf16 a[12:15], a[224:227], a[76:79], a[12:15]
ds_read_b64_tr_b16 a[96:97], v238 offset:24576
v_mfma_f32_16x16x32_bf16 a[12:15], a[228:231], a[92:95], a[12:15]
ds_read_b64_tr_b16 a[98:99], v238 offset:25088
v_mfma_f32_16x16x32_bf16 v[96:99], a[232:235], a[64:67], v[96:99]
s_waitcnt lgkmcnt(3)
ds_read_b64_tr_b16 a[100:101], v238 offset:28672
v_mfma_f32_16x16x32_bf16 v[96:99], a[236:239], a[80:83], v[96:99]
ds_read_b64_tr_b16 a[102:103], v238 offset:29184
v_mfma_f32_16x16x32_bf16 v[100:103], a[232:235], a[68:71], v[100:103]
v_mfma_f32_16x16x32_bf16 v[100:103], a[236:239], a[84:87], v[100:103]
buffer_load_dwordx4 a[152:155], v226, s[32:35], s101 offen offset:3072 sc1
v_mfma_f32_16x16x32_bf16 v[104:107], a[232:235], a[72:75], v[104:107]
v_mfma_f32_16x16x32_bf16 v[104:107], a[236:239], a[88:91], v[104:107]
v_mfma_f32_16x16x32_bf16 v[108:111], a[232:235], a[76:79], v[108:111]
ds_read_b64_tr_b16 a[104:105], v238 offset:16384
v_mfma_f32_16x16x32_bf16 v[108:111], a[236:239], a[92:95], v[108:111]
ds_read_b64_tr_b16 a[106:107], v238 offset:16896
v_mfma_f32_16x16x32_bf16 a[16:19], a[240:243], a[64:67], a[16:19]
ds_read_b64_tr_b16 a[108:109], v238 offset:20480
v_mfma_f32_16x16x32_bf16 a[16:19], a[244:247], a[80:83], a[16:19]
ds_read_b64_tr_b16 a[110:111], v238 offset:20992
v_mfma_f32_16x16x32_bf16 a[20:23], a[240:243], a[68:71], a[20:23]
global_load_dwordx4 v[216:219], v215, s[20:21] offset:1024
v_mfma_f32_16x16x32_bf16 a[20:23], a[244:247], a[84:87], a[20:23]
buffer_load_dwordx4 a[156:159], v227, s[32:35], s101 offen offset:3072 sc1
v_mfma_f32_16x16x32_bf16 a[24:27], a[240:243], a[72:75], a[24:27]
v_mfma_f32_16x16x32_bf16 a[24:27], a[244:247], a[88:91], a[24:27]
v_mfma_f32_16x16x32_bf16 a[28:31], a[240:243], a[76:79], a[28:31]
ds_read_b64_tr_b16 a[224:225], v239 offset:24576
v_mfma_f32_16x16x32_bf16 a[28:31], a[244:247], a[92:95], a[28:31]
ds_read_b64_tr_b16 a[226:227], v239 offset:25088
v_mfma_f32_16x16x32_bf16 v[112:115], a[248:251], a[64:67], v[112:115]
s_waitcnt lgkmcnt(2)
ds_read_b64_tr_b16 a[228:229], v239 offset:28672
v_mfma_f32_16x16x32_bf16 v[112:115], a[252:255], a[80:83], v[112:115]
ds_read_b64_tr_b16 a[230:231], v239 offset:29184
v_mfma_f32_16x16x32_bf16 v[116:119], a[248:251], a[68:71], v[116:119]
v_mfma_f32_16x16x32_bf16 v[116:119], a[252:255], a[84:87], v[116:119]
v_mfma_f32_16x16x32_bf16 v[120:123], a[248:251], a[72:75], v[120:123]
v_mfma_f32_16x16x32_bf16 v[120:123], a[252:255], a[88:91], v[120:123]
v_mfma_f32_16x16x32_bf16 v[124:127], a[248:251], a[76:79], v[124:127]
ds_read_b64_tr_b16 a[232:233], v239 offset:16384
v_mfma_f32_16x16x32_bf16 v[124:127], a[252:255], a[92:95], v[124:127]
ds_read_b64_tr_b16 a[234:235], v239 offset:16896
v_mfma_f32_16x16x32_bf16 a[32:35], a[96:99], a[64:67], a[32:35]
ds_read_b64_tr_b16 a[236:237], v239 offset:20480
v_mfma_f32_16x16x32_bf16 a[32:35], a[100:103], a[80:83], a[32:35]
ds_read_b64_tr_b16 a[238:239], v239 offset:20992
v_mfma_f32_16x16x32_bf16 a[36:39], a[96:99], a[68:71], a[36:39]
v_mfma_f32_16x16x32_bf16 a[36:39], a[100:103], a[84:87], a[36:39]
v_mfma_f32_16x16x32_bf16 a[40:43], a[96:99], a[72:75], a[40:43]
v_mfma_f32_16x16x32_bf16 a[40:43], a[100:103], a[88:91], a[40:43]
v_mfma_f32_16x16x32_bf16 a[44:47], a[96:99], a[76:79], a[44:47]
v_mfma_f32_16x16x32_bf16 a[44:47], a[100:103], a[92:95], a[44:47]
s_waitcnt vmcnt(20)
s_barrier
s_add_u32 m0, s100, 65536
v_mfma_f32_16x16x32_bf16 v[128:131], a[104:107], a[64:67], v[128:131]
ds_read_b64_tr_b16 a[240:241], v236 offset:32768
s_add_u32 s98, s98, s99
v_mfma_f32_16x16x32_bf16 v[128:131], a[108:111], a[80:83], v[128:131]
ds_read_b64_tr_b16 a[242:243], v236 offset:33280
v_mfma_f32_16x16x32_bf16 v[132:135], a[104:107], a[68:71], v[132:135]
ds_read_b64_tr_b16 a[244:245], v236 offset:36864
v_mfma_f32_16x16x32_bf16 v[132:135], a[108:111], a[84:87], v[132:135]
ds_read_b64_tr_b16 a[246:247], v236 offset:37376
v_mfma_f32_16x16x32_bf16 v[136:139], a[104:107], a[72:75], v[136:139]
buffer_load_dwordx4 v228, s[28:31], s98 offen offset:0 lds
v_mfma_f32_16x16x32_bf16 v[136:139], a[108:111], a[88:91], v[136:139]
v_mfma_f32_16x16x32_bf16 v[140:143], a[104:107], a[76:79], v[140:143]
ds_read_b64_tr_b16 a[248:249], v237 offset:32768
v_mfma_f32_16x16x32_bf16 v[140:143], a[108:111], a[92:95], v[140:143]
s_waitcnt lgkmcnt(4)
ds_read_b64_tr_b16 a[250:251], v237 offset:33280
v_mfma_f32_16x16x32_bf16 a[48:51], a[224:227], a[64:67], a[48:51]
ds_read_b64_tr_b16 a[252:253], v237 offset:36864
v_mfma_f32_16x16x32_bf16 a[48:51], a[228:231], a[80:83], a[48:51]
ds_read_b64_tr_b16 a[254:255], v237 offset:37376
v_mfma_f32_16x16x32_bf16 a[52:55], a[224:227], a[68:71], a[52:55]
buffer_load_dwordx4 v229, s[28:31], s98 offen offset:1024 lds
v_mfma_f32_16x16x32_bf16 a[52:55], a[228:231], a[84:87], a[52:55]
v_mfma_f32_16x16x32_bf16 a[56:59], a[224:227], a[72:75], a[56:59]
v_mfma_f32_16x16x32_bf16 a[56:59], a[228:231], a[88:91], a[56:59]
v_mfma_f32_16x16x32_bf16 a[60:63], a[224:227], a[76:79], a[60:63]
ds_read_b64_tr_b16 a[96:97], v238 offset:32768
v_mfma_f32_16x16x32_bf16 a[60:63], a[228:231], a[92:95], a[60:63]
buffer_load_dwordx4 v230, s[28:31], s98 offen offset:2048 lds
v_mfma_f32_16x16x32_bf16 v[144:147], a[232:235], a[64:67], v[144:147]
ds_read_b64_tr_b16 a[98:99], v238 offset:33280
v_mfma_f32_16x16x32_bf16 v[144:147], a[236:239], a[80:83], v[144:147]
ds_read_b64_tr_b16 a[100:101], v238 offset:36864
s_lshr_b32 s8, s8, 1
v_mfma_f32_16x16x32_bf16 v[148:151], a[232:235], a[68:71], v[148:151]
ds_read_b64_tr_b16 a[102:103], v238 offset:37376
v_mfma_f32_16x16x32_bf16 v[148:151], a[236:239], a[84:87], v[148:151]
v_mfma_f32_16x16x32_bf16 v[152:155], a[232:235], a[72:75], v[152:155]
v_mfma_f32_16x16x32_bf16 v[152:155], a[236:239], a[88:91], v[152:155]
buffer_load_dwordx4 v231, s[28:31], s98 offen offset:3072 lds
v_mfma_f32_16x16x32_bf16 v[156:159], a[232:235], a[76:79], v[156:159]
ds_read_b64_tr_b16 a[104:105], v239 offset:32768
v_mfma_f32_16x16x32_bf16 v[156:159], a[236:239], a[92:95], v[156:159]
s_waitcnt lgkmcnt(3)
ds_read_b64_tr_b16 a[106:107], v239 offset:33280
v_mfma_f32_16x16x32_bf16 v[0:3], a[240:243], a[192:195], v[0:3]
ds_read_b64_tr_b16 a[108:109], v239 offset:36864
v_mfma_f32_16x16x32_bf16 v[0:3], a[244:247], a[208:211], v[0:3]
ds_read_b64_tr_b16 a[110:111], v239 offset:37376
v_mfma_f32_16x16x32_bf16 v[4:7], a[240:243], a[196:199], v[4:7]
v_mfma_f32_16x16x32_bf16 v[4:7], a[244:247], a[212:215], v[4:7]
v_add_u32 v214, s8, v242
s_add_u32 m0, s100, 69632
v_mfma_f32_16x16x32_bf16 v[8:11], a[240:243], a[200:203], v[8:11]
v_mfma_f32_16x16x32_bf16 v[8:11], a[244:247], a[216:219], v[8:11]
s_add_u32 s98, s98, s99
v_mfma_f32_16x16x32_bf16 v[12:15], a[240:243], a[204:207], v[12:15]
ds_read_b64_tr_b16 a[224:225], v236 offset:40960
v_mfma_f32_16x16x32_bf16 v[12:15], a[244:247], a[220:223], v[12:15]
ds_read_b64_tr_b16 a[226:227], v236 offset:41472
v_mfma_f32_16x16x32_bf16 v[16:19], a[248:251], a[192:195], v[16:19]
buffer_load_dwordx4 v228, s[28:31], s98 offen offset:0 lds
v_mfma_f32_16x16x32_bf16 v[16:19], a[252:255], a[208:211], v[16:19]
ds_read_b64_tr_b16 a[228:229], v236 offset:45056
v_mfma_f32_16x16x32_bf16 v[20:23], a[248:251], a[196:199], v[20:23]
ds_read_b64_tr_b16 a[230:231], v236 offset:45568
v_mfma_f32_16x16x32_bf16 v[20:23], a[252:255], a[212:215], v[20:23]
v_mfma_f32_16x16x32_bf16 v[24:27], a[248:251], a[200:203], v[24:27]
v_mfma_f32_16x16x32_bf16 v[24:27], a[252:255], a[216:219], v[24:27]
buffer_load_dwordx4 v229, s[28:31], s98 offen offset:1024 lds
v_mfma_f32_16x16x32_bf16 v[28:31], a[248:251], a[204:207], v[28:31]
ds_read_b64_tr_b16 a[232:233], v237 offset:40960
v_mfma_f32_16x16x32_bf16 v[28:31], a[252:255], a[220:223], v[28:31]
ds_read_b64_tr_b16 a[234:235], v237 offset:41472
v_mfma_f32_16x16x32_bf16 v[32:35], a[96:99], a[192:195], v[32:35]
s_waitcnt lgkmcnt(3)
ds_read_b64_tr_b16 a[236:237], v237 offset:45056
v_mfma_f32_16x16x32_bf16 v[32:35], a[100:103], a[208:211], v[32:35]
ds_read_b64_tr_b16 a[238:239], v237 offset:45568
v_mfma_f32_16x16x32_bf16 v[36:39], a[96:99], a[196:199], v[36:39]
v_mfma_f32_16x16x32_bf16 v[36:39], a[100:103], a[212:215], v[36:39]
v_mfma_f32_16x16x32_bf16 v[40:43], a[96:99], a[200:203], v[40:43]
buffer_load_dwordx4 v230, s[28:31], s98 offen offset:2048 lds
v_mfma_f32_16x16x32_bf16 v[40:43], a[100:103], a[216:219], v[40:43]
v_mfma_f32_16x16x32_bf16 v[44:47], a[96:99], a[204:207], v[44:47]
ds_read_b64_tr_b16 a[240:241], v238 offset:40960
v_mfma_f32_16x16x32_bf16 v[44:47], a[100:103], a[220:223], v[44:47]
ds_read_b64_tr_b16 a[242:243], v238 offset:41472
v_mfma_f32_16x16x32_bf16 v[48:51], a[104:107], a[192:195], v[48:51]
ds_read_b64_tr_b16 a[244:245], v238 offset:45056
v_mfma_f32_16x16x32_bf16 v[48:51], a[108:111], a[208:211], v[48:51]
ds_read_b64_tr_b16 a[246:247], v238 offset:45568
v_mfma_f32_16x16x32_bf16 v[52:55], a[104:107], a[196:199], v[52:55]
global_load_dwordx4 v[216:219], v214, s[22:23] offset:0
v_mfma_f32_16x16x32_bf16 v[52:55], a[108:111], a[212:215], v[52:55]
buffer_load_dwordx4 v231, s[28:31], s98 offen offset:3072 lds
v_mfma_f32_16x16x32_bf16 v[56:59], a[104:107], a[200:203], v[56:59]
v_mfma_f32_16x16x32_bf16 v[56:59], a[108:111], a[216:219], v[56:59]
v_mfma_f32_16x16x32_bf16 v[60:63], a[104:107], a[204:207], v[60:63]
ds_read_b64_tr_b16 a[248:249], v239 offset:40960
v_mfma_f32_16x16x32_bf16 v[60:63], a[108:111], a[220:223], v[60:63]
ds_read_b64_tr_b16 a[250:251], v239 offset:41472
v_mfma_f32_16x16x32_bf16 v[64:67], a[224:227], a[192:195], v[64:67]
s_waitcnt lgkmcnt(2)
ds_read_b64_tr_b16 a[252:253], v239 offset:45056
v_mfma_f32_16x16x32_bf16 v[64:67], a[228:231], a[208:211], v[64:67]
ds_read_b64_tr_b16 a[254:255], v239 offset:45568
v_mfma_f32_16x16x32_bf16 v[68:71], a[224:227], a[196:199], v[68:71]
v_mfma_f32_16x16x32_bf16 v[68:71], a[228:231], a[212:215], v[68:71]
v_mfma_f32_16x16x32_bf16 v[72:75], a[224:227], a[200:203], v[72:75]
v_mfma_f32_16x16x32_bf16 v[72:75], a[228:231], a[216:219], v[72:75]
v_mfma_f32_16x16x32_bf16 v[76:79], a[224:227], a[204:207], v[76:79]
ds_read_b64_tr_b16 a[96:97], v236 offset:57344
s_mov_b32 s101, 12288
v_mfma_f32_16x16x32_bf16 v[76:79], a[228:231], a[220:223], v[76:79]
ds_read_b64_tr_b16 a[98:99], v236 offset:57856
v_mfma_f32_16x16x32_bf16 v[80:83], a[232:235], a[192:195], v[80:83]
ds_read_b64_tr_b16 a[100:101], v236 offset:61440
v_mfma_f32_16x16x32_bf16 v[80:83], a[236:239], a[208:211], v[80:83]
ds_read_b64_tr_b16 a[102:103], v236 offset:61952
v_mfma_f32_16x16x32_bf16 v[84:87], a[232:235], a[196:199], v[84:87]
buffer_load_dwordx4 a[64:67], v224, s[32:35], s101 offen offset:0 sc1
v_mfma_f32_16x16x32_bf16 v[84:87], a[236:239], a[212:215], v[84:87]
v_mfma_f32_16x16x32_bf16 v[88:91], a[232:235], a[200:203], v[88:91]
v_mfma_f32_16x16x32_bf16 v[88:91], a[236:239], a[216:219], v[88:91]
v_mfma_f32_16x16x32_bf16 v[92:95], a[232:235], a[204:207], v[92:95]
buffer_load_dwordx4 a[68:71], v225, s[32:35], s101 offen offset:0 sc1
v_mfma_f32_16x16x32_bf16 v[92:95], a[236:239], a[220:223], v[92:95]
ds_read_b64_tr_b16 a[104:105], v236 offset:49152
v_mfma_f32_16x16x32_bf16 v[160:163], a[240:243], a[192:195], v[160:163]
ds_read_b64_tr_b16 a[106:107], v236 offset:49664
v_mfma_f32_16x16x32_bf16 v[160:163], a[244:247], a[208:211], v[160:163]
ds_read_b64_tr_b16 a[108:109], v236 offset:53248
v_mfma_f32_16x16x32_bf16 v[164:167], a[240:243], a[196:199], v[164:167]
ds_read_b64_tr_b16 a[110:111], v236 offset:53760
v_mfma_f32_16x16x32_bf16 v[164:167], a[244:247], a[212:215], v[164:167]
v_mfma_f32_16x16x32_bf16 v[168:171], a[240:243], a[200:203], v[168:171]
buffer_load_dwordx4 a[72:75], v226, s[32:35], s101 offen offset:0 sc1
v_mfma_f32_16x16x32_bf16 v[168:171], a[244:247], a[216:219], v[168:171]
v_mfma_f32_16x16x32_bf16 v[172:175], a[240:243], a[204:207], v[172:175]
ds_read_b64_tr_b16 a[224:225], v237 offset:57344
v_mfma_f32_16x16x32_bf16 v[172:175], a[244:247], a[220:223], v[172:175]
s_waitcnt lgkmcnt(3)
ds_read_b64_tr_b16 a[226:227], v237 offset:57856
v_mfma_f32_16x16x32_bf16 v[176:179], a[248:251], a[192:195], v[176:179]
ds_read_b64_tr_b16 a[228:229], v237 offset:61440
v_mfma_f32_16x16x32_bf16 v[176:179], a[252:255], a[208:211], v[176:179]
ds_read_b64_tr_b16 a[230:231], v237 offset:61952
v_mfma_f32_16x16x32_bf16 v[180:183], a[248:251], a[196:199], v[180:183]
buffer_load_dwordx4 a[76:79], v227, s[32:35], s101 offen offset:0 sc1
v_mfma_f32_16x16x32_bf16 v[180:183], a[252:255], a[212:215], v[180:183]
v_mfma_f32_16x16x32_bf16 v[184:187], a[248:251], a[200:203], v[184:187]
v_mfma_f32_16x16x32_bf16 v[184:187], a[252:255], a[216:219], v[184:187]
v_mfma_f32_16x16x32_bf16 v[188:191], a[248:251], a[204:207], v[188:191]
ds_read_b64_tr_b16 a[232:233], v237 offset:49152
v_mfma_f32_16x16x32_bf16 v[188:191], a[252:255], a[220:223], v[188:191]
ds_read_b64_tr_b16 a[234:235], v237 offset:49664
L_c1600:
v_mfma_f32_16x16x32_bf16 a[0:3], a[96:99], a[192:195], a[0:3]
ds_read_b64_tr_b16 a[236:237], v237 offset:53248
v_mfma_f32_16x16x32_bf16 a[0:3], a[100:103], a[208:211], a[0:3]
ds_read_b64_tr_b16 a[238:239], v237 offset:53760
v_mfma_f32_16x16x32_bf16 a[4:7], a[96:99], a[196:199], a[4:7]
buffer_load_dwordx4 a[80:83], v224, s[32:35], s101 offen offset:1024 sc1
v_mfma_f32_16x16x32_bf16 a[4:7], a[100:103], a[212:215], a[4:7]
global_load_dwordx4 v[216:219], v214, s[22:23] offset:1024
v_mfma_f32_16x16x32_bf16 a[8:11], a[96:99], a[200:203], a[8:11]
v_mfma_f32_16x16x32_bf16 a[8:11], a[100:103], a[216:219], a[8:11]
v_mfma_f32_16x16x32_bf16 a[12:15], a[96:99], a[204:207], a[12:15]
buffer_load_dwordx4 a[84:87], v225, s[32:35], s101 offen offset:1024 sc1
v_mfma_f32_16x16x32_bf16 a[12:15], a[100:103], a[220:223], a[12:15]
ds_read_b64_tr_b16 a[240:241], v238 offset:57344
v_mfma_f32_16x16x32_bf16 v[96:99], a[104:107], a[192:195], v[96:99]
s_waitcnt lgkmcnt(1)
ds_read_b64_tr_b16 a[242:243], v238 offset:57856
v_mfma_f32_16x16x32_bf16 v[96:99], a[108:111], a[208:211], v[96:99]
ds_read_b64_tr_b16 a[244:245], v238 offset:61440
v_mfma_f32_16x16x32_bf16 v[100:103], a[104:107], a[196:199], v[100:103]
ds_read_b64_tr_b16 a[246:247], v238 offset:61952
v_mfma_f32_16x16x32_bf16 v[100:103], a[108:111], a[212:215], v[100:103]
v_mfma_f32_16x16x32_bf16 v[104:107], a[104:107], a[200:203], v[104:107]
buffer_load_dwordx4 a[88:91], v226, s[32:35], s101 offen offset:1024 sc1
v_mfma_f32_16x16x32_bf16 v[104:107], a[108:111], a[216:219], v[104:107]
v_mfma_f32_16x16x32_bf16 v[108:111], a[104:107], a[204:207], v[108:111]
ds_read_b64_tr_b16 a[248:249], v238 offset:49152
v_mfma_f32_16x16x32_bf16 v[108:111], a[108:111], a[220:223], v[108:111]
ds_read_b64_tr_b16 a[250:251], v238 offset:49664
v_mfma_f32_16x16x32_bf16 a[16:19], a[224:227], a[192:195], a[16:19]
ds_read_b64_tr_b16 a[252:253], v238 offset:53248
v_mfma_f32_16x16x32_bf16 a[16:19], a[228:231], a[208:211], a[16:19]
ds_read_b64_tr_b16 a[254:255], v238 offset:53760
v_mfma_f32_16x16x32_bf16 a[20:23], a[224:227], a[196:199], a[20:23]
buffer_load_dwordx4 a[92:95], v227, s[32:35], s101 offen offset:1024 sc1
v_mfma_f32_16x16x32_bf16 a[20:23], a[228:231], a[212:215], a[20:23]
v_mfma_f32_16x16x32_bf16 a[24:27], a[224:227], a[200:203], a[24:27]
v_mfma_f32_16x16x32_bf16 a[24:27], a[228:231], a[216:219], a[24:27]
v_mfma_f32_16x16x32_bf16 a[28:31], a[224:227], a[204:207], a[28:31]
ds_read_b64_tr_b16 a[96:97], v239 offset:57344
v_mfma_f32_16x16x32_bf16 a[28:31], a[228:231], a[220:223], a[28:31]
ds_read_b64_tr_b16 a[98:99], v239 offset:57856
v_mfma_f32_16x16x32_bf16 v[112:115], a[232:235], a[192:195], v[112:115]
ds_read_b64_tr_b16 a[100:101], v239 offset:61440
v_mfma_f32_16x16x32_bf16 v[112:115], a[236:239], a[208:211], v[112:115]
ds_read_b64_tr_b16 a[102:103], v239 offset:61952
v_mfma_f32_16x16x32_bf16 v[116:119], a[232:235], a[196:199], v[116:119]
v_mfma_f32_16x16x32_bf16 v[116:119], a[236:239], a[212:215], v[116:119]
v_mfma_f32_16x16x32_bf16 v[120:123], a[232:235], a[200:203], v[120:123]
v_mfma_f32_16x16x32_bf16 v[120:123], a[236:239], a[216:219], v[120:123]
v_mfma_f32_16x16x32_bf16 v[124:127], a[232:235], a[204:207], v[124:127]
ds_read_b64_tr_b16 a[104:105], v239 offset:49152
v_mfma_f32_16x16x32_bf16 v[124:127], a[236:239], a[220:223], v[124:127]
s_waitcnt lgkmcnt(2)
ds_read_b64_tr_b16 a[106:107], v239 offset:49664
v_mfma_f32_16x16x32_bf16 a[32:35], a[240:243], a[192:195], a[32:35]
ds_read_b64_tr_b16 a[108:109], v239 offset:53248
v_mfma_f32_16x16x32_bf16 a[32:35], a[244:247], a[208:211], a[32:35]
ds_read_b64_tr_b16 a[110:111], v239 offset:53760
v_mfma_f32_16x16x32_bf16 a[36:39], a[240:243], a[196:199], a[36:39]
v_mfma_f32_16x16x32_bf16 a[36:39], a[244:247], a[212:215], a[36:39]
v_mfma_f32_16x16x32_bf16 a[40:43], a[240:243], a[200:203], a[40:43]
v_mfma_f32_16x16x32_bf16 a[40:43], a[244:247], a[216:219], a[40:43]
v_mfma_f32_16x16x32_bf16 a[44:47], a[240:243], a[204:207], a[44:47]
v_mfma_f32_16x16x32_bf16 a[44:47], a[244:247], a[220:223], a[44:47]
s_waitcnt vmcnt(18)
s_barrier
s_mul_i32 s42, s62, 16384
v_mfma_f32_16x16x32_bf16 v[128:131], a[248:251], a[192:195], v[128:131]
ds_read_b64_tr_b16 a[224:225], v232 offset:32768
s_add_u32 m0, s100, 0
v_mfma_f32_16x16x32_bf16 v[128:131], a[252:255], a[208:211], v[128:131]
ds_read_b64_tr_b16 a[226:227], v232 offset:33280
s_add_u32 s98, s98, s99
v_mfma_f32_16x16x32_bf16 v[132:135], a[248:251], a[196:199], v[132:135]
ds_read_b64_tr_b16 a[228:229], v232 offset:36864
v_mfma_f32_16x16x32_bf16 v[132:135], a[252:255], a[212:215], v[132:135]
ds_read_b64_tr_b16 a[230:231], v232 offset:37376
v_mfma_f32_16x16x32_bf16 v[136:139], a[248:251], a[200:203], v[136:139]
buffer_load_dwordx4 v228, s[28:31], s98 offen offset:0 lds
v_mfma_f32_16x16x32_bf16 v[136:139], a[252:255], a[216:219], v[136:139]
v_mfma_f32_16x16x32_bf16 v[140:143], a[248:251], a[204:207], v[140:143]
ds_read_b64_tr_b16 a[232:233], v233 offset:32768
v_mfma_f32_16x16x32_bf16 v[140:143], a[252:255], a[220:223], v[140:143]
ds_read_b64_tr_b16 a[234:235], v233 offset:33280
v_mfma_f32_16x16x32_bf16 a[48:51], a[96:99], a[192:195], a[48:51]
s_waitcnt lgkmcnt(4)
ds_read_b64_tr_b16 a[236:237], v233 offset:36864
v_mfma_f32_16x16x32_bf16 a[48:51], a[100:103], a[208:211], a[48:51]
ds_read_b64_tr_b16 a[238:239], v233 offset:37376
v_mfma_f32_16x16x32_bf16 a[52:55], a[96:99], a[196:199], a[52:55]
buffer_load_dwordx4 v229, s[28:31], s98 offen offset:1024 lds
v_mfma_f32_16x16x32_bf16 a[52:55], a[100:103], a[212:215], a[52:55]
v_mfma_f32_16x16x32_bf16 a[56:59], a[96:99], a[200:203], a[56:59]
v_mfma_f32_16x16x32_bf16 a[56:59], a[100:103], a[216:219], a[56:59]
v_mfma_f32_16x16x32_bf16 a[60:63], a[96:99], a[204:207], a[60:63]
ds_read_b64_tr_b16 a[240:241], v234 offset:32768
v_mfma_f32_16x16x32_bf16 a[60:63], a[100:103], a[220:223], a[60:63]
buffer_load_dwordx4 v230, s[28:31], s98 offen offset:2048 lds
v_mfma_f32_16x16x32_bf16 v[144:147], a[104:107], a[192:195], v[144:147]
ds_read_b64_tr_b16 a[242:243], v234 offset:33280
v_mfma_f32_16x16x32_bf16 v[144:147], a[108:111], a[208:211], v[144:147]
ds_read_b64_tr_b16 a[244:245], v234 offset:36864
v_mfma_f32_16x16x32_bf16 v[148:151], a[104:107], a[196:199], v[148:151]
ds_read_b64_tr_b16 a[246:247], v234 offset:37376
v_mfma_f32_16x16x32_bf16 v[148:151], a[108:111], a[212:215], v[148:151]
v_mfma_f32_16x16x32_bf16 v[152:155], a[104:107], a[200:203], v[152:155]
v_mfma_f32_16x16x32_bf16 v[152:155], a[108:111], a[216:219], v[152:155]
buffer_load_dwordx4 v231, s[28:31], s98 offen offset:3072 lds
v_mfma_f32_16x16x32_bf16 v[156:159], a[104:107], a[204:207], v[156:159]
ds_read_b64_tr_b16 a[248:249], v235 offset:32768
v_mfma_f32_16x16x32_bf16 v[156:159], a[108:111], a[220:223], v[156:159]
ds_read_b64_tr_b16 a[250:251], v235 offset:33280
v_mfma_f32_16x16x32_bf16 v[0:3], a[224:227], a[128:131], v[0:3]
s_waitcnt lgkmcnt(3)
ds_read_b64_tr_b16 a[252:253], v235 offset:36864
v_mfma_f32_16x16x32_bf16 v[0:3], a[228:231], a[144:147], v[0:3]
ds_read_b64_tr_b16 a[254:255], v235 offset:37376
v_mfma_f32_16x16x32_bf16 v[4:7], a[224:227], a[132:135], v[4:7]
v_mfma_f32_16x16x32_bf16 v[4:7], a[228:231], a[148:151], v[4:7]
s_add_u32 m0, s100, 4096
v_mfma_f32_16x16x32_bf16 v[8:11], a[224:227], a[136:139], v[8:11]
v_mfma_f32_16x16x32_bf16 v[8:11], a[228:231], a[152:155], v[8:11]
s_add_u32 s98, s98, s99
v_mfma_f32_16x16x32_bf16 v[12:15], a[224:227], a[140:143], v[12:15]
ds_read_b64_tr_b16 a[96:97], v232 offset:40960
v_mfma_f32_16x16x32_bf16 v[12:15], a[228:231], a[156:159], v[12:15]
ds_read_b64_tr_b16 a[98:99], v232 offset:41472
v_mfma_f32_16x16x32_bf16 v[16:19], a[232:235], a[128:131], v[16:19]
buffer_load_dwordx4 v228, s[28:31], s98 offen offset:0 lds
v_mfma_f32_16x16x32_bf16 v[16:19], a[236:239], a[144:147], v[16:19]
ds_read_b64_tr_b16 a[100:101], v232 offset:45056
v_mfma_f32_16x16x32_bf16 v[20:23], a[232:235], a[132:135], v[20:23]
ds_read_b64_tr_b16 a[102:103], v232 offset:45568
v_mfma_f32_16x16x32_bf16 v[20:23], a[236:239], a[148:151], v[20:23]
v_mfma_f32_16x16x32_bf16 v[24:27], a[232:235], a[136:139], v[24:27]
v_mfma_f32_16x16x32_bf16 v[24:27], a[236:239], a[152:155], v[24:27]
buffer_load_dwordx4 v229, s[28:31], s98 offen offset:1024 lds
v_mfma_f32_16x16x32_bf16 v[28:31], a[232:235], a[140:143], v[28:31]
ds_read_b64_tr_b16 a[104:105], v233 offset:40960
v_mfma_f32_16x16x32_bf16 v[28:31], a[236:239], a[156:159], v[28:31]
ds_read_b64_tr_b16 a[106:107], v233 offset:41472
v_mfma_f32_16x16x32_bf16 v[32:35], a[240:243], a[128:131], v[32:35]
s_waitcnt lgkmcnt(3)
ds_read_b64_tr_b16 a[108:109], v233 offset:45056
v_mfma_f32_16x16x32_bf16 v[32:35], a[244:247], a[144:147], v[32:35]
ds_read_b64_tr_b16 a[110:111], v233 offset:45568
v_mfma_f32_16x16x32_bf16 v[36:39], a[240:243], a[132:135], v[36:39]
v_mfma_f32_16x16x32_bf16 v[36:39], a[244:247], a[148:151], v[36:39]
s_lshl_b32 s97, s57, 7
s_add_u32 s97, s97, 2048
buffer_load_dword v220, v222, s[48:51], s97 offen sc1
v_mfma_f32_16x16x32_bf16 v[40:43], a[240:243], a[136:139], v[40:43]
buffer_load_dwordx4 v230, s[28:31], s98 offen offset:2048 lds
v_mfma_f32_16x16x32_bf16 v[40:43], a[244:247], a[152:155], v[40:43]
v_mfma_f32_16x16x32_bf16 v[44:47], a[240:243], a[140:143], v[44:47]
ds_read_b64_tr_b16 a[224:225], v234 offset:40960
v_mfma_f32_16x16x32_bf16 v[44:47], a[244:247], a[156:159], v[44:47]
ds_read_b64_tr_b16 a[226:227], v234 offset:41472
v_mfma_f32_16x16x32_bf16 v[48:51], a[248:251], a[128:131], v[48:51]
ds_read_b64_tr_b16 a[228:229], v234 offset:45056
v_mfma_f32_16x16x32_bf16 v[48:51], a[252:255], a[144:147], v[48:51]
ds_read_b64_tr_b16 a[230:231], v234 offset:45568
v_mfma_f32_16x16x32_bf16 v[52:55], a[248:251], a[132:135], v[52:55]
buffer_load_dwordx4 v231, s[28:31], s98 offen offset:3072 lds
v_mfma_f32_16x16x32_bf16 v[52:55], a[252:255], a[148:151], v[52:55]
v_mfma_f32_16x16x32_bf16 v[56:59], a[248:251], a[136:139], v[56:59]
v_mfma_f32_16x16x32_bf16 v[56:59], a[252:255], a[152:155], v[56:59]
v_mfma_f32_16x16x32_bf16 v[60:63], a[248:251], a[140:143], v[60:63]
ds_read_b64_tr_b16 a[232:233], v235 offset:40960
v_mfma_f32_16x16x32_bf16 v[60:63], a[252:255], a[156:159], v[60:63]
ds_read_b64_tr_b16 a[234:235], v235 offset:41472
v_mfma_f32_16x16x32_bf16 v[64:67], a[96:99], a[128:131], v[64:67]
s_waitcnt lgkmcnt(2)
ds_read_b64_tr_b16 a[236:237], v235 offset:45056
v_mfma_f32_16x16x32_bf16 v[64:67], a[100:103], a[144:147], v[64:67]
ds_read_b64_tr_b16 a[238:239], v235 offset:45568
v_mfma_f32_16x16x32_bf16 v[68:71], a[96:99], a[132:135], v[68:71]
v_mfma_f32_16x16x32_bf16 v[68:71], a[100:103], a[148:151], v[68:71]
v_mfma_f32_16x16x32_bf16 v[72:75], a[96:99], a[136:139], v[72:75]
v_mfma_f32_16x16x32_bf16 v[72:75], a[100:103], a[152:155], v[72:75]
v_mfma_f32_16x16x32_bf16 v[76:79], a[96:99], a[140:143], v[76:79]
ds_read_b64_tr_b16 a[240:241], v232 offset:57344
v_mfma_f32_16x16x32_bf16 v[76:79], a[100:103], a[156:159], v[76:79]
buffer_load_dwordx4 a[192:195], v224, s[32:35], s101 offen offset:2048 sc1
v_mfma_f32_16x16x32_bf16 v[80:83], a[104:107], a[128:131], v[80:83]
ds_read_b64_tr_b16 a[242:243], v232 offset:57856
v_mfma_f32_16x16x32_bf16 v[80:83], a[108:111], a[144:147], v[80:83]
ds_read_b64_tr_b16 a[244:245], v232 offset:61440
v_mfma_f32_16x16x32_bf16 v[84:87], a[104:107], a[132:135], v[84:87]
ds_read_b64_tr_b16 a[246:247], v232 offset:61952
v_mfma_f32_16x16x32_bf16 v[84:87], a[108:111], a[148:151], v[84:87]
v_mfma_f32_16x16x32_bf16 v[88:91], a[104:107], a[136:139], v[88:91]
buffer_load_dwordx4 a[196:199], v225, s[32:35], s101 offen offset:2048 sc1
v_mfma_f32_16x16x32_bf16 v[88:91], a[108:111], a[152:155], v[88:91]
s_lshr_b32 s0, s2, 3
s_cmp_lg_u32 s0, 10
s_cbranch_scc1 L_ct15
s_lshl_b32 s0, s56, 13
v_lshl_add_u32 v221, v243, 7, s0
v_min_u32 v221, L_z1-L_p0-4, v221
s_getpc_b64 s[0:1]
L_cp15:
s_add_u32 s0, s0, L_p0-L_cp15
s_addc_u32 s1, s1, 0
global_load_dword v213, v221, s[0:1]
L_ct15:
v_mfma_f32_16x16x32_bf16 v[92:95], a[104:107], a[140:143], v[92:95]
ds_read_b64_tr_b16 a[248:249], v232 offset:49152
v_mfma_f32_16x16x32_bf16 v[92:95], a[108:111], a[156:159], v[92:95]
ds_read_b64_tr_b16 a[250:251], v232 offset:49664
v_mfma_f32_16x16x32_bf16 v[160:163], a[224:227], a[128:131], v[160:163]
ds_read_b64_tr_b16 a[252:253], v232 offset:53248
v_mfma_f32_16x16x32_bf16 v[160:163], a[228:231], a[144:147], v[160:163]
ds_read_b64_tr_b16 a[254:255], v232 offset:53760
v_mfma_f32_16x16x32_bf16 v[164:167], a[224:227], a[132:135], v[164:167]
buffer_load_dwordx4 a[200:203], v226, s[32:35], s101 offen offset:2048 sc1
v_mfma_f32_16x16x32_bf16 v[164:167], a[228:231], a[148:151], v[164:167]
v_mfma_f32_16x16x32_bf16 v[168:171], a[224:227], a[136:139], v[168:171]
v_mfma_f32_16x16x32_bf16 v[168:171], a[228:231], a[152:155], v[168:171]
v_mfma_f32_16x16x32_bf16 v[172:175], a[224:227], a[140:143], v[172:175]
ds_read_b64_tr_b16 a[96:97], v233 offset:57344
v_mfma_f32_16x16x32_bf16 v[172:175], a[228:231], a[156:159], v[172:175]
s_waitcnt lgkmcnt(2)
ds_read_b64_tr_b16 a[98:99], v233 offset:57856
v_mfma_f32_16x16x32_bf16 v[176:179], a[232:235], a[128:131], v[176:179]
ds_read_b64_tr_b16 a[100:101], v233 offset:61440
v_mfma_f32_16x16x32_bf16 v[176:179], a[236:239], a[144:147], v[176:179]
ds_read_b64_tr_b16 a[102:103], v233 offset:61952
v_mfma_f32_16x16x32_bf16 v[180:183], a[232:235], a[132:135], v[180:183]
buffer_load_dwordx4 a[204:207], v227, s[32:35], s101 offen offset:2048 sc1
v_mfma_f32_16x16x32_bf16 v[180:183], a[236:239], a[148:151], v[180:183]
v_mfma_f32_16x16x32_bf16 v[184:187], a[232:235], a[136:139], v[184:187]
v_mfma_f32_16x16x32_bf16 v[184:187], a[236:239], a[152:155], v[184:187]
v_mfma_f32_16x16x32_bf16 v[188:191], a[232:235], a[140:143], v[188:191]
ds_read_b64_tr_b16 a[104:105], v233 offset:49152
v_mfma_f32_16x16x32_bf16 v[188:191], a[236:239], a[156:159], v[188:191]
ds_read_b64_tr_b16 a[106:107], v233 offset:49664
v_mfma_f32_16x16x32_bf16 a[0:3], a[240:243], a[128:131], a[0:3]
ds_read_b64_tr_b16 a[108:109], v233 offset:53248
v_mfma_f32_16x16x32_bf16 a[0:3], a[244:247], a[144:147], a[0:3]
buffer_load_dwordx4 a[208:211], v224, s[32:35], s101 offen offset:3072 sc1
s_lshr_b32 s0, s2, 3
s_cmp_lg_u32 s0, 11
s_cbranch_scc1 L_ct16
s_lshl_b32 s0, s56, 13
v_lshl_add_u32 v221, v243, 7, s0
v_min_u32 v221, L_end-L_ool-4, v221
s_getpc_b64 s[0:1]
L_cp16:
s_add_u32 s0, s0, L_ool-L_cp16
s_addc_u32 s1, s1, 0
global_load_dword v213, v221, s[0:1]
L_ct16:
v_mfma_f32_16x16x32_bf16 a[4:7], a[240:243], a[132:135], a[4:7]
ds_read_b64_tr_b16 a[110:111], v233 offset:53760
v_mfma_f32_16x16x32_bf16 a[4:7], a[244:247], a[148:151], a[4:7]
v_mfma_f32_16x16x32_bf16 a[8:11], a[240:243], a[136:139], a[8:11]
v_mfma_f32_16x16x32_bf16 a[8:11], a[244:247], a[152:155], a[8:11]
buffer_load_dwordx4 a[212:215], v225, s[32:35], s101 offen offset:3072 sc1
v_mfma_f32_16x16x32_bf16 a[12:15], a[240:243], a[140:143], a[12:15]
ds_read_b64_tr_b16 a[224:225], v234 offset:57344
v_mfma_f32_16x16x32_bf16 a[12:15], a[244:247], a[156:159], a[12:15]
ds_read_b64_tr_b16 a[226:227], v234 offset:57856
v_mfma_f32_16x16x32_bf16 v[96:99], a[248:251], a[128:131], v[96:99]
s_waitcnt lgkmcnt(3)
ds_read_b64_tr_b16 a[228:229], v234 offset:61440
v_mfma_f32_16x16x32_bf16 v[96:99], a[252:255], a[144:147], v[96:99]
ds_read_b64_tr_b16 a[230:231], v234 offset:61952
v_mfma_f32_16x16x32_bf16 v[100:103], a[248:251], a[132:135], v[100:103]
v_mfma_f32_16x16x32_bf16 v[100:103], a[252:255], a[148:151], v[100:103]
buffer_load_dwordx4 a[216:219], v226, s[32:35], s101 offen offset:3072 sc1
v_mfma_f32_16x16x32_bf16 v[104:107], a[248:251], a[136:139], v[104:107]
v_mfma_f32_16x16x32_bf16 v[104:107], a[252:255], a[152:155], v[104:107]
v_mfma_f32_16x16x32_bf16 v[108:111], a[248:251], a[140:143], v[108:111]
ds_read_b64_tr_b16 a[232:233], v234 offset:49152
v_mfma_f32_16x16x32_bf16 v[108:111], a[252:255], a[156:159], v[108:111]
ds_read_b64_tr_b16 a[234:235], v234 offset:49664
v_mfma_f32_16x16x32_bf16 a[16:19], a[96:99], a[128:131], a[16:19]
ds_read_b64_tr_b16 a[236:237], v234 offset:53248
v_mfma_f32_16x16x32_bf16 a[16:19], a[100:103], a[144:147], a[16:19]
ds_read_b64_tr_b16 a[238:239], v234 offset:53760
v_mfma_f32_16x16x32_bf16 a[20:23], a[96:99], a[132:135], a[20:23]
buffer_load_dwordx4 a[220:223], v227, s[32:35], s101 offen offset:3072 sc1
v_mfma_f32_16x16x32_bf16 a[20:23], a[100:103], a[148:151], a[20:23]
v_mfma_f32_16x16x32_bf16 a[24:27], a[96:99], a[136:139], a[24:27]
v_mfma_f32_16x16x32_bf16 a[24:27], a[100:103], a[152:155], a[24:27]
v_mfma_f32_16x16x32_bf16 a[28:31], a[96:99], a[140:143], a[28:31]
ds_read_b64_tr_b16 a[240:241], v235 offset:57344
v_mfma_f32_16x16x32_bf16 a[28:31], a[100:103], a[156:159], a[28:31]
ds_read_b64_tr_b16 a[242:243], v235 offset:57856
v_mfma_f32_16x16x32_bf16 v[112:115], a[104:107], a[128:131], v[112:115]
s_waitcnt lgkmcnt(2)
ds_read_b64_tr_b16 a[244:245], v235 offset:61440
v_mfma_f32_16x16x32_bf16 v[112:115], a[108:111], a[144:147], v[112:115]
ds_read_b64_tr_b16 a[246:247], v235 offset:61952
v_mfma_f32_16x16x32_bf16 v[116:119], a[104:107], a[132:135], v[116:119]
v_mfma_f32_16x16x32_bf16 v[116:119], a[108:111], a[148:151], v[116:119]
v_mfma_f32_16x16x32_bf16 v[120:123], a[104:107], a[136:139], v[120:123]
v_mfma_f32_16x16x32_bf16 v[120:123], a[108:111], a[152:155], v[120:123]
v_mfma_f32_16x16x32_bf16 v[124:127], a[104:107], a[140:143], v[124:127]
ds_read_b64_tr_b16 a[248:249], v235 offset:49152
v_mfma_f32_16x16x32_bf16 v[124:127], a[108:111], a[156:159], v[124:127]
ds_read_b64_tr_b16 a[250:251], v235 offset:49664
v_mfma_f32_16x16x32_bf16 a[32:35], a[224:227], a[128:131], a[32:35]
ds_read_b64_tr_b16 a[252:253], v235 offset:53248
v_mfma_f32_16x16x32_bf16 a[32:35], a[228:231], a[144:147], a[32:35]
ds_read_b64_tr_b16 a[254:255], v235 offset:53760
v_mfma_f32_16x16x32_bf16 a[36:39], a[224:227], a[132:135], a[36:39]
v_mfma_f32_16x16x32_bf16 a[36:39], a[228:231], a[148:151], a[36:39]
v_mfma_f32_16x16x32_bf16 a[40:43], a[224:227], a[136:139], a[40:43]
v_mfma_f32_16x16x32_bf16 a[40:43], a[228:231], a[152:155], a[40:43]
s_waitcnt vmcnt(10)
v_readfirstlane_b32 s8, v220
s_nop 2
s_cmp_ge_u32 s8, 8
s_cbranch_scc0 L_spin9
L_got9:
v_mfma_f32_16x16x32_bf16 a[44:47], a[224:227], a[140:143], a[44:47]
v_mfma_f32_16x16x32_bf16 a[44:47], a[228:231], a[156:159], a[44:47]
s_waitcnt vmcnt(17)
s_barrier
s_add_u32 s97, s58, 48
v_mfma_f32_16x16x32_bf16 v[128:131], a[232:235], a[128:131], v[128:131]
s_lshl_b32 s97, s97, 7
ds_read_b64_tr_b16 a[96:97], v232 offset:24576
v_mfma_f32_16x16x32_bf16 v[128:131], a[236:239], a[144:147], v[128:131]
s_add_u32 m0, s6, 0
ds_read_b64_tr_b16 a[98:99], v232 offset:25088
v_mfma_f32_16x16x32_bf16 v[132:135], a[232:235], a[132:135], v[132:135]
s_add_u32 s3, s63, 0
ds_read_b64_tr_b16 a[100:101], v232 offset:28672
v_mfma_f32_16x16x32_bf16 v[132:135], a[236:239], a[148:151], v[132:135]
ds_read_b64_tr_b16 a[102:103], v232 offset:29184
v_mfma_f32_16x16x32_bf16 v[136:139], a[232:235], a[136:139], v[136:139]
buffer_load_dwordx4 v242, s[40:43], s3 offen offset:0 sc1 lds
v_mfma_f32_16x16x32_bf16 v[136:139], a[236:239], a[152:155], v[136:139]
buffer_load_dwordx4 v242, s[40:43], s3 offen offset:1024 sc1 lds
v_mfma_f32_16x16x32_bf16 v[140:143], a[232:235], a[140:143], v[140:143]
ds_read_b64_tr_b16 a[104:105], v232 offset:16384
v_mfma_f32_16x16x32_bf16 v[140:143], a[236:239], a[156:159], v[140:143]
s_waitcnt lgkmcnt(4)
ds_read_b64_tr_b16 a[106:107], v232 offset:16896
v_mfma_f32_16x16x32_bf16 a[48:51], a[240:243], a[128:131], a[48:51]
buffer_load_dwordx4 v242, s[40:43], s3 offen offset:2048 sc1 lds
v_mfma_f32_16x16x32_bf16 a[48:51], a[244:247], a[144:147], a[48:51]
ds_read_b64_tr_b16 a[108:109], v232 offset:20480
v_mfma_f32_16x16x32_bf16 a[52:55], a[240:243], a[132:135], a[52:55]
ds_read_b64_tr_b16 a[110:111], v232 offset:20992
v_mfma_f32_16x16x32_bf16 a[52:55], a[244:247], a[148:151], a[52:55]
buffer_load_dwordx4 v242, s[40:43], s3 offen offset:3072 sc1 lds
v_mfma_f32_16x16x32_bf16 a[56:59], a[240:243], a[136:139], a[56:59]
v_mfma_f32_16x16x32_bf16 a[56:59], a[244:247], a[152:155], a[56:59]
s_add_u32 m0, s6, 8192
v_mfma_f32_16x16x32_bf16 a[60:63], a[240:243], a[140:143], a[60:63]
ds_read_b64_tr_b16 a[224:225], v233 offset:24576
s_add_u32 s3, s63, 16384
v_mfma_f32_16x16x32_bf16 a[60:63], a[244:247], a[156:159], a[60:63]
ds_read_b64_tr_b16 a[226:227], v233 offset:25088
v_mfma_f32_16x16x32_bf16 v[144:147], a[248:251], a[128:131], v[144:147]
buffer_load_dwordx4 v242, s[40:43], s3 offen offset:0 sc1 lds
v_mfma_f32_16x16x32_bf16 v[144:147], a[252:255], a[144:147], v[144:147]
ds_read_b64_tr_b16 a[228:229], v233 offset:28672
v_mfma_f32_16x16x32_bf16 v[148:151], a[248:251], a[132:135], v[148:151]
ds_read_b64_tr_b16 a[230:231], v233 offset:29184
v_mfma_f32_16x16x32_bf16 v[148:151], a[252:255], a[148:151], v[148:151]
buffer_load_dwordx4 v242, s[40:43], s3 offen offset:1024 sc1 lds
v_mfma_f32_16x16x32_bf16 v[152:155], a[248:251], a[136:139], v[152:155]
v_mfma_f32_16x16x32_bf16 v[152:155], a[252:255], a[152:155], v[152:155]
v_mfma_f32_16x16x32_bf16 v[156:159], a[248:251], a[140:143], v[156:159]
buffer_load_dwordx4 v242, s[40:43], s3 offen offset:2048 sc1 lds
v_mfma_f32_16x16x32_bf16 v[156:159], a[252:255], a[156:159], v[156:159]
s_waitcnt lgkmcnt(2)
ds_read_b64_tr_b16 a[232:233], v233 offset:16384
v_mfma_f32_16x16x32_bf16 a[0:3], a[96:99], a[64:67], a[0:3]
ds_read_b64_tr_b16 a[234:235], v233 offset:16896
v_mfma_f32_16x16x32_bf16 a[0:3], a[100:103], a[80:83], a[0:3]
ds_read_b64_tr_b16 a[236:237], v233 offset:20480
v_mfma_f32_16x16x32_bf16 a[4:7], a[96:99], a[68:71], a[4:7]
ds_read_b64_tr_b16 a[238:239], v233 offset:20992
v_mfma_f32_16x16x32_bf16 a[4:7], a[100:103], a[84:87], a[4:7]
buffer_load_dwordx4 v242, s[40:43], s3 offen offset:3072 sc1 lds
v_mfma_f32_16x16x32_bf16 a[8:11], a[96:99], a[72:75], a[8:11]
s_add_u32 m0, s6, 16384
v_mfma_f32_16x16x32_bf16 a[8:11], a[100:103], a[88:91], a[8:11]
s_add_u32 s3, s63, 32768
v_mfma_f32_16x16x32_bf16 a[12:15], a[96:99], a[76:79], a[12:15]
ds_read_b64_tr_b16 a[240:241], v234 offset:24576
v_mfma_f32_16x16x32_bf16 a[12:15], a[100:103], a[92:95], a[12:15]
buffer_load_dwordx4 v242, s[40:43], s3 offen offset:0 sc1 lds
v_mfma_f32_16x16x32_bf16 v[96:99], a[104:107], a[64:67], v[96:99]
ds_read_b64_tr_b16 a[242:243], v234 offset:25088
v_mfma_f32_16x16x32_bf16 v[96:99], a[108:111], a[80:83], v[96:99]
ds_read_b64_tr_b16 a[244:245], v234 offset:28672
v_mfma_f32_16x16x32_bf16 v[100:103], a[104:107], a[68:71], v[100:103]
ds_read_b64_tr_b16 a[246:247], v234 offset:29184
v_mfma_f32_16x16x32_bf16 v[100:103], a[108:111], a[84:87], v[100:103]
buffer_load_dwordx4 v242, s[40:43], s3 offen offset:1024 sc1 lds
v_mfma_f32_16x16x32_bf16 v[104:107], a[104:107], a[72:75], v[104:107]
v_mfma_f32_16x16x32_bf16 v[104:107], a[108:111], a[88:91], v[104:107]
buffer_load_dwordx4 v242, s[40:43], s3 offen offset:2048 sc1 lds
v_mfma_f32_16x16x32_bf16 v[108:111], a[104:107], a[76:79], v[108:111]
ds_read_b64_tr_b16 a[248:249], v234 offset:16384
v_mfma_f32_16x16x32_bf16 v[108:111], a[108:111], a[92:95], v[108:111]
ds_read_b64_tr_b16 a[250:251], v234 offset:16896
v_mfma_f32_16x16x32_bf16 a[16:19], a[224:227], a[64:67], a[16:19]
s_waitcnt lgkmcnt(3)
ds_read_b64_tr_b16 a[252:253], v234 offset:20480
v_mfma_f32_16x16x32_bf16 a[16:19], a[228:231], a[80:83], a[16:19]
ds_read_b64_tr_b16 a[254:255], v234 offset:20992
v_mfma_f32_16x16x32_bf16 a[20:23], a[224:227], a[68:71], a[20:23]
buffer_load_dwordx4 v242, s[40:43], s3 offen offset:3072 sc1 lds
v_mfma_f32_16x16x32_bf16 a[20:23], a[228:231], a[84:87], a[20:23]
v_mfma_f32_16x16x32_bf16 a[24:27], a[224:227], a[72:75], a[24:27]
s_add_u32 m0, s6, 24576
v_mfma_f32_16x16x32_bf16 a[24:27], a[228:231], a[88:91], a[24:27]
s_add_u32 s3, s63, 49152
v_mfma_f32_16x16x32_bf16 a[28:31], a[224:227], a[76:79], a[28:31]
buffer_load_dwordx4 v242, s[40:43], s3 offen offset:0 sc1 lds
v_mfma_f32_16x16x32_bf16 a[28:31], a[228:231], a[92:95], a[28:31]
ds_read_b64_tr_b16 a[96:97], v235 offset:24576
v_mfma_f32_16x16x32_bf16 v[112:115], a[232:235], a[64:67], v[112:115]
ds_read_b64_tr_b16 a[98:99], v235 offset:25088
v_mfma_f32_16x16x32_bf16 v[112:115], a[236:239], a[80:83], v[112:115]
ds_read_b64_tr_b16 a[100:101], v235 offset:28672
v_mfma_f32_16x16x32_bf16 v[116:119], a[232:235], a[68:71], v[116:119]
ds_read_b64_tr_b16 a[102:103], v235 offset:29184
v_mfma_f32_16x16x32_bf16 v[116:119], a[236:239], a[84:87], v[116:119]
buffer_load_dwordx4 v242, s[40:43], s3 offen offset:1024 sc1 lds
v_mfma_f32_16x16x32_bf16 v[120:123], a[232:235], a[72:75], v[120:123]
buffer_load_dwordx4 v242, s[40:43], s3 offen offset:2048 sc1 lds
v_mfma_f32_16x16x32_bf16 v[120:123], a[236:239], a[88:91], v[120:123]
v_mfma_f32_16x16x32_bf16 v[124:127], a[232:235], a[76:79], v[124:127]
ds_read_b64_tr_b16 a[104:105], v235 offset:16384
v_mfma_f32_16x16x32_bf16 v[124:127], a[236:239], a[92:95], v[124:127]
ds_read_b64_tr_b16 a[106:107], v235 offset:16896
v_mfma_f32_16x16x32_bf16 a[32:35], a[240:243], a[64:67], a[32:35]
s_waitcnt lgkmcnt(3)
ds_read_b64_tr_b16 a[108:109], v235 offset:20480
v_mfma_f32_16x16x32_bf16 a[32:35], a[244:247], a[80:83], a[32:35]
ds_read_b64_tr_b16 a[110:111], v235 offset:20992
v_mfma_f32_16x16x32_bf16 a[36:39], a[240:243], a[68:71], a[36:39]
buffer_load_dwordx4 v242, s[40:43], s3 offen offset:3072 sc1 lds
v_mfma_f32_16x16x32_bf16 a[36:39], a[244:247], a[84:87], a[36:39]
v_mfma_f32_16x16x32_bf16 a[40:43], a[240:243], a[72:75], a[40:43]
v_mfma_f32_16x16x32_bf16 a[40:43], a[244:247], a[88:91], a[40:43]
v_mfma_f32_16x16x32_bf16 a[44:47], a[240:243], a[76:79], a[44:47]
v_mfma_f32_16x16x32_bf16 a[44:47], a[244:247], a[92:95], a[44:47]
s_waitcnt vmcnt(16)
s_barrier
s_add_u32 m0, s100, 98304
v_mfma_f32_16x16x32_bf16 v[128:131], a[248:251], a[64:67], v[128:131]
ds_read_b64_tr_b16 a[224:225], v236 offset:24576
s_mul_i32 s3, s56, 16384
v_mfma_f32_16x16x32_bf16 v[128:131], a[252:255], a[80:83], v[128:131]
ds_read_b64_tr_b16 a[226:227], v236 offset:25088
s_add_u32 s3, s3, 65536
v_mfma_f32_16x16x32_bf16 v[132:135], a[248:251], a[68:71], v[132:135]
ds_read_b64_tr_b16 a[228:229], v236 offset:28672
v_mfma_f32_16x16x32_bf16 v[132:135], a[252:255], a[84:87], v[132:135]
ds_read_b64_tr_b16 a[230:231], v236 offset:29184
v_mfma_f32_16x16x32_bf16 v[136:139], a[248:251], a[72:75], v[136:139]
buffer_load_dwordx4 v242, s[40:43], s3 offen offset:0 sc1 lds
v_mfma_f32_16x16x32_bf16 v[136:139], a[252:255], a[88:91], v[136:139]
v_mfma_f32_16x16x32_bf16 v[140:143], a[248:251], a[76:79], v[140:143]
ds_read_b64_tr_b16 a[232:233], v236 offset:16384
v_mfma_f32_16x16x32_bf16 v[140:143], a[252:255], a[92:95], v[140:143]
ds_read_b64_tr_b16 a[234:235], v236 offset:16896
v_mfma_f32_16x16x32_bf16 a[48:51], a[96:99], a[64:67], a[48:51]
s_waitcnt lgkmcnt(4)
ds_read_b64_tr_b16 a[236:237], v236 offset:20480
v_mfma_f32_16x16x32_bf16 a[48:51], a[100:103], a[80:83], a[48:51]
buffer_load_dwordx4 v242, s[40:43], s3 offen offset:1024 sc1 lds
v_mfma_f32_16x16x32_bf16 a[52:55], a[96:99], a[68:71], a[52:55]
ds_read_b64_tr_b16 a[238:239], v236 offset:20992
v_mfma_f32_16x16x32_bf16 a[52:55], a[100:103], a[84:87], a[52:55]
v_mfma_f32_16x16x32_bf16 a[56:59], a[96:99], a[72:75], a[56:59]
buffer_load_dwordx4 v242, s[40:43], s3 offen offset:2048 sc1 lds
v_mfma_f32_16x16x32_bf16 a[56:59], a[100:103], a[88:91], a[56:59]
v_mfma_f32_16x16x32_bf16 a[60:63], a[96:99], a[76:79], a[60:63]
ds_read_b64_tr_b16 a[240:241], v237 offset:24576
v_mfma_f32_16x16x32_bf16 a[60:63], a[100:103], a[92:95], a[60:63]
ds_read_b64_tr_b16 a[242:243], v237 offset:25088
v_mfma_f32_16x16x32_bf16 v[144:147], a[104:107], a[64:67], v[144:147]
ds_read_b64_tr_b16 a[244:245], v237 offset:28672
v_mfma_f32_16x16x32_bf16 v[144:147], a[108:111], a[80:83], v[144:147]
ds_read_b64_tr_b16 a[246:247], v237 offset:29184
v_mfma_f32_16x16x32_bf16 v[148:151], a[104:107], a[68:71], v[148:151]
buffer_load_dwordx4 v242, s[40:43], s3 offen offset:3072 sc1 lds
v_mfma_f32_16x16x32_bf16 v[148:151], a[108:111], a[84:87], v[148:151]
v_mfma_f32_16x16x32_bf16 v[152:155], a[104:107], a[72:75], v[152:155]
v_mfma_f32_16x16x32_bf16 v[152:155], a[108:111], a[88:91], v[152:155]
v_mfma_f32_16x16x32_bf16 v[156:159], a[104:107], a[76:79], v[156:159]
ds_read_b64_tr_b16 a[248:249], v237 offset:16384
s_add_u32 m0, s100, 102400
v_mfma_f32_16x16x32_bf16 v[156:159], a[108:111], a[92:95], v[156:159]
ds_read_b64_tr_b16 a[250:251], v237 offset:16896
v_mfma_f32_16x16x32_bf16 a[0:3], a[224:227], a[192:195], a[0:3]
s_waitcnt lgkmcnt(2)
ds_read_b64_tr_b16 a[252:253], v237 offset:20480
v_mfma_f32_16x16x32_bf16 a[0:3], a[228:231], a[208:211], a[0:3]
ds_read_b64_tr_b16 a[254:255], v237 offset:20992
s_mul_i32 s3, s56, 16384
v_mfma_f32_16x16x32_bf16 a[4:7], a[224:227], a[196:199], a[4:7]
s_add_u32 s3, s3, 69632
v_mfma_f32_16x16x32_bf16 a[4:7], a[228:231], a[212:215], a[4:7]
buffer_load_dwordx4 v242, s[40:43], s3 offen offset:0 sc1 lds
v_mfma_f32_16x16x32_bf16 a[8:11], a[224:227], a[200:203], a[8:11]
v_mfma_f32_16x16x32_bf16 a[8:11], a[228:231], a[216:219], a[8:11]
v_mfma_f32_16x16x32_bf16 a[12:15], a[224:227], a[204:207], a[12:15]
ds_read_b64_tr_b16 a[96:97], v238 offset:24576
v_mfma_f32_16x16x32_bf16 a[12:15], a[228:231], a[220:223], a[12:15]
ds_read_b64_tr_b16 a[98:99], v238 offset:25088
v_mfma_f32_16x16x32_bf16 v[96:99], a[232:235], a[192:195], v[96:99]
ds_read_b64_tr_b16 a[100:101], v238 offset:28672
v_mfma_f32_16x16x32_bf16 v[96:99], a[236:239], a[208:211], v[96:99]
ds_read_b64_tr_b16 a[102:103], v238 offset:29184
v_mfma_f32_16x16x32_bf16 v[100:103], a[232:235], a[196:199], v[100:103]
buffer_load_dwordx4 v242, s[40:43], s3 offen offset:1024 sc1 lds
v_mfma_f32_16x16x32_bf16 v[100:103], a[236:239], a[212:215], v[100:103]
v_mfma_f32_16x16x32_bf16 v[104:107], a[232:235], a[200:203], v[104:107]
v_mfma_f32_16x16x32_bf16 v[104:107], a[236:239], a[216:219], v[104:107]
buffer_load_dwordx4 v242, s[40:43], s3 offen offset:2048 sc1 lds
v_mfma_f32_16x16x32_bf16 v[108:111], a[232:235], a[204:207], v[108:111]
ds_read_b64_tr_b16 a[104:105], v238 offset:16384
v_mfma_f32_16x16x32_bf16 v[108:111], a[236:239], a[220:223], v[108:111]
ds_read_b64_tr_b16 a[106:107], v238 offset:16896
v_mfma_f32_16x16x32_bf16 a[16:19], a[240:243], a[192:195], a[16:19]
ds_read_b64_tr_b16 a[108:109], v238 offset:20480
v_mfma_f32_16x16x32_bf16 a[16:19], a[244:247], a[208:211], a[16:19]
ds_read_b64_tr_b16 a[110:111], v238 offset:20992
v_mfma_f32_16x16x32_bf16 a[20:23], a[240:243], a[196:199], a[20:23]
buffer_load_dwordx4 v242, s[40:43], s3 offen offset:3072 sc1 lds
v_mfma_f32_16x16x32_bf16 a[20:23], a[244:247], a[212:215], a[20:23]
v_mfma_f32_16x16x32_bf16 a[24:27], a[240:243], a[200:203], a[24:27]
v_mfma_f32_16x16x32_bf16 a[24:27], a[244:247], a[216:219], a[24:27]
v_mfma_f32_16x16x32_bf16 a[28:31], a[240:243], a[204:207], a[28:31]
ds_read_b64_tr_b16 a[224:225], v239 offset:24576
v_mfma_f32_16x16x32_bf16 a[28:31], a[244:247], a[220:223], a[28:31]
s_waitcnt lgkmcnt(2)
ds_read_b64_tr_b16 a[226:227], v239 offset:25088
v_mfma_f32_16x16x32_bf16 v[112:115], a[248:251], a[192:195], v[112:115]
ds_read_b64_tr_b16 a[228:229], v239 offset:28672
v_mfma_f32_16x16x32_bf16 v[112:115], a[252:255], a[208:211], v[112:115]
ds_read_b64_tr_b16 a[230:231], v239 offset:29184
v_mfma_f32_16x16x32_bf16 v[116:119], a[248:251], a[196:199], v[116:119]
v_mfma_f32_16x16x32_bf16 v[116:119], a[252:255], a[212:215], v[116:119]
v_mfma_f32_16x16x32_bf16 v[120:123], a[248:251], a[200:203], v[120:123]
v_mfma_f32_16x16x32_bf16 v[120:123], a[252:255], a[216:219], v[120:123]
v_mfma_f32_16x16x32_bf16 v[124:127], a[248:251], a[204:207], v[124:127]
ds_read_b64_tr_b16 a[232:233], v239 offset:16384
v_mfma_f32_16x16x32_bf16 v[124:127], a[252:255], a[220:223], v[124:127]
ds_read_b64_tr_b16 a[234:235], v239 offset:16896
v_mfma_f32_16x16x32_bf16 a[32:35], a[96:99], a[192:195], a[32:35]
ds_read_b64_tr_b16 a[236:237], v239 offset:20480
v_mfma_f32_16x16x32_bf16 a[32:35], a[100:103], a[208:211], a[32:35]
ds_read_b64_tr_b16 a[238:239], v239 offset:20992
v_mfma_f32_16x16x32_bf16 a[36:39], a[96:99], a[196:199], a[36:39]
v_mfma_f32_16x16x32_bf16 a[36:39], a[100:103], a[212:215], a[36:39]
v_mfma_f32_16x16x32_bf16 a[40:43], a[96:99], a[200:203], a[40:43]
v_mfma_f32_16x16x32_bf16 a[40:43], a[100:103], a[216:219], a[40:43]
v_mfma_f32_16x16x32_bf16 a[44:47], a[96:99], a[204:207], a[44:47]
ds_read_b64_tr_b16 a[240:241], v232 offset:0
v_mfma_f32_16x16x32_bf16 a[44:47], a[100:103], a[220:223], a[44:47]
ds_read_b64_tr_b16 a[242:243], v232 offset:512
v_mfma_f32_16x16x32_bf16 v[128:131], a[104:107], a[192:195], v[128:131]
s_waitcnt lgkmcnt(2)
ds_read_b64_tr_b16 a[244:245], v232 offset:4096
v_mfma_f32_16x16x32_bf16 v[128:131], a[108:111], a[208:211], v[128:131]
ds_read_b64_tr_b16 a[246:247], v232 offset:4608
v_mfma_f32_16x16x32_bf16 v[132:135], a[104:107], a[196:199], v[132:135]
ds_read_b64_tr_b16 a[248:249], v236 offset:0
v_mfma_f32_16x16x32_bf16 v[132:135], a[108:111], a[212:215], v[132:135]
ds_read_b64_tr_b16 a[250:251], v236 offset:512
v_mfma_f32_16x16x32_bf16 v[136:139], a[104:107], a[200:203], v[136:139]
ds_read_b64_tr_b16 a[252:253], v236 offset:4096
v_mfma_f32_16x16x32_bf16 v[136:139], a[108:111], a[216:219], v[136:139]
ds_read_b64_tr_b16 a[254:255], v236 offset:4608
v_mfma_f32_16x16x32_bf16 v[140:143], a[104:107], a[204:207], v[140:143]
v_mfma_f32_16x16x32_bf16 v[140:143], a[108:111], a[220:223], v[140:143]
v_mfma_f32_16x16x32_bf16 a[48:51], a[224:227], a[192:195], a[48:51]
v_mfma_f32_16x16x32_bf16 a[48:51], a[228:231], a[208:211], a[48:51]
v_mfma_f32_16x16x32_bf16 a[52:55], a[224:227], a[196:199], a[52:55]
v_mfma_f32_16x16x32_bf16 a[52:55], a[228:231], a[212:215], a[52:55]
v_mfma_f32_16x16x32_bf16 a[56:59], a[224:227], a[200:203], a[56:59]
v_mfma_f32_16x16x32_bf16 a[56:59], a[228:231], a[216:219], a[56:59]
v_mfma_f32_16x16x32_bf16 a[60:63], a[224:227], a[204:207], a[60:63]
ds_read_b64_tr_b16 a[96:97], v233 offset:0
v_mfma_f32_16x16x32_bf16 a[60:63], a[228:231], a[220:223], a[60:63]
ds_read_b64_tr_b16 a[98:99], v233 offset:512
v_mfma_f32_16x16x32_bf16 v[144:147], a[232:235], a[192:195], v[144:147]
ds_read_b64_tr_b16 a[100:101], v233 offset:4096
v_accvgpr_read_b32 v192, a0
v_mfma_f32_16x16x32_bf16 v[144:147], a[236:239], a[208:211], v[144:147]
ds_read_b64_tr_b16 a[102:103], v233 offset:4608
v_accvgpr_read_b32 v193, a1
v_mfma_f32_16x16x32_bf16 v[148:151], a[232:235], a[196:199], v[148:151]
ds_read_b64_tr_b16 a[104:105], v237 offset:0
v_accvgpr_read_b32 v194, a2
v_mfma_f32_16x16x32_bf16 v[148:151], a[236:239], a[212:215], v[148:151]
ds_read_b64_tr_b16 a[106:107], v237 offset:512
v_accvgpr_read_b32 v195, a3
v_mfma_f32_16x16x32_bf16 v[152:155], a[232:235], a[200:203], v[152:155]
v_mul_f32 v192, v192, v96
v_mul_f32 v193, v193, v97
v_mfma_f32_16x16x32_bf16 v[152:155], a[236:239], a[216:219], v[152:155]
ds_read_b64_tr_b16 a[108:109], v237 offset:4096
v_mul_f32 v194, v194, v98
v_mfma_f32_16x16x32_bf16 v[156:159], a[232:235], a[204:207], v[156:159]
ds_read_b64_tr_b16 a[110:111], v237 offset:4608
v_mul_f32 v195, v195, v99
v_mfma_f32_16x16x32_bf16 v[156:159], a[236:239], a[220:223], v[156:159]
s_waitcnt lgkmcnt(5)
v_cvt_pk_bf16_f32 v208, v192, v193
v_cvt_pk_bf16_f32 v209, v194, v195
v_mfma_f32_16x16x32_bf16 v[0:3], a[240:243], a[64:67], v[0:3]
v_accvgpr_read_b32 v196, a16
v_accvgpr_read_b32 v197, a17
v_mfma_f32_16x16x32_bf16 v[0:3], a[244:247], a[80:83], v[0:3]
v_accvgpr_read_b32 v198, a18
v_accvgpr_read_b32 v199, a19
v_mfma_f32_16x16x32_bf16 v[0:3], a[248:251], a[192:195], v[0:3]
v_mul_f32 v196, v196, v112
v_mul_f32 v197, v197, v113
v_mfma_f32_16x16x32_bf16 v[0:3], a[252:255], a[208:211], v[0:3]
v_mul_f32 v198, v198, v114
v_mul_f32 v199, v199, v115
v_mfma_f32_16x16x32_bf16 v[4:7], a[240:243], a[68:71], v[4:7]
v_cvt_pk_bf16_f32 v210, v196, v197
v_cvt_pk_bf16_f32 v211, v198, v199
v_mfma_f32_16x16x32_bf16 v[4:7], a[244:247], a[84:87], v[4:7]
buffer_store_dwordx4 v[208:211], v242, s[36:39], s10 offen offset:0 sc1
v_mfma_f32_16x16x32_bf16 v[4:7], a[248:251], a[196:199], v[4:7]
v_accvgpr_read_b32 v200, a4
v_accvgpr_read_b32 v201, a5
v_mfma_f32_16x16x32_bf16 v[4:7], a[252:255], a[212:215], v[4:7]
v_accvgpr_read_b32 v202, a6
v_accvgpr_read_b32 v203, a7
v_mfma_f32_16x16x32_bf16 v[8:11], a[240:243], a[72:75], v[8:11]
v_mul_f32 v200, v200, v100
v_mul_f32 v201, v201, v101
v_mfma_f32_16x16x32_bf16 v[8:11], a[244:247], a[88:91], v[8:11]
v_mul_f32 v202, v202, v102
v_mul_f32 v203, v203, v103
v_mfma_f32_16x16x32_bf16 v[8:11], a[248:251], a[200:203], v[8:11]
v_cvt_pk_bf16_f32 v212, v200, v201
v_cvt_pk_bf16_f32 v213, v202, v203
v_mfma_f32_16x16x32_bf16 v[8:11], a[252:255], a[216:219], v[8:11]
ds_read_b64_tr_b16 a[224:225], v234 offset:0
v_accvgpr_read_b32 v204, a20
v_mfma_f32_16x16x32_bf16 v[12:15], a[240:243], a[76:79], v[12:15]
ds_read_b64_tr_b16 a[226:227], v234 offset:512
v_accvgpr_read_b32 v205, a21
v_mfma_f32_16x16x32_bf16 v[12:15], a[244:247], a[92:95], v[12:15]
ds_read_b64_tr_b16 a[228:229], v234 offset:4096
v_accvgpr_read_b32 v206, a22
v_accvgpr_read_b32 v207, a23
v_mfma_f32_16x16x32_bf16 v[12:15], a[248:251], a[204:207], v[12:15]
ds_read_b64_tr_b16 a[230:231], v234 offset:4608
v_mul_f32 v204, v204, v116
v_mul_f32 v205, v205, v117
v_mfma_f32_16x16x32_bf16 v[12:15], a[252:255], a[220:223], v[12:15]
ds_read_b64_tr_b16 a[232:233], v238 offset:0
v_mul_f32 v206, v206, v118
v_mul_f32 v207, v207, v119
v_mfma_f32_16x16x32_bf16 v[16:19], a[96:99], a[64:67], v[16:19]
s_waitcnt lgkmcnt(5)
ds_read_b64_tr_b16 a[234:235], v238 offset:512
v_cvt_pk_bf16_f32 v214, v204, v205
v_cvt_pk_bf16_f32 v215, v206, v207
v_mfma_f32_16x16x32_bf16 v[16:19], a[100:103], a[80:83], v[16:19]
ds_read_b64_tr_b16 a[236:237], v238 offset:4096
ds_read_b64_tr_b16 a[238:239], v238 offset:4608
v_mfma_f32_16x16x32_bf16 v[16:19], a[104:107], a[192:195], v[16:19]
buffer_store_dwordx4 v[212:215], v242, s[36:39], s11 offen offset:0 sc1
v_accvgpr_read_b32 v192, a8
v_accvgpr_read_b32 v193, a9
v_mfma_f32_16x16x32_bf16 v[16:19], a[108:111], a[208:211], v[16:19]
v_accvgpr_read_b32 v194, a10
v_accvgpr_read_b32 v195, a11
v_mfma_f32_16x16x32_bf16 v[20:23], a[96:99], a[68:71], v[20:23]
v_mul_f32 v192, v192, v104
v_mul_f32 v193, v193, v105
v_mfma_f32_16x16x32_bf16 v[20:23], a[100:103], a[84:87], v[20:23]
v_mul_f32 v194, v194, v106
v_mul_f32 v195, v195, v107
v_mfma_f32_16x16x32_bf16 v[20:23], a[104:107], a[196:199], v[20:23]
v_cvt_pk_bf16_f32 v208, v192, v193
v_cvt_pk_bf16_f32 v209, v194, v195
v_mfma_f32_16x16x32_bf16 v[20:23], a[108:111], a[212:215], v[20:23]
v_accvgpr_read_b32 v196, a24
v_accvgpr_read_b32 v197, a25
v_mfma_f32_16x16x32_bf16 v[24:27], a[96:99], a[72:75], v[24:27]
v_accvgpr_read_b32 v198, a26
v_accvgpr_read_b32 v199, a27
v_mfma_f32_16x16x32_bf16 v[24:27], a[100:103], a[88:91], v[24:27]
v_mul_f32 v196, v196, v120
v_mul_f32 v197, v197, v121
v_mfma_f32_16x16x32_bf16 v[24:27], a[104:107], a[200:203], v[24:27]
v_mul_f32 v198, v198, v122
v_mul_f32 v199, v199, v123
v_mfma_f32_16x16x32_bf16 v[24:27], a[108:111], a[216:219], v[24:27]
ds_read_b64_tr_b16 a[240:241], v235 offset:0
v_cvt_pk_bf16_f32 v210, v196, v197
v_cvt_pk_bf16_f32 v211, v198, v199
v_mfma_f32_16x16x32_bf16 v[28:31], a[96:99], a[76:79], v[28:31]
buffer_store_dwordx4 v[208:211], v242, s[36:39], s12 offen offset:0 sc1
v_mfma_f32_16x16x32_bf16 v[28:31], a[100:103], a[92:95], v[28:31]
ds_read_b64_tr_b16 a[242:243], v235 offset:512
v_accvgpr_read_b32 v200, a12
v_accvgpr_read_b32 v201, a13
v_mfma_f32_16x16x32_bf16 v[28:31], a[104:107], a[204:207], v[28:31]
ds_read_b64_tr_b16 a[244:245], v235 offset:4096
v_accvgpr_read_b32 v202, a14
v_accvgpr_read_b32 v203, a15
v_mfma_f32_16x16x32_bf16 v[28:31], a[108:111], a[220:223], v[28:31]
s_waitcnt lgkmcnt(3)
ds_read_b64_tr_b16 a[246:247], v235 offset:4608
v_mul_f32 v200, v200, v108
v_mul_f32 v201, v201, v109
v_mfma_f32_16x16x32_bf16 v[32:35], a[224:227], a[64:67], v[32:35]
ds_read_b64_tr_b16 a[248:249], v239 offset:0
v_mul_f32 v202, v202, v110
v_mul_f32 v203, v203, v111
v_mfma_f32_16x16x32_bf16 v[32:35], a[228:231], a[80:83], v[32:35]
ds_read_b64_tr_b16 a[250:251], v239 offset:512
v_cvt_pk_bf16_f32 v212, v200, v201
v_cvt_pk_bf16_f32 v213, v202, v203
v_mfma_f32_16x16x32_bf16 v[32:35], a[232:235], a[192:195], v[32:35]
ds_read_b64_tr_b16 a[252:253], v239 offset:4096
v_accvgpr_read_b32 v204, a28
v_accvgpr_read_b32 v205, a29
v_mfma_f32_16x16x32_bf16 v[32:35], a[236:239], a[208:211], v[32:35]
ds_read_b64_tr_b16 a[254:255], v239 offset:4608
v_accvgpr_read_b32 v206, a30
v_mfma_f32_16x16x32_bf16 v[36:39], a[224:227], a[68:71], v[36:39]
v_accvgpr_read_b32 v207, a31
v_mul_f32 v204, v204, v124
v_mfma_f32_16x16x32_bf16 v[36:39], a[228:231], a[84:87], v[36:39]
v_mul_f32 v205, v205, v125
v_mul_f32 v206, v206, v126
v_mfma_f32_16x16x32_bf16 v[36:39], a[232:235], a[196:199], v[36:39]
v_mul_f32 v207, v207, v127
v_cvt_pk_bf16_f32 v214, v204, v205
v_mfma_f32_16x16x32_bf16 v[36:39], a[236:239], a[212:215], v[36:39]
ds_read_b64_tr_b16 a[96:97], v232 offset:8192
v_cvt_pk_bf16_f32 v215, v206, v207
v_mfma_f32_16x16x32_bf16 v[40:43], a[224:227], a[72:75], v[40:43]
buffer_store_dwordx4 v[212:215], v242, s[36:39], s13 offen offset:0 sc1
v_cvt_pk_bf16_f32 v96, v0, v1
v_mfma_f32_16x16x32_bf16 v[40:43], a[228:231], a[88:91], v[40:43]
v_cvt_pk_bf16_f32 v97, v2, v3
v_cvt_pk_bf16_f32 v98, v16, v17
v_mfma_f32_16x16x32_bf16 v[40:43], a[232:235], a[200:203], v[40:43]
v_cvt_pk_bf16_f32 v99, v18, v19
v_cvt_pk_bf16_f32 v100, v4, v5
v_mfma_f32_16x16x32_bf16 v[40:43], a[236:239], a[216:219], v[40:43]
v_cvt_pk_bf16_f32 v101, v6, v7
v_cvt_pk_bf16_f32 v102, v20, v21
v_mfma_f32_16x16x32_bf16 v[44:47], a[224:227], a[76:79], v[44:47]
ds_read_b64_tr_b16 a[98:99], v232 offset:8704
v_cvt_pk_bf16_f32 v103, v22, v23
v_cvt_pk_bf16_f32 v104, v8, v9
v_mfma_f32_16x16x32_bf16 v[44:47], a[228:231], a[92:95], v[44:47]
ds_read_b64_tr_b16 a[100:101], v232 offset:12288
v_cvt_pk_bf16_f32 v105, v10, v11
v_cvt_pk_bf16_f32 v106, v24, v25
v_mfma_f32_16x16x32_bf16 v[44:47], a[232:235], a[204:207], v[44:47]
ds_read_b64_tr_b16 a[102:103], v232 offset:12800
v_cvt_pk_bf16_f32 v107, v26, v27
v_cvt_pk_bf16_f32 v108, v12, v13
v_mfma_f32_16x16x32_bf16 v[44:47], a[236:239], a[220:223], v[44:47]
s_waitcnt lgkmcnt(3)
ds_read_b64_tr_b16 a[104:105], v236 offset:8192
v_cvt_pk_bf16_f32 v109, v14, v15
v_cvt_pk_bf16_f32 v110, v28, v29
v_mfma_f32_16x16x32_bf16 v[48:51], a[240:243], a[64:67], v[48:51]
ds_read_b64_tr_b16 a[106:107], v236 offset:8704
v_cvt_pk_bf16_f32 v111, v30, v31
v_mfma_f32_16x16x32_bf16 v[48:51], a[244:247], a[80:83], v[48:51]
ds_read_b64_tr_b16 a[108:109], v236 offset:12288
ds_read_b64_tr_b16 a[110:111], v236 offset:12800
v_mfma_f32_16x16x32_bf16 v[48:51], a[248:251], a[192:195], v[48:51]
v_mfma_f32_16x16x32_bf16 v[48:51], a[252:255], a[208:211], v[48:51]
v_mfma_f32_16x16x32_bf16 v[52:55], a[240:243], a[68:71], v[52:55]
v_mfma_f32_16x16x32_bf16 v[52:55], a[244:247], a[84:87], v[52:55]
v_mfma_f32_16x16x32_bf16 v[52:55], a[248:251], a[196:199], v[52:55]
ds_read_b64_tr_b16 a[224:225], v233 offset:8192
v_mfma_f32_16x16x32_bf16 v[52:55], a[252:255], a[212:215], v[52:55]
ds_read_b64_tr_b16 a[226:227], v233 offset:8704
v_mfma_f32_16x16x32_bf16 v[56:59], a[240:243], a[72:75], v[56:59]
ds_read_b64_tr_b16 a[228:229], v233 offset:12288
v_mfma_f32_16x16x32_bf16 v[56:59], a[244:247], a[88:91], v[56:59]
ds_read_b64_tr_b16 a[230:231], v233 offset:12800
v_mfma_f32_16x16x32_bf16 v[56:59], a[248:251], a[200:203], v[56:59]
ds_read_b64_tr_b16 a[232:233], v237 offset:8192
v_mfma_f32_16x16x32_bf16 v[56:59], a[252:255], a[216:219], v[56:59]
ds_read_b64_tr_b16 a[234:235], v237 offset:8704
v_mfma_f32_16x16x32_bf16 v[60:63], a[240:243], a[76:79], v[60:63]
ds_read_b64_tr_b16 a[236:237], v237 offset:12288
v_mfma_f32_16x16x32_bf16 v[60:63], a[244:247], a[92:95], v[60:63]
ds_read_b64_tr_b16 a[238:239], v237 offset:12800
v_mfma_f32_16x16x32_bf16 v[60:63], a[248:251], a[204:207], v[60:63]
v_mfma_f32_16x16x32_bf16 v[60:63], a[252:255], a[220:223], v[60:63]
s_waitcnt lgkmcnt(5)
v_mfma_f32_16x16x32_bf16 v[64:67], a[96:99], a[64:67], v[64:67]
v_mfma_f32_16x16x32_bf16 v[64:67], a[100:103], a[80:83], v[64:67]
v_mfma_f32_16x16x32_bf16 v[64:67], a[104:107], a[192:195], v[64:67]
v_mfma_f32_16x16x32_bf16 v[64:67], a[108:111], a[208:211], v[64:67]
v_mfma_f32_16x16x32_bf16 v[68:71], a[96:99], a[68:71], v[68:71]
v_mfma_f32_16x16x32_bf16 v[68:71], a[100:103], a[84:87], v[68:71]
v_cvt_pk_bf16_f32 v112, v32, v33
v_cvt_pk_bf16_f32 v113, v34, v35
v_cvt_pk_bf16_f32 v114, v48, v49
v_cvt_pk_bf16_f32 v115, v50, v51
v_cvt_pk_bf16_f32 v116, v36, v37
v_cvt_pk_bf16_f32 v117, v38, v39
v_cvt_pk_bf16_f32 v118, v52, v53
v_cvt_pk_bf16_f32 v119, v54, v55
v_cvt_pk_bf16_f32 v120, v40, v41
v_cvt_pk_bf16_f32 v121, v42, v43
v_cvt_pk_bf16_f32 v122, v56, v57
v_cvt_pk_bf16_f32 v123, v58, v59
v_cvt_pk_bf16_f32 v124, v44, v45
v_cvt_pk_bf16_f32 v125, v46, v47
v_cvt_pk_bf16_f32 v126, v60, v61
v_cvt_pk_bf16_f32 v127, v62, v63
v_accvgpr_read_b32 v192, a32
v_accvgpr_read_b32 v193, a33
v_accvgpr_read_b32 v194, a34
v_accvgpr_read_b32 v195, a35
v_mul_f32 v192, v192, v128
v_mul_f32 v193, v193, v129
v_mul_f32 v194, v194, v130
v_mul_f32 v195, v195, v131
v_cvt_pk_bf16_f32 v208, v192, v193
v_cvt_pk_bf16_f32 v209, v194, v195
v_accvgpr_read_b32 v196, a48
v_accvgpr_read_b32 v197, a49
v_accvgpr_read_b32 v198, a50
v_accvgpr_read_b32 v199, a51
v_mul_f32 v196, v196, v144
v_mul_f32 v197, v197, v145
v_mul_f32 v198, v198, v146
v_mul_f32 v199, v199, v147
v_cvt_pk_bf16_f32 v210, v196, v197
v_cvt_pk_bf16_f32 v211, v198, v199
v_mfma_f32_16x16x32_bf16 v[68:71], a[104:107], a[196:199], v[68:71]
buffer_store_dwordx4 v[208:211], v242, s[36:39], s10 offen offset:1024 sc1
v_accvgpr_read_b32 v200, a36
v_accvgpr_read_b32 v201, a37
v_accvgpr_read_b32 v202, a38
v_accvgpr_read_b32 v203, a39
v_mul_f32 v200, v200, v132
v_mul_f32 v201, v201, v133
v_mul_f32 v202, v202, v134
v_mfma_f32_16x16x32_bf16 v[68:71], a[108:111], a[212:215], v[68:71]
v_mul_f32 v203, v203, v135
v_cvt_pk_bf16_f32 v212, v200, v201
v_mfma_f32_16x16x32_bf16 v[72:75], a[96:99], a[72:75], v[72:75]
v_cvt_pk_bf16_f32 v213, v202, v203
v_accvgpr_read_b32 v204, a52
v_mfma_f32_16x16x32_bf16 v[72:75], a[100:103], a[88:91], v[72:75]
v_accvgpr_read_b32 v205, a53
v_accvgpr_read_b32 v206, a54
v_mfma_f32_16x16x32_bf16 v[72:75], a[104:107], a[200:203], v[72:75]
v_accvgpr_read_b32 v207, a55
v_mul_f32 v204, v204, v148
v_mfma_f32_16x16x32_bf16 v[72:75], a[108:111], a[216:219], v[72:75]
ds_read_b64_tr_b16 a[240:241], v234 offset:8192
v_mul_f32 v205, v205, v149
v_mfma_f32_16x16x32_bf16 v[76:79], a[96:99], a[76:79], v[76:79]
ds_read_b64_tr_b16 a[242:243], v234 offset:8704
v_mul_f32 v206, v206, v150
v_mul_f32 v207, v207, v151
v_mfma_f32_16x16x32_bf16 v[76:79], a[100:103], a[92:95], v[76:79]
ds_read_b64_tr_b16 a[244:245], v234 offset:12288
v_cvt_pk_bf16_f32 v214, v204, v205
v_cvt_pk_bf16_f32 v215, v206, v207
v_mfma_f32_16x16x32_bf16 v[76:79], a[104:107], a[204:207], v[76:79]
ds_read_b64_tr_b16 a[246:247], v234 offset:12800
ds_read_b64_tr_b16 a[248:249], v238 offset:8192
v_mfma_f32_16x16x32_bf16 v[76:79], a[108:111], a[220:223], v[76:79]
buffer_store_dwordx4 v[212:215], v242, s[36:39], s11 offen offset:1024 sc1
v_accvgpr_read_b32 v192, a40
v_accvgpr_read_b32 v193, a41
v_mfma_f32_16x16x32_bf16 v[80:83], a[224:227], a[64:67], v[80:83]
s_waitcnt lgkmcnt(5)
ds_read_b64_tr_b16 a[250:251], v238 offset:8704
v_accvgpr_read_b32 v194, a42
v_accvgpr_read_b32 v195, a43
v_mfma_f32_16x16x32_bf16 v[80:83], a[228:231], a[80:83], v[80:83]
ds_read_b64_tr_b16 a[252:253], v238 offset:12288
v_mul_f32 v192, v192, v136
v_mul_f32 v193, v193, v137
v_mfma_f32_16x16x32_bf16 v[80:83], a[232:235], a[192:195], v[80:83]
ds_read_b64_tr_b16 a[254:255], v238 offset:12800
v_mul_f32 v194, v194, v138
v_mul_f32 v195, v195, v139
v_mfma_f32_16x16x32_bf16 v[80:83], a[236:239], a[208:211], v[80:83]
v_cvt_pk_bf16_f32 v208, v192, v193
v_cvt_pk_bf16_f32 v209, v194, v195
v_mfma_f32_16x16x32_bf16 v[84:87], a[224:227], a[68:71], v[84:87]
v_accvgpr_read_b32 v196, a56
v_accvgpr_read_b32 v197, a57
v_mfma_f32_16x16x32_bf16 v[84:87], a[228:231], a[84:87], v[84:87]
v_accvgpr_read_b32 v198, a58
v_accvgpr_read_b32 v199, a59
v_mfma_f32_16x16x32_bf16 v[84:87], a[232:235], a[196:199], v[84:87]
v_mul_f32 v196, v196, v152
v_mul_f32 v197, v197, v153
v_mfma_f32_16x16x32_bf16 v[84:87], a[236:239], a[212:215], v[84:87]
v_mul_f32 v198, v198, v154
v_mul_f32 v199, v199, v155
v_mfma_f32_16x16x32_bf16 v[88:91], a[224:227], a[72:75], v[88:91]
v_cvt_pk_bf16_f32 v210, v196, v197
v_cvt_pk_bf16_f32 v211, v198, v199
v_mfma_f32_16x16x32_bf16 v[88:91], a[228:231], a[88:91], v[88:91]
buffer_store_dwordx4 v[208:211], v242, s[36:39], s12 offen offset:1024 sc1
v_mfma_f32_16x16x32_bf16 v[88:91], a[232:235], a[200:203], v[88:91]
v_accvgpr_read_b32 v200, a44
v_accvgpr_read_b32 v201, a45
v_mfma_f32_16x16x32_bf16 v[88:91], a[236:239], a[216:219], v[88:91]
ds_read_b64_tr_b16 a[96:97], v235 offset:8192
v_accvgpr_read_b32 v202, a46
v_accvgpr_read_b32 v203, a47
v_mfma_f32_16x16x32_bf16 v[92:95], a[224:227], a[76:79], v[92:95]
ds_read_b64_tr_b16 a[98:99], v235 offset:8704
v_mul_f32 v200, v200, v140
v_mul_f32 v201, v201, v141
v_mfma_f32_16x16x32_bf16 v[92:95], a[228:231], a[92:95], v[92:95]
ds_read_b64_tr_b16 a[100:101], v235 offset:12288
v_mul_f32 v202, v202, v142
v_mul_f32 v203, v203, v143
v_mfma_f32_16x16x32_bf16 v[92:95], a[232:235], a[204:207], v[92:95]
ds_read_b64_tr_b16 a[102:103], v235 offset:12800
v_cvt_pk_bf16_f32 v212, v200, v201
v_cvt_pk_bf16_f32 v213, v202, v203
v_mfma_f32_16x16x32_bf16 v[92:95], a[236:239], a[220:223], v[92:95]
s_waitcnt lgkmcnt(4)
ds_read_b64_tr_b16 a[104:105], v239 offset:8192
v_accvgpr_read_b32 v204, a60
v_accvgpr_read_b32 v205, a61
v_mfma_f32_16x16x32_bf16 v[160:163], a[240:243], a[64:67], v[160:163]
ds_read_b64_tr_b16 a[106:107], v239 offset:8704
v_accvgpr_read_b32 v206, a62
v_accvgpr_read_b32 v207, a63
v_mfma_f32_16x16x32_bf16 v[160:163], a[244:247], a[80:83], v[160:163]
ds_read_b64_tr_b16 a[108:109], v239 offset:12288
v_mul_f32 v204, v204, v156
v_mul_f32 v205, v205, v157
v_mfma_f32_16x16x32_bf16 v[160:163], a[248:251], a[192:195], v[160:163]
ds_read_b64_tr_b16 a[110:111], v239 offset:12800
v_mul_f32 v206, v206, v158
v_mul_f32 v207, v207, v159
v_mfma_f32_16x16x32_bf16 v[160:163], a[252:255], a[208:211], v[160:163]
v_cvt_pk_bf16_f32 v214, v204, v205
v_cvt_pk_bf16_f32 v215, v206, v207
v_mfma_f32_16x16x32_bf16 v[164:167], a[240:243], a[68:71], v[164:167]
buffer_store_dwordx4 v[212:215], v242, s[36:39], s13 offen offset:1024 sc1
v_mfma_f32_16x16x32_bf16 v[164:167], a[244:247], a[84:87], v[164:167]
s_nop 1
v_mov_b32 v192, 0
v_mov_b32 v193, 0
v_mfma_f32_16x16x32_bf16 v[164:167], a[248:251], a[196:199], v[164:167]
v_mov_b32 v194, 0
v_mov_b32 v195, 0
v_mfma_f32_16x16x32_bf16 v[164:167], a[252:255], a[212:215], v[164:167]
v_mov_b32 v196, 0
v_mov_b32 v197, 0
v_mfma_f32_16x16x32_bf16 v[168:171], a[240:243], a[72:75], v[168:171]
v_mov_b32 v198, 0
v_mov_b32 v199, 0
v_mfma_f32_16x16x32_bf16 v[168:171], a[244:247], a[88:91], v[168:171]
v_mov_b32 v200, 0
v_mov_b32 v201, 0
v_mfma_f32_16x16x32_bf16 v[168:171], a[248:251], a[200:203], v[168:171]
v_mov_b32 v202, 0
v_mov_b32 v203, 0
v_mfma_f32_16x16x32_bf16 v[168:171], a[252:255], a[216:219], v[168:171]
v_mov_b32 v204, 0
v_mov_b32 v205, 0
v_mfma_f32_16x16x32_bf16 v[172:175], a[240:243], a[76:79], v[172:175]
v_mov_b32 v206, 0
v_mov_b32 v207, 0
v_mfma_f32_16x16x32_bf16 v[172:175], a[244:247], a[92:95], v[172:175]
v_mov_b32 v208, v252
v_mov_b32 v209, v253
v_mfma_f32_16x16x32_bf16 v[172:175], a[248:251], a[204:207], v[172:175]
v_mov_b32 v210, v254
v_mov_b32 v211, v255
v_mfma_f32_16x16x32_bf16 v[172:175], a[252:255], a[220:223], v[172:175]
s_waitcnt lgkmcnt(0)
v_mov_b32 v212, v252
v_mov_b32 v213, v253
v_mfma_f32_16x16x32_bf16 v[176:179], a[96:99], a[64:67], v[176:179]
v_mov_b32 v214, v254
v_mov_b32 v215, v255
v_mfma_f32_16x16x32_bf16 v[176:179], a[100:103], a[80:83], v[176:179]
v_mov_b32 v216, v252
v_mov_b32 v217, v253
v_mfma_f32_16x16x32_bf16 v[176:179], a[104:107], a[192:195], v[176:179]
v_mov_b32 v218, v254
v_mov_b32 v219, v255
v_mfma_f32_16x16x32_bf16 v[176:179], a[108:111], a[208:211], v[176:179]
v_mov_b32 v220, v252
v_mov_b32 v221, v253
v_mfma_f32_16x16x32_bf16 v[180:183], a[96:99], a[68:71], v[180:183]
s_waitcnt vmcnt(16)
s_barrier
v_mov_b32 v222, v254
v_mfma_f32_16x16x32_bf16 v[180:183], a[100:103], a[84:87], v[180:183]
v_mov_b32 v223, v255
v_cvt_pk_bf16_f32 v128, v64, v65
v_mfma_f32_16x16x32_bf16 v[180:183], a[104:107], a[196:199], v[180:183]
v_cvt_pk_bf16_f32 v129, v66, v67
v_cvt_pk_bf16_f32 v130, v80, v81
v_mfma_f32_16x16x32_bf16 v[180:183], a[108:111], a[212:215], v[180:183]
v_cvt_pk_bf16_f32 v131, v82, v83
v_cvt_pk_bf16_f32 v132, v68, v69
v_mfma_f32_16x16x32_bf16 v[184:187], a[96:99], a[72:75], v[184:187]
ds_read_b128 a[144:147], v240 offset:0
v_cvt_pk_bf16_f32 v133, v70, v71
v_cvt_pk_bf16_f32 v134, v84, v85
v_mfma_f32_16x16x32_bf16 v[184:187], a[100:103], a[88:91], v[184:187]
v_cvt_pk_bf16_f32 v135, v86, v87
v_cvt_pk_bf16_f32 v136, v72, v73
v_mfma_f32_16x16x32_bf16 v[184:187], a[104:107], a[200:203], v[184:187]
ds_read_b128 a[148:151], v240 offset:1024
v_cvt_pk_bf16_f32 v137, v74, v75
v_cvt_pk_bf16_f32 v138, v88, v89
v_mfma_f32_16x16x32_bf16 v[184:187], a[108:111], a[216:219], v[184:187]
ds_read_b128 a[152:155], v240 offset:2048
v_cvt_pk_bf16_f32 v139, v90, v91
v_cvt_pk_bf16_f32 v140, v76, v77
v_mfma_f32_16x16x32_bf16 v[188:191], a[96:99], a[76:79], v[188:191]
v_cvt_pk_bf16_f32 v141, v78, v79
v_cvt_pk_bf16_f32 v142, v92, v93
v_mfma_f32_16x16x32_bf16 v[188:191], a[100:103], a[92:95], v[188:191]
ds_read_b128 a[156:159], v240 offset:3072
v_cvt_pk_bf16_f32 v143, v94, v95
v_mfma_f32_16x16x32_bf16 v[188:191], a[104:107], a[204:207], v[188:191]
ds_read_b128 a[160:163], v240 offset:4096
v_mfma_f32_16x16x32_bf16 v[188:191], a[108:111], a[220:223], v[188:191]
ds_read_b128 a[164:167], v240 offset:5120
s_nop 7
v_cvt_pk_bf16_f32 v144, v160, v161
v_cvt_pk_bf16_f32 v145, v162, v163
v_cvt_pk_bf16_f32 v146, v176, v177
v_cvt_pk_bf16_f32 v147, v178, v179
v_cvt_pk_bf16_f32 v148, v164, v165
v_cvt_pk_bf16_f32 v149, v166, v167
v_cvt_pk_bf16_f32 v150, v180, v181
v_cvt_pk_bf16_f32 v151, v182, v183
v_cvt_pk_bf16_f32 v152, v168, v169
v_cvt_pk_bf16_f32 v153, v170, v171
v_cvt_pk_bf16_f32 v154, v184, v185
v_cvt_pk_bf16_f32 v155, v186, v187
v_cvt_pk_bf16_f32 v156, v172, v173
v_cvt_pk_bf16_f32 v157, v174, v175
v_cvt_pk_bf16_f32 v158, v188, v189
v_cvt_pk_bf16_f32 v159, v190, v191
v_mov_b32 v238, 0
v_mov_b32 v239, 1
L_p0:
s_waitcnt lgkmcnt(1)
s_cmp_ge_u32 s60, 2
s_cbranch_scc0 L_alt0_1
v_mfma_f32_16x16x32_bf16 v[0:3], a[144:147], v[96:99], v[192:195]
v_mfma_f32_16x16x32_bf16 v[4:7], a[160:163], v[96:99], v[192:195]
L_ret0:
ds_read_b128 a[168:171], v240 offset:6144
s_add_u32 s68, s68, 8192
v_mfma_f32_16x16x32_bf16 v[16:19], a[144:147], v[104:107], v[200:203]
ds_read_b128 a[172:175], v240 offset:7168
s_and_b32 s68, s68, 0xffff
v_mfma_f32_16x16x32_bf16 v[16:19], a[148:151], v[120:123], v[16:19]
v_mfma_f32_16x16x32_bf16 v[16:19], a[152:155], v[136:139], v[16:19]
v_mfma_f32_16x16x32_bf16 v[16:19], a[156:159], v[152:155], v[16:19]
s_add_u32 s69, s68, 98304
v_mfma_f32_16x16x32_bf16 v[24:27], a[144:147], v[108:111], v[204:207]
v_mfma_f32_16x16x32_bf16 v[24:27], a[148:151], v[124:127], v[24:27]
v_mfma_f32_16x16x32_bf16 v[24:27], a[152:155], v[140:143], v[24:27]
v_mfma_f32_16x16x32_bf16 v[24:27], a[156:159], v[156:159], v[24:27]
v_mfma_f32_16x16x32_bf16 v[8:11], a[144:147], v[100:103], v[196:199]
v_mfma_f32_16x16x32_bf16 v[8:11], a[148:151], v[116:119], v[8:11]
v_mfma_f32_16x16x32_bf16 v[8:11], a[152:155], v[132:135], v[8:11]
v_mfma_f32_16x16x32_bf16 v[8:11], a[156:159], v[148:151], v[8:11]
v_add_u32 v240, s69, v242
v_mfma_f32_16x16x32_bf16 v[0:3], a[148:151], v[112:115], v[0:3]
v_mfma_f32_16x16x32_bf16 v[0:3], a[152:155], v[128:131], v[0:3]
v_mfma_f32_16x16x32_bf16 v[0:3], a[156:159], v[144:147], v[0:3]
v_mfma_f32_16x16x32_bf16 v[20:23], a[160:163], v[104:107], v[200:203]
s_waitcnt lgkmcnt(0)
v_mfma_f32_16x16x32_bf16 v[20:23], a[164:167], v[120:123], v[20:23]
s_waitcnt vmcnt(16)
s_waitcnt lgkmcnt(0)
s_barrier
v_mfma_f32_16x16x32_bf16 v[20:23], a[168:171], v[136:139], v[20:23]
ds_read_b128 a[144:147], v240 offset:0
v_mfma_f32_16x16x32_bf16 v[20:23], a[172:175], v[152:155], v[20:23]
ds_read_b128 a[148:151], v240 offset:1024
v_mfma_f32_16x16x32_bf16 v[28:31], a[160:163], v[108:111], v[204:207]
ds_read_b128 a[152:155], v240 offset:2048
v_mfma_f32_16x16x32_bf16 v[28:31], a[164:167], v[124:127], v[28:31]
ds_read_b128 a[156:159], v240 offset:3072
v_mfma_f32_16x16x32_bf16 v[28:31], a[168:171], v[140:143], v[28:31]
v_mfma_f32_16x16x32_bf16 v[28:31], a[172:175], v[156:159], v[28:31]
v_mfma_f32_16x16x32_bf16 v[12:15], a[160:163], v[100:103], v[196:199]
ds_read_b128 a[160:163], v240 offset:4096
v_mfma_f32_16x16x32_bf16 v[12:15], a[164:167], v[116:119], v[12:15]
v_mfma_f32_16x16x32_bf16 v[12:15], a[168:171], v[132:135], v[12:15]
v_mfma_f32_16x16x32_bf16 v[12:15], a[172:175], v[148:151], v[12:15]
v_mfma_f32_16x16x32_bf16 v[4:7], a[164:167], v[112:115], v[4:7]
ds_read_b128 a[164:167], v240 offset:5120
v_mfma_f32_16x16x32_bf16 v[4:7], a[168:171], v[128:131], v[4:7]
v_mfma_f32_16x16x32_bf16 v[4:7], a[172:175], v[144:147], v[4:7]
L_p1:
s_waitcnt lgkmcnt(1)
s_cmp_ge_u32 s60, 4
s_cbranch_scc0 L_alt1_1
v_mfma_f32_16x16x32_bf16 v[32:35], a[144:147], v[96:99], v[192:195]
v_mfma_f32_16x16x32_bf16 v[36:39], a[160:163], v[96:99], v[192:195]
L_ret1:
ds_read_b128 a[168:171], v240 offset:6144
s_add_u32 m0, s66, s67
v_mfma_f32_16x16x32_bf16 v[48:51], a[144:147], v[104:107], v[200:203]
s_add_u32 s68, s68, 8192
v_exp_f32 v160, v0
v_mfma_f32_16x16x32_bf16 v[48:51], a[148:151], v[120:123], v[48:51]
buffer_load_dwordx4 v242, s[40:43], s65 offen offset:0 sc1 lds
v_mfma_f32_16x16x32_bf16 v[48:51], a[152:155], v[136:139], v[48:51]
s_and_b32 s68, s68, 0xffff
v_exp_f32 v161, v1
v_mfma_f32_16x16x32_bf16 v[48:51], a[156:159], v[152:155], v[48:51]
ds_read_b128 a[172:175], v240 offset:7168
s_add_u32 s69, s68, 98304
v_mfma_f32_16x16x32_bf16 v[56:59], a[144:147], v[108:111], v[204:207]
v_exp_f32 v162, v2
v_mfma_f32_16x16x32_bf16 v[56:59], a[148:151], v[124:127], v[56:59]
v_exp_f32 v163, v3
v_mfma_f32_16x16x32_bf16 v[56:59], a[152:155], v[140:143], v[56:59]
v_cvt_pk_bf16_f32 v64, v160, v161
v_mfma_f32_16x16x32_bf16 v[56:59], a[156:159], v[156:159], v[56:59]
v_exp_f32 v164, v4
v_mfma_f32_16x16x32_bf16 v[40:43], a[144:147], v[100:103], v[196:199]
buffer_load_dwordx4 v242, s[40:43], s65 offen offset:1024 sc1 lds
v_mfma_f32_16x16x32_bf16 v[40:43], a[148:151], v[116:119], v[40:43]
v_exp_f32 v165, v5
v_cvt_pk_bf16_f32 v65, v162, v163
v_mfma_f32_16x16x32_bf16 v[40:43], a[152:155], v[132:135], v[40:43]
v_exp_f32 v166, v6
v_mfma_f32_16x16x32_bf16 v[40:43], a[156:159], v[148:151], v[40:43]
v_exp_f32 v167, v7
v_cvt_pk_bf16_f32 v66, v164, v165
v_mfma_f32_16x16x32_bf16 v[32:35], a[148:151], v[112:115], v[32:35]
buffer_load_dwordx4 v242, s[40:43], s65 offen offset:2048 sc1 lds
v_mfma_f32_16x16x32_bf16 v[32:35], a[152:155], v[128:131], v[32:35]
v_exp_f32 v160, v8
v_mfma_f32_16x16x32_bf16 v[32:35], a[156:159], v[144:147], v[32:35]
v_exp_f32 v161, v9
v_cvt_pk_bf16_f32 v67, v166, v167
v_mfma_f32_16x16x32_bf16 v[52:55], a[160:163], v[104:107], v[200:203]
s_waitcnt lgkmcnt(0)
buffer_load_dwordx4 v242, s[40:43], s65 offen offset:3072 sc1 lds
s_add_u32 s65, s65, 16384
s_add_u32 s67, s67, 8192
v_add_u32 v240, s69, v242
s_and_b32 s67, s67, 0xffff
v_mfma_f32_16x16x32_bf16 v[52:55], a[164:167], v[120:123], v[52:55]
s_waitcnt vmcnt(20)
s_waitcnt lgkmcnt(0)
s_barrier
v_mfma_f32_16x16x32_bf16 v[52:55], a[168:171], v[136:139], v[52:55]
v_exp_f32 v162, v10
v_mfma_f32_16x16x32_bf16 v[52:55], a[172:175], v[152:155], v[52:55]
v_exp_f32 v163, v11
v_cvt_pk_bf16_f32 v68, v160, v161
v_mfma_f32_16x16x32_bf16 v[60:63], a[160:163], v[108:111], v[204:207]
v_exp_f32 v164, v12
v_mfma_f32_16x16x32_bf16 v[60:63], a[164:167], v[124:127], v[60:63]
v_exp_f32 v165, v13
v_cvt_pk_bf16_f32 v69, v162, v163
v_mfma_f32_16x16x32_bf16 v[60:63], a[168:171], v[140:143], v[60:63]
ds_read_b128 a[144:147], v240 offset:0
v_exp_f32 v166, v14
v_mfma_f32_16x16x32_bf16 v[60:63], a[172:175], v[156:159], v[60:63]
v_exp_f32 v167, v15
v_cvt_pk_bf16_f32 v70, v164, v165
v_mfma_f32_16x16x32_bf16 v[44:47], a[160:163], v[100:103], v[196:199]
ds_read_b128 a[148:151], v240 offset:1024
v_exp_f32 v160, v16
v_mfma_f32_16x16x32_bf16 v[44:47], a[164:167], v[116:119], v[44:47]
ds_read_b128 a[152:155], v240 offset:2048
v_exp_f32 v161, v17
v_cvt_pk_bf16_f32 v71, v166, v167
v_mfma_f32_16x16x32_bf16 v[44:47], a[168:171], v[132:135], v[44:47]
v_exp_f32 v162, v18
v_mfma_f32_16x16x32_bf16 v[44:47], a[172:175], v[148:151], v[44:47]
ds_read_b128 a[156:159], v240 offset:3072
v_exp_f32 v163, v19
v_cvt_pk_bf16_f32 v72, v160, v161
v_mfma_f32_16x16x32_bf16 v[36:39], a[164:167], v[112:115], v[36:39]
ds_read_b128 a[160:163], v240 offset:4096
v_exp_f32 v164, v20
v_mfma_f32_16x16x32_bf16 v[36:39], a[168:171], v[128:131], v[36:39]
v_exp_f32 v165, v21
v_cvt_pk_bf16_f32 v73, v162, v163
v_mfma_f32_16x16x32_bf16 v[36:39], a[172:175], v[144:147], v[36:39]
v_exp_f32 v166, v22
v_exp_f32 v167, v23
v_cvt_pk_bf16_f32 v74, v164, v165
v_exp_f32 v160, v24
v_exp_f32 v161, v25
v_cvt_pk_bf16_f32 v75, v166, v167
v_exp_f32 v162, v26
v_exp_f32 v163, v27
v_cvt_pk_bf16_f32 v76, v160, v161
v_exp_f32 v164, v28
v_exp_f32 v165, v29
v_cvt_pk_bf16_f32 v77, v162, v163
v_exp_f32 v166, v30
ds_read_b128 a[164:167], v240 offset:5120
v_exp_f32 v167, v31
v_cvt_pk_bf16_f32 v78, v164, v165
v_cvt_pk_bf16_f32 v79, v166, v167
s_waitcnt lgkmcnt(1)
s_cmp_ge_u32 s60, 64
s_cbranch_scc0 L_alt2_1
v_mfma_f32_16x16x32_bf16 v[0:3], a[144:147], v[96:99], v[192:195]
v_mfma_f32_16x16x32_bf16 v[4:7], a[160:163], v[96:99], v[192:195]
v_mfma_f32_16x16x32_bf16 v[8:11], a[144:147], v[100:103], v[196:199]
v_mfma_f32_16x16x32_bf16 v[12:15], a[160:163], v[100:103], v[196:199]
L_ret2:
ds_read_b128 a[168:171], v240 offset:6144
s_add_u32 m0, s66, s67
v_mfma_f32_16x16x32_bf16 v[16:19], a[144:147], v[104:107], v[200:203]
ds_read_b128 a[172:175], v240 offset:7168
s_add_u32 s68, s68, 8192
v_mfma_f32_16x16x32_bf16 v[16:19], a[148:151], v[120:123], v[16:19]
v_exp_f32 v160, v32
v_mfma_f32_16x16x32_bf16 v[16:19], a[152:155], v[136:139], v[16:19]
v_exp_f32 v161, v33
v_mfma_f32_16x16x32_bf16 v[16:19], a[156:159], v[152:155], v[16:19]
buffer_load_dwordx4 v242, s[40:43], s65 offen offset:0 sc1 lds
v_mfma_f32_16x16x32_bf16 v[24:27], a[144:147], v[108:111], v[204:207]
s_and_b32 s68, s68, 0xffff
v_exp_f32 v162, v34
v_mfma_f32_16x16x32_bf16 v[24:27], a[148:151], v[124:127], v[24:27]
v_exp_f32 v163, v35
v_mfma_f32_16x16x32_bf16 v[24:27], a[152:155], v[140:143], v[24:27]
v_cvt_pk_bf16_f32 v80, v160, v161
v_mfma_f32_16x16x32_bf16 v[24:27], a[156:159], v[156:159], v[24:27]
v_exp_f32 v164, v36
v_mfma_f32_16x16x32_bf16 v[8:11], a[148:151], v[116:119], v[8:11]
s_add_u32 s69, s68, 98304
v_exp_f32 v165, v37
v_mfma_f32_16x16x32_bf16 v[8:11], a[152:155], v[132:135], v[8:11]
ds_read_b128 a[176:179], v241 offset:0
v_cvt_pk_bf16_f32 v81, v162, v163
v_mfma_f32_16x16x32_bf16 v[8:11], a[156:159], v[148:151], v[8:11]
buffer_load_dwordx4 v242, s[40:43], s65 offen offset:1024 sc1 lds
v_mfma_f32_16x16x32_bf16 v[0:3], a[148:151], v[112:115], v[0:3]
v_exp_f32 v166, v38
v_mfma_f32_16x16x32_bf16 v[0:3], a[152:155], v[128:131], v[0:3]
s_add_u32 s70, s70, 8192
v_exp_f32 v167, v39
v_mfma_f32_16x16x32_bf16 v[0:3], a[156:159], v[144:147], v[0:3]
ds_read_b128 a[180:183], v241 offset:1024
v_cvt_pk_bf16_f32 v82, v164, v165
v_mfma_f32_16x16x32_bf16 v[20:23], a[160:163], v[104:107], v[200:203]
s_waitcnt lgkmcnt(2)
v_exp_f32 v160, v40
v_mfma_f32_16x16x32_bf16 v[20:23], a[164:167], v[120:123], v[20:23]
v_exp_f32 v161, v41
v_mfma_f32_16x16x32_bf16 v[20:23], a[168:171], v[136:139], v[20:23]
v_cvt_pk_bf16_f32 v83, v166, v167
v_mfma_f32_16x16x32_bf16 v[20:23], a[172:175], v[152:155], v[20:23]
buffer_load_dwordx4 v242, s[40:43], s65 offen offset:2048 sc1 lds
v_mfma_f32_16x16x32_bf16 v[28:31], a[160:163], v[108:111], v[204:207]
s_and_b32 s70, s70, 0xffff
v_exp_f32 v162, v42
v_mfma_f32_16x16x32_bf16 v[28:31], a[164:167], v[124:127], v[28:31]
ds_read_b128 a[184:187], v241 offset:2048
v_mfma_f32_16x16x32_bf16 v[28:31], a[168:171], v[140:143], v[28:31]
v_exp_f32 v163, v43
v_mfma_f32_16x16x32_bf16 v[28:31], a[172:175], v[156:159], v[28:31]
ds_read_b128 a[188:191], v241 offset:3072
v_cvt_pk_bf16_f32 v84, v160, v161
v_mfma_f32_16x16x32_bf16 v[12:15], a[164:167], v[116:119], v[12:15]
s_add_u32 s71, s70, 32768
v_exp_f32 v164, v44
v_mfma_f32_16x16x32_bf16 v[12:15], a[168:171], v[132:135], v[12:15]
v_exp_f32 v165, v45
v_mfma_f32_16x16x32_bf16 v[12:15], a[172:175], v[148:151], v[12:15]
v_cvt_pk_bf16_f32 v85, v162, v163
v_mfma_f32_16x16x32_bf16 v[4:7], a[164:167], v[112:115], v[4:7]
v_exp_f32 v166, v46
v_mfma_f32_16x16x32_bf16 v[4:7], a[168:171], v[128:131], v[4:7]
buffer_load_dwordx4 v242, s[40:43], s65 offen offset:3072 sc1 lds
v_mfma_f32_16x16x32_bf16 v[4:7], a[172:175], v[144:147], v[4:7]
s_waitcnt lgkmcnt(1)
v_exp_f32 v167, v47
v_mfma_f32_16x16x32_bf16 a[0:3], a[176:179], v[64:67], 0
ds_read_b128 a[192:195], v241 offset:4096
v_cvt_pk_bf16_f32 v86, v164, v165
v_mfma_f32_16x16x32_bf16 a[32:35], a[176:179], v[68:71], 0
v_exp_f32 v160, v48
v_mfma_f32_16x16x32_bf16 a[64:67], a[176:179], v[72:75], 0
v_exp_f32 v161, v49
v_mfma_f32_16x16x32_bf16 a[96:99], a[176:179], v[76:79], 0
ds_read_b128 a[196:199], v241 offset:5120
v_cvt_pk_bf16_f32 v87, v166, v167
v_mfma_f32_16x16x32_bf16 a[4:7], a[180:183], v[64:67], 0
v_exp_f32 v162, v50
v_mfma_f32_16x16x32_bf16 a[36:39], a[180:183], v[68:71], 0
s_add_u32 s65, s65, 16384
v_mfma_f32_16x16x32_bf16 a[68:71], a[180:183], v[72:75], 0
v_exp_f32 v163, v51
v_mfma_f32_16x16x32_bf16 a[100:103], a[180:183], v[76:79], 0
ds_read_b128 a[200:203], v241 offset:6144
s_add_u32 s67, s67, 8192
v_mfma_f32_16x16x32_bf16 a[128:131], v[248:251], v[64:67], 0
ds_read_b128 a[204:207], v241 offset:7168
v_cvt_pk_bf16_f32 v88, v160, v161
v_mfma_f32_16x16x32_bf16 a[8:11], a[184:187], v[64:67], 0
s_and_b32 s67, s67, 0xffff
v_exp_f32 v164, v52
v_mfma_f32_16x16x32_bf16 a[40:43], a[184:187], v[68:71], 0
v_exp_f32 v165, v53
v_mfma_f32_16x16x32_bf16 a[72:75], a[184:187], v[72:75], 0
v_add_u32 v240, s69, v242
v_mfma_f32_16x16x32_bf16 a[104:107], a[184:187], v[76:79], 0
s_waitcnt lgkmcnt(2)
v_cvt_pk_bf16_f32 v89, v162, v163
v_mfma_f32_16x16x32_bf16 a[12:15], a[188:191], v[64:67], 0
v_exp_f32 v166, v54
v_mfma_f32_16x16x32_bf16 a[44:47], a[188:191], v[68:71], 0
v_exp_f32 v167, v55
v_mfma_f32_16x16x32_bf16 a[76:79], a[188:191], v[72:75], 0
v_cvt_pk_bf16_f32 v90, v164, v165
v_mfma_f32_16x16x32_bf16 a[108:111], a[188:191], v[76:79], 0
s_waitcnt vmcnt(24)
s_waitcnt lgkmcnt(0)
s_barrier
v_mfma_f32_16x16x32_bf16 a[132:135], v[248:251], v[68:71], 0
ds_read_b128 a[144:147], v240 offset:0
v_mfma_f32_16x16x32_bf16 a[16:19], a[192:195], v[64:67], 0
v_exp_f32 v160, v56
v_mfma_f32_16x16x32_bf16 a[48:51], a[192:195], v[68:71], 0
ds_read_b128 a[148:151], v240 offset:1024
v_mfma_f32_16x16x32_bf16 a[80:83], a[192:195], v[72:75], 0
v_exp_f32 v161, v57
v_mfma_f32_16x16x32_bf16 a[112:115], a[192:195], v[76:79], 0
ds_read_b128 a[152:155], v240 offset:2048
v_cvt_pk_bf16_f32 v91, v166, v167
v_mfma_f32_16x16x32_bf16 a[20:23], a[196:199], v[64:67], 0
ds_read_b128 a[156:159], v240 offset:3072
v_mfma_f32_16x16x32_bf16 a[52:55], a[196:199], v[68:71], 0
v_exp_f32 v162, v58
v_mfma_f32_16x16x32_bf16 a[84:87], a[196:199], v[72:75], 0
ds_read_b128 a[160:163], v240 offset:4096
v_mfma_f32_16x16x32_bf16 a[116:119], a[196:199], v[76:79], 0
v_exp_f32 v163, v59
v_mfma_f32_16x16x32_bf16 a[136:139], v[248:251], v[72:75], 0
ds_read_b128 a[164:167], v240 offset:5120
v_cvt_pk_bf16_f32 v92, v160, v161
v_mfma_f32_16x16x32_bf16 a[24:27], a[200:203], v[64:67], 0
v_exp_f32 v164, v60
v_mfma_f32_16x16x32_bf16 a[56:59], a[200:203], v[68:71], 0
v_exp_f32 v165, v61
v_mfma_f32_16x16x32_bf16 a[88:91], a[200:203], v[72:75], 0
v_cvt_pk_bf16_f32 v93, v162, v163
v_mfma_f32_16x16x32_bf16 a[120:123], a[200:203], v[76:79], 0
v_exp_f32 v166, v62
v_mfma_f32_16x16x32_bf16 a[28:31], a[204:207], v[64:67], 0
v_exp_f32 v167, v63
v_mfma_f32_16x16x32_bf16 a[60:63], a[204:207], v[68:71], 0
v_cvt_pk_bf16_f32 v94, v164, v165
v_mfma_f32_16x16x32_bf16 a[92:95], a[204:207], v[72:75], 0
v_cvt_pk_bf16_f32 v95, v166, v167
v_mfma_f32_16x16x32_bf16 a[124:127], a[204:207], v[76:79], 0
v_add_u32 v241, s71, v242
v_mfma_f32_16x16x32_bf16 a[140:143], v[248:251], v[76:79], 0
s_waitcnt lgkmcnt(1)
s_cmp_ge_u32 s60, 64
s_cbranch_scc0 L_alt3_1
v_mfma_f32_16x16x32_bf16 v[32:35], a[144:147], v[96:99], v[192:195]
v_mfma_f32_16x16x32_bf16 v[36:39], a[160:163], v[96:99], v[192:195]
v_mfma_f32_16x16x32_bf16 v[40:43], a[144:147], v[100:103], v[196:199]
v_mfma_f32_16x16x32_bf16 v[44:47], a[160:163], v[100:103], v[196:199]
L_ret3:
ds_read_b128 a[168:171], v240 offset:6144
s_add_u32 m0, s66, s67
v_mfma_f32_16x16x32_bf16 v[48:51], a[144:147], v[104:107], v[200:203]
ds_read_b128 a[172:175], v240 offset:7168
s_add_u32 s68, s68, 8192
v_mfma_f32_16x16x32_bf16 v[48:51], a[148:151], v[120:123], v[48:51]
v_exp_f32 v160, v0
v_mfma_f32_16x16x32_bf16 v[48:51], a[152:155], v[136:139], v[48:51]
v_exp_f32 v161, v1
v_mfma_f32_16x16x32_bf16 v[48:51], a[156:159], v[152:155], v[48:51]
buffer_load_dwordx4 v242, s[40:43], s65 offen offset:0 sc1 lds
v_mfma_f32_16x16x32_bf16 v[56:59], a[144:147], v[108:111], v[204:207]
s_and_b32 s68, s68, 0xffff
v_exp_f32 v162, v2
v_mfma_f32_16x16x32_bf16 v[56:59], a[148:151], v[124:127], v[56:59]
v_exp_f32 v163, v3
v_mfma_f32_16x16x32_bf16 v[56:59], a[152:155], v[140:143], v[56:59]
v_cvt_pk_bf16_f32 v64, v160, v161
v_mfma_f32_16x16x32_bf16 v[56:59], a[156:159], v[156:159], v[56:59]
v_exp_f32 v164, v4
v_mfma_f32_16x16x32_bf16 v[40:43], a[148:151], v[116:119], v[40:43]
s_add_u32 s69, s68, 98304
v_exp_f32 v165, v5
v_mfma_f32_16x16x32_bf16 v[40:43], a[152:155], v[132:135], v[40:43]
ds_read_b128 a[176:179], v241 offset:0
v_cvt_pk_bf16_f32 v65, v162, v163
v_mfma_f32_16x16x32_bf16 v[40:43], a[156:159], v[148:151], v[40:43]
buffer_load_dwordx4 v242, s[40:43], s65 offen offset:1024 sc1 lds
v_mfma_f32_16x16x32_bf16 v[32:35], a[148:151], v[112:115], v[32:35]
v_exp_f32 v166, v6
v_mfma_f32_16x16x32_bf16 v[32:35], a[152:155], v[128:131], v[32:35]
s_add_u32 s70, s70, 8192
v_exp_f32 v167, v7
v_mfma_f32_16x16x32_bf16 v[32:35], a[156:159], v[144:147], v[32:35]
ds_read_b128 a[180:183], v241 offset:1024
v_cvt_pk_bf16_f32 v66, v164, v165
v_mfma_f32_16x16x32_bf16 v[52:55], a[160:163], v[104:107], v[200:203]
s_waitcnt lgkmcnt(2)
v_exp_f32 v160, v8
v_mfma_f32_16x16x32_bf16 v[52:55], a[164:167], v[120:123], v[52:55]
v_exp_f32 v161, v9
v_mfma_f32_16x16x32_bf16 v[52:55], a[168:171], v[136:139], v[52:55]
v_cvt_pk_bf16_f32 v67, v166, v167
v_mfma_f32_16x16x32_bf16 v[52:55], a[172:175], v[152:155], v[52:55]
buffer_load_dwordx4 v242, s[40:43], s65 offen offset:2048 sc1 lds
v_mfma_f32_16x16x32_bf16 v[60:63], a[160:163], v[108:111], v[204:207]
s_and_b32 s70, s70, 0xffff
v_exp_f32 v162, v10
v_mfma_f32_16x16x32_bf16 v[60:63], a[164:167], v[124:127], v[60:63]
ds_read_b128 a[184:187], v241 offset:2048
v_mfma_f32_16x16x32_bf16 v[60:63], a[168:171], v[140:143], v[60:63]
v_exp_f32 v163, v11
v_mfma_f32_16x16x32_bf16 v[60:63], a[172:175], v[156:159], v[60:63]
ds_read_b128 a[188:191], v241 offset:3072
v_cvt_pk_bf16_f32 v68, v160, v161
v_mfma_f32_16x16x32_bf16 v[44:47], a[164:167], v[116:119], v[44:47]
s_add_u32 s71, s70, 32768
v_exp_f32 v164, v12
v_mfma_f32_16x16x32_bf16 v[44:47], a[168:171], v[132:135], v[44:47]
v_exp_f32 v165, v13
v_mfma_f32_16x16x32_bf16 v[44:47], a[172:175], v[148:151], v[44:47]
v_cvt_pk_bf16_f32 v69, v162, v163
v_mfma_f32_16x16x32_bf16 v[36:39], a[164:167], v[112:115], v[36:39]
v_exp_f32 v166, v14
v_mfma_f32_16x16x32_bf16 v[36:39], a[168:171], v[128:131], v[36:39]
buffer_load_dwordx4 v242, s[40:43], s65 offen offset:3072 sc1 lds
v_mfma_f32_16x16x32_bf16 v[36:39], a[172:175], v[144:147], v[36:39]
s_waitcnt lgkmcnt(1)
v_exp_f32 v167, v15
v_mfma_f32_16x16x32_bf16 a[0:3], a[176:179], v[80:83], a[0:3]
ds_read_b128 a[192:195], v241 offset:4096
v_cvt_pk_bf16_f32 v70, v164, v165
v_mfma_f32_16x16x32_bf16 a[32:35], a[176:179], v[84:87], a[32:35]
v_exp_f32 v160, v16
v_mfma_f32_16x16x32_bf16 a[64:67], a[176:179], v[88:91], a[64:67]
v_exp_f32 v161, v17
v_mfma_f32_16x16x32_bf16 a[96:99], a[176:179], v[92:95], a[96:99]
ds_read_b128 a[196:199], v241 offset:5120
v_cvt_pk_bf16_f32 v71, v166, v167
v_mfma_f32_16x16x32_bf16 a[4:7], a[180:183], v[80:83], a[4:7]
v_exp_f32 v162, v18
v_mfma_f32_16x16x32_bf16 a[36:39], a[180:183], v[84:87], a[36:39]
s_add_u32 s65, s65, 16384
v_mfma_f32_16x16x32_bf16 a[68:71], a[180:183], v[88:91], a[68:71]
v_exp_f32 v163, v19
v_mfma_f32_16x16x32_bf16 a[100:103], a[180:183], v[92:95], a[100:103]
ds_read_b128 a[200:203], v241 offset:6144
s_add_u32 s67, s67, 8192
v_mfma_f32_16x16x32_bf16 a[128:131], v[248:251], v[80:83], a[128:131]
ds_read_b128 a[204:207], v241 offset:7168
v_cvt_pk_bf16_f32 v72, v160, v161
v_mfma_f32_16x16x32_bf16 a[8:11], a[184:187], v[80:83], a[8:11]
s_and_b32 s67, s67, 0xffff
v_exp_f32 v164, v20
v_mfma_f32_16x16x32_bf16 a[40:43], a[184:187], v[84:87], a[40:43]
v_exp_f32 v165, v21
v_mfma_f32_16x16x32_bf16 a[72:75], a[184:187], v[88:91], a[72:75]
v_add_u32 v240, s69, v242
v_mfma_f32_16x16x32_bf16 a[104:107], a[184:187], v[92:95], a[104:107]
s_waitcnt lgkmcnt(2)
v_cvt_pk_bf16_f32 v73, v162, v163
v_mfma_f32_16x16x32_bf16 a[12:15], a[188:191], v[80:83], a[12:15]
v_exp_f32 v166, v22
v_mfma_f32_16x16x32_bf16 a[44:47], a[188:191], v[84:87], a[44:47]
v_exp_f32 v167, v23
v_mfma_f32_16x16x32_bf16 a[76:79], a[188:191], v[88:91], a[76:79]
v_cvt_pk_bf16_f32 v74, v164, v165
v_mfma_f32_16x16x32_bf16 a[108:111], a[188:191], v[92:95], a[108:111]
s_waitcnt vmcnt(12)
s_waitcnt lgkmcnt(0)
s_barrier
s_cmp_lg_u32 s7, 0
s_cbranch_scc1 L_nohs
s_cmp_lg_u32 s56, 0
s_cbranch_scc1 L_sig17
s_mov_b64 exec, 1
buffer_atomic_add v239, v238, s[48:51], s97 offen sc1
s_mov_b64 exec, -1
L_sig17:
L_nohs:
v_mfma_f32_16x16x32_bf16 a[132:135], v[248:251], v[84:87], a[132:135]
ds_read_b128 a[144:147], v240 offset:0
v_mfma_f32_16x16x32_bf16 a[16:19], a[192:195], v[80:83], a[16:19]
v_exp_f32 v160, v24
v_mfma_f32_16x16x32_bf16 a[48:51], a[192:195], v[84:87], a[48:51]
ds_read_b128 a[148:151], v240 offset:1024
v_mfma_f32_16x16x32_bf16 a[80:83], a[192:195], v[88:91], a[80:83]
v_exp_f32 v161, v25
v_mfma_f32_16x16x32_bf16 a[112:115], a[192:195], v[92:95], a[112:115]
ds_read_b128 a[152:155], v240 offset:2048
v_cvt_pk_bf16_f32 v75, v166, v167
v_mfma_f32_16x16x32_bf16 a[20:23], a[196:199], v[80:83], a[20:23]
ds_read_b128 a[156:159], v240 offset:3072
v_mfma_f32_16x16x32_bf16 a[52:55], a[196:199], v[84:87], a[52:55]
v_exp_f32 v162, v26
v_mfma_f32_16x16x32_bf16 a[84:87], a[196:199], v[88:91], a[84:87]
ds_read_b128 a[160:163], v240 offset:4096
v_mfma_f32_16x16x32_bf16 a[116:119], a[196:199], v[92:95], a[116:119]
v_exp_f32 v163, v27
v_mfma_f32_16x16x32_bf16 a[136:139], v[248:251], v[88:91], a[136:139]
ds_read_b128 a[164:167], v240 offset:5120
v_cvt_pk_bf16_f32 v76, v160, v161
v_mfma_f32_16x16x32_bf16 a[24:27], a[200:203], v[80:83], a[24:27]
v_exp_f32 v164, v28
v_mfma_f32_16x16x32_bf16 a[56:59], a[200:203], v[84:87], a[56:59]
v_exp_f32 v165, v29
v_mfma_f32_16x16x32_bf16 a[88:91], a[200:203], v[88:91], a[88:91]
v_cvt_pk_bf16_f32 v77, v162, v163
v_mfma_f32_16x16x32_bf16 a[120:123], a[200:203], v[92:95], a[120:123]
v_exp_f32 v166, v30
v_mfma_f32_16x16x32_bf16 a[28:31], a[204:207], v[80:83], a[28:31]
v_exp_f32 v167, v31
v_mfma_f32_16x16x32_bf16 a[60:63], a[204:207], v[84:87], a[60:63]
v_cvt_pk_bf16_f32 v78, v164, v165
v_mfma_f32_16x16x32_bf16 a[92:95], a[204:207], v[88:91], a[92:95]
v_cvt_pk_bf16_f32 v79, v166, v167
v_mfma_f32_16x16x32_bf16 a[124:127], a[204:207], v[92:95], a[124:127]
v_add_u32 v241, s71, v242
v_mfma_f32_16x16x32_bf16 a[140:143], v[248:251], v[92:95], a[140:143]
s_cmp_eq_u32 s58, 0
s_cbranch_scc1 L_x1
s_lshl_b32 s96, s58, 1
s_sub_u32 s96, s96, 2
s_cmp_eq_u32 s96, 0
s_cbranch_scc1 L_m0
.p2align 6
L_cloop:
s_waitcnt lgkmcnt(4)
v_mfma_f32_16x16x32_bf16 v[0:3], a[144:147], v[96:99], v[192:195]
ds_read_b128 a[168:171], v240 offset:6144
s_add_u32 m0, s66, s67
v_mfma_f32_16x16x32_bf16 v[0:3], a[148:151], v[112:115], v[0:3]
s_waitcnt lgkmcnt(4)
v_exp_f32 v160, v32
v_mfma_f32_16x16x32_bf16 v[0:3], a[152:155], v[128:131], v[0:3]
s_waitcnt lgkmcnt(3)
ds_read_b128 a[172:175], v240 offset:7168
v_mfma_f32_16x16x32_bf16 v[0:3], a[156:159], v[144:147], v[0:3]
s_add_u32 s68, s68, 8192
v_exp_f32 v161, v33
v_mfma_f32_16x16x32_bf16 v[8:11], a[144:147], v[100:103], v[196:199]
buffer_load_dwordx4 v242, s[40:43], s65 offen offset:0 sc1 lds
v_mfma_f32_16x16x32_bf16 v[8:11], a[148:151], v[116:119], v[8:11]
s_and_b32 s68, s68, 0xffff
v_exp_f32 v162, v34
v_mfma_f32_16x16x32_bf16 v[8:11], a[152:155], v[132:135], v[8:11]
v_exp_f32 v163, v35
v_mfma_f32_16x16x32_bf16 v[8:11], a[156:159], v[148:151], v[8:11]
v_cvt_pk_bf16_f32 v80, v160, v161
v_mfma_f32_16x16x32_bf16 v[16:19], a[144:147], v[104:107], v[200:203]
v_exp_f32 v164, v36
v_mfma_f32_16x16x32_bf16 v[16:19], a[148:151], v[120:123], v[16:19]
s_add_u32 s69, s68, 98304
v_exp_f32 v165, v37
v_mfma_f32_16x16x32_bf16 v[16:19], a[152:155], v[136:139], v[16:19]
v_cvt_pk_bf16_f32 v81, v162, v163
v_mfma_f32_16x16x32_bf16 v[16:19], a[156:159], v[152:155], v[16:19]
buffer_load_dwordx4 v242, s[40:43], s65 offen offset:1024 sc1 lds
v_mfma_f32_16x16x32_bf16 v[24:27], a[144:147], v[108:111], v[204:207]
v_exp_f32 v166, v38
v_mfma_f32_16x16x32_bf16 v[24:27], a[148:151], v[124:127], v[24:27]
s_add_u32 s70, s70, 8192
v_exp_f32 v167, v39
v_mfma_f32_16x16x32_bf16 v[24:27], a[152:155], v[140:143], v[24:27]
ds_read_b128 a[176:179], v241 offset:0
v_cvt_pk_bf16_f32 v82, v164, v165
v_mfma_f32_16x16x32_bf16 v[24:27], a[156:159], v[156:159], v[24:27]
s_waitcnt lgkmcnt(1)
v_exp_f32 v160, v40
v_mfma_f32_16x16x32_bf16 v[4:7], a[160:163], v[96:99], v[192:195]
v_exp_f32 v161, v41
v_mfma_f32_16x16x32_bf16 v[4:7], a[164:167], v[112:115], v[4:7]
ds_read_b128 a[180:183], v241 offset:1024
v_cvt_pk_bf16_f32 v83, v166, v167
v_mfma_f32_16x16x32_bf16 v[4:7], a[168:171], v[128:131], v[4:7]
s_and_b32 s70, s70, 0xffff
v_exp_f32 v162, v42
v_mfma_f32_16x16x32_bf16 v[4:7], a[172:175], v[144:147], v[4:7]
buffer_load_dwordx4 v242, s[40:43], s65 offen offset:2048 sc1 lds
v_mfma_f32_16x16x32_bf16 v[12:15], a[160:163], v[100:103], v[196:199]
v_exp_f32 v163, v43
v_mfma_f32_16x16x32_bf16 v[12:15], a[164:167], v[116:119], v[12:15]
ds_read_b128 a[184:187], v241 offset:2048
v_cvt_pk_bf16_f32 v84, v160, v161
v_mfma_f32_16x16x32_bf16 v[12:15], a[168:171], v[132:135], v[12:15]
v_exp_f32 v164, v44
v_mfma_f32_16x16x32_bf16 v[12:15], a[172:175], v[148:151], v[12:15]
s_add_u32 s71, s70, 32768
v_mfma_f32_16x16x32_bf16 v[20:23], a[160:163], v[104:107], v[200:203]
v_exp_f32 v165, v45
v_mfma_f32_16x16x32_bf16 v[20:23], a[164:167], v[120:123], v[20:23]
ds_read_b128 a[188:191], v241 offset:3072
v_cvt_pk_bf16_f32 v85, v162, v163
v_mfma_f32_16x16x32_bf16 v[20:23], a[168:171], v[136:139], v[20:23]
v_exp_f32 v166, v46
v_mfma_f32_16x16x32_bf16 v[20:23], a[172:175], v[152:155], v[20:23]
buffer_load_dwordx4 v242, s[40:43], s65 offen offset:3072 sc1 lds
v_mfma_f32_16x16x32_bf16 v[28:31], a[160:163], v[108:111], v[204:207]
v_exp_f32 v167, v47
v_mfma_f32_16x16x32_bf16 v[28:31], a[164:167], v[124:127], v[28:31]
v_mfma_f32_16x16x32_bf16 v[28:31], a[168:171], v[140:143], v[28:31]
ds_read_b128 a[192:195], v241 offset:4096
v_cvt_pk_bf16_f32 v86, v164, v165
v_mfma_f32_16x16x32_bf16 v[28:31], a[172:175], v[156:159], v[28:31]
s_waitcnt lgkmcnt(2)
v_exp_f32 v160, v48
v_mfma_f32_16x16x32_bf16 a[0:3], a[176:179], v[64:67], a[0:3]
v_exp_f32 v161, v49
v_mfma_f32_16x16x32_bf16 a[32:35], a[176:179], v[68:71], a[32:35]
v_mfma_f32_16x16x32_bf16 a[64:67], a[176:179], v[72:75], a[64:67]
ds_read_b128 a[196:199], v241 offset:5120
v_cvt_pk_bf16_f32 v87, v166, v167
v_mfma_f32_16x16x32_bf16 a[96:99], a[176:179], v[76:79], a[96:99]
v_exp_f32 v162, v50
v_mfma_f32_16x16x32_bf16 a[4:7], a[180:183], v[64:67], a[4:7]
s_add_u32 s65, s65, 16384
v_exp_f32 v163, v51
v_mfma_f32_16x16x32_bf16 a[36:39], a[180:183], v[68:71], a[36:39]
v_mfma_f32_16x16x32_bf16 a[68:71], a[180:183], v[72:75], a[68:71]
v_cvt_pk_bf16_f32 v88, v160, v161
s_add_u32 s67, s67, 8192
v_mfma_f32_16x16x32_bf16 a[100:103], a[180:183], v[76:79], a[100:103]
v_exp_f32 v164, v52
v_mfma_f32_16x16x32_bf16 a[128:131], v[248:251], v[64:67], a[128:131]
ds_read_b128 a[200:203], v241 offset:6144
v_mfma_f32_16x16x32_bf16 a[8:11], a[184:187], v[64:67], a[8:11]
ds_read_b128 a[204:207], v241 offset:7168
s_and_b32 s67, s67, 0xffff
v_mfma_f32_16x16x32_bf16 a[40:43], a[184:187], v[68:71], a[40:43]
v_exp_f32 v165, v53
v_mfma_f32_16x16x32_bf16 a[72:75], a[184:187], v[72:75], a[72:75]
v_add_u32 v240, s69, v242
v_mfma_f32_16x16x32_bf16 a[104:107], a[184:187], v[76:79], a[104:107]
s_waitcnt lgkmcnt(2)
v_cvt_pk_bf16_f32 v89, v162, v163
v_mfma_f32_16x16x32_bf16 a[12:15], a[188:191], v[64:67], a[12:15]
v_exp_f32 v166, v54
v_mfma_f32_16x16x32_bf16 a[44:47], a[188:191], v[68:71], a[44:47]
v_exp_f32 v167, v55
v_mfma_f32_16x16x32_bf16 a[76:79], a[188:191], v[72:75], a[76:79]
v_cvt_pk_bf16_f32 v90, v164, v165
v_mfma_f32_16x16x32_bf16 a[108:111], a[188:191], v[76:79], a[108:111]
s_waitcnt vmcnt(16) lgkmcnt(0)
s_barrier
v_mfma_f32_16x16x32_bf16 a[132:135], v[248:251], v[68:71], a[132:135]
ds_read_b128 a[144:147], v240 offset:0
v_mfma_f32_16x16x32_bf16 a[16:19], a[192:195], v[64:67], a[16:19]
v_exp_f32 v160, v56
v_mfma_f32_16x16x32_bf16 a[48:51], a[192:195], v[68:71], a[48:51]
ds_read_b128 a[148:151], v240 offset:1024
v_mfma_f32_16x16x32_bf16 a[80:83], a[192:195], v[72:75], a[80:83]
v_exp_f32 v161, v57
v_mfma_f32_16x16x32_bf16 a[112:115], a[192:195], v[76:79], a[112:115]
ds_read_b128 a[152:155], v240 offset:2048
v_cvt_pk_bf16_f32 v91, v166, v167
v_mfma_f32_16x16x32_bf16 a[20:23], a[196:199], v[64:67], a[20:23]
v_exp_f32 v162, v58
v_mfma_f32_16x16x32_bf16 a[52:55], a[196:199], v[68:71], a[52:55]
ds_read_b128 a[156:159], v240 offset:3072
v_mfma_f32_16x16x32_bf16 a[84:87], a[196:199], v[72:75], a[84:87]
v_exp_f32 v163, v59
v_mfma_f32_16x16x32_bf16 a[116:119], a[196:199], v[76:79], a[116:119]
ds_read_b128 a[160:163], v240 offset:4096
v_cvt_pk_bf16_f32 v92, v160, v161
v_mfma_f32_16x16x32_bf16 a[136:139], v[248:251], v[72:75], a[136:139]
ds_read_b128 a[164:167], v240 offset:5120
v_mfma_f32_16x16x32_bf16 a[24:27], a[200:203], v[64:67], a[24:27]
v_exp_f32 v164, v60
v_mfma_f32_16x16x32_bf16 a[56:59], a[200:203], v[68:71], a[56:59]
v_exp_f32 v165, v61
v_mfma_f32_16x16x32_bf16 a[88:91], a[200:203], v[72:75], a[88:91]
v_cvt_pk_bf16_f32 v93, v162, v163
v_mfma_f32_16x16x32_bf16 a[120:123], a[200:203], v[76:79], a[120:123]
v_exp_f32 v166, v62
v_mfma_f32_16x16x32_bf16 a[28:31], a[204:207], v[64:67], a[28:31]
v_exp_f32 v167, v63
v_mfma_f32_16x16x32_bf16 a[60:63], a[204:207], v[68:71], a[60:63]
v_cvt_pk_bf16_f32 v94, v164, v165
v_mfma_f32_16x16x32_bf16 a[92:95], a[204:207], v[72:75], a[92:95]
v_cvt_pk_bf16_f32 v95, v166, v167
v_mfma_f32_16x16x32_bf16 a[124:127], a[204:207], v[76:79], a[124:127]
v_add_u32 v241, s71, v242
v_mfma_f32_16x16x32_bf16 a[140:143], v[248:251], v[76:79], a[140:143]
s_waitcnt lgkmcnt(4)
v_mfma_f32_16x16x32_bf16 v[32:35], a[144:147], v[96:99], v[192:195]
ds_read_b128 a[168:171], v240 offset:6144
s_add_u32 m0, s66, s67
v_mfma_f32_16x16x32_bf16 v[32:35], a[148:151], v[112:115], v[32:35]
s_waitcnt lgkmcnt(4)
v_exp_f32 v160, v0
v_mfma_f32_16x16x32_bf16 v[32:35], a[152:155], v[128:131], v[32:35]
s_waitcnt lgkmcnt(3)
ds_read_b128 a[172:175], v240 offset:7168
v_mfma_f32_16x16x32_bf16 v[32:35], a[156:159], v[144:147], v[32:35]
s_add_u32 s68, s68, 8192
v_exp_f32 v161, v1
v_mfma_f32_16x16x32_bf16 v[40:43], a[144:147], v[100:103], v[196:199]
buffer_load_dwordx4 v242, s[40:43], s65 offen offset:0 sc1 lds
v_mfma_f32_16x16x32_bf16 v[40:43], a[148:151], v[116:119], v[40:43]
s_and_b32 s68, s68, 0xffff
v_exp_f32 v162, v2
v_mfma_f32_16x16x32_bf16 v[40:43], a[152:155], v[132:135], v[40:43]
v_exp_f32 v163, v3
v_mfma_f32_16x16x32_bf16 v[40:43], a[156:159], v[148:151], v[40:43]
v_cvt_pk_bf16_f32 v64, v160, v161
v_mfma_f32_16x16x32_bf16 v[48:51], a[144:147], v[104:107], v[200:203]
v_exp_f32 v164, v4
v_mfma_f32_16x16x32_bf16 v[48:51], a[148:151], v[120:123], v[48:51]
s_add_u32 s69, s68, 98304
v_exp_f32 v165, v5
v_mfma_f32_16x16x32_bf16 v[48:51], a[152:155], v[136:139], v[48:51]
v_cvt_pk_bf16_f32 v65, v162, v163
v_mfma_f32_16x16x32_bf16 v[48:51], a[156:159], v[152:155], v[48:51]
buffer_load_dwordx4 v242, s[40:43], s65 offen offset:1024 sc1 lds
v_mfma_f32_16x16x32_bf16 v[56:59], a[144:147], v[108:111], v[204:207]
v_exp_f32 v166, v6
v_mfma_f32_16x16x32_bf16 v[56:59], a[148:151], v[124:127], v[56:59]
s_add_u32 s70, s70, 8192
v_exp_f32 v167, v7
v_mfma_f32_16x16x32_bf16 v[56:59], a[152:155], v[140:143], v[56:59]
ds_read_b128 a[176:179], v241 offset:0
v_cvt_pk_bf16_f32 v66, v164, v165
v_mfma_f32_16x16x32_bf16 v[56:59], a[156:159], v[156:159], v[56:59]
s_waitcnt lgkmcnt(1)
v_exp_f32 v160, v8
v_mfma_f32_16x16x32_bf16 v[36:39], a[160:163], v[96:99], v[192:195]
v_exp_f32 v161, v9
v_mfma_f32_16x16x32_bf16 v[36:39], a[164:167], v[112:115], v[36:39]
ds_read_b128 a[180:183], v241 offset:1024
v_cvt_pk_bf16_f32 v67, v166, v167
v_mfma_f32_16x16x32_bf16 v[36:39], a[168:171], v[128:131], v[36:39]
s_and_b32 s70, s70, 0xffff
v_exp_f32 v162, v10
v_mfma_f32_16x16x32_bf16 v[36:39], a[172:175], v[144:147], v[36:39]
buffer_load_dwordx4 v242, s[40:43], s65 offen offset:2048 sc1 lds
v_mfma_f32_16x16x32_bf16 v[44:47], a[160:163], v[100:103], v[196:199]
v_exp_f32 v163, v11
v_mfma_f32_16x16x32_bf16 v[44:47], a[164:167], v[116:119], v[44:47]
ds_read_b128 a[184:187], v241 offset:2048
v_cvt_pk_bf16_f32 v68, v160, v161
v_mfma_f32_16x16x32_bf16 v[44:47], a[168:171], v[132:135], v[44:47]
v_exp_f32 v164, v12
v_mfma_f32_16x16x32_bf16 v[44:47], a[172:175], v[148:151], v[44:47]
s_add_u32 s71, s70, 32768
v_mfma_f32_16x16x32_bf16 v[52:55], a[160:163], v[104:107], v[200:203]
v_exp_f32 v165, v13
v_mfma_f32_16x16x32_bf16 v[52:55], a[164:167], v[120:123], v[52:55]
ds_read_b128 a[188:191], v241 offset:3072
v_cvt_pk_bf16_f32 v69, v162, v163
v_mfma_f32_16x16x32_bf16 v[52:55], a[168:171], v[136:139], v[52:55]
v_exp_f32 v166, v14
v_mfma_f32_16x16x32_bf16 v[52:55], a[172:175], v[152:155], v[52:55]
buffer_load_dwordx4 v242, s[40:43], s65 offen offset:3072 sc1 lds
v_mfma_f32_16x16x32_bf16 v[60:63], a[160:163], v[108:111], v[204:207]
v_exp_f32 v167, v15
v_mfma_f32_16x16x32_bf16 v[60:63], a[164:167], v[124:127], v[60:63]
v_mfma_f32_16x16x32_bf16 v[60:63], a[168:171], v[140:143], v[60:63]
ds_read_b128 a[192:195], v241 offset:4096
v_cvt_pk_bf16_f32 v70, v164, v165
v_mfma_f32_16x16x32_bf16 v[60:63], a[172:175], v[156:159], v[60:63]
s_waitcnt lgkmcnt(2)
v_exp_f32 v160, v16
v_mfma_f32_16x16x32_bf16 a[0:3], a[176:179], v[80:83], a[0:3]
v_exp_f32 v161, v17
v_mfma_f32_16x16x32_bf16 a[32:35], a[176:179], v[84:87], a[32:35]
v_mfma_f32_16x16x32_bf16 a[64:67], a[176:179], v[88:91], a[64:67]
ds_read_b128 a[196:199], v241 offset:5120
v_cvt_pk_bf16_f32 v71, v166, v167
v_mfma_f32_16x16x32_bf16 a[96:99], a[176:179], v[92:95], a[96:99]
v_exp_f32 v162, v18
v_mfma_f32_16x16x32_bf16 a[4:7], a[180:183], v[80:83], a[4:7]
s_add_u32 s65, s65, 16384
v_exp_f32 v163, v19
v_mfma_f32_16x16x32_bf16 a[36:39], a[180:183], v[84:87], a[36:39]
v_mfma_f32_16x16x32_bf16 a[68:71], a[180:183], v[88:91], a[68:71]
v_cvt_pk_bf16_f32 v72, v160, v161
s_add_u32 s67, s67, 8192
v_mfma_f32_16x16x32_bf16 a[100:103], a[180:183], v[92:95], a[100:103]
v_exp_f32 v164, v20
v_mfma_f32_16x16x32_bf16 a[128:131], v[248:251], v[80:83], a[128:131]
ds_read_b128 a[200:203], v241 offset:6144
v_mfma_f32_16x16x32_bf16 a[8:11], a[184:187], v[80:83], a[8:11]
ds_read_b128 a[204:207], v241 offset:7168
s_and_b32 s67, s67, 0xffff
v_mfma_f32_16x16x32_bf16 a[40:43], a[184:187], v[84:87], a[40:43]
v_exp_f32 v165, v21
v_mfma_f32_16x16x32_bf16 a[72:75], a[184:187], v[88:91], a[72:75]
v_add_u32 v240, s69, v242
v_mfma_f32_16x16x32_bf16 a[104:107], a[184:187], v[92:95], a[104:107]
s_waitcnt lgkmcnt(2)
v_cvt_pk_bf16_f32 v73, v162, v163
v_mfma_f32_16x16x32_bf16 a[12:15], a[188:191], v[80:83], a[12:15]
v_exp_f32 v166, v22
v_mfma_f32_16x16x32_bf16 a[44:47], a[188:191], v[84:87], a[44:47]
v_exp_f32 v167, v23
v_mfma_f32_16x16x32_bf16 a[76:79], a[188:191], v[88:91], a[76:79]
v_cvt_pk_bf16_f32 v74, v164, v165
v_mfma_f32_16x16x32_bf16 a[108:111], a[188:191], v[92:95], a[108:111]
s_waitcnt vmcnt(16) lgkmcnt(0)
s_barrier
v_mfma_f32_16x16x32_bf16 a[132:135], v[248:251], v[84:87], a[132:135]
ds_read_b128 a[144:147], v240 offset:0
v_mfma_f32_16x16x32_bf16 a[16:19], a[192:195], v[80:83], a[16:19]
v_exp_f32 v160, v24
v_mfma_f32_16x16x32_bf16 a[48:51], a[192:195], v[84:87], a[48:51]
ds_read_b128 a[148:151], v240 offset:1024
v_mfma_f32_16x16x32_bf16 a[80:83], a[192:195], v[88:91], a[80:83]
v_exp_f32 v161, v25
v_mfma_f32_16x16x32_bf16 a[112:115], a[192:195], v[92:95], a[112:115]
ds_read_b128 a[152:155], v240 offset:2048
v_cvt_pk_bf16_f32 v75, v166, v167
v_mfma_f32_16x16x32_bf16 a[20:23], a[196:199], v[80:83], a[20:23]
v_exp_f32 v162, v26
v_mfma_f32_16x16x32_bf16 a[52:55], a[196:199], v[84:87], a[52:55]
ds_read_b128 a[156:159], v240 offset:3072
v_mfma_f32_16x16x32_bf16 a[84:87], a[196:199], v[88:91], a[84:87]
v_exp_f32 v163, v27
v_mfma_f32_16x16x32_bf16 a[116:119], a[196:199], v[92:95], a[116:119]
ds_read_b128 a[160:163], v240 offset:4096
v_cvt_pk_bf16_f32 v76, v160, v161
v_mfma_f32_16x16x32_bf16 a[136:139], v[248:251], v[88:91], a[136:139]
ds_read_b128 a[164:167], v240 offset:5120
v_mfma_f32_16x16x32_bf16 a[24:27], a[200:203], v[80:83], a[24:27]
v_exp_f32 v164, v28
v_mfma_f32_16x16x32_bf16 a[56:59], a[200:203], v[84:87], a[56:59]
v_exp_f32 v165, v29
v_mfma_f32_16x16x32_bf16 a[88:91], a[200:203], v[88:91], a[88:91]
v_cvt_pk_bf16_f32 v77, v162, v163
v_mfma_f32_16x16x32_bf16 a[120:123], a[200:203], v[92:95], a[120:123]
v_exp_f32 v166, v30
v_mfma_f32_16x16x32_bf16 a[28:31], a[204:207], v[80:83], a[28:31]
v_exp_f32 v167, v31
v_mfma_f32_16x16x32_bf16 a[60:63], a[204:207], v[84:87], a[60:63]
v_cvt_pk_bf16_f32 v78, v164, v165
v_mfma_f32_16x16x32_bf16 a[92:95], a[204:207], v[88:91], a[92:95]
s_sub_u32 s96, s96, 1
s_cmp_lg_u32 s96, 0
v_cvt_pk_bf16_f32 v79, v166, v167
v_mfma_f32_16x16x32_bf16 a[124:127], a[204:207], v[92:95], a[124:127]
v_add_u32 v241, s71, v242
v_mfma_f32_16x16x32_bf16 a[140:143], v[248:251], v[92:95], a[140:143]
s_cbranch_scc1 L_cloop
L_m0:
s_waitcnt lgkmcnt(1)
s_cmp_ge_u32 s56, 2
s_cbranch_scc0 L_alt4_1
v_mfma_f32_16x16x32_bf16 v[0:3], a[144:147], v[96:99], v[192:195]
v_mfma_f32_16x16x32_bf16 v[4:7], a[160:163], v[96:99], v[192:195]
L_ret4:
ds_read_b128 a[168:171], v240 offset:6144
s_add_u32 m0, s66, s67
v_mfma_f32_16x16x32_bf16 v[16:19], a[144:147], v[104:107], v[200:203]
s_add_u32 s68, s68, 8192
v_exp_f32 v160, v32
v_mfma_f32_16x16x32_bf16 v[16:19], a[148:151], v[120:123], v[16:19]
ds_read_b128 a[172:175], v240 offset:7168
v_mfma_f32_16x16x32_bf16 v[16:19], a[152:155], v[136:139], v[16:19]
v_exp_f32 v161, v33
v_mfma_f32_16x16x32_bf16 v[16:19], a[156:159], v[152:155], v[16:19]
buffer_load_dwordx4 v242, s[40:43], s65 offen offset:0 sc1 lds
v_mfma_f32_16x16x32_bf16 v[24:27], a[144:147], v[108:111], v[204:207]
s_and_b32 s68, s68, 0xffff
v_exp_f32 v162, v34
v_mfma_f32_16x16x32_bf16 v[24:27], a[148:151], v[124:127], v[24:27]
v_exp_f32 v163, v35
v_mfma_f32_16x16x32_bf16 v[24:27], a[152:155], v[140:143], v[24:27]
v_cvt_pk_bf16_f32 v80, v160, v161
v_mfma_f32_16x16x32_bf16 v[24:27], a[156:159], v[156:159], v[24:27]
v_exp_f32 v164, v36
v_mfma_f32_16x16x32_bf16 v[8:11], a[144:147], v[100:103], v[196:199]
s_add_u32 s69, s68, 98304
v_exp_f32 v165, v37
v_mfma_f32_16x16x32_bf16 v[8:11], a[148:151], v[116:119], v[8:11]
v_cvt_pk_bf16_f32 v81, v162, v163
v_mfma_f32_16x16x32_bf16 v[8:11], a[152:155], v[132:135], v[8:11]
buffer_load_dwordx4 v242, s[40:43], s65 offen offset:1024 sc1 lds
v_mfma_f32_16x16x32_bf16 v[8:11], a[156:159], v[148:151], v[8:11]
v_exp_f32 v166, v38
v_mfma_f32_16x16x32_bf16 v[0:3], a[148:151], v[112:115], v[0:3]
ds_read_b128 a[176:179], v241 offset:0
s_add_u32 s70, s70, 8192
v_mfma_f32_16x16x32_bf16 v[0:3], a[152:155], v[128:131], v[0:3]
v_exp_f32 v167, v39
v_mfma_f32_16x16x32_bf16 v[0:3], a[156:159], v[144:147], v[0:3]
ds_read_b128 a[180:183], v241 offset:1024
v_cvt_pk_bf16_f32 v82, v164, v165
v_mfma_f32_16x16x32_bf16 v[20:23], a[160:163], v[104:107], v[200:203]
s_waitcnt lgkmcnt(2)
v_exp_f32 v160, v40
v_mfma_f32_16x16x32_bf16 v[20:23], a[164:167], v[120:123], v[20:23]
v_exp_f32 v161, v41
v_mfma_f32_16x16x32_bf16 v[20:23], a[168:171], v[136:139], v[20:23]
v_cvt_pk_bf16_f32 v83, v166, v167
s_and_b32 s70, s70, 0xffff
v_mfma_f32_16x16x32_bf16 v[20:23], a[172:175], v[152:155], v[20:23]
v_exp_f32 v162, v42
v_mfma_f32_16x16x32_bf16 v[28:31], a[160:163], v[108:111], v[204:207]
buffer_load_dwordx4 v242, s[40:43], s65 offen offset:2048 sc1 lds
v_mfma_f32_16x16x32_bf16 v[28:31], a[164:167], v[124:127], v[28:31]
v_exp_f32 v163, v43
v_mfma_f32_16x16x32_bf16 v[28:31], a[168:171], v[140:143], v[28:31]
ds_read_b128 a[184:187], v241 offset:2048
v_cvt_pk_bf16_f32 v84, v160, v161
v_mfma_f32_16x16x32_bf16 v[28:31], a[172:175], v[156:159], v[28:31]
s_add_u32 s71, s70, 32768
v_exp_f32 v164, v44
v_mfma_f32_16x16x32_bf16 v[12:15], a[160:163], v[100:103], v[196:199]
v_exp_f32 v165, v45
v_mfma_f32_16x16x32_bf16 v[12:15], a[164:167], v[116:119], v[12:15]
ds_read_b128 a[188:191], v241 offset:3072
v_cvt_pk_bf16_f32 v85, v162, v163
v_mfma_f32_16x16x32_bf16 v[12:15], a[168:171], v[132:135], v[12:15]
v_exp_f32 v166, v46
v_mfma_f32_16x16x32_bf16 v[12:15], a[172:175], v[148:151], v[12:15]
buffer_load_dwordx4 v242, s[40:43], s65 offen offset:3072 sc1 lds
v_mfma_f32_16x16x32_bf16 v[4:7], a[164:167], v[112:115], v[4:7]
v_exp_f32 v167, v47
v_mfma_f32_16x16x32_bf16 v[4:7], a[168:171], v[128:131], v[4:7]
ds_read_b128 a[192:195], v241 offset:4096
v_cvt_pk_bf16_f32 v86, v164, v165
v_mfma_f32_16x16x32_bf16 v[4:7], a[172:175], v[144:147], v[4:7]
s_waitcnt lgkmcnt(2)
v_exp_f32 v160, v48
v_mfma_f32_16x16x32_bf16 a[0:3], a[176:179], v[64:67], a[0:3]
v_mfma_f32_16x16x32_bf16 a[32:35], a[176:179], v[68:71], a[32:35]
v_exp_f32 v161, v49
v_mfma_f32_16x16x32_bf16 a[64:67], a[176:179], v[72:75], a[64:67]
ds_read_b128 a[196:199], v241 offset:5120
v_cvt_pk_bf16_f32 v87, v166, v167
v_mfma_f32_16x16x32_bf16 a[96:99], a[176:179], v[76:79], a[96:99]
v_exp_f32 v162, v50
v_mfma_f32_16x16x32_bf16 a[4:7], a[180:183], v[64:67], a[4:7]
s_add_u32 s65, s65, 16384
v_mfma_f32_16x16x32_bf16 a[36:39], a[180:183], v[68:71], a[36:39]
v_exp_f32 v163, v51
v_mfma_f32_16x16x32_bf16 a[68:71], a[180:183], v[72:75], a[68:71]
v_cvt_pk_bf16_f32 v88, v160, v161
v_mfma_f32_16x16x32_bf16 a[100:103], a[180:183], v[76:79], a[100:103]
s_add_u32 s67, s67, 8192
ds_read_b128 a[200:203], v241 offset:6144
v_mfma_f32_16x16x32_bf16 a[128:131], v[248:251], v[64:67], a[128:131]
v_exp_f32 v164, v52
v_mfma_f32_16x16x32_bf16 a[8:11], a[184:187], v[64:67], a[8:11]
ds_read_b128 a[204:207], v241 offset:7168
s_and_b32 s67, s67, 0xffff
v_mfma_f32_16x16x32_bf16 a[40:43], a[184:187], v[68:71], a[40:43]
v_exp_f32 v165, v53
v_mfma_f32_16x16x32_bf16 a[72:75], a[184:187], v[72:75], a[72:75]
v_add_u32 v240, s69, v242
v_mfma_f32_16x16x32_bf16 a[104:107], a[184:187], v[76:79], a[104:107]
s_waitcnt lgkmcnt(2)
v_cvt_pk_bf16_f32 v89, v162, v163
v_mfma_f32_16x16x32_bf16 a[12:15], a[188:191], v[64:67], a[12:15]
v_exp_f32 v166, v54
v_mfma_f32_16x16x32_bf16 a[44:47], a[188:191], v[68:71], a[44:47]
v_exp_f32 v167, v55
v_mfma_f32_16x16x32_bf16 a[76:79], a[188:191], v[72:75], a[76:79]
v_cvt_pk_bf16_f32 v90, v164, v165
v_mfma_f32_16x16x32_bf16 a[108:111], a[188:191], v[76:79], a[108:111]
s_waitcnt vmcnt(16) lgkmcnt(0)
s_barrier
v_mfma_f32_16x16x32_bf16 a[132:135], v[248:251], v[68:71], a[132:135]
ds_read_b128 a[144:147], v240 offset:0
v_mfma_f32_16x16x32_bf16 a[16:19], a[192:195], v[64:67], a[16:19]
v_exp_f32 v160, v56
v_mfma_f32_16x16x32_bf16 a[48:51], a[192:195], v[68:71], a[48:51]
ds_read_b128 a[148:151], v240 offset:1024
v_mfma_f32_16x16x32_bf16 a[80:83], a[192:195], v[72:75], a[80:83]
v_exp_f32 v161, v57
v_mfma_f32_16x16x32_bf16 a[112:115], a[192:195], v[76:79], a[112:115]
ds_read_b128 a[152:155], v240 offset:2048
v_cvt_pk_bf16_f32 v91, v166, v167
v_mfma_f32_16x16x32_bf16 a[20:23], a[196:199], v[64:67], a[20:23]
v_exp_f32 v162, v58
v_mfma_f32_16x16x32_bf16 a[52:55], a[196:199], v[68:71], a[52:55]
ds_read_b128 a[156:159], v240 offset:3072
v_mfma_f32_16x16x32_bf16 a[84:87], a[196:199], v[72:75], a[84:87]
ds_read_b128 a[160:163], v240 offset:4096
v_mfma_f32_16x16x32_bf16 a[116:119], a[196:199], v[76:79], a[116:119]
v_exp_f32 v163, v59
v_mfma_f32_16x16x32_bf16 a[136:139], v[248:251], v[72:75], a[136:139]
ds_read_b128 a[164:167], v240 offset:5120
v_cvt_pk_bf16_f32 v92, v160, v161
v_mfma_f32_16x16x32_bf16 a[24:27], a[200:203], v[64:67], a[24:27]
v_exp_f32 v164, v60
v_mfma_f32_16x16x32_bf16 a[56:59], a[200:203], v[68:71], a[56:59]
v_exp_f32 v165, v61
v_mfma_f32_16x16x32_bf16 a[88:91], a[200:203], v[72:75], a[88:91]
v_cvt_pk_bf16_f32 v93, v162, v163
v_mfma_f32_16x16x32_bf16 a[120:123], a[200:203], v[76:79], a[120:123]
v_exp_f32 v166, v62
v_mfma_f32_16x16x32_bf16 a[28:31], a[204:207], v[64:67], a[28:31]
v_exp_f32 v167, v63
v_mfma_f32_16x16x32_bf16 a[60:63], a[204:207], v[68:71], a[60:63]
v_cvt_pk_bf16_f32 v94, v164, v165
v_mfma_f32_16x16x32_bf16 a[92:95], a[204:207], v[72:75], a[92:95]
v_cvt_pk_bf16_f32 v95, v166, v167
v_mfma_f32_16x16x32_bf16 a[124:127], a[204:207], v[76:79], a[124:127]
v_add_u32 v241, s71, v242
v_mfma_f32_16x16x32_bf16 a[140:143], v[248:251], v[76:79], a[140:143]
s_waitcnt lgkmcnt(1)
s_cmp_eq_u32 s56, 3
s_cbranch_scc0 L_alt5_1
v_mfma_f32_16x16x32_bf16 v[32:35], a[144:147], v[96:99], v[192:195]
v_mfma_f32_16x16x32_bf16 v[36:39], a[160:163], v[96:99], v[208:211]
L_ret5:
ds_read_b128 a[168:171], v240 offset:6144
s_add_u32 m0, s66, s67
v_mfma_f32_16x16x32_bf16 v[48:51], a[144:147], v[104:107], v[200:203]
s_add_u32 s68, s68, 8192
v_exp_f32 v160, v0
v_mfma_f32_16x16x32_bf16 v[48:51], a[148:151], v[120:123], v[48:51]
ds_read_b128 a[172:175], v240 offset:7168
v_mfma_f32_16x16x32_bf16 v[48:51], a[152:155], v[136:139], v[48:51]
v_exp_f32 v161, v1
v_mfma_f32_16x16x32_bf16 v[48:51], a[156:159], v[152:155], v[48:51]
buffer_load_dwordx4 v242, s[40:43], s65 offen offset:0 sc1 lds
v_mfma_f32_16x16x32_bf16 v[56:59], a[144:147], v[108:111], v[204:207]
s_and_b32 s68, s68, 0xffff
v_exp_f32 v162, v2
v_mfma_f32_16x16x32_bf16 v[56:59], a[148:151], v[124:127], v[56:59]
v_exp_f32 v163, v3
v_mfma_f32_16x16x32_bf16 v[56:59], a[152:155], v[140:143], v[56:59]
v_cvt_pk_bf16_f32 v64, v160, v161
v_mfma_f32_16x16x32_bf16 v[56:59], a[156:159], v[156:159], v[56:59]
v_exp_f32 v164, v4
v_mfma_f32_16x16x32_bf16 v[40:43], a[144:147], v[100:103], v[196:199]
s_add_u32 s69, s68, 98304
v_exp_f32 v165, v5
v_mfma_f32_16x16x32_bf16 v[40:43], a[148:151], v[116:119], v[40:43]
v_cvt_pk_bf16_f32 v65, v162, v163
v_mfma_f32_16x16x32_bf16 v[40:43], a[152:155], v[132:135], v[40:43]
buffer_load_dwordx4 v242, s[40:43], s65 offen offset:1024 sc1 lds
v_mfma_f32_16x16x32_bf16 v[40:43], a[156:159], v[148:151], v[40:43]
v_exp_f32 v166, v6
v_mfma_f32_16x16x32_bf16 v[32:35], a[148:151], v[112:115], v[32:35]
ds_read_b128 a[176:179], v241 offset:0
s_add_u32 s70, s70, 8192
v_mfma_f32_16x16x32_bf16 v[32:35], a[152:155], v[128:131], v[32:35]
v_exp_f32 v167, v7
v_mfma_f32_16x16x32_bf16 v[32:35], a[156:159], v[144:147], v[32:35]
ds_read_b128 a[180:183], v241 offset:1024
v_cvt_pk_bf16_f32 v66, v164, v165
v_mfma_f32_16x16x32_bf16 v[52:55], a[160:163], v[104:107], v[200:203]
s_waitcnt lgkmcnt(2)
v_exp_f32 v160, v8
v_mfma_f32_16x16x32_bf16 v[52:55], a[164:167], v[120:123], v[52:55]
v_exp_f32 v161, v9
v_mfma_f32_16x16x32_bf16 v[52:55], a[168:171], v[136:139], v[52:55]
v_cvt_pk_bf16_f32 v67, v166, v167
s_and_b32 s70, s70, 0xffff
v_mfma_f32_16x16x32_bf16 v[52:55], a[172:175], v[152:155], v[52:55]
v_exp_f32 v162, v10
v_mfma_f32_16x16x32_bf16 v[60:63], a[160:163], v[108:111], v[204:207]
buffer_load_dwordx4 v242, s[40:43], s65 offen offset:2048 sc1 lds
v_mfma_f32_16x16x32_bf16 v[60:63], a[164:167], v[124:127], v[60:63]
v_exp_f32 v163, v11
v_mfma_f32_16x16x32_bf16 v[60:63], a[168:171], v[140:143], v[60:63]
ds_read_b128 a[184:187], v241 offset:2048
v_cvt_pk_bf16_f32 v68, v160, v161
v_mfma_f32_16x16x32_bf16 v[60:63], a[172:175], v[156:159], v[60:63]
s_add_u32 s71, s70, 32768
v_exp_f32 v164, v12
v_mfma_f32_16x16x32_bf16 v[44:47], a[160:163], v[100:103], v[196:199]
v_exp_f32 v165, v13
v_mfma_f32_16x16x32_bf16 v[44:47], a[164:167], v[116:119], v[44:47]
ds_read_b128 a[188:191], v241 offset:3072
v_cvt_pk_bf16_f32 v69, v162, v163
v_mfma_f32_16x16x32_bf16 v[44:47], a[168:171], v[132:135], v[44:47]
v_exp_f32 v166, v14
v_mfma_f32_16x16x32_bf16 v[44:47], a[172:175], v[148:151], v[44:47]
buffer_load_dwordx4 v242, s[40:43], s65 offen offset:3072 sc1 lds
v_mfma_f32_16x16x32_bf16 v[36:39], a[164:167], v[112:115], v[36:39]
v_exp_f32 v167, v15
v_mfma_f32_16x16x32_bf16 v[36:39], a[168:171], v[128:131], v[36:39]
ds_read_b128 a[192:195], v241 offset:4096
v_cvt_pk_bf16_f32 v70, v164, v165
v_mfma_f32_16x16x32_bf16 v[36:39], a[172:175], v[144:147], v[36:39]
s_waitcnt lgkmcnt(2)
v_exp_f32 v160, v16
v_mfma_f32_16x16x32_bf16 a[0:3], a[176:179], v[80:83], a[0:3]
v_mfma_f32_16x16x32_bf16 a[32:35], a[176:179], v[84:87], a[32:35]
v_exp_f32 v161, v17
v_mfma_f32_16x16x32_bf16 a[64:67], a[176:179], v[88:91], a[64:67]
ds_read_b128 a[196:199], v241 offset:5120
v_cvt_pk_bf16_f32 v71, v166, v167
v_mfma_f32_16x16x32_bf16 a[96:99], a[176:179], v[92:95], a[96:99]
v_exp_f32 v162, v18
v_mfma_f32_16x16x32_bf16 a[4:7], a[180:183], v[80:83], a[4:7]
s_add_u32 s65, s65, 16384
v_mfma_f32_16x16x32_bf16 a[36:39], a[180:183], v[84:87], a[36:39]
v_exp_f32 v163, v19
v_mfma_f32_16x16x32_bf16 a[68:71], a[180:183], v[88:91], a[68:71]
v_cvt_pk_bf16_f32 v72, v160, v161
v_mfma_f32_16x16x32_bf16 a[100:103], a[180:183], v[92:95], a[100:103]
s_add_u32 s67, s67, 8192
ds_read_b128 a[200:203], v241 offset:6144
v_mfma_f32_16x16x32_bf16 a[128:131], v[248:251], v[80:83], a[128:131]
v_exp_f32 v164, v20
v_mfma_f32_16x16x32_bf16 a[8:11], a[184:187], v[80:83], a[8:11]
ds_read_b128 a[204:207], v241 offset:7168
s_and_b32 s67, s67, 0xffff
v_mfma_f32_16x16x32_bf16 a[40:43], a[184:187], v[84:87], a[40:43]
v_exp_f32 v165, v21
v_mfma_f32_16x16x32_bf16 a[72:75], a[184:187], v[88:91], a[72:75]
v_add_u32 v240, s69, v242
v_mfma_f32_16x16x32_bf16 a[104:107], a[184:187], v[92:95], a[104:107]
s_waitcnt lgkmcnt(2)
v_cvt_pk_bf16_f32 v73, v162, v163
v_mfma_f32_16x16x32_bf16 a[12:15], a[188:191], v[80:83], a[12:15]
v_exp_f32 v166, v22
v_mfma_f32_16x16x32_bf16 a[44:47], a[188:191], v[84:87], a[44:47]
v_exp_f32 v167, v23
v_mfma_f32_16x16x32_bf16 a[76:79], a[188:191], v[88:91], a[76:79]
v_cvt_pk_bf16_f32 v74, v164, v165
v_mfma_f32_16x16x32_bf16 a[108:111], a[188:191], v[92:95], a[108:111]
s_waitcnt vmcnt(16) lgkmcnt(0)
s_barrier
v_mfma_f32_16x16x32_bf16 a[132:135], v[248:251], v[84:87], a[132:135]
ds_read_b128 a[144:147], v240 offset:0
v_mfma_f32_16x16x32_bf16 a[16:19], a[192:195], v[80:83], a[16:19]
v_exp_f32 v160, v24
v_mfma_f32_16x16x32_bf16 a[48:51], a[192:195], v[84:87], a[48:51]
ds_read_b128 a[148:151], v240 offset:1024
v_mfma_f32_16x16x32_bf16 a[80:83], a[192:195], v[88:91], a[80:83]
v_exp_f32 v161, v25
v_mfma_f32_16x16x32_bf16 a[112:115], a[192:195], v[92:95], a[112:115]
ds_read_b128 a[152:155], v240 offset:2048
v_cvt_pk_bf16_f32 v75, v166, v167
v_mfma_f32_16x16x32_bf16 a[20:23], a[196:199], v[80:83], a[20:23]
v_exp_f32 v162, v26
v_mfma_f32_16x16x32_bf16 a[52:55], a[196:199], v[84:87], a[52:55]
ds_read_b128 a[156:159], v240 offset:3072
v_mfma_f32_16x16x32_bf16 a[84:87], a[196:199], v[88:91], a[84:87]
ds_read_b128 a[160:163], v240 offset:4096
v_mfma_f32_16x16x32_bf16 a[116:119], a[196:199], v[92:95], a[116:119]
v_exp_f32 v163, v27
v_mfma_f32_16x16x32_bf16 a[136:139], v[248:251], v[88:91], a[136:139]
ds_read_b128 a[164:167], v240 offset:5120
v_cvt_pk_bf16_f32 v76, v160, v161
v_mfma_f32_16x16x32_bf16 a[24:27], a[200:203], v[80:83], a[24:27]
v_exp_f32 v164, v28
v_mfma_f32_16x16x32_bf16 a[56:59], a[200:203], v[84:87], a[56:59]
v_exp_f32 v165, v29
v_mfma_f32_16x16x32_bf16 a[88:91], a[200:203], v[88:91], a[88:91]
v_cvt_pk_bf16_f32 v77, v162, v163
v_mfma_f32_16x16x32_bf16 a[120:123], a[200:203], v[92:95], a[120:123]
v_exp_f32 v166, v30
v_mfma_f32_16x16x32_bf16 a[28:31], a[204:207], v[80:83], a[28:31]
v_exp_f32 v167, v31
v_mfma_f32_16x16x32_bf16 a[60:63], a[204:207], v[84:87], a[60:63]
v_cvt_pk_bf16_f32 v78, v164, v165
v_mfma_f32_16x16x32_bf16 a[92:95], a[204:207], v[88:91], a[92:95]
v_cvt_pk_bf16_f32 v79, v166, v167
v_mfma_f32_16x16x32_bf16 a[124:127], a[204:207], v[92:95], a[124:127]
v_add_u32 v241, s71, v242
v_mfma_f32_16x16x32_bf16 a[140:143], v[248:251], v[92:95], a[140:143]
s_waitcnt lgkmcnt(1)
s_cmp_ge_u32 s56, 2
s_cbranch_scc0 L_alt6_1
v_mfma_f32_16x16x32_bf16 v[8:11], a[144:147], v[100:103], v[196:199]
v_mfma_f32_16x16x32_bf16 v[12:15], a[160:163], v[100:103], v[196:199]
L_ret6:
ds_read_b128 a[168:171], v240 offset:6144
s_add_u32 m0, s66, s67
v_mfma_f32_16x16x32_bf16 v[16:19], a[144:147], v[104:107], v[200:203]
ds_read_b128 a[172:175], v240 offset:7168
s_add_u32 s68, s68, 8192
v_mfma_f32_16x16x32_bf16 v[16:19], a[148:151], v[120:123], v[16:19]
v_exp_f32 v160, v32
v_mfma_f32_16x16x32_bf16 v[16:19], a[152:155], v[136:139], v[16:19]
v_exp_f32 v161, v33
v_mfma_f32_16x16x32_bf16 v[16:19], a[156:159], v[152:155], v[16:19]
buffer_load_dwordx4 v242, s[40:43], s65 offen offset:0 sc1 lds
v_mfma_f32_16x16x32_bf16 v[24:27], a[144:147], v[108:111], v[204:207]
s_and_b32 s68, s68, 0xffff
v_exp_f32 v162, v34
v_mfma_f32_16x16x32_bf16 v[24:27], a[148:151], v[124:127], v[24:27]
v_exp_f32 v163, v35
v_mfma_f32_16x16x32_bf16 v[24:27], a[152:155], v[140:143], v[24:27]
ds_read_b128 a[176:179], v241 offset:0
v_cvt_pk_bf16_f32 v80, v160, v161
v_mfma_f32_16x16x32_bf16 v[24:27], a[156:159], v[156:159], v[24:27]
v_exp_f32 v164, v36
v_mfma_f32_16x16x32_bf16 v[8:11], a[148:151], v[116:119], v[8:11]
s_add_u32 s69, s68, 98304
v_exp_f32 v165, v37
v_mfma_f32_16x16x32_bf16 v[8:11], a[152:155], v[132:135], v[8:11]
ds_read_b128 a[180:183], v241 offset:1024
v_cvt_pk_bf16_f32 v81, v162, v163
v_mfma_f32_16x16x32_bf16 v[8:11], a[156:159], v[148:151], v[8:11]
buffer_load_dwordx4 v242, s[40:43], s65 offen offset:1024 sc1 lds
v_mfma_f32_16x16x32_bf16 v[20:23], a[160:163], v[104:107], v[200:203]
s_waitcnt lgkmcnt(2)
v_exp_f32 v166, v38
v_mfma_f32_16x16x32_bf16 v[20:23], a[164:167], v[120:123], v[20:23]
s_add_u32 s70, s70, 8192
v_exp_f32 v167, v39
v_mfma_f32_16x16x32_bf16 v[20:23], a[168:171], v[136:139], v[20:23]
ds_read_b128 a[184:187], v241 offset:2048
v_cvt_pk_bf16_f32 v82, v164, v165
v_mfma_f32_16x16x32_bf16 v[20:23], a[172:175], v[152:155], v[20:23]
v_exp_f32 v160, v40
v_mfma_f32_16x16x32_bf16 v[28:31], a[160:163], v[108:111], v[204:207]
v_exp_f32 v161, v41
v_mfma_f32_16x16x32_bf16 v[28:31], a[164:167], v[124:127], v[28:31]
buffer_load_dwordx4 v242, s[40:43], s65 offen offset:2048 sc1 lds
v_mfma_f32_16x16x32_bf16 v[28:31], a[168:171], v[140:143], v[28:31]
ds_read_b128 a[188:191], v241 offset:3072
v_cvt_pk_bf16_f32 v83, v166, v167
v_mfma_f32_16x16x32_bf16 v[28:31], a[172:175], v[156:159], v[28:31]
s_and_b32 s70, s70, 0xffff
v_exp_f32 v162, v42
v_mfma_f32_16x16x32_bf16 v[12:15], a[164:167], v[116:119], v[12:15]
v_exp_f32 v163, v43
v_mfma_f32_16x16x32_bf16 v[12:15], a[168:171], v[132:135], v[12:15]
ds_read_b128 a[192:195], v241 offset:4096
v_cvt_pk_bf16_f32 v84, v160, v161
v_mfma_f32_16x16x32_bf16 v[12:15], a[172:175], v[148:151], v[12:15]
s_waitcnt lgkmcnt(2)
v_exp_f32 v164, v44
v_mfma_f32_16x16x32_bf16 a[0:3], a[176:179], v[64:67], a[0:3]
s_add_u32 s71, s70, 32768
v_exp_f32 v165, v45
v_mfma_f32_16x16x32_bf16 a[32:35], a[176:179], v[68:71], a[32:35]
buffer_load_dwordx4 v242, s[40:43], s65 offen offset:3072 sc1 lds
v_mfma_f32_16x16x32_bf16 a[64:67], a[176:179], v[72:75], a[64:67]
ds_read_b128 a[196:199], v241 offset:5120
v_cvt_pk_bf16_f32 v85, v162, v163
v_mfma_f32_16x16x32_bf16 a[96:99], a[176:179], v[76:79], a[96:99]
v_exp_f32 v166, v46
v_mfma_f32_16x16x32_bf16 a[4:7], a[180:183], v[64:67], a[4:7]
v_exp_f32 v167, v47
v_mfma_f32_16x16x32_bf16 a[36:39], a[180:183], v[68:71], a[36:39]
v_cvt_pk_bf16_f32 v86, v164, v165
v_mfma_f32_16x16x32_bf16 a[68:71], a[180:183], v[72:75], a[68:71]
s_add_u32 s65, s65, 16384
v_exp_f32 v160, v48
v_mfma_f32_16x16x32_bf16 a[100:103], a[180:183], v[76:79], a[100:103]
s_add_u32 s67, s67, 8192
v_exp_f32 v161, v49
v_mfma_f32_16x16x32_bf16 a[128:131], v[248:251], v[64:67], a[128:131]
ds_read_b128 a[200:203], v241 offset:6144
v_cvt_pk_bf16_f32 v87, v166, v167
v_mfma_f32_16x16x32_bf16 a[8:11], a[184:187], v[64:67], a[8:11]
s_and_b32 s67, s67, 0xffff
v_exp_f32 v162, v50
v_mfma_f32_16x16x32_bf16 a[40:43], a[184:187], v[68:71], a[40:43]
ds_read_b128 a[204:207], v241 offset:7168
v_mfma_f32_16x16x32_bf16 a[72:75], a[184:187], v[72:75], a[72:75]
v_exp_f32 v163, v51
v_mfma_f32_16x16x32_bf16 a[104:107], a[184:187], v[76:79], a[104:107]
s_waitcnt lgkmcnt(2)
v_cvt_pk_bf16_f32 v88, v160, v161
v_mfma_f32_16x16x32_bf16 a[12:15], a[188:191], v[64:67], a[12:15]
v_add_u32 v240, s69, v242
v_mfma_f32_16x16x32_bf16 a[44:47], a[188:191], v[68:71], a[44:47]
v_exp_f32 v164, v52
v_mfma_f32_16x16x32_bf16 a[76:79], a[188:191], v[72:75], a[76:79]
v_exp_f32 v165, v53
v_mfma_f32_16x16x32_bf16 a[108:111], a[188:191], v[76:79], a[108:111]
s_waitcnt vmcnt(16) lgkmcnt(0)
s_barrier
v_cvt_pk_bf16_f32 v89, v162, v163
v_mfma_f32_16x16x32_bf16 a[132:135], v[248:251], v[68:71], a[132:135]
v_exp_f32 v166, v54
v_mfma_f32_16x16x32_bf16 a[16:19], a[192:195], v[64:67], a[16:19]
ds_read_b128 a[144:147], v240 offset:0
v_mfma_f32_16x16x32_bf16 a[48:51], a[192:195], v[68:71], a[48:51]
v_exp_f32 v167, v55
v_mfma_f32_16x16x32_bf16 a[80:83], a[192:195], v[72:75], a[80:83]
ds_read_b128 a[148:151], v240 offset:1024
v_cvt_pk_bf16_f32 v90, v164, v165
v_mfma_f32_16x16x32_bf16 a[112:115], a[192:195], v[76:79], a[112:115]
v_exp_f32 v160, v56
v_mfma_f32_16x16x32_bf16 a[20:23], a[196:199], v[64:67], a[20:23]
ds_read_b128 a[152:155], v240 offset:2048
v_mfma_f32_16x16x32_bf16 a[52:55], a[196:199], v[68:71], a[52:55]
v_exp_f32 v161, v57
v_mfma_f32_16x16x32_bf16 a[84:87], a[196:199], v[72:75], a[84:87]
ds_read_b128 a[156:159], v240 offset:3072
v_cvt_pk_bf16_f32 v91, v166, v167
v_mfma_f32_16x16x32_bf16 a[116:119], a[196:199], v[76:79], a[116:119]
ds_read_b128 a[160:163], v240 offset:4096
v_mfma_f32_16x16x32_bf16 a[136:139], v[248:251], v[72:75], a[136:139]
v_exp_f32 v162, v58
v_mfma_f32_16x16x32_bf16 a[24:27], a[200:203], v[64:67], a[24:27]
v_exp_f32 v163, v59
v_mfma_f32_16x16x32_bf16 a[56:59], a[200:203], v[68:71], a[56:59]
ds_read_b128 a[164:167], v240 offset:5120
v_cvt_pk_bf16_f32 v92, v160, v161
v_mfma_f32_16x16x32_bf16 a[88:91], a[200:203], v[72:75], a[88:91]
v_exp_f32 v164, v60
v_mfma_f32_16x16x32_bf16 a[120:123], a[200:203], v[76:79], a[120:123]
v_exp_f32 v165, v61
v_mfma_f32_16x16x32_bf16 a[28:31], a[204:207], v[64:67], a[28:31]
v_cvt_pk_bf16_f32 v93, v162, v163
v_mfma_f32_16x16x32_bf16 a[60:63], a[204:207], v[68:71], a[60:63]
v_exp_f32 v166, v62
v_mfma_f32_16x16x32_bf16 a[92:95], a[204:207], v[72:75], a[92:95]
v_exp_f32 v167, v63
v_mfma_f32_16x16x32_bf16 a[124:127], a[204:207], v[76:79], a[124:127]
v_cvt_pk_bf16_f32 v94, v164, v165
v_mfma_f32_16x16x32_bf16 a[140:143], v[248:251], v[76:79], a[140:143]
v_cvt_pk_bf16_f32 v95, v166, v167
v_add_u32 v241, s71, v242
s_waitcnt lgkmcnt(1)
s_cmp_eq_u32 s56, 3
s_cbranch_scc0 L_alt7_1
v_mfma_f32_16x16x32_bf16 v[40:43], a[144:147], v[100:103], v[196:199]
v_mfma_f32_16x16x32_bf16 v[44:47], a[160:163], v[100:103], v[212:215]
L_ret7:
ds_read_b128 a[168:171], v240 offset:6144
s_add_u32 m0, s66, s67
v_mfma_f32_16x16x32_bf16 v[48:51], a[144:147], v[104:107], v[200:203]
ds_read_b128 a[172:175], v240 offset:7168
s_add_u32 s68, s68, 8192
v_mfma_f32_16x16x32_bf16 v[48:51], a[148:151], v[120:123], v[48:51]
v_exp_f32 v160, v8
v_mfma_f32_16x16x32_bf16 v[48:51], a[152:155], v[136:139], v[48:51]
buffer_load_dwordx4 v242, s[40:43], s65 offen offset:0 sc1 lds
v_mfma_f32_16x16x32_bf16 v[48:51], a[156:159], v[152:155], v[48:51]
s_and_b32 s68, s68, 0xffff
v_exp_f32 v161, v9
v_mfma_f32_16x16x32_bf16 v[56:59], a[144:147], v[108:111], v[204:207]
v_exp_f32 v162, v10
v_mfma_f32_16x16x32_bf16 v[56:59], a[148:151], v[124:127], v[56:59]
ds_read_b128 a[176:179], v241 offset:0
v_mfma_f32_16x16x32_bf16 v[56:59], a[152:155], v[140:143], v[56:59]
v_exp_f32 v163, v11
v_mfma_f32_16x16x32_bf16 v[56:59], a[156:159], v[156:159], v[56:59]
ds_read_b128 a[180:183], v241 offset:1024
v_cvt_pk_bf16_f32 v68, v160, v161
v_mfma_f32_16x16x32_bf16 v[40:43], a[148:151], v[116:119], v[40:43]
s_add_u32 s69, s68, 98304
v_exp_f32 v164, v12
v_mfma_f32_16x16x32_bf16 v[40:43], a[152:155], v[132:135], v[40:43]
buffer_load_dwordx4 v242, s[40:43], s65 offen offset:1024 sc1 lds
v_mfma_f32_16x16x32_bf16 v[40:43], a[156:159], v[148:151], v[40:43]
v_exp_f32 v165, v13
v_mfma_f32_16x16x32_bf16 v[52:55], a[160:163], v[104:107], v[200:203]
s_waitcnt lgkmcnt(2)
v_cvt_pk_bf16_f32 v69, v162, v163
v_mfma_f32_16x16x32_bf16 v[52:55], a[164:167], v[120:123], v[52:55]
s_add_u32 s70, s70, 8192
v_exp_f32 v166, v14
v_mfma_f32_16x16x32_bf16 v[52:55], a[168:171], v[136:139], v[52:55]
ds_read_b128 a[184:187], v241 offset:2048
v_mfma_f32_16x16x32_bf16 v[52:55], a[172:175], v[152:155], v[52:55]
v_exp_f32 v167, v15
v_mfma_f32_16x16x32_bf16 v[60:63], a[160:163], v[108:111], v[204:207]
buffer_load_dwordx4 v242, s[40:43], s65 offen offset:2048 sc1 lds
v_mfma_f32_16x16x32_bf16 v[60:63], a[164:167], v[124:127], v[60:63]
ds_read_b128 a[188:191], v241 offset:3072
v_cvt_pk_bf16_f32 v70, v164, v165
v_mfma_f32_16x16x32_bf16 v[60:63], a[168:171], v[140:143], v[60:63]
s_and_b32 s70, s70, 0xffff
v_exp_f32 v160, v16
v_mfma_f32_16x16x32_bf16 v[60:63], a[172:175], v[156:159], v[60:63]
v_exp_f32 v161, v17
v_mfma_f32_16x16x32_bf16 v[44:47], a[164:167], v[116:119], v[44:47]
v_cvt_pk_bf16_f32 v71, v166, v167
v_mfma_f32_16x16x32_bf16 v[44:47], a[168:171], v[132:135], v[44:47]
ds_read_b128 a[192:195], v241 offset:4096
v_mfma_f32_16x16x32_bf16 v[44:47], a[172:175], v[148:151], v[44:47]
s_waitcnt lgkmcnt(2)
v_exp_f32 v162, v18
v_mfma_f32_16x16x32_bf16 a[0:3], a[176:179], v[80:83], a[0:3]
buffer_load_dwordx4 v242, s[40:43], s65 offen offset:3072 sc1 lds
v_mfma_f32_16x16x32_bf16 a[32:35], a[176:179], v[84:87], a[32:35]
s_add_u32 s71, s70, 32768
v_exp_f32 v163, v19
v_mfma_f32_16x16x32_bf16 a[64:67], a[176:179], v[88:91], a[64:67]
ds_read_b128 a[196:199], v241 offset:5120
v_cvt_pk_bf16_f32 v72, v160, v161
v_mfma_f32_16x16x32_bf16 a[96:99], a[176:179], v[92:95], a[96:99]
v_exp_f32 v164, v20
v_mfma_f32_16x16x32_bf16 a[4:7], a[180:183], v[80:83], a[4:7]
v_mfma_f32_16x16x32_bf16 a[36:39], a[180:183], v[84:87], a[36:39]
v_exp_f32 v165, v21
v_mfma_f32_16x16x32_bf16 a[68:71], a[180:183], v[88:91], a[68:71]
s_add_u32 s65, s65, 16384
v_mfma_f32_16x16x32_bf16 a[100:103], a[180:183], v[92:95], a[100:103]
ds_read_b128 a[200:203], v241 offset:6144
v_cvt_pk_bf16_f32 v73, v162, v163
v_mfma_f32_16x16x32_bf16 a[128:131], v[248:251], v[80:83], a[128:131]
s_add_u32 s67, s67, 8192
v_exp_f32 v166, v22
v_mfma_f32_16x16x32_bf16 a[8:11], a[184:187], v[80:83], a[8:11]
ds_read_b128 a[204:207], v241 offset:7168
s_and_b32 s67, s67, 0xffff
v_mfma_f32_16x16x32_bf16 a[40:43], a[184:187], v[84:87], a[40:43]
v_exp_f32 v167, v23
v_mfma_f32_16x16x32_bf16 a[72:75], a[184:187], v[88:91], a[72:75]
v_add_u32 v240, s69, v242
v_mfma_f32_16x16x32_bf16 a[104:107], a[184:187], v[92:95], a[104:107]
s_waitcnt lgkmcnt(2)
v_cvt_pk_bf16_f32 v74, v164, v165
v_mfma_f32_16x16x32_bf16 a[12:15], a[188:191], v[80:83], a[12:15]
v_exp_f32 v160, v24
v_mfma_f32_16x16x32_bf16 a[44:47], a[188:191], v[84:87], a[44:47]
v_exp_f32 v161, v25
v_mfma_f32_16x16x32_bf16 a[76:79], a[188:191], v[88:91], a[76:79]
v_mfma_f32_16x16x32_bf16 a[108:111], a[188:191], v[92:95], a[108:111]
s_waitcnt vmcnt(16) lgkmcnt(0)
s_barrier
v_cvt_pk_bf16_f32 v75, v166, v167
v_mfma_f32_16x16x32_bf16 a[132:135], v[248:251], v[84:87], a[132:135]
ds_read_b128 a[144:147], v240 offset:0
v_mfma_f32_16x16x32_bf16 a[16:19], a[192:195], v[80:83], a[16:19]
ds_read_b128 a[148:151], v240 offset:1024
v_mfma_f32_16x16x32_bf16 a[48:51], a[192:195], v[84:87], a[48:51]
v_exp_f32 v162, v26
v_mfma_f32_16x16x32_bf16 a[80:83], a[192:195], v[88:91], a[80:83]
ds_read_b128 a[152:155], v240 offset:2048
v_mfma_f32_16x16x32_bf16 a[112:115], a[192:195], v[92:95], a[112:115]
v_exp_f32 v163, v27
v_mfma_f32_16x16x32_bf16 a[20:23], a[196:199], v[80:83], a[20:23]
ds_read_b128 a[156:159], v240 offset:3072
v_cvt_pk_bf16_f32 v76, v160, v161
v_mfma_f32_16x16x32_bf16 a[52:55], a[196:199], v[84:87], a[52:55]
ds_read_b128 a[160:163], v240 offset:4096
v_mfma_f32_16x16x32_bf16 a[84:87], a[196:199], v[88:91], a[84:87]
v_exp_f32 v164, v28
v_mfma_f32_16x16x32_bf16 a[116:119], a[196:199], v[92:95], a[116:119]
ds_read_b128 a[164:167], v240 offset:5120
v_mfma_f32_16x16x32_bf16 a[136:139], v[248:251], v[88:91], a[136:139]
v_exp_f32 v165, v29
v_mfma_f32_16x16x32_bf16 a[24:27], a[200:203], v[80:83], a[24:27]
v_cvt_pk_bf16_f32 v77, v162, v163
v_mfma_f32_16x16x32_bf16 a[56:59], a[200:203], v[84:87], a[56:59]
v_exp_f32 v166, v30
v_mfma_f32_16x16x32_bf16 a[88:91], a[200:203], v[88:91], a[88:91]
v_exp_f32 v167, v31
v_mfma_f32_16x16x32_bf16 a[120:123], a[200:203], v[92:95], a[120:123]
v_mfma_f32_16x16x32_bf16 a[28:31], a[204:207], v[80:83], a[28:31]
v_cvt_pk_bf16_f32 v78, v164, v165
v_mfma_f32_16x16x32_bf16 a[60:63], a[204:207], v[84:87], a[60:63]
v_cvt_pk_bf16_f32 v79, v166, v167
v_mfma_f32_16x16x32_bf16 a[92:95], a[204:207], v[88:91], a[92:95]
v_add_u32 v241, s71, v242
v_mfma_f32_16x16x32_bf16 a[124:127], a[204:207], v[92:95], a[124:127]
v_mfma_f32_16x16x32_bf16 a[140:143], v[248:251], v[92:95], a[140:143]
L_x1:
s_waitcnt lgkmcnt(1)
s_cmp_ge_u32 s61, 2
s_cbranch_scc0 L_alt8_1
v_mfma_f32_16x16x32_bf16 v[0:3], a[144:147], v[104:107], v[200:203]
v_mfma_f32_16x16x32_bf16 v[4:7], a[160:163], v[104:107], v[200:203]
L_ret8:
ds_read_b128 a[168:171], v240 offset:6144
s_add_u32 m0, s66, s67
v_mfma_f32_16x16x32_bf16 v[16:19], a[144:147], v[108:111], v[204:207]
ds_read_b128 a[172:175], v240 offset:7168
s_add_u32 s68, s68, 16384
v_mfma_f32_16x16x32_bf16 v[16:19], a[148:151], v[124:127], v[16:19]
ds_read_b128 a[176:179], v240 offset:8192
v_mfma_f32_16x16x32_bf16 v[16:19], a[152:155], v[140:143], v[16:19]
ds_read_b128 a[180:183], v240 offset:9216
v_mfma_f32_16x16x32_bf16 v[16:19], a[156:159], v[156:159], v[16:19]
ds_read_b128 a[184:187], v240 offset:10240
s_and_b32 s68, s68, 0xffff
v_mfma_f32_16x16x32_bf16 v[0:3], a[148:151], v[120:123], v[0:3]
ds_read_b128 a[188:191], v240 offset:11264
v_exp_f32 v160, v40
v_mfma_f32_16x16x32_bf16 v[0:3], a[152:155], v[136:139], v[0:3]
ds_read_b128 a[192:195], v240 offset:12288
v_exp_f32 v161, v41
v_mfma_f32_16x16x32_bf16 v[0:3], a[156:159], v[152:155], v[0:3]
buffer_load_dwordx4 v242, s[40:43], s65 offen offset:0 sc1 lds
v_mfma_f32_16x16x32_bf16 v[20:23], a[160:163], v[108:111], v[204:207]
s_waitcnt lgkmcnt(5)
v_exp_f32 v162, v42
v_mfma_f32_16x16x32_bf16 v[20:23], a[164:167], v[124:127], v[20:23]
s_add_u32 s69, s68, 98304
v_exp_f32 v163, v43
v_mfma_f32_16x16x32_bf16 v[20:23], a[168:171], v[140:143], v[20:23]
ds_read_b128 a[196:199], v240 offset:13312
v_cvt_pk_bf16_f32 v84, v160, v161
v_mfma_f32_16x16x32_bf16 v[20:23], a[172:175], v[156:159], v[20:23]
ds_read_b128 a[200:203], v240 offset:14336
v_mfma_f32_16x16x32_bf16 v[4:7], a[164:167], v[120:123], v[4:7]
ds_read_b128 a[204:207], v240 offset:15360
v_mfma_f32_16x16x32_bf16 v[4:7], a[168:171], v[136:139], v[4:7]
s_add_u32 s70, s70, 8192
v_exp_f32 v164, v44
v_mfma_f32_16x16x32_bf16 v[4:7], a[172:175], v[152:155], v[4:7]
s_waitcnt lgkmcnt(3)
v_exp_f32 v165, v45
s_cmp_ge_u32 s61, 4
s_cbranch_scc0 L_alt9_1
v_mfma_f32_16x16x32_bf16 v[8:11], a[176:179], v[104:107], v[200:203]
v_mfma_f32_16x16x32_bf16 v[12:15], a[192:195], v[104:107], v[200:203]
L_ret9:
buffer_load_dwordx4 v242, s[40:43], s65 offen offset:1024 sc1 lds
v_mfma_f32_16x16x32_bf16 v[24:27], a[176:179], v[108:111], v[204:207]
ds_read_b128 a[144:147], v241 offset:0
v_cvt_pk_bf16_f32 v85, v162, v163
v_mfma_f32_16x16x32_bf16 v[24:27], a[180:183], v[124:127], v[24:27]
v_exp_f32 v166, v46
v_mfma_f32_16x16x32_bf16 v[24:27], a[184:187], v[140:143], v[24:27]
s_and_b32 s70, s70, 0xffff
v_exp_f32 v167, v47
v_mfma_f32_16x16x32_bf16 v[24:27], a[188:191], v[156:159], v[24:27]
ds_read_b128 a[148:151], v241 offset:1024
v_cvt_pk_bf16_f32 v86, v164, v165
v_mfma_f32_16x16x32_bf16 v[8:11], a[180:183], v[120:123], v[8:11]
v_exp_f32 v160, v48
v_mfma_f32_16x16x32_bf16 v[8:11], a[184:187], v[136:139], v[8:11]
ds_read_b128 a[152:155], v241 offset:2048
v_mfma_f32_16x16x32_bf16 v[8:11], a[188:191], v[152:155], v[8:11]
buffer_load_dwordx4 v242, s[40:43], s65 offen offset:2048 sc1 lds
v_mfma_f32_16x16x32_bf16 v[28:31], a[192:195], v[108:111], v[204:207]
s_waitcnt lgkmcnt(2)
v_exp_f32 v161, v49
v_mfma_f32_16x16x32_bf16 v[28:31], a[196:199], v[124:127], v[28:31]
ds_read_b128 a[156:159], v241 offset:3072
v_cvt_pk_bf16_f32 v87, v166, v167
v_mfma_f32_16x16x32_bf16 v[28:31], a[200:203], v[140:143], v[28:31]
s_add_u32 s71, s70, 32768
v_exp_f32 v162, v50
v_mfma_f32_16x16x32_bf16 v[28:31], a[204:207], v[156:159], v[28:31]
v_exp_f32 v163, v51
v_mfma_f32_16x16x32_bf16 v[12:15], a[196:199], v[120:123], v[12:15]
ds_read_b128 a[160:163], v241 offset:4096
v_cvt_pk_bf16_f32 v88, v160, v161
v_mfma_f32_16x16x32_bf16 v[12:15], a[200:203], v[136:139], v[12:15]
buffer_load_dwordx4 v242, s[40:43], s65 offen offset:3072 sc1 lds
v_mfma_f32_16x16x32_bf16 v[12:15], a[204:207], v[152:155], v[12:15]
v_exp_f32 v164, v52
v_mfma_f32_16x16x32_bf16 a[32:35], a[144:147], v[68:71], a[32:35]
ds_read_b128 a[164:167], v241 offset:5120
v_mfma_f32_16x16x32_bf16 a[64:67], a[144:147], v[72:75], a[64:67]
v_exp_f32 v165, v53
v_mfma_f32_16x16x32_bf16 a[96:99], a[144:147], v[76:79], a[96:99]
s_waitcnt lgkmcnt(2)
v_cvt_pk_bf16_f32 v89, v162, v163
s_add_u32 s65, s65, 16384
v_mfma_f32_16x16x32_bf16 a[36:39], a[148:151], v[68:71], a[36:39]
v_exp_f32 v166, v54
v_mfma_f32_16x16x32_bf16 a[68:71], a[148:151], v[72:75], a[68:71]
ds_read_b128 a[168:171], v241 offset:6144
s_add_u32 s67, s67, 8192
v_mfma_f32_16x16x32_bf16 a[100:103], a[148:151], v[76:79], a[100:103]
v_exp_f32 v167, v55
v_mfma_f32_16x16x32_bf16 a[40:43], a[152:155], v[68:71], a[40:43]
ds_read_b128 a[172:175], v241 offset:7168
v_cvt_pk_bf16_f32 v90, v164, v165
v_mfma_f32_16x16x32_bf16 a[72:75], a[152:155], v[72:75], a[72:75]
s_and_b32 s67, s67, 0xffff
v_exp_f32 v160, v56
v_mfma_f32_16x16x32_bf16 a[104:107], a[152:155], v[76:79], a[104:107]
v_exp_f32 v161, v57
v_mfma_f32_16x16x32_bf16 a[44:47], a[156:159], v[68:71], a[44:47]
v_add_u32 v240, s69, v242
v_mfma_f32_16x16x32_bf16 a[76:79], a[156:159], v[72:75], a[76:79]
v_cvt_pk_bf16_f32 v91, v166, v167
v_mfma_f32_16x16x32_bf16 a[108:111], a[156:159], v[76:79], a[108:111]
v_exp_f32 v162, v58
v_mfma_f32_16x16x32_bf16 a[132:135], v[248:251], v[68:71], a[132:135]
s_waitcnt lgkmcnt(1)
v_exp_f32 v163, v59
v_mfma_f32_16x16x32_bf16 a[48:51], a[160:163], v[68:71], a[48:51]
s_waitcnt vmcnt(16) lgkmcnt(0)
s_barrier
v_cvt_pk_bf16_f32 v92, v160, v161
v_mfma_f32_16x16x32_bf16 a[80:83], a[160:163], v[72:75], a[80:83]
ds_read_b128 a[144:147], v240 offset:0
v_mfma_f32_16x16x32_bf16 a[112:115], a[160:163], v[76:79], a[112:115]
v_exp_f32 v164, v60
v_mfma_f32_16x16x32_bf16 a[52:55], a[164:167], v[68:71], a[52:55]
ds_read_b128 a[148:151], v240 offset:1024
v_mfma_f32_16x16x32_bf16 a[84:87], a[164:167], v[72:75], a[84:87]
ds_read_b128 a[152:155], v240 offset:2048
v_mfma_f32_16x16x32_bf16 a[116:119], a[164:167], v[76:79], a[116:119]
v_exp_f32 v165, v61
v_mfma_f32_16x16x32_bf16 a[136:139], v[248:251], v[72:75], a[136:139]
ds_read_b128 a[156:159], v240 offset:3072
v_cvt_pk_bf16_f32 v93, v162, v163
v_mfma_f32_16x16x32_bf16 a[56:59], a[168:171], v[68:71], a[56:59]
v_exp_f32 v166, v62
v_mfma_f32_16x16x32_bf16 a[88:91], a[168:171], v[72:75], a[88:91]
ds_read_b128 a[160:163], v240 offset:4096
v_mfma_f32_16x16x32_bf16 a[120:123], a[168:171], v[76:79], a[120:123]
ds_read_b128 a[164:167], v240 offset:5120
v_mfma_f32_16x16x32_bf16 a[60:63], a[172:175], v[68:71], a[60:63]
v_exp_f32 v167, v63
v_mfma_f32_16x16x32_bf16 a[92:95], a[172:175], v[72:75], a[92:95]
v_cvt_pk_bf16_f32 v94, v164, v165
v_mfma_f32_16x16x32_bf16 a[124:127], a[172:175], v[76:79], a[124:127]
v_cvt_pk_bf16_f32 v95, v166, v167
v_mfma_f32_16x16x32_bf16 a[140:143], v[248:251], v[76:79], a[140:143]
v_add_u32 v241, s71, v242
s_waitcnt lgkmcnt(1)
s_cmp_ge_u32 s61, 64
s_cbranch_scc0 L_alt10_1
v_mfma_f32_16x16x32_bf16 v[32:35], a[144:147], v[104:107], v[200:203]
v_mfma_f32_16x16x32_bf16 v[36:39], a[160:163], v[104:107], v[200:203]
v_mfma_f32_16x16x32_bf16 v[48:51], a[144:147], v[108:111], v[204:207]
v_mfma_f32_16x16x32_bf16 v[52:55], a[160:163], v[108:111], v[204:207]
L_ret10:
ds_read_b128 a[168:171], v240 offset:6144
s_add_u32 m0, s66, s67
v_mfma_f32_16x16x32_bf16 v[48:51], a[148:151], v[124:127], v[48:51]
ds_read_b128 a[172:175], v240 offset:7168
s_add_u32 s68, s68, 16384
v_mfma_f32_16x16x32_bf16 v[48:51], a[152:155], v[140:143], v[48:51]
ds_read_b128 a[176:179], v240 offset:8192
v_mfma_f32_16x16x32_bf16 v[48:51], a[156:159], v[156:159], v[48:51]
ds_read_b128 a[180:183], v240 offset:9216
v_mfma_f32_16x16x32_bf16 v[32:35], a[148:151], v[120:123], v[32:35]
ds_read_b128 a[184:187], v240 offset:10240
s_and_b32 s68, s68, 0xffff
v_mfma_f32_16x16x32_bf16 v[32:35], a[152:155], v[136:139], v[32:35]
ds_read_b128 a[188:191], v240 offset:11264
ds_read_b128 a[192:195], v240 offset:12288
v_mfma_f32_16x16x32_bf16 v[32:35], a[156:159], v[152:155], v[32:35]
s_waitcnt lgkmcnt(7)
v_exp_f32 v160, v0
v_mfma_f32_16x16x32_bf16 v[52:55], a[164:167], v[124:127], v[52:55]
s_waitcnt lgkmcnt(6)
v_exp_f32 v161, v1
v_mfma_f32_16x16x32_bf16 v[52:55], a[168:171], v[140:143], v[52:55]
s_waitcnt lgkmcnt(5)
ds_read_b128 a[196:199], v240 offset:13312
v_mfma_f32_16x16x32_bf16 v[52:55], a[172:175], v[156:159], v[52:55]
buffer_load_dwordx4 v242, s[40:43], s65 offen offset:0 sc1 lds
v_mfma_f32_16x16x32_bf16 v[36:39], a[164:167], v[120:123], v[36:39]
s_add_u32 s69, s68, 98304
v_exp_f32 v162, v2
v_mfma_f32_16x16x32_bf16 v[36:39], a[168:171], v[136:139], v[36:39]
ds_read_b128 a[200:203], v240 offset:14336
v_exp_f32 v163, v3
v_cvt_pk_bf16_f32 v64, v160, v161
v_mfma_f32_16x16x32_bf16 v[36:39], a[172:175], v[152:155], v[36:39]
s_waitcnt lgkmcnt(2)
ds_read_b128 a[204:207], v240 offset:15360
s_cmp_ge_u32 s61, 64
s_cbranch_scc0 L_alt11_1
v_mfma_f32_16x16x32_bf16 v[40:43], a[176:179], v[104:107], v[200:203]
v_mfma_f32_16x16x32_bf16 v[44:47], a[192:195], v[104:107], v[200:203]
v_mfma_f32_16x16x32_bf16 v[56:59], a[176:179], v[108:111], v[204:207]
v_mfma_f32_16x16x32_bf16 v[60:63], a[192:195], v[108:111], v[204:207]
L_ret11:
buffer_load_dwordx4 v242, s[40:43], s65 offen offset:1024 sc1 lds
v_mfma_f32_16x16x32_bf16 v[56:59], a[180:183], v[124:127], v[56:59]
s_add_u32 s70, s70, 8192
v_exp_f32 v164, v4
v_mfma_f32_16x16x32_bf16 v[56:59], a[184:187], v[140:143], v[56:59]
ds_read_b128 a[144:147], v241 offset:0
v_exp_f32 v165, v5
v_cvt_pk_bf16_f32 v65, v162, v163
v_mfma_f32_16x16x32_bf16 v[56:59], a[188:191], v[156:159], v[56:59]
buffer_load_dwordx4 v242, s[40:43], s65 offen offset:2048 sc1 lds
v_mfma_f32_16x16x32_bf16 v[40:43], a[180:183], v[120:123], v[40:43]
ds_read_b128 a[148:151], v241 offset:1024
v_exp_f32 v166, v6
v_mfma_f32_16x16x32_bf16 v[40:43], a[184:187], v[136:139], v[40:43]
s_and_b32 s70, s70, 0xffff
v_exp_f32 v167, v7
v_cvt_pk_bf16_f32 v66, v164, v165
v_mfma_f32_16x16x32_bf16 v[40:43], a[188:191], v[152:155], v[40:43]
s_waitcnt lgkmcnt(2)
v_exp_f32 v160, v8
v_mfma_f32_16x16x32_bf16 v[60:63], a[196:199], v[124:127], v[60:63]
buffer_load_dwordx4 v242, s[40:43], s65 offen offset:3072 sc1 lds
s_add_u32 s65, s65, 16384
v_mfma_f32_16x16x32_bf16 v[60:63], a[200:203], v[140:143], v[60:63]
s_add_u32 s67, s67, 8192
v_exp_f32 v161, v9
v_cvt_pk_bf16_f32 v67, v166, v167
v_mfma_f32_16x16x32_bf16 v[60:63], a[204:207], v[156:159], v[60:63]
ds_read_b128 a[152:155], v241 offset:2048
s_and_b32 s67, s67, 0xffff
s_add_u32 m0, s66, s67
v_mfma_f32_16x16x32_bf16 v[44:47], a[196:199], v[120:123], v[44:47]
s_add_u32 s71, s70, 32768
v_exp_f32 v162, v10
v_mfma_f32_16x16x32_bf16 v[44:47], a[200:203], v[136:139], v[44:47]
ds_read_b128 a[156:159], v241 offset:3072
v_exp_f32 v163, v11
v_cvt_pk_bf16_f32 v68, v160, v161
v_mfma_f32_16x16x32_bf16 v[44:47], a[204:207], v[152:155], v[44:47]
s_waitcnt lgkmcnt(2)
v_exp_f32 v164, v12
v_mfma_f32_16x16x32_bf16 a[32:35], a[144:147], v[84:87], a[32:35]
buffer_load_dwordx4 v242, s[40:43], s65 offen offset:0 sc1 lds
v_mfma_f32_16x16x32_bf16 a[64:67], a[144:147], v[88:91], a[64:67]
ds_read_b128 a[160:163], v241 offset:4096
v_exp_f32 v165, v13
v_cvt_pk_bf16_f32 v69, v162, v163
v_mfma_f32_16x16x32_bf16 a[96:99], a[144:147], v[92:95], a[96:99]
v_exp_f32 v166, v14
v_mfma_f32_16x16x32_bf16 a[36:39], a[148:151], v[84:87], a[36:39]
buffer_load_dwordx4 v242, s[40:43], s65 offen offset:1024 sc1 lds
v_mfma_f32_16x16x32_bf16 a[68:71], a[148:151], v[88:91], a[68:71]
ds_read_b128 a[164:167], v241 offset:5120
v_exp_f32 v167, v15
v_cvt_pk_bf16_f32 v70, v164, v165
v_mfma_f32_16x16x32_bf16 a[100:103], a[148:151], v[92:95], a[100:103]
s_waitcnt lgkmcnt(2)
v_exp_f32 v160, v16
v_mfma_f32_16x16x32_bf16 a[40:43], a[152:155], v[84:87], a[40:43]
buffer_load_dwordx4 v242, s[40:43], s65 offen offset:2048 sc1 lds
v_mfma_f32_16x16x32_bf16 a[72:75], a[152:155], v[88:91], a[72:75]
ds_read_b128 a[168:171], v241 offset:6144
ds_read_b128 a[172:175], v241 offset:7168
v_mfma_f32_16x16x32_bf16 a[104:107], a[152:155], v[92:95], a[104:107]
v_exp_f32 v161, v17
v_cvt_pk_bf16_f32 v71, v166, v167
v_mfma_f32_16x16x32_bf16 a[44:47], a[156:159], v[84:87], a[44:47]
v_exp_f32 v162, v18
v_mfma_f32_16x16x32_bf16 a[76:79], a[156:159], v[88:91], a[76:79]
v_exp_f32 v163, v19
v_cvt_pk_bf16_f32 v72, v160, v161
v_mfma_f32_16x16x32_bf16 a[108:111], a[156:159], v[92:95], a[108:111]
buffer_load_dwordx4 v242, s[40:43], s65 offen offset:3072 sc1 lds
v_mfma_f32_16x16x32_bf16 a[132:135], v[248:251], v[84:87], a[132:135]
s_waitcnt lgkmcnt(2)
s_add_u32 s65, s65, 16384
s_add_u32 s67, s67, 8192
v_add_u32 v240, s69, v242
s_and_b32 s67, s67, 0xffff
v_mfma_f32_16x16x32_bf16 a[48:51], a[160:163], v[84:87], a[48:51]
s_waitcnt vmcnt(8) lgkmcnt(0)
s_barrier
v_exp_f32 v164, v20
v_mfma_f32_16x16x32_bf16 a[80:83], a[160:163], v[88:91], a[80:83]
v_exp_f32 v165, v21
v_cvt_pk_bf16_f32 v73, v162, v163
v_mfma_f32_16x16x32_bf16 a[112:115], a[160:163], v[92:95], a[112:115]
v_exp_f32 v166, v22
v_mfma_f32_16x16x32_bf16 a[52:55], a[164:167], v[84:87], a[52:55]
v_exp_f32 v167, v23
v_cvt_pk_bf16_f32 v74, v164, v165
v_mfma_f32_16x16x32_bf16 a[84:87], a[164:167], v[88:91], a[84:87]
v_exp_f32 v160, v24
v_mfma_f32_16x16x32_bf16 a[116:119], a[164:167], v[92:95], a[116:119]
ds_read_b128 a[144:147], v240 offset:0
v_exp_f32 v161, v25
v_mfma_f32_16x16x32_bf16 a[136:139], v[248:251], v[88:91], a[136:139]
ds_read_b128 a[148:151], v240 offset:1024
v_cvt_pk_bf16_f32 v75, v166, v167
v_mfma_f32_16x16x32_bf16 a[56:59], a[168:171], v[84:87], a[56:59]
v_exp_f32 v162, v26
v_mfma_f32_16x16x32_bf16 a[88:91], a[168:171], v[88:91], a[88:91]
ds_read_b128 a[152:155], v240 offset:2048
v_exp_f32 v163, v27
v_mfma_f32_16x16x32_bf16 a[120:123], a[168:171], v[92:95], a[120:123]
ds_read_b128 a[156:159], v240 offset:3072
v_cvt_pk_bf16_f32 v76, v160, v161
v_mfma_f32_16x16x32_bf16 a[60:63], a[172:175], v[84:87], a[60:63]
v_exp_f32 v164, v28
v_mfma_f32_16x16x32_bf16 a[92:95], a[172:175], v[88:91], a[92:95]
ds_read_b128 a[160:163], v240 offset:4096
v_exp_f32 v165, v29
v_mfma_f32_16x16x32_bf16 a[124:127], a[172:175], v[92:95], a[124:127]
ds_read_b128 a[164:167], v240 offset:5120
v_cvt_pk_bf16_f32 v77, v162, v163
v_mfma_f32_16x16x32_bf16 a[140:143], v[248:251], v[92:95], a[140:143]
v_exp_f32 v166, v30
v_exp_f32 v167, v31
v_cvt_pk_bf16_f32 v78, v164, v165
v_cvt_pk_bf16_f32 v79, v166, v167
v_add_u32 v241, s71, v242
s_lshr_b32 s0, s2, 3
s_cmp_lg_u32 s0, 24
s_cbranch_scc1 L_ct18
s_lshl_b32 s0, s56, 13
v_lshl_add_u32 v237, v243, 7, s0
v_min_u32 v237, 16384-4, v237
s_getpc_b64 s[0:1]
L_cp18:
s_add_u32 s0, s0, L_n0-L_cp18
s_addc_u32 s1, s1, 0
global_load_dword v236, v237, s[0:1]
L_ct18:
s_lshr_b32 s0, s2, 3
s_cmp_lg_u32 s0, 28
s_cbranch_scc1 L_ct19
s_lshl_b32 s0, s56, 13
v_lshl_add_u32 v237, v243, 7, s0
v_min_u32 v237, 16384-4, v237
s_getpc_b64 s[0:1]
L_cp19:
s_add_u32 s0, s0, L_n0-L_cp19
s_addc_u32 s1, s1, 0
global_load_dword v236, v237, s[0:1]
L_ct19:
s_and_b32 s99, s2, 3
s_lshr_b32 s98, s2, 2
s_and_b32 s98, s98, 1
s_lshl_b32 s98, s98, 5
s_lshr_b32 s101, s2, 3
s_add_u32 s101, s101, s98
s_lshr_b32 s19, s101, 2
s_sub_u32 s98, 15, s19
s_min_u32 s19, s19, s98
s_add_u32 s19, s19, 48
s_lshl_b32 s19, s19, 7
s_lshr_b32 s1, s101, 2
s_and_b32 s1, s1, 0
s_xor_b32 s1, s1, s99
buffer_load_dword v236, v238, s[48:51], s19 offen sc1
s_lshl_b32 s16, s101, 17
s_add_u32 s16, s16, 60817408
s_add_u32 s52, s26, s16
s_addc_u32 s53, s27, 0
s_mov_b32 s54, 8519680
s_mov_b32 s55, 0x20000
s_lshl_b32 s16, s1, 15
s_lshl_b32 s17, s56, 11
s_add_u32 s16, s16, s17
v_mov_b32 v224, -1
v_mov_b32 v225, -1
v_mov_b32 v226, -1
v_mov_b32 v227, -1
v_accvgpr_read_b32 v160, a128
v_accvgpr_read_b32 v161, a132
v_rcp_f32 v162, v160
v_cmp_nle_f32 vcc, s74, v160
v_cmp_nge_f32 s[8:9], s75, v160
v_mov_b32 v163, v162
s_nop 1
s_or_b64 s[72:73], s[72:73], vcc
s_or_b64 s[72:73], s[72:73], s[8:9]
v_rcp_f32 v164, v161
v_cmp_nle_f32 vcc, s74, v161
v_cmp_nge_f32 s[8:9], s75, v161
v_mov_b32 v165, v164
s_nop 1
s_or_b64 s[72:73], s[72:73], vcc
s_or_b64 s[72:73], s[72:73], s[8:9]
v_accvgpr_read_b32 v168, a0
v_accvgpr_read_b32 v169, a1
v_accvgpr_read_b32 v170, a2
v_accvgpr_read_b32 v171, a3
v_accvgpr_read_b32 v172, a4
v_accvgpr_read_b32 v173, a5
v_accvgpr_read_b32 v174, a6
v_accvgpr_read_b32 v175, a7
v_pk_mul_f32 v[168:169], v[168:169], v[162:163]
v_pk_mul_f32 v[170:171], v[170:171], v[162:163]
v_pk_mul_f32 v[172:173], v[172:173], v[162:163]
v_pk_mul_f32 v[174:175], v[174:175], v[162:163]
v_cvt_pk_bf16_f32 v184, v168, v169
v_cvt_pk_bf16_f32 v185, v170, v171
v_cvt_pk_bf16_f32 v186, v172, v173
v_cvt_pk_bf16_f32 v187, v174, v175
buffer_store_dwordx4 v[184:187], v242, s[44:47], s76 offen offset:0 sc1
v_accvgpr_read_b32 v176, a8
v_accvgpr_read_b32 v177, a9
v_accvgpr_read_b32 v178, a10
v_accvgpr_read_b32 v179, a11
v_accvgpr_read_b32 v180, a12
v_accvgpr_read_b32 v181, a13
v_accvgpr_read_b32 v182, a14
v_accvgpr_read_b32 v183, a15
v_pk_mul_f32 v[176:177], v[176:177], v[162:163]
v_pk_mul_f32 v[178:179], v[178:179], v[162:163]
v_pk_mul_f32 v[180:181], v[180:181], v[162:163]
v_pk_mul_f32 v[182:183], v[182:183], v[162:163]
v_cvt_pk_bf16_f32 v188, v176, v177
v_cvt_pk_bf16_f32 v189, v178, v179
v_cvt_pk_bf16_f32 v190, v180, v181
v_cvt_pk_bf16_f32 v191, v182, v183
buffer_store_dwordx4 v[188:191], v242, s[44:47], s76 offen offset:1024 sc1
v_accvgpr_read_b32 v168, a16
v_accvgpr_read_b32 v169, a17
v_accvgpr_read_b32 v170, a18
v_accvgpr_read_b32 v171, a19
v_accvgpr_read_b32 v172, a20
v_accvgpr_read_b32 v173, a21
v_accvgpr_read_b32 v174, a22
v_accvgpr_read_b32 v175, a23
v_pk_mul_f32 v[168:169], v[168:169], v[162:163]
v_pk_mul_f32 v[170:171], v[170:171], v[162:163]
v_pk_mul_f32 v[172:173], v[172:173], v[162:163]
v_pk_mul_f32 v[174:175], v[174:175], v[162:163]
v_cvt_pk_bf16_f32 v184, v168, v169
v_cvt_pk_bf16_f32 v185, v170, v171
v_cvt_pk_bf16_f32 v186, v172, v173
v_cvt_pk_bf16_f32 v187, v174, v175
buffer_store_dwordx4 v[184:187], v242, s[44:47], s76 offen offset:2048 sc1
v_accvgpr_read_b32 v176, a24
v_accvgpr_read_b32 v177, a25
v_accvgpr_read_b32 v178, a26
v_accvgpr_read_b32 v179, a27
v_accvgpr_read_b32 v180, a28
v_accvgpr_read_b32 v181, a29
v_accvgpr_read_b32 v182, a30
v_accvgpr_read_b32 v183, a31
v_pk_mul_f32 v[176:177], v[176:177], v[162:163]
v_pk_mul_f32 v[178:179], v[178:179], v[162:163]
v_pk_mul_f32 v[180:181], v[180:181], v[162:163]
v_pk_mul_f32 v[182:183], v[182:183], v[162:163]
v_cvt_pk_bf16_f32 v188, v176, v177
v_cvt_pk_bf16_f32 v189, v178, v179
v_cvt_pk_bf16_f32 v190, v180, v181
v_cvt_pk_bf16_f32 v191, v182, v183
buffer_store_dwordx4 v[188:191], v242, s[44:47], s76 offen offset:3072 sc1
v_accvgpr_read_b32 v168, a32
v_accvgpr_read_b32 v169, a33
v_accvgpr_read_b32 v170, a34
v_accvgpr_read_b32 v171, a35
v_accvgpr_read_b32 v172, a36
v_accvgpr_read_b32 v173, a37
v_accvgpr_read_b32 v174, a38
v_accvgpr_read_b32 v175, a39
v_pk_mul_f32 v[168:169], v[168:169], v[164:165]
v_pk_mul_f32 v[170:171], v[170:171], v[164:165]
v_pk_mul_f32 v[172:173], v[172:173], v[164:165]
v_pk_mul_f32 v[174:175], v[174:175], v[164:165]
v_cvt_pk_bf16_f32 v184, v168, v169
v_cvt_pk_bf16_f32 v185, v170, v171
v_cvt_pk_bf16_f32 v186, v172, v173
v_cvt_pk_bf16_f32 v187, v174, v175
buffer_store_dwordx4 v[184:187], v242, s[44:47], s77 offen offset:0 sc1
v_accvgpr_read_b32 v176, a40
v_accvgpr_read_b32 v177, a41
v_accvgpr_read_b32 v178, a42
v_accvgpr_read_b32 v179, a43
v_accvgpr_read_b32 v180, a44
v_accvgpr_read_b32 v181, a45
v_accvgpr_read_b32 v182, a46
v_accvgpr_read_b32 v183, a47
v_pk_mul_f32 v[176:177], v[176:177], v[164:165]
v_pk_mul_f32 v[178:179], v[178:179], v[164:165]
v_pk_mul_f32 v[180:181], v[180:181], v[164:165]
v_pk_mul_f32 v[182:183], v[182:183], v[164:165]
v_cvt_pk_bf16_f32 v188, v176, v177
v_cvt_pk_bf16_f32 v189, v178, v179
v_cvt_pk_bf16_f32 v190, v180, v181
v_cvt_pk_bf16_f32 v191, v182, v183
buffer_store_dwordx4 v[188:191], v242, s[44:47], s77 offen offset:1024 sc1
v_accvgpr_read_b32 v168, a48
v_accvgpr_read_b32 v169, a49
v_accvgpr_read_b32 v170, a50
v_accvgpr_read_b32 v171, a51
v_accvgpr_read_b32 v172, a52
v_accvgpr_read_b32 v173, a53
v_accvgpr_read_b32 v174, a54
v_accvgpr_read_b32 v175, a55
v_pk_mul_f32 v[168:169], v[168:169], v[164:165]
v_pk_mul_f32 v[170:171], v[170:171], v[164:165]
v_pk_mul_f32 v[172:173], v[172:173], v[164:165]
v_pk_mul_f32 v[174:175], v[174:175], v[164:165]
v_cvt_pk_bf16_f32 v184, v168, v169
v_cvt_pk_bf16_f32 v185, v170, v171
v_cvt_pk_bf16_f32 v186, v172, v173
v_cvt_pk_bf16_f32 v187, v174, v175
buffer_store_dwordx4 v[184:187], v242, s[44:47], s77 offen offset:2048 sc1
v_accvgpr_read_b32 v176, a56
v_accvgpr_read_b32 v177, a57
v_accvgpr_read_b32 v178, a58
v_accvgpr_read_b32 v179, a59
v_accvgpr_read_b32 v180, a60
v_accvgpr_read_b32 v181, a61
v_accvgpr_read_b32 v182, a62
v_accvgpr_read_b32 v183, a63
v_pk_mul_f32 v[176:177], v[176:177], v[164:165]
v_pk_mul_f32 v[178:179], v[178:179], v[164:165]
v_pk_mul_f32 v[180:181], v[180:181], v[164:165]
v_pk_mul_f32 v[182:183], v[182:183], v[164:165]
v_cvt_pk_bf16_f32 v188, v176, v177
v_cvt_pk_bf16_f32 v189, v178, v179
v_cvt_pk_bf16_f32 v190, v180, v181
v_cvt_pk_bf16_f32 v191, v182, v183
buffer_store_dwordx4 v[188:191], v242, s[44:47], s77 offen offset:3072 sc1
s_add_u32 s17, s99, 1
s_and_b32 s17, s17, 3
s_lshl_b32 s17, s17, 13
s_add_u32 s17, s17, s16
buffer_store_dwordx4 v[224:227], v242, s[52:55], s17 offen offset:0 sc1
buffer_store_dwordx4 v[224:227], v242, s[52:55], s17 offen offset:1024 sc1
s_add_u32 s17, s99, 2
s_and_b32 s17, s17, 3
s_lshl_b32 s17, s17, 13
s_add_u32 s17, s17, s16
buffer_store_dwordx4 v[224:227], v242, s[52:55], s17 offen offset:0 sc1
buffer_store_dwordx4 v[224:227], v242, s[52:55], s17 offen offset:1024 sc1
s_add_u32 s17, s99, 3
s_and_b32 s17, s17, 3
s_lshl_b32 s17, s17, 13
s_add_u32 s17, s17, s16
buffer_store_dwordx4 v[224:227], v242, s[52:55], s17 offen offset:0 sc1
buffer_store_dwordx4 v[224:227], v242, s[52:55], s17 offen offset:1024 sc1
s_cmp_eq_u32 s58, 7
s_cbranch_scc1 L_z0
s_lshl_b32 s96, s58, 1
s_sub_u32 s96, 13, s96
.p2align 6
L_sloop:
s_waitcnt lgkmcnt(3)
v_mfma_f32_16x16x32_bf16 v[0:3], a[144:147], v[104:107], v[200:203]
s_waitcnt lgkmcnt(2)
v_exp_f32 v160, v32
v_mfma_f32_16x16x32_bf16 v[0:3], a[148:151], v[120:123], v[0:3]
ds_read_b128 a[168:171], v240 offset:6144
s_add_u32 m0, s66, s67
v_mfma_f32_16x16x32_bf16 v[0:3], a[152:155], v[136:139], v[0:3]
s_add_u32 s68, s68, 16384
v_exp_f32 v161, v33
v_mfma_f32_16x16x32_bf16 v[0:3], a[156:159], v[152:155], v[0:3]
ds_read_b128 a[172:175], v240 offset:7168
v_cvt_pk_bf16_f32 v80, v160, v161
v_mfma_f32_16x16x32_bf16 v[16:19], a[144:147], v[108:111], v[204:207]
v_exp_f32 v162, v34
v_mfma_f32_16x16x32_bf16 v[16:19], a[148:151], v[124:127], v[16:19]
buffer_load_dwordx4 v242, s[40:43], s65 offen offset:0 sc1 lds
ds_read_b128 a[176:179], v240 offset:8192
v_mfma_f32_16x16x32_bf16 v[16:19], a[152:155], v[140:143], v[16:19]
s_waitcnt lgkmcnt(3)
v_exp_f32 v163, v35
v_mfma_f32_16x16x32_bf16 v[16:19], a[156:159], v[156:159], v[16:19]
ds_read_b128 a[180:183], v240 offset:9216
v_cvt_pk_bf16_f32 v81, v162, v163
v_mfma_f32_16x16x32_bf16 v[4:7], a[160:163], v[104:107], v[200:203]
s_waitcnt lgkmcnt(2)
v_exp_f32 v164, v36
v_mfma_f32_16x16x32_bf16 v[4:7], a[164:167], v[120:123], v[4:7]
ds_read_b128 a[184:187], v240 offset:10240
s_and_b32 s68, s68, 0xffff
v_mfma_f32_16x16x32_bf16 v[4:7], a[168:171], v[136:139], v[4:7]
s_add_u32 s69, s68, 98304
v_exp_f32 v165, v37
v_mfma_f32_16x16x32_bf16 v[4:7], a[172:175], v[152:155], v[4:7]
ds_read_b128 a[188:191], v240 offset:11264
v_cvt_pk_bf16_f32 v82, v164, v165
v_mfma_f32_16x16x32_bf16 v[20:23], a[160:163], v[108:111], v[204:207]
v_exp_f32 v166, v38
v_mfma_f32_16x16x32_bf16 v[20:23], a[164:167], v[124:127], v[20:23]
buffer_load_dwordx4 v242, s[40:43], s65 offen offset:1024 sc1 lds
ds_read_b128 a[192:195], v240 offset:12288
v_mfma_f32_16x16x32_bf16 v[20:23], a[168:171], v[140:143], v[20:23]
s_waitcnt lgkmcnt(3)
v_exp_f32 v167, v39
v_mfma_f32_16x16x32_bf16 v[20:23], a[172:175], v[156:159], v[20:23]
ds_read_b128 a[196:199], v240 offset:13312
v_cvt_pk_bf16_f32 v83, v166, v167
v_mfma_f32_16x16x32_bf16 v[8:11], a[176:179], v[104:107], v[200:203]
s_waitcnt lgkmcnt(3)
v_exp_f32 v160, v40
v_mfma_f32_16x16x32_bf16 v[8:11], a[180:183], v[120:123], v[8:11]
ds_read_b128 a[200:203], v240 offset:14336
v_mfma_f32_16x16x32_bf16 v[8:11], a[184:187], v[136:139], v[8:11]
s_waitcnt lgkmcnt(3)
v_exp_f32 v161, v41
v_mfma_f32_16x16x32_bf16 v[8:11], a[188:191], v[152:155], v[8:11]
ds_read_b128 a[204:207], v240 offset:15360
v_cvt_pk_bf16_f32 v84, v160, v161
v_mfma_f32_16x16x32_bf16 v[24:27], a[176:179], v[108:111], v[204:207]
v_exp_f32 v162, v42
v_mfma_f32_16x16x32_bf16 v[24:27], a[180:183], v[124:127], v[24:27]
buffer_load_dwordx4 v242, s[40:43], s65 offen offset:2048 sc1 lds
ds_read_b128 a[144:147], v241 offset:0
v_mfma_f32_16x16x32_bf16 v[24:27], a[184:187], v[140:143], v[24:27]
s_waitcnt lgkmcnt(3)
v_exp_f32 v163, v43
v_mfma_f32_16x16x32_bf16 v[24:27], a[188:191], v[156:159], v[24:27]
ds_read_b128 a[148:151], v241 offset:8192
v_cvt_pk_bf16_f32 v85, v162, v163
v_mfma_f32_16x16x32_bf16 v[12:15], a[192:195], v[104:107], v[200:203]
s_waitcnt lgkmcnt(3)
v_exp_f32 v164, v44
v_mfma_f32_16x16x32_bf16 v[12:15], a[196:199], v[120:123], v[12:15]
ds_read_b128 a[152:155], v241 offset:1024
v_add_u32 v240, s69, v242
v_mfma_f32_16x16x32_bf16 v[12:15], a[200:203], v[136:139], v[12:15]
s_waitcnt lgkmcnt(3)
v_exp_f32 v165, v45
v_mfma_f32_16x16x32_bf16 v[12:15], a[204:207], v[152:155], v[12:15]
ds_read_b128 a[156:159], v241 offset:9216
v_cvt_pk_bf16_f32 v86, v164, v165
v_mfma_f32_16x16x32_bf16 v[28:31], a[192:195], v[108:111], v[204:207]
v_exp_f32 v166, v46
v_mfma_f32_16x16x32_bf16 v[28:31], a[196:199], v[124:127], v[28:31]
buffer_load_dwordx4 v242, s[40:43], s65 offen offset:3072 sc1 lds
ds_read_b128 a[160:163], v241 offset:2048
v_mfma_f32_16x16x32_bf16 v[28:31], a[200:203], v[140:143], v[28:31]
s_waitcnt lgkmcnt(3)
v_exp_f32 v167, v47
v_mfma_f32_16x16x32_bf16 v[28:31], a[204:207], v[156:159], v[28:31]
ds_read_b128 a[164:167], v241 offset:10240
v_cvt_pk_bf16_f32 v87, v166, v167
v_mfma_f32_16x16x32_bf16 a[64:67], a[144:147], v[64:67], a[64:67]
s_waitcnt lgkmcnt(3)
v_exp_f32 v160, v48
v_mfma_f32_16x16x32_bf16 a[64:67], a[148:151], v[68:71], a[64:67]
ds_read_b128 a[168:171], v241 offset:3072
s_add_u32 s65, s65, 16384
v_mfma_f32_16x16x32_bf16 a[96:99], a[144:147], v[72:75], a[96:99]
s_add_u32 m0, m0, 8192
v_exp_f32 v161, v49
v_mfma_f32_16x16x32_bf16 a[96:99], a[148:151], v[76:79], a[96:99]
ds_read_b128 a[172:175], v241 offset:11264
v_cvt_pk_bf16_f32 v88, v160, v161
v_mfma_f32_16x16x32_bf16 a[68:71], a[152:155], v[64:67], a[68:71]
s_waitcnt lgkmcnt(3)
v_exp_f32 v162, v50
v_mfma_f32_16x16x32_bf16 a[68:71], a[156:159], v[68:71], a[68:71]
buffer_load_dwordx4 v242, s[40:43], s65 offen offset:0 sc1 lds
ds_read_b128 a[176:179], v241 offset:4096
v_mfma_f32_16x16x32_bf16 a[100:103], a[152:155], v[72:75], a[100:103]
v_exp_f32 v163, v51
v_mfma_f32_16x16x32_bf16 a[100:103], a[156:159], v[76:79], a[100:103]
ds_read_b128 a[180:183], v241 offset:12288
v_cvt_pk_bf16_f32 v89, v162, v163
v_mfma_f32_16x16x32_bf16 a[72:75], a[160:163], v[64:67], a[72:75]
s_waitcnt lgkmcnt(3)
v_exp_f32 v164, v52
v_mfma_f32_16x16x32_bf16 a[72:75], a[164:167], v[68:71], a[72:75]
ds_read_b128 a[184:187], v241 offset:5120
s_add_u32 s67, s67, 16384
v_mfma_f32_16x16x32_bf16 a[104:107], a[160:163], v[72:75], a[104:107]
s_and_b32 s67, s67, 0xffff
v_exp_f32 v165, v53
v_mfma_f32_16x16x32_bf16 a[104:107], a[164:167], v[76:79], a[104:107]
ds_read_b128 a[188:191], v241 offset:13312
v_cvt_pk_bf16_f32 v90, v164, v165
v_mfma_f32_16x16x32_bf16 a[76:79], a[168:171], v[64:67], a[76:79]
s_waitcnt lgkmcnt(3)
v_exp_f32 v166, v54
v_mfma_f32_16x16x32_bf16 a[76:79], a[172:175], v[68:71], a[76:79]
buffer_load_dwordx4 v242, s[40:43], s65 offen offset:1024 sc1 lds
ds_read_b128 a[192:195], v241 offset:6144
v_mfma_f32_16x16x32_bf16 a[108:111], a[168:171], v[72:75], a[108:111]
v_exp_f32 v167, v55
v_mfma_f32_16x16x32_bf16 a[108:111], a[172:175], v[76:79], a[108:111]
ds_read_b128 a[196:199], v241 offset:14336
v_cvt_pk_bf16_f32 v91, v166, v167
v_mfma_f32_16x16x32_bf16 a[136:139], v[248:251], v[64:67], a[136:139]
s_waitcnt lgkmcnt(3)
v_exp_f32 v160, v56
v_mfma_f32_16x16x32_bf16 a[136:139], v[248:251], v[68:71], a[136:139]
ds_read_b128 a[200:203], v241 offset:7168
s_add_u32 s70, s70, 16384
v_mfma_f32_16x16x32_bf16 a[80:83], a[176:179], v[64:67], a[80:83]
s_and_b32 s70, s70, 0xffff
v_exp_f32 v161, v57
v_mfma_f32_16x16x32_bf16 a[80:83], a[180:183], v[68:71], a[80:83]
ds_read_b128 a[204:207], v241 offset:15360
v_cvt_pk_bf16_f32 v92, v160, v161
v_mfma_f32_16x16x32_bf16 a[112:115], a[176:179], v[72:75], a[112:115]
s_add_u32 s71, s70, 32768
v_exp_f32 v162, v58
v_mfma_f32_16x16x32_bf16 a[112:115], a[180:183], v[76:79], a[112:115]
buffer_load_dwordx4 v242, s[40:43], s65 offen offset:2048 sc1 lds
v_mfma_f32_16x16x32_bf16 a[84:87], a[184:187], v[64:67], a[84:87]
s_waitcnt lgkmcnt(2)
v_exp_f32 v163, v59
v_mfma_f32_16x16x32_bf16 a[84:87], a[188:191], v[68:71], a[84:87]
buffer_load_dwordx4 v242, s[40:43], s65 offen offset:3072 sc1 lds
v_mfma_f32_16x16x32_bf16 a[116:119], a[184:187], v[72:75], a[116:119]
v_exp_f32 v164, v60
v_mfma_f32_16x16x32_bf16 a[116:119], a[188:191], v[76:79], a[116:119]
s_waitcnt vmcnt(16) lgkmcnt(0)
s_barrier
v_cvt_pk_bf16_f32 v93, v162, v163
v_mfma_f32_16x16x32_bf16 a[88:91], a[192:195], v[64:67], a[88:91]
ds_read_b128 a[144:147], v240 offset:0
s_add_u32 s65, s65, 16384
v_mfma_f32_16x16x32_bf16 a[88:91], a[196:199], v[68:71], a[88:91]
ds_read_b128 a[148:151], v240 offset:1024
v_mfma_f32_16x16x32_bf16 a[120:123], a[192:195], v[72:75], a[120:123]
v_exp_f32 v165, v61
v_mfma_f32_16x16x32_bf16 a[120:123], a[196:199], v[76:79], a[120:123]
ds_read_b128 a[152:155], v240 offset:2048
v_cvt_pk_bf16_f32 v94, v164, v165
v_mfma_f32_16x16x32_bf16 a[92:95], a[200:203], v[64:67], a[92:95]
v_exp_f32 v166, v62
v_mfma_f32_16x16x32_bf16 a[92:95], a[204:207], v[68:71], a[92:95]
ds_read_b128 a[156:159], v240 offset:3072
v_add_u32 v241, s71, v242
v_mfma_f32_16x16x32_bf16 a[124:127], a[200:203], v[72:75], a[124:127]
v_exp_f32 v167, v63
v_mfma_f32_16x16x32_bf16 a[124:127], a[204:207], v[76:79], a[124:127]
ds_read_b128 a[160:163], v240 offset:4096
v_cvt_pk_bf16_f32 v95, v166, v167
v_mfma_f32_16x16x32_bf16 a[140:143], v[248:251], v[72:75], a[140:143]
ds_read_b128 a[164:167], v240 offset:5120
v_mfma_f32_16x16x32_bf16 a[140:143], v[248:251], v[76:79], a[140:143]
s_waitcnt lgkmcnt(3)
v_mfma_f32_16x16x32_bf16 v[32:35], a[144:147], v[104:107], v[200:203]
s_waitcnt lgkmcnt(2)
v_exp_f32 v160, v0
v_mfma_f32_16x16x32_bf16 v[32:35], a[148:151], v[120:123], v[32:35]
ds_read_b128 a[168:171], v240 offset:6144
s_add_u32 m0, s66, s67
v_mfma_f32_16x16x32_bf16 v[32:35], a[152:155], v[136:139], v[32:35]
s_add_u32 s68, s68, 16384
v_exp_f32 v161, v1
v_mfma_f32_16x16x32_bf16 v[32:35], a[156:159], v[152:155], v[32:35]
ds_read_b128 a[172:175], v240 offset:7168
v_cvt_pk_bf16_f32 v64, v160, v161
v_mfma_f32_16x16x32_bf16 v[48:51], a[144:147], v[108:111], v[204:207]
v_exp_f32 v162, v2
v_mfma_f32_16x16x32_bf16 v[48:51], a[148:151], v[124:127], v[48:51]
buffer_load_dwordx4 v242, s[40:43], s65 offen offset:0 sc1 lds
ds_read_b128 a[176:179], v240 offset:8192
v_mfma_f32_16x16x32_bf16 v[48:51], a[152:155], v[140:143], v[48:51]
s_waitcnt lgkmcnt(3)
v_exp_f32 v163, v3
v_mfma_f32_16x16x32_bf16 v[48:51], a[156:159], v[156:159], v[48:51]
ds_read_b128 a[180:183], v240 offset:9216
v_cvt_pk_bf16_f32 v65, v162, v163
v_mfma_f32_16x16x32_bf16 v[36:39], a[160:163], v[104:107], v[200:203]
s_waitcnt lgkmcnt(2)
v_exp_f32 v164, v4
v_mfma_f32_16x16x32_bf16 v[36:39], a[164:167], v[120:123], v[36:39]
ds_read_b128 a[184:187], v240 offset:10240
s_and_b32 s68, s68, 0xffff
v_mfma_f32_16x16x32_bf16 v[36:39], a[168:171], v[136:139], v[36:39]
s_add_u32 s69, s68, 98304
v_exp_f32 v165, v5
v_mfma_f32_16x16x32_bf16 v[36:39], a[172:175], v[152:155], v[36:39]
ds_read_b128 a[188:191], v240 offset:11264
v_cvt_pk_bf16_f32 v66, v164, v165
v_mfma_f32_16x16x32_bf16 v[52:55], a[160:163], v[108:111], v[204:207]
v_exp_f32 v166, v6
v_mfma_f32_16x16x32_bf16 v[52:55], a[164:167], v[124:127], v[52:55]
buffer_load_dwordx4 v242, s[40:43], s65 offen offset:1024 sc1 lds
ds_read_b128 a[192:195], v240 offset:12288
v_mfma_f32_16x16x32_bf16 v[52:55], a[168:171], v[140:143], v[52:55]
s_waitcnt lgkmcnt(3)
v_exp_f32 v167, v7
v_mfma_f32_16x16x32_bf16 v[52:55], a[172:175], v[156:159], v[52:55]
ds_read_b128 a[196:199], v240 offset:13312
v_cvt_pk_bf16_f32 v67, v166, v167
v_mfma_f32_16x16x32_bf16 v[40:43], a[176:179], v[104:107], v[200:203]
s_waitcnt lgkmcnt(3)
v_exp_f32 v160, v8
v_mfma_f32_16x16x32_bf16 v[40:43], a[180:183], v[120:123], v[40:43]
ds_read_b128 a[200:203], v240 offset:14336
v_mfma_f32_16x16x32_bf16 v[40:43], a[184:187], v[136:139], v[40:43]
s_waitcnt lgkmcnt(3)
v_exp_f32 v161, v9
v_mfma_f32_16x16x32_bf16 v[40:43], a[188:191], v[152:155], v[40:43]
ds_read_b128 a[204:207], v240 offset:15360
v_cvt_pk_bf16_f32 v68, v160, v161
v_mfma_f32_16x16x32_bf16 v[56:59], a[176:179], v[108:111], v[204:207]
v_exp_f32 v162, v10
v_mfma_f32_16x16x32_bf16 v[56:59], a[180:183], v[124:127], v[56:59]
buffer_load_dwordx4 v242, s[40:43], s65 offen offset:2048 sc1 lds
ds_read_b128 a[144:147], v241 offset:0
v_mfma_f32_16x16x32_bf16 v[56:59], a[184:187], v[140:143], v[56:59]
s_waitcnt lgkmcnt(3)
v_exp_f32 v163, v11
v_mfma_f32_16x16x32_bf16 v[56:59], a[188:191], v[156:159], v[56:59]
ds_read_b128 a[148:151], v241 offset:8192
v_cvt_pk_bf16_f32 v69, v162, v163
v_mfma_f32_16x16x32_bf16 v[44:47], a[192:195], v[104:107], v[200:203]
s_waitcnt lgkmcnt(3)
v_exp_f32 v164, v12
v_mfma_f32_16x16x32_bf16 v[44:47], a[196:199], v[120:123], v[44:47]
ds_read_b128 a[152:155], v241 offset:1024
v_add_u32 v240, s69, v242
v_mfma_f32_16x16x32_bf16 v[44:47], a[200:203], v[136:139], v[44:47]
s_waitcnt lgkmcnt(3)
v_exp_f32 v165, v13
v_mfma_f32_16x16x32_bf16 v[44:47], a[204:207], v[152:155], v[44:47]
ds_read_b128 a[156:159], v241 offset:9216
v_cvt_pk_bf16_f32 v70, v164, v165
v_mfma_f32_16x16x32_bf16 v[60:63], a[192:195], v[108:111], v[204:207]
v_exp_f32 v166, v14
v_mfma_f32_16x16x32_bf16 v[60:63], a[196:199], v[124:127], v[60:63]
buffer_load_dwordx4 v242, s[40:43], s65 offen offset:3072 sc1 lds
ds_read_b128 a[160:163], v241 offset:2048
v_mfma_f32_16x16x32_bf16 v[60:63], a[200:203], v[140:143], v[60:63]
s_waitcnt lgkmcnt(3)
v_exp_f32 v167, v15
v_mfma_f32_16x16x32_bf16 v[60:63], a[204:207], v[156:159], v[60:63]
ds_read_b128 a[164:167], v241 offset:10240
v_cvt_pk_bf16_f32 v71, v166, v167
v_mfma_f32_16x16x32_bf16 a[64:67], a[144:147], v[80:83], a[64:67]
s_waitcnt lgkmcnt(3)
v_exp_f32 v160, v16
v_mfma_f32_16x16x32_bf16 a[64:67], a[148:151], v[84:87], a[64:67]
ds_read_b128 a[168:171], v241 offset:3072
s_add_u32 s65, s65, 16384
v_mfma_f32_16x16x32_bf16 a[96:99], a[144:147], v[88:91], a[96:99]
s_add_u32 m0, m0, 8192
v_exp_f32 v161, v17
v_mfma_f32_16x16x32_bf16 a[96:99], a[148:151], v[92:95], a[96:99]
ds_read_b128 a[172:175], v241 offset:11264
v_cvt_pk_bf16_f32 v72, v160, v161
v_mfma_f32_16x16x32_bf16 a[68:71], a[152:155], v[80:83], a[68:71]
s_waitcnt lgkmcnt(3)
v_exp_f32 v162, v18
v_mfma_f32_16x16x32_bf16 a[68:71], a[156:159], v[84:87], a[68:71]
buffer_load_dwordx4 v242, s[40:43], s65 offen offset:0 sc1 lds
ds_read_b128 a[176:179], v241 offset:4096
v_mfma_f32_16x16x32_bf16 a[100:103], a[152:155], v[88:91], a[100:103]
v_exp_f32 v163, v19
v_mfma_f32_16x16x32_bf16 a[100:103], a[156:159], v[92:95], a[100:103]
ds_read_b128 a[180:183], v241 offset:12288
v_cvt_pk_bf16_f32 v73, v162, v163
v_mfma_f32_16x16x32_bf16 a[72:75], a[160:163], v[80:83], a[72:75]
s_waitcnt lgkmcnt(3)
v_exp_f32 v164, v20
v_mfma_f32_16x16x32_bf16 a[72:75], a[164:167], v[84:87], a[72:75]
ds_read_b128 a[184:187], v241 offset:5120
s_add_u32 s67, s67, 16384
v_mfma_f32_16x16x32_bf16 a[104:107], a[160:163], v[88:91], a[104:107]
s_and_b32 s67, s67, 0xffff
v_exp_f32 v165, v21
v_mfma_f32_16x16x32_bf16 a[104:107], a[164:167], v[92:95], a[104:107]
ds_read_b128 a[188:191], v241 offset:13312
v_cvt_pk_bf16_f32 v74, v164, v165
v_mfma_f32_16x16x32_bf16 a[76:79], a[168:171], v[80:83], a[76:79]
s_waitcnt lgkmcnt(3)
v_exp_f32 v166, v22
v_mfma_f32_16x16x32_bf16 a[76:79], a[172:175], v[84:87], a[76:79]
buffer_load_dwordx4 v242, s[40:43], s65 offen offset:1024 sc1 lds
ds_read_b128 a[192:195], v241 offset:6144
v_mfma_f32_16x16x32_bf16 a[108:111], a[168:171], v[88:91], a[108:111]
v_exp_f32 v167, v23
v_mfma_f32_16x16x32_bf16 a[108:111], a[172:175], v[92:95], a[108:111]
ds_read_b128 a[196:199], v241 offset:14336
v_cvt_pk_bf16_f32 v75, v166, v167
v_mfma_f32_16x16x32_bf16 a[136:139], v[248:251], v[80:83], a[136:139]
s_waitcnt lgkmcnt(3)
v_exp_f32 v160, v24
v_mfma_f32_16x16x32_bf16 a[136:139], v[248:251], v[84:87], a[136:139]
ds_read_b128 a[200:203], v241 offset:7168
s_add_u32 s70, s70, 16384
v_mfma_f32_16x16x32_bf16 a[80:83], a[176:179], v[80:83], a[80:83]
s_and_b32 s70, s70, 0xffff
v_exp_f32 v161, v25
v_mfma_f32_16x16x32_bf16 a[80:83], a[180:183], v[84:87], a[80:83]
ds_read_b128 a[204:207], v241 offset:15360
v_cvt_pk_bf16_f32 v76, v160, v161
v_mfma_f32_16x16x32_bf16 a[112:115], a[176:179], v[88:91], a[112:115]
s_add_u32 s71, s70, 32768
v_exp_f32 v162, v26
v_mfma_f32_16x16x32_bf16 a[112:115], a[180:183], v[92:95], a[112:115]
buffer_load_dwordx4 v242, s[40:43], s65 offen offset:2048 sc1 lds
v_mfma_f32_16x16x32_bf16 a[84:87], a[184:187], v[80:83], a[84:87]
s_waitcnt lgkmcnt(2)
v_exp_f32 v163, v27
v_mfma_f32_16x16x32_bf16 a[84:87], a[188:191], v[84:87], a[84:87]
buffer_load_dwordx4 v242, s[40:43], s65 offen offset:3072 sc1 lds
v_mfma_f32_16x16x32_bf16 a[116:119], a[184:187], v[88:91], a[116:119]
s_waitcnt lgkmcnt(1)
v_exp_f32 v164, v28
v_mfma_f32_16x16x32_bf16 a[116:119], a[188:191], v[92:95], a[116:119]
s_waitcnt vmcnt(16) lgkmcnt(0)
s_barrier
v_cvt_pk_bf16_f32 v77, v162, v163
v_mfma_f32_16x16x32_bf16 a[88:91], a[192:195], v[80:83], a[88:91]
ds_read_b128 a[144:147], v240 offset:0
s_add_u32 s65, s65, 16384
v_mfma_f32_16x16x32_bf16 a[88:91], a[196:199], v[84:87], a[88:91]
ds_read_b128 a[148:151], v240 offset:1024
v_mfma_f32_16x16x32_bf16 a[120:123], a[192:195], v[88:91], a[120:123]
s_sub_u32 s96, s96, 1
v_exp_f32 v165, v29
v_mfma_f32_16x16x32_bf16 a[120:123], a[196:199], v[92:95], a[120:123]
ds_read_b128 a[152:155], v240 offset:2048
v_cvt_pk_bf16_f32 v78, v164, v165
v_mfma_f32_16x16x32_bf16 a[92:95], a[200:203], v[80:83], a[92:95]
v_exp_f32 v166, v30
v_mfma_f32_16x16x32_bf16 a[92:95], a[204:207], v[84:87], a[92:95]
ds_read_b128 a[156:159], v240 offset:3072
v_add_u32 v241, s71, v242
v_mfma_f32_16x16x32_bf16 a[124:127], a[200:203], v[88:91], a[124:127]
v_exp_f32 v167, v31
v_mfma_f32_16x16x32_bf16 a[124:127], a[204:207], v[92:95], a[124:127]
ds_read_b128 a[160:163], v240 offset:4096
v_cvt_pk_bf16_f32 v79, v166, v167
v_mfma_f32_16x16x32_bf16 a[140:143], v[248:251], v[88:91], a[140:143]
ds_read_b128 a[164:167], v240 offset:5120
s_cmp_lg_u32 s96, 0
v_mfma_f32_16x16x32_bf16 a[140:143], v[248:251], v[92:95], a[140:143]
s_cbranch_scc1 L_sloop
L_n0:
s_waitcnt lgkmcnt(1)
s_cmp_ge_u32 s56, 2
s_cbranch_scc0 L_alt12_1
v_mfma_f32_16x16x32_bf16 v[0:3], a[144:147], v[104:107], v[200:203]
v_mfma_f32_16x16x32_bf16 v[4:7], a[160:163], v[104:107], v[200:203]
L_ret12:
ds_read_b128 a[168:171], v240 offset:6144
s_add_u32 m0, s66, s67
v_mfma_f32_16x16x32_bf16 v[16:19], a[144:147], v[108:111], v[204:207]
ds_read_b128 a[172:175], v240 offset:7168
s_add_u32 s68, s68, 16384
v_mfma_f32_16x16x32_bf16 v[16:19], a[148:151], v[124:127], v[16:19]
ds_read_b128 a[176:179], v240 offset:8192
v_mfma_f32_16x16x32_bf16 v[16:19], a[152:155], v[140:143], v[16:19]
ds_read_b128 a[180:183], v240 offset:9216
v_mfma_f32_16x16x32_bf16 v[16:19], a[156:159], v[156:159], v[16:19]
ds_read_b128 a[184:187], v240 offset:10240
s_and_b32 s68, s68, 0xffff
v_mfma_f32_16x16x32_bf16 v[0:3], a[148:151], v[120:123], v[0:3]
ds_read_b128 a[188:191], v240 offset:11264
v_exp_f32 v160, v32
v_mfma_f32_16x16x32_bf16 v[0:3], a[152:155], v[136:139], v[0:3]
ds_read_b128 a[192:195], v240 offset:12288
v_exp_f32 v161, v33
v_mfma_f32_16x16x32_bf16 v[0:3], a[156:159], v[152:155], v[0:3]
buffer_load_dwordx4 v242, s[40:43], s65 offen offset:0 sc1 lds
v_mfma_f32_16x16x32_bf16 v[20:23], a[160:163], v[108:111], v[204:207]
s_waitcnt lgkmcnt(5)
v_exp_f32 v162, v34
v_mfma_f32_16x16x32_bf16 v[20:23], a[164:167], v[124:127], v[20:23]
s_add_u32 s69, s68, 98304
v_exp_f32 v163, v35
v_mfma_f32_16x16x32_bf16 v[20:23], a[168:171], v[140:143], v[20:23]
ds_read_b128 a[196:199], v240 offset:13312
v_cvt_pk_bf16_f32 v80, v160, v161
v_mfma_f32_16x16x32_bf16 v[20:23], a[172:175], v[156:159], v[20:23]
buffer_load_dwordx4 v242, s[40:43], s65 offen offset:1024 sc1 lds
v_mfma_f32_16x16x32_bf16 v[4:7], a[164:167], v[120:123], v[4:7]
ds_read_b128 a[200:203], v240 offset:14336
v_exp_f32 v164, v36
v_mfma_f32_16x16x32_bf16 v[4:7], a[168:171], v[136:139], v[4:7]
ds_read_b128 a[204:207], v240 offset:15360
s_add_u32 s70, s70, 16384
v_mfma_f32_16x16x32_bf16 v[4:7], a[172:175], v[152:155], v[4:7]
s_waitcnt lgkmcnt(3)
ds_read_b128 a[144:147], v241 offset:0
s_cmp_eq_u32 s56, 3
s_cbranch_scc0 L_alt13_1
v_mfma_f32_16x16x32_bf16 v[8:11], a[176:179], v[104:107], v[200:203]
v_mfma_f32_16x16x32_bf16 v[12:15], a[192:195], v[104:107], v[216:219]
L_ret13:
ds_read_b128 a[148:151], v241 offset:8192
v_exp_f32 v165, v37
v_cvt_pk_bf16_f32 v81, v162, v163
v_mfma_f32_16x16x32_bf16 v[24:27], a[176:179], v[108:111], v[204:207]
buffer_load_dwordx4 v242, s[40:43], s65 offen offset:2048 sc1 lds
v_mfma_f32_16x16x32_bf16 v[24:27], a[180:183], v[124:127], v[24:27]
ds_read_b128 a[152:155], v241 offset:1024
v_exp_f32 v166, v38
v_mfma_f32_16x16x32_bf16 v[24:27], a[184:187], v[140:143], v[24:27]
s_and_b32 s70, s70, 0xffff
v_exp_f32 v167, v39
v_mfma_f32_16x16x32_bf16 v[24:27], a[188:191], v[156:159], v[24:27]
ds_read_b128 a[156:159], v241 offset:9216
v_cvt_pk_bf16_f32 v82, v164, v165
v_mfma_f32_16x16x32_bf16 v[8:11], a[180:183], v[120:123], v[8:11]
v_exp_f32 v160, v40
v_mfma_f32_16x16x32_bf16 v[8:11], a[184:187], v[136:139], v[8:11]
buffer_load_dwordx4 v242, s[40:43], s65 offen offset:3072 sc1 lds
v_mfma_f32_16x16x32_bf16 v[8:11], a[188:191], v[152:155], v[8:11]
s_add_u32 s65, s65, 16384
v_exp_f32 v161, v41
v_mfma_f32_16x16x32_bf16 v[28:31], a[192:195], v[108:111], v[204:207]
s_waitcnt lgkmcnt(2)
ds_read_b128 a[160:163], v241 offset:2048
v_cvt_pk_bf16_f32 v83, v166, v167
v_mfma_f32_16x16x32_bf16 v[28:31], a[196:199], v[124:127], v[28:31]
s_add_u32 s67, s67, 8192
v_exp_f32 v162, v42
v_mfma_f32_16x16x32_bf16 v[28:31], a[200:203], v[140:143], v[28:31]
ds_read_b128 a[164:167], v241 offset:10240
s_and_b32 s67, s67, 0xffff
v_mfma_f32_16x16x32_bf16 v[28:31], a[204:207], v[156:159], v[28:31]
s_add_u32 m0, s66, s67
v_exp_f32 v163, v43
v_mfma_f32_16x16x32_bf16 v[12:15], a[196:199], v[120:123], v[12:15]
ds_read_b128 a[168:171], v241 offset:3072
v_cvt_pk_bf16_f32 v84, v160, v161
v_mfma_f32_16x16x32_bf16 v[12:15], a[200:203], v[136:139], v[12:15]
s_add_u32 s71, s70, 32768
v_exp_f32 v164, v44
v_mfma_f32_16x16x32_bf16 v[12:15], a[204:207], v[152:155], v[12:15]
ds_read_b128 a[172:175], v241 offset:11264
v_exp_f32 v165, v45
v_mfma_f32_16x16x32_bf16 a[64:67], a[144:147], v[64:67], a[64:67]
buffer_load_dwordx4 v242, s[40:43], s65 offen offset:0 sc1 lds
v_mfma_f32_16x16x32_bf16 a[64:67], a[148:151], v[68:71], a[64:67]
ds_read_b128 a[176:179], v241 offset:4096
v_cvt_pk_bf16_f32 v85, v162, v163
v_mfma_f32_16x16x32_bf16 a[96:99], a[144:147], v[72:75], a[96:99]
v_exp_f32 v166, v46
v_mfma_f32_16x16x32_bf16 a[96:99], a[148:151], v[76:79], a[96:99]
s_waitcnt lgkmcnt(3)
v_exp_f32 v167, v47
v_mfma_f32_16x16x32_bf16 a[68:71], a[152:155], v[64:67], a[68:71]
buffer_load_dwordx4 v242, s[40:43], s65 offen offset:1024 sc1 lds
v_mfma_f32_16x16x32_bf16 a[68:71], a[156:159], v[68:71], a[68:71]
ds_read_b128 a[180:183], v241 offset:12288
v_cvt_pk_bf16_f32 v86, v164, v165
v_mfma_f32_16x16x32_bf16 a[100:103], a[152:155], v[72:75], a[100:103]
v_exp_f32 v160, v48
v_mfma_f32_16x16x32_bf16 a[100:103], a[156:159], v[76:79], a[100:103]
v_exp_f32 v161, v49
v_mfma_f32_16x16x32_bf16 a[72:75], a[160:163], v[64:67], a[72:75]
ds_read_b128 a[184:187], v241 offset:5120
v_cvt_pk_bf16_f32 v87, v166, v167
v_mfma_f32_16x16x32_bf16 a[72:75], a[164:167], v[68:71], a[72:75]
ds_read_b128 a[188:191], v241 offset:13312
v_mfma_f32_16x16x32_bf16 a[104:107], a[160:163], v[72:75], a[104:107]
v_exp_f32 v162, v50
v_mfma_f32_16x16x32_bf16 a[104:107], a[164:167], v[76:79], a[104:107]
s_waitcnt lgkmcnt(3)
v_exp_f32 v163, v51
v_mfma_f32_16x16x32_bf16 a[76:79], a[168:171], v[64:67], a[76:79]
buffer_load_dwordx4 v242, s[40:43], s65 offen offset:2048 sc1 lds
v_mfma_f32_16x16x32_bf16 a[76:79], a[172:175], v[68:71], a[76:79]
ds_read_b128 a[192:195], v241 offset:6144
v_cvt_pk_bf16_f32 v88, v160, v161
v_mfma_f32_16x16x32_bf16 a[108:111], a[168:171], v[72:75], a[108:111]
ds_read_b128 a[196:199], v241 offset:14336
v_exp_f32 v164, v52
v_mfma_f32_16x16x32_bf16 a[108:111], a[172:175], v[76:79], a[108:111]
buffer_load_dwordx4 v242, s[40:43], s65 offen offset:3072 sc1 lds
v_mfma_f32_16x16x32_bf16 a[136:139], v[248:251], v[64:67], a[136:139]
ds_read_b128 a[200:203], v241 offset:7168
ds_read_b128 a[204:207], v241 offset:15360
v_mfma_f32_16x16x32_bf16 a[136:139], v[248:251], v[68:71], a[136:139]
s_add_u32 s65, s65, 16384
v_exp_f32 v165, v53
v_cvt_pk_bf16_f32 v89, v162, v163
v_mfma_f32_16x16x32_bf16 a[80:83], a[176:179], v[64:67], a[80:83]
s_waitcnt lgkmcnt(4)
v_exp_f32 v166, v54
v_mfma_f32_16x16x32_bf16 a[80:83], a[180:183], v[68:71], a[80:83]
s_add_u32 s67, s67, 8192
v_exp_f32 v167, v55
v_mfma_f32_16x16x32_bf16 a[112:115], a[176:179], v[72:75], a[112:115]
s_and_b32 s67, s67, 0xffff
v_cvt_pk_bf16_f32 v90, v164, v165
v_add_u32 v240, s69, v242
v_mfma_f32_16x16x32_bf16 a[112:115], a[180:183], v[76:79], a[112:115]
v_exp_f32 v160, v56
v_mfma_f32_16x16x32_bf16 a[84:87], a[184:187], v[64:67], a[84:87]
s_waitcnt vmcnt(16) lgkmcnt(0)
s_barrier
v_mfma_f32_16x16x32_bf16 a[84:87], a[188:191], v[68:71], a[84:87]
v_exp_f32 v161, v57
v_mfma_f32_16x16x32_bf16 a[116:119], a[184:187], v[72:75], a[116:119]
ds_read_b128 a[144:147], v240 offset:0
v_cvt_pk_bf16_f32 v91, v166, v167
v_mfma_f32_16x16x32_bf16 a[116:119], a[188:191], v[76:79], a[116:119]
v_exp_f32 v162, v58
v_mfma_f32_16x16x32_bf16 a[88:91], a[192:195], v[64:67], a[88:91]
v_exp_f32 v163, v59
v_mfma_f32_16x16x32_bf16 a[88:91], a[196:199], v[68:71], a[88:91]
ds_read_b128 a[148:151], v240 offset:1024
v_cvt_pk_bf16_f32 v92, v160, v161
v_mfma_f32_16x16x32_bf16 a[120:123], a[192:195], v[72:75], a[120:123]
v_exp_f32 v164, v60
v_mfma_f32_16x16x32_bf16 a[120:123], a[196:199], v[76:79], a[120:123]
ds_read_b128 a[152:155], v240 offset:2048
v_mfma_f32_16x16x32_bf16 a[92:95], a[200:203], v[64:67], a[92:95]
v_exp_f32 v165, v61
v_mfma_f32_16x16x32_bf16 a[92:95], a[204:207], v[68:71], a[92:95]
ds_read_b128 a[156:159], v240 offset:3072
v_cvt_pk_bf16_f32 v93, v162, v163
v_mfma_f32_16x16x32_bf16 a[124:127], a[200:203], v[72:75], a[124:127]
ds_read_b128 a[160:163], v240 offset:4096
v_mfma_f32_16x16x32_bf16 a[124:127], a[204:207], v[76:79], a[124:127]
v_exp_f32 v166, v62
v_mfma_f32_16x16x32_bf16 a[140:143], v[248:251], v[72:75], a[140:143]
buffer_load_dword v236, v238, s[48:51], s19 offen sc1
v_mfma_f32_16x16x32_bf16 a[140:143], v[248:251], v[76:79], a[140:143]
ds_read_b128 a[164:167], v240 offset:5120
v_exp_f32 v167, v63
v_cvt_pk_bf16_f32 v94, v164, v165
v_cvt_pk_bf16_f32 v95, v166, v167
v_add_u32 v241, s71, v242
s_waitcnt lgkmcnt(1)
s_cmp_ge_u32 s56, 2
s_cbranch_scc0 L_alt14_1
v_mfma_f32_16x16x32_bf16 v[48:51], a[144:147], v[108:111], v[204:207]
v_mfma_f32_16x16x32_bf16 v[52:55], a[160:163], v[108:111], v[204:207]
L_ret14:
ds_read_b128 a[168:171], v240 offset:6144
ds_read_b128 a[172:175], v240 offset:7168
ds_read_b128 a[176:179], v240 offset:8192
ds_read_b128 a[180:183], v240 offset:9216
ds_read_b128 a[184:187], v240 offset:10240
ds_read_b128 a[188:191], v240 offset:11264
ds_read_b128 a[192:195], v240 offset:12288
v_mfma_f32_16x16x32_bf16 v[48:51], a[148:151], v[124:127], v[48:51]
ds_read_b128 a[196:199], v240 offset:13312
s_add_u32 s68, s68, 16384
v_mfma_f32_16x16x32_bf16 v[48:51], a[152:155], v[140:143], v[48:51]
ds_read_b128 a[200:203], v240 offset:14336
v_mfma_f32_16x16x32_bf16 v[48:51], a[156:159], v[156:159], v[48:51]
s_waitcnt lgkmcnt(9)
ds_read_b128 a[204:207], v240 offset:15360
v_mfma_f32_16x16x32_bf16 v[52:55], a[164:167], v[124:127], v[52:55]
ds_read_b128 a[144:147], v241 offset:0
s_waitcnt lgkmcnt(10)
v_mfma_f32_16x16x32_bf16 v[52:55], a[168:171], v[140:143], v[52:55]
s_waitcnt lgkmcnt(9)
v_exp_f32 v160, v0
v_mfma_f32_16x16x32_bf16 v[52:55], a[172:175], v[156:159], v[52:55]
s_waitcnt lgkmcnt(4)
ds_read_b128 a[148:151], v241 offset:8192
s_cmp_eq_u32 s56, 3
s_cbranch_scc0 L_alt15_1
v_mfma_f32_16x16x32_bf16 v[56:59], a[176:179], v[108:111], v[204:207]
v_mfma_f32_16x16x32_bf16 v[60:63], a[192:195], v[108:111], v[220:223]
L_ret15:
s_and_b32 s68, s68, 0xffff
v_exp_f32 v161, v1
v_mfma_f32_16x16x32_bf16 v[56:59], a[180:183], v[124:127], v[56:59]
ds_read_b128 a[152:155], v241 offset:1024
s_add_u32 s69, s68, 98304
v_mfma_f32_16x16x32_bf16 v[56:59], a[184:187], v[140:143], v[56:59]
ds_read_b128 a[156:159], v241 offset:9216
v_exp_f32 v162, v2
v_mfma_f32_16x16x32_bf16 v[56:59], a[188:191], v[156:159], v[56:59]
s_waitcnt lgkmcnt(4)
ds_read_b128 a[160:163], v241 offset:2048
v_mfma_f32_16x16x32_bf16 v[60:63], a[196:199], v[124:127], v[60:63]
ds_read_b128 a[164:167], v241 offset:10240
v_exp_f32 v163, v3
v_cvt_pk_bf16_f32 v64, v160, v161
v_mfma_f32_16x16x32_bf16 v[60:63], a[200:203], v[140:143], v[60:63]
s_add_u32 s70, s70, 16384
v_exp_f32 v164, v4
v_mfma_f32_16x16x32_bf16 v[60:63], a[204:207], v[156:159], v[60:63]
s_waitcnt lgkmcnt(4)
v_exp_f32 v165, v5
v_cvt_pk_bf16_f32 v65, v162, v163
v_mfma_f32_16x16x32_bf16 a[64:67], a[144:147], v[80:83], a[64:67]
ds_read_b128 a[168:171], v241 offset:3072
v_exp_f32 v166, v6
v_mfma_f32_16x16x32_bf16 a[64:67], a[148:151], v[84:87], a[64:67]
ds_read_b128 a[172:175], v241 offset:11264
v_exp_f32 v167, v7
v_cvt_pk_bf16_f32 v66, v164, v165
v_mfma_f32_16x16x32_bf16 a[96:99], a[144:147], v[88:91], a[96:99]
s_and_b32 s70, s70, 0xffff
v_exp_f32 v160, v8
v_mfma_f32_16x16x32_bf16 a[96:99], a[148:151], v[92:95], a[96:99]
s_waitcnt lgkmcnt(3)
v_exp_f32 v161, v9
v_mfma_f32_16x16x32_bf16 a[68:71], a[152:155], v[80:83], a[68:71]
ds_read_b128 a[176:179], v241 offset:4096
v_cvt_pk_bf16_f32 v67, v166, v167
v_mfma_f32_16x16x32_bf16 a[68:71], a[156:159], v[84:87], a[68:71]
ds_read_b128 a[180:183], v241 offset:12288
v_exp_f32 v162, v10
v_mfma_f32_16x16x32_bf16 a[100:103], a[152:155], v[88:91], a[100:103]
v_exp_f32 v163, v11
v_mfma_f32_16x16x32_bf16 a[100:103], a[156:159], v[92:95], a[100:103]
ds_read_b128 a[184:187], v241 offset:5120
v_cvt_pk_bf16_f32 v68, v160, v161
v_mfma_f32_16x16x32_bf16 a[72:75], a[160:163], v[80:83], a[72:75]
s_waitcnt lgkmcnt(3)
v_exp_f32 v164, v12
v_mfma_f32_16x16x32_bf16 a[72:75], a[164:167], v[84:87], a[72:75]
s_add_u32 s71, s70, 32768
v_exp_f32 v165, v13
v_mfma_f32_16x16x32_bf16 a[104:107], a[160:163], v[88:91], a[104:107]
ds_read_b128 a[188:191], v241 offset:13312
v_cvt_pk_bf16_f32 v69, v162, v163
v_mfma_f32_16x16x32_bf16 a[104:107], a[164:167], v[92:95], a[104:107]
v_exp_f32 v166, v14
v_mfma_f32_16x16x32_bf16 a[76:79], a[168:171], v[80:83], a[76:79]
ds_read_b128 a[192:195], v241 offset:6144
v_exp_f32 v167, v15
v_mfma_f32_16x16x32_bf16 a[76:79], a[172:175], v[84:87], a[76:79]
ds_read_b128 a[196:199], v241 offset:14336
v_cvt_pk_bf16_f32 v70, v164, v165
v_mfma_f32_16x16x32_bf16 a[108:111], a[168:171], v[88:91], a[108:111]
v_exp_f32 v160, v16
v_mfma_f32_16x16x32_bf16 a[108:111], a[172:175], v[92:95], a[108:111]
v_exp_f32 v161, v17
v_mfma_f32_16x16x32_bf16 a[136:139], v[248:251], v[80:83], a[136:139]
ds_read_b128 a[200:203], v241 offset:7168
ds_read_b128 a[204:207], v241 offset:15360
v_mfma_f32_16x16x32_bf16 a[136:139], v[248:251], v[84:87], a[136:139]
s_waitcnt lgkmcnt(4)
v_cvt_pk_bf16_f32 v71, v166, v167
v_exp_f32 v162, v18
v_mfma_f32_16x16x32_bf16 a[80:83], a[176:179], v[80:83], a[80:83]
v_exp_f32 v163, v19
v_mfma_f32_16x16x32_bf16 a[80:83], a[180:183], v[84:87], a[80:83]
v_cvt_pk_bf16_f32 v72, v160, v161
v_add_u32 v240, s69, v242
v_mfma_f32_16x16x32_bf16 a[112:115], a[176:179], v[88:91], a[112:115]
v_exp_f32 v164, v20
v_mfma_f32_16x16x32_bf16 a[112:115], a[180:183], v[92:95], a[112:115]
v_exp_f32 v165, v21
v_mfma_f32_16x16x32_bf16 a[84:87], a[184:187], v[80:83], a[84:87]
s_waitcnt vmcnt(0) lgkmcnt(0)
s_barrier
v_cvt_pk_bf16_f32 v73, v162, v163
v_mfma_f32_16x16x32_bf16 a[84:87], a[188:191], v[84:87], a[84:87]
v_exp_f32 v166, v22
v_mfma_f32_16x16x32_bf16 a[116:119], a[184:187], v[88:91], a[116:119]
v_exp_f32 v167, v23
v_add_u32 v241, s71, v242
v_mfma_f32_16x16x32_bf16 a[116:119], a[188:191], v[92:95], a[116:119]
ds_read_b128 a[144:147], v241 offset:0
v_cvt_pk_bf16_f32 v74, v164, v165
v_mfma_f32_16x16x32_bf16 a[88:91], a[192:195], v[80:83], a[88:91]
v_exp_f32 v160, v24
v_mfma_f32_16x16x32_bf16 a[88:91], a[196:199], v[84:87], a[88:91]
v_exp_f32 v161, v25
v_mfma_f32_16x16x32_bf16 a[120:123], a[192:195], v[88:91], a[120:123]
ds_read_b128 a[148:151], v241 offset:8192
v_cvt_pk_bf16_f32 v75, v166, v167
v_mfma_f32_16x16x32_bf16 a[120:123], a[196:199], v[92:95], a[120:123]
v_exp_f32 v162, v26
v_mfma_f32_16x16x32_bf16 a[92:95], a[200:203], v[80:83], a[92:95]
ds_read_b128 a[152:155], v241 offset:1024
v_mfma_f32_16x16x32_bf16 a[92:95], a[204:207], v[84:87], a[92:95]
v_exp_f32 v163, v27
v_mfma_f32_16x16x32_bf16 a[124:127], a[200:203], v[88:91], a[124:127]
ds_read_b128 a[156:159], v241 offset:9216
v_cvt_pk_bf16_f32 v76, v160, v161
v_mfma_f32_16x16x32_bf16 a[124:127], a[204:207], v[92:95], a[124:127]
ds_read_b128 a[160:163], v241 offset:2048
v_exp_f32 v164, v28
v_mfma_f32_16x16x32_bf16 a[140:143], v[248:251], v[88:91], a[140:143]
v_exp_f32 v165, v29
v_mfma_f32_16x16x32_bf16 a[140:143], v[248:251], v[92:95], a[140:143]
ds_read_b128 a[164:167], v241 offset:10240
v_cvt_pk_bf16_f32 v77, v162, v163
v_exp_f32 v166, v30
v_exp_f32 v167, v31
v_cvt_pk_bf16_f32 v78, v164, v165
v_cvt_pk_bf16_f32 v79, v166, v167
L_z1:
s_waitcnt lgkmcnt(4)
v_mfma_f32_16x16x32_bf16 a[64:67], a[144:147], v[64:67], a[64:67]
ds_read_b128 a[168:171], v241 offset:3072
s_mov_b32 s32, s20
v_mfma_f32_16x16x32_bf16 a[64:67], a[148:151], v[68:71], a[64:67]
ds_read_b128 a[172:175], v241 offset:11264
s_mov_b32 s33, s21
v_mfma_f32_16x16x32_bf16 a[96:99], a[144:147], v[72:75], a[96:99]
ds_read_b128 a[176:179], v241 offset:4096
s_mov_b32 s34, 1835008
v_mfma_f32_16x16x32_bf16 a[96:99], a[148:151], v[76:79], a[96:99]
s_waitcnt lgkmcnt(5)
v_exp_f32 v160, v48
v_mfma_f32_16x16x32_bf16 a[68:71], a[152:155], v[64:67], a[68:71]
s_mov_b32 s35, 0x20000
ds_read_b128 a[180:183], v241 offset:12288
v_mfma_f32_16x16x32_bf16 a[68:71], a[156:159], v[68:71], a[68:71]
s_add_u32 s70, s70, 16384
s_mov_b32 s38, 7340032
s_lshr_b32 s17, s101, 2
v_mfma_f32_16x16x32_bf16 a[100:103], a[152:155], v[72:75], a[100:103]
s_lshl_b32 s17, s17, 3
v_exp_f32 v161, v49
v_mfma_f32_16x16x32_bf16 a[100:103], a[156:159], v[76:79], a[100:103]
s_waitcnt lgkmcnt(3)
s_lshl_b32 s18, s56, 1
s_add_u32 s17, s17, s18
s_mul_i32 s17, s17, 57344
v_add_u32 v224, s17, v242
v_mfma_f32_16x16x32_bf16 a[72:75], a[160:163], v[64:67], a[72:75]
s_and_b32 s70, s70, 0xffff
v_exp_f32 v162, v50
v_add_u32 v225, 57344, v224
v_mfma_f32_16x16x32_bf16 a[72:75], a[164:167], v[68:71], a[72:75]
ds_read_b128 a[184:187], v241 offset:5120
s_mul_i32 s17, s99, 14336
s_and_b32 s10, s101, 3
s_lshl_b32 s10, s10, 7
s_and_b32 s18, s56, 1
v_mfma_f32_16x16x32_bf16 a[104:107], a[160:163], v[72:75], a[104:107]
ds_read_b128 a[188:191], v241 offset:13312
s_lshl_b32 s18, s18, 9
s_add_u32 s10, s10, s18
s_lshr_b32 s18, s56, 1
v_mfma_f32_16x16x32_bf16 a[104:107], a[164:167], v[76:79], a[104:107]
s_lshl_b32 s18, s18, 15
v_exp_f32 v163, v51
s_add_u32 s10, s10, s18
s_mul_i32 s16, s99, 458752
v_cvt_pk_bf16_f32 v88, v160, v161
s_add_u32 s16, s16, s10
v_mfma_f32_16x16x32_bf16 a[76:79], a[168:171], v[64:67], a[76:79]
s_waitcnt lgkmcnt(2)
s_lshl_b32 s11, s56, 12
v_lshrrev_b32 v232, 3, v243
v_mfma_f32_16x16x32_bf16 a[76:79], a[172:175], v[68:71], a[76:79]
s_add_u32 s71, s70, 32768
v_exp_f32 v164, v52
v_lshlrev_b32 v233, 10, v232
v_and_b32 v234, 1, v243
v_mfma_f32_16x16x32_bf16 a[108:111], a[168:171], v[72:75], a[108:111]
ds_read_b128 a[192:195], v241 offset:6144
v_lshl_add_u32 v233, v234, 4, v233
v_lshrrev_b32 v232, 1, v232
v_mfma_f32_16x16x32_bf16 a[108:111], a[172:175], v[76:79], a[108:111]
ds_read_b128 a[196:199], v241 offset:14336
v_bfe_u32 v234, v243, 1, 2
v_mfma_f32_16x16x32_bf16 a[136:139], v[248:251], v[64:67], a[136:139]
ds_read_b128 a[200:203], v241 offset:7168
v_exp_f32 v165, v53
v_xor_b32 v232, v232, v234
v_cvt_pk_bf16_f32 v89, v162, v163
v_lshl_add_u32 v228, v232, 5, v233
v_mfma_f32_16x16x32_bf16 a[136:139], v[248:251], v[68:71], a[136:139]
ds_read_b128 a[204:207], v241 offset:15360
v_exp_f32 v166, v54
v_add_u32 v229, 7168, v228
v_add_u32 v230, 14336, v228
v_mfma_f32_16x16x32_bf16 a[80:83], a[176:179], v[64:67], a[80:83]
v_add_u32 v231, 21504, v228
v_exp_f32 v167, v55
v_mfma_f32_16x16x32_bf16 a[80:83], a[180:183], v[68:71], a[80:83]
v_cvt_pk_bf16_f32 v90, v164, v165
v_mfma_f32_16x16x32_bf16 a[112:115], a[176:179], v[72:75], a[112:115]
v_exp_f32 v160, v56
v_mfma_f32_16x16x32_bf16 a[112:115], a[180:183], v[76:79], a[112:115]
s_waitcnt lgkmcnt(3)
v_exp_f32 v161, v57
v_mfma_f32_16x16x32_bf16 a[84:87], a[184:187], v[64:67], a[84:87]
v_cvt_pk_bf16_f32 v91, v166, v167
v_mfma_f32_16x16x32_bf16 a[84:87], a[188:191], v[68:71], a[84:87]
v_exp_f32 v162, v58
v_mfma_f32_16x16x32_bf16 a[116:119], a[184:187], v[72:75], a[116:119]
v_exp_f32 v163, v59
v_mfma_f32_16x16x32_bf16 a[116:119], a[188:191], v[76:79], a[116:119]
v_cvt_pk_bf16_f32 v92, v160, v161
v_mfma_f32_16x16x32_bf16 a[88:91], a[192:195], v[64:67], a[88:91]
s_waitcnt lgkmcnt(0)
v_exp_f32 v164, v60
s_waitcnt vmcnt(14)
v_readfirstlane_b32 s18, v236
s_nop 2
s_cmp_ge_u32 s18, 32
s_cbranch_scc0 L_spin20
L_got20:
s_add_u32 m0, s11, 0
s_add_u32 s18, s16, 0
s_add_u32 s98, s17, 0
v_mfma_f32_16x16x32_bf16 a[88:91], a[196:199], v[68:71], a[88:91]
buffer_load_dwordx4 v228, s[32:35], s18 offen offset:0 lds
v_mfma_f32_16x16x32_bf16 a[120:123], a[192:195], v[72:75], a[120:123]
buffer_load_dwordx4 a[0:3], v224, s[36:39], s98 offen offset:0 sc1
v_mfma_f32_16x16x32_bf16 a[120:123], a[196:199], v[76:79], a[120:123]
buffer_load_dwordx4 v229, s[32:35], s18 offen offset:1024 lds
v_mfma_f32_16x16x32_bf16 a[92:95], a[200:203], v[64:67], a[92:95]
buffer_load_dwordx4 a[4:7], v225, s[36:39], s98 offen offset:0 sc1
v_mfma_f32_16x16x32_bf16 a[92:95], a[204:207], v[68:71], a[92:95]
buffer_load_dwordx4 v230, s[32:35], s18 offen offset:2048 lds
v_mfma_f32_16x16x32_bf16 a[124:127], a[200:203], v[72:75], a[124:127]
buffer_load_dwordx4 a[8:11], v224, s[36:39], s98 offen offset:1024 sc1
v_mfma_f32_16x16x32_bf16 a[124:127], a[204:207], v[76:79], a[124:127]
buffer_load_dwordx4 v231, s[32:35], s18 offen offset:3072 lds
v_mfma_f32_16x16x32_bf16 a[140:143], v[248:251], v[72:75], a[140:143]
buffer_load_dwordx4 a[12:15], v225, s[36:39], s98 offen offset:1024 sc1
s_add_u32 m0, s11, 16384
s_add_u32 s18, s16, 65536
s_add_u32 s98, s17, 2048
v_mfma_f32_16x16x32_bf16 a[140:143], v[248:251], v[76:79], a[140:143]
buffer_load_dwordx4 v228, s[32:35], s18 offen offset:0 lds
buffer_load_dwordx4 a[16:19], v224, s[36:39], s98 offen offset:0 sc1
buffer_load_dwordx4 v229, s[32:35], s18 offen offset:1024 lds
v_exp_f32 v165, v61
v_cvt_pk_bf16_f32 v93, v162, v163
buffer_load_dwordx4 a[20:23], v225, s[36:39], s98 offen offset:0 sc1
v_exp_f32 v166, v62
buffer_load_dwordx4 v230, s[32:35], s18 offen offset:2048 lds
v_exp_f32 v167, v63
buffer_load_dwordx4 a[24:27], v224, s[36:39], s98 offen offset:1024 sc1
buffer_load_dwordx4 v231, s[32:35], s18 offen offset:3072 lds
v_cvt_pk_bf16_f32 v94, v164, v165
v_cvt_pk_bf16_f32 v95, v166, v167
buffer_load_dwordx4 a[28:31], v225, s[36:39], s98 offen offset:1024 sc1
v_add_u32 v241, s71, v242
ds_read_b128 a[144:147], v241 offset:0
ds_read_b128 a[148:151], v241 offset:8192
ds_read_b128 a[152:155], v241 offset:1024
ds_read_b128 a[156:159], v241 offset:9216
ds_read_b128 a[160:163], v241 offset:2048
ds_read_b128 a[164:167], v241 offset:10240
ds_read_b128 a[168:171], v241 offset:3072
ds_read_b128 a[172:175], v241 offset:11264
s_nop 1
v_accvgpr_read_b32 v160, a136
v_rcp_f32 v162, v160
v_cmp_nle_f32 vcc, s74, v160
v_cmp_nge_f32 s[8:9], s75, v160
v_mov_b32 v163, v162
s_nop 1
s_or_b64 s[72:73], s[72:73], vcc
s_or_b64 s[72:73], s[72:73], s[8:9]
v_accvgpr_read_b32 v168, a64
v_accvgpr_read_b32 v169, a65
v_accvgpr_read_b32 v170, a66
v_accvgpr_read_b32 v171, a67
v_accvgpr_read_b32 v172, a68
v_accvgpr_read_b32 v173, a69
v_accvgpr_read_b32 v174, a70
v_accvgpr_read_b32 v175, a71
v_pk_mul_f32 v[168:169], v[168:169], v[162:163]
v_pk_mul_f32 v[170:171], v[170:171], v[162:163]
v_pk_mul_f32 v[172:173], v[172:173], v[162:163]
v_pk_mul_f32 v[174:175], v[174:175], v[162:163]
v_cvt_pk_bf16_f32 v184, v168, v169
v_cvt_pk_bf16_f32 v185, v170, v171
v_cvt_pk_bf16_f32 v186, v172, v173
v_cvt_pk_bf16_f32 v187, v174, v175
buffer_store_dwordx4 v[184:187], v242, s[44:47], s78 offen offset:0 sc1
v_accvgpr_read_b32 v176, a72
v_accvgpr_read_b32 v177, a73
v_accvgpr_read_b32 v178, a74
v_accvgpr_read_b32 v179, a75
v_accvgpr_read_b32 v180, a76
v_accvgpr_read_b32 v181, a77
v_accvgpr_read_b32 v182, a78
v_accvgpr_read_b32 v183, a79
v_pk_mul_f32 v[176:177], v[176:177], v[162:163]
v_pk_mul_f32 v[178:179], v[178:179], v[162:163]
v_pk_mul_f32 v[180:181], v[180:181], v[162:163]
v_pk_mul_f32 v[182:183], v[182:183], v[162:163]
v_cvt_pk_bf16_f32 v188, v176, v177
v_cvt_pk_bf16_f32 v189, v178, v179
v_cvt_pk_bf16_f32 v190, v180, v181
v_cvt_pk_bf16_f32 v191, v182, v183
buffer_store_dwordx4 v[188:191], v242, s[44:47], s78 offen offset:1024 sc1
v_accvgpr_read_b32 v168, a80
v_accvgpr_read_b32 v169, a81
v_accvgpr_read_b32 v170, a82
v_accvgpr_read_b32 v171, a83
v_accvgpr_read_b32 v172, a84
v_accvgpr_read_b32 v173, a85
v_accvgpr_read_b32 v174, a86
v_accvgpr_read_b32 v175, a87
v_pk_mul_f32 v[168:169], v[168:169], v[162:163]
v_pk_mul_f32 v[170:171], v[170:171], v[162:163]
v_pk_mul_f32 v[172:173], v[172:173], v[162:163]
v_pk_mul_f32 v[174:175], v[174:175], v[162:163]
v_cvt_pk_bf16_f32 v184, v168, v169
v_cvt_pk_bf16_f32 v185, v170, v171
v_cvt_pk_bf16_f32 v186, v172, v173
v_cvt_pk_bf16_f32 v187, v174, v175
buffer_store_dwordx4 v[184:187], v242, s[44:47], s78 offen offset:2048 sc1
v_accvgpr_read_b32 v176, a88
v_accvgpr_read_b32 v177, a89
v_accvgpr_read_b32 v178, a90
v_accvgpr_read_b32 v179, a91
v_accvgpr_read_b32 v180, a92
v_accvgpr_read_b32 v181, a93
v_accvgpr_read_b32 v182, a94
v_accvgpr_read_b32 v183, a95
v_pk_mul_f32 v[176:177], v[176:177], v[162:163]
v_pk_mul_f32 v[178:179], v[178:179], v[162:163]
v_pk_mul_f32 v[180:181], v[180:181], v[162:163]
v_pk_mul_f32 v[182:183], v[182:183], v[162:163]
v_cvt_pk_bf16_f32 v188, v176, v177
v_cvt_pk_bf16_f32 v189, v178, v179
v_cvt_pk_bf16_f32 v190, v180, v181
v_cvt_pk_bf16_f32 v191, v182, v183
buffer_store_dwordx4 v[188:191], v242, s[44:47], s78 offen offset:3072 sc1
s_waitcnt lgkmcnt(7)
v_mfma_f32_16x16x32_bf16 a[96:99], a[144:147], v[88:91], a[96:99]
ds_read_b128 a[176:179], v241 offset:4096
s_waitcnt lgkmcnt(7)
v_mfma_f32_16x16x32_bf16 a[96:99], a[148:151], v[92:95], a[96:99]
ds_read_b128 a[180:183], v241 offset:12288
s_waitcnt lgkmcnt(7)
v_mfma_f32_16x16x32_bf16 a[100:103], a[152:155], v[88:91], a[100:103]
ds_read_b128 a[184:187], v241 offset:5120
s_waitcnt lgkmcnt(7)
v_mfma_f32_16x16x32_bf16 a[100:103], a[156:159], v[92:95], a[100:103]
ds_read_b128 a[188:191], v241 offset:13312
s_waitcnt lgkmcnt(7)
v_mfma_f32_16x16x32_bf16 a[104:107], a[160:163], v[88:91], a[104:107]
s_waitcnt lgkmcnt(6)
ds_read_b128 a[192:195], v241 offset:6144
v_mfma_f32_16x16x32_bf16 a[104:107], a[164:167], v[92:95], a[104:107]
s_waitcnt lgkmcnt(6)
ds_read_b128 a[196:199], v241 offset:14336
v_mfma_f32_16x16x32_bf16 a[108:111], a[168:171], v[88:91], a[108:111]
s_waitcnt lgkmcnt(6)
ds_read_b128 a[200:203], v241 offset:7168
v_mfma_f32_16x16x32_bf16 a[108:111], a[172:175], v[92:95], a[108:111]
s_waitcnt lgkmcnt(6)
ds_read_b128 a[204:207], v241 offset:15360
v_mfma_f32_16x16x32_bf16 a[112:115], a[176:179], v[88:91], a[112:115]
s_waitcnt lgkmcnt(6)
s_getpc_b64 s[96:97]
L_pc3:
s_add_u32 s96, s96, L_k3-L_pc3
s_addc_u32 s97, s97, 0
s_lshl_b32 s18, s59, 13
v_lshl_add_u32 v237, v243, 7, s18
v_min_u32 v237, L_end-L_k3, v237
v_mfma_f32_16x16x32_bf16 a[112:115], a[180:183], v[92:95], a[112:115]
s_waitcnt lgkmcnt(5)
global_load_dword v236, v237, s[96:97]
s_mov_b32 s28, s14
s_mov_b32 s29, s15
s_mov_b32 s30, 4194304
s_mov_b32 s31, 0x20000
v_mfma_f32_16x16x32_bf16 a[116:119], a[184:187], v[88:91], a[116:119]
s_waitcnt lgkmcnt(4)
s_lshl_b32 s3, s99, 20
s_add_u32 s10, s10, s3
s_lshl_b32 s3, s56, 2
s_add_u32 s3, s3, 147456
v_mfma_f32_16x16x32_bf16 a[116:119], a[188:191], v[92:95], a[116:119]
s_waitcnt lgkmcnt(3)
v_mov_b32 v2, s3
v_mov_b32 v3, 147456
v_mfma_f32_16x16x32_bf16 a[120:123], a[192:195], v[88:91], a[120:123]
s_waitcnt lgkmcnt(2)
v_lshrrev_b32 v4, 5, v243
v_lshlrev_b32 v4, 10, v4
v_mfma_f32_16x16x32_bf16 a[120:123], a[196:199], v[92:95], a[120:123]
s_waitcnt lgkmcnt(1)
v_bfe_u32 v5, v243, 2, 3
v_lshl_add_u32 v4, v5, 7, v4
v_mfma_f32_16x16x32_bf16 a[124:127], a[200:203], v[88:91], a[124:127]
s_waitcnt lgkmcnt(0)
v_and_b32 v6, 3, v243
v_lshl_add_u32 v4, v6, 3, v4
v_mfma_f32_16x16x32_bf16 a[124:127], a[204:207], v[92:95], a[124:127]
v_lshrrev_b32 v5, 1, v5
v_xor_b32 v6, 0, v5
v_mfma_f32_16x16x32_bf16 a[140:143], v[248:251], v[88:91], a[140:143]
v_lshl_add_u32 v232, v6, 5, v4
v_xor_b32 v6, 1, v5
v_mfma_f32_16x16x32_bf16 a[140:143], v[248:251], v[92:95], a[140:143]
v_lshl_add_u32 v233, v6, 5, v4
v_xor_b32 v6, 2, v5
v_lshl_add_u32 v234, v6, 5, v4
v_xor_b32 v6, 3, v5
v_lshl_add_u32 v235, v6, 5, v4
s_nop 7
v_accvgpr_read_b32 v160, a140
v_rcp_f32 v162, v160
v_cmp_nle_f32 vcc, s74, v160
v_cmp_nge_f32 s[8:9], s75, v160
v_mov_b32 v163, v162
s_nop 1
s_or_b64 s[72:73], s[72:73], vcc
s_or_b64 s[72:73], s[72:73], s[8:9]
s_cmp_lg_u64 s[72:73], 0
s_cselect_b32 s3, 1, 0
v_mov_b32 v1, s3
s_waitcnt vmcnt(21) lgkmcnt(0)
s_barrier
ds_write_b32 v2, v1
v_accvgpr_read_b32 v168, a96
v_accvgpr_read_b32 v169, a97
v_accvgpr_read_b32 v170, a98
v_accvgpr_read_b32 v171, a99
v_accvgpr_read_b32 v172, a100
v_accvgpr_read_b32 v173, a101
v_accvgpr_read_b32 v174, a102
v_accvgpr_read_b32 v175, a103
v_pk_mul_f32 v[168:169], v[168:169], v[162:163]
v_pk_mul_f32 v[170:171], v[170:171], v[162:163]
v_pk_mul_f32 v[172:173], v[172:173], v[162:163]
v_pk_mul_f32 v[174:175], v[174:175], v[162:163]
v_cvt_pk_bf16_f32 v184, v168, v169
v_cvt_pk_bf16_f32 v185, v170, v171
v_cvt_pk_bf16_f32 v186, v172, v173
v_cvt_pk_bf16_f32 v187, v174, v175
buffer_store_dwordx4 v[184:187], v242, s[44:47], s79 offen offset:0 sc1
v_accvgpr_read_b32 v176, a104
v_accvgpr_read_b32 v177, a105
v_accvgpr_read_b32 v178, a106
v_accvgpr_read_b32 v179, a107
v_accvgpr_read_b32 v180, a108
v_accvgpr_read_b32 v181, a109
v_accvgpr_read_b32 v182, a110
v_accvgpr_read_b32 v183, a111
v_pk_mul_f32 v[176:177], v[176:177], v[162:163]
v_pk_mul_f32 v[178:179], v[178:179], v[162:163]
v_pk_mul_f32 v[180:181], v[180:181], v[162:163]
v_pk_mul_f32 v[182:183], v[182:183], v[162:163]
v_cvt_pk_bf16_f32 v188, v176, v177
v_cvt_pk_bf16_f32 v189, v178, v179
v_cvt_pk_bf16_f32 v190, v180, v181
v_cvt_pk_bf16_f32 v191, v182, v183
buffer_store_dwordx4 v[188:191], v242, s[44:47], s79 offen offset:1024 sc1
v_accvgpr_read_b32 v168, a112
v_accvgpr_read_b32 v169, a113
v_accvgpr_read_b32 v170, a114
v_accvgpr_read_b32 v171, a115
v_accvgpr_read_b32 v172, a116
v_accvgpr_read_b32 v173, a117
v_accvgpr_read_b32 v174, a118
v_accvgpr_read_b32 v175, a119
v_pk_mul_f32 v[168:169], v[168:169], v[162:163]
v_pk_mul_f32 v[170:171], v[170:171], v[162:163]
v_pk_mul_f32 v[172:173], v[172:173], v[162:163]
v_pk_mul_f32 v[174:175], v[174:175], v[162:163]
v_cvt_pk_bf16_f32 v184, v168, v169
v_cvt_pk_bf16_f32 v185, v170, v171
v_cvt_pk_bf16_f32 v186, v172, v173
v_cvt_pk_bf16_f32 v187, v174, v175
buffer_store_dwordx4 v[184:187], v242, s[44:47], s79 offen offset:2048 sc1
v_accvgpr_read_b32 v176, a120
v_accvgpr_read_b32 v177, a121
v_accvgpr_read_b32 v178, a122
v_accvgpr_read_b32 v179, a123
v_accvgpr_read_b32 v180, a124
v_accvgpr_read_b32 v181, a125
v_accvgpr_read_b32 v182, a126
v_accvgpr_read_b32 v183, a127
v_pk_mul_f32 v[176:177], v[176:177], v[162:163]
v_pk_mul_f32 v[178:179], v[178:179], v[162:163]
v_pk_mul_f32 v[180:181], v[180:181], v[162:163]
v_pk_mul_f32 v[182:183], v[182:183], v[162:163]
v_cvt_pk_bf16_f32 v188, v176, v177
v_cvt_pk_bf16_f32 v189, v178, v179
v_cvt_pk_bf16_f32 v190, v180, v181
v_cvt_pk_bf16_f32 v191, v182, v183
buffer_store_dwordx4 v[188:191], v242, s[44:47], s79 offen offset:3072 sc1
s_waitcnt vmcnt(9)
s_waitcnt lgkmcnt(0)
s_barrier
ds_read_b128 v[4:7], v3
s_waitcnt lgkmcnt(0)
v_or_b32 v4, v4, v5
v_or_b32 v6, v6, v7
v_or_b32 v4, v4, v6
s_nop 0
v_readfirstlane_b32 s3, v4
s_nop 3
s_cmp_gt_u32 s3, s7
s_cbranch_scc1 L_fallback
L_k3:
ds_read_b64_tr_b16 v[128:129], v232 offset:0
ds_read_b64_tr_b16 v[130:131], v232 offset:2048
ds_read_b64_tr_b16 v[132:133], v232 offset:8192
ds_read_b64_tr_b16 v[134:135], v232 offset:10240
ds_read_b64_tr_b16 v[136:137], v233 offset:0
ds_read_b64_tr_b16 v[138:139], v233 offset:2048
ds_read_b64_tr_b16 v[140:141], v233 offset:8192
ds_read_b64_tr_b16 v[142:143], v233 offset:10240
ds_read_b64_tr_b16 v[144:145], v234 offset:0
ds_read_b64_tr_b16 v[146:147], v234 offset:2048
ds_read_b64_tr_b16 v[148:149], v234 offset:8192
ds_read_b64_tr_b16 v[150:151], v234 offset:10240
ds_read_b64_tr_b16 v[152:153], v235 offset:0
ds_read_b64_tr_b16 v[154:155], v235 offset:2048
ds_read_b64_tr_b16 v[156:157], v235 offset:8192
ds_read_b64_tr_b16 v[158:159], v235 offset:10240
s_waitcnt lgkmcnt(14)
v_mfma_f32_16x16x32_bf16 v[64:67], v[128:131], a[0:3], 0
s_add_u32 m0, s11, 32768
s_lshr_b32 s3, s57, 3
s_waitcnt lgkmcnt(12)
v_mfma_f32_16x16x32_bf16 v[64:67], v[132:135], a[8:11], v[64:67]
s_add_u32 s18, s16, 131072
s_add_u32 s98, s17, 4096
s_lshl_b32 s67, s58, 2
v_mfma_f32_16x16x32_bf16 v[96:99], v[128:131], a[4:7], 0
buffer_load_dwordx4 v228, s[32:35], s18 offen offset:0 lds
v_mfma_f32_16x16x32_bf16 v[96:99], v[132:135], a[12:15], v[96:99]
ds_read_b64_tr_b16 v[160:161], v232 offset:4096
s_waitcnt lgkmcnt(11)
v_mfma_f32_16x16x32_bf16 v[68:71], v[136:139], a[0:3], 0
s_waitcnt lgkmcnt(9)
ds_read_b64_tr_b16 v[162:163], v232 offset:6144
v_mfma_f32_16x16x32_bf16 v[68:71], v[140:143], a[8:11], v[68:71]
s_sub_u32 s68, 60, s67
ds_read_b64_tr_b16 v[164:165], v232 offset:12288
v_mfma_f32_16x16x32_bf16 v[100:103], v[136:139], a[4:7], 0
buffer_load_dwordx4 a[32:35], v224, s[36:39], s98 offen offset:0 sc1
v_mfma_f32_16x16x32_bf16 v[100:103], v[140:143], a[12:15], v[100:103]
s_waitcnt lgkmcnt(3)
ds_read_b64_tr_b16 v[166:167], v232 offset:14336
s_add_u32 s3, s3, 56
v_mfma_f32_16x16x32_bf16 v[72:75], v[144:147], a[0:3], 0
buffer_load_dwordx4 v229, s[32:35], s18 offen offset:1024 lds
s_add_u32 s67, s67, s3
v_mfma_f32_16x16x32_bf16 v[72:75], v[148:151], a[8:11], v[72:75]
ds_read_b64_tr_b16 v[168:169], v233 offset:4096
s_add_u32 s68, s68, s3
v_mfma_f32_16x16x32_bf16 v[104:107], v[144:147], a[4:7], 0
ds_read_b64_tr_b16 v[170:171], v233 offset:6144
s_lshl_b32 s67, s67, 7
v_mfma_f32_16x16x32_bf16 v[104:107], v[148:151], a[12:15], v[104:107]
buffer_load_dwordx4 a[36:39], v225, s[36:39], s98 offen offset:0 sc1
v_mfma_f32_16x16x32_bf16 v[76:79], v[152:155], a[0:3], 0
ds_read_b64_tr_b16 v[172:173], v233 offset:12288
s_lshl_b32 s68, s68, 7
v_mfma_f32_16x16x32_bf16 v[76:79], v[156:159], a[8:11], v[76:79]
ds_read_b64_tr_b16 v[174:175], v233 offset:14336
s_add_u32 s66, s101, 120
v_mfma_f32_16x16x32_bf16 v[108:111], v[152:155], a[4:7], 0
buffer_load_dwordx4 v230, s[32:35], s18 offen offset:2048 lds
v_mfma_f32_16x16x32_bf16 v[108:111], v[156:159], a[12:15], v[108:111]
s_waitcnt lgkmcnt(4)
ds_read_b64_tr_b16 v[128:129], v234 offset:4096
s_lshl_b32 s66, s66, 7
v_mfma_f32_16x16x32_bf16 v[80:83], v[160:163], a[0:3], 0
buffer_load_dwordx4 a[40:43], v224, s[36:39], s98 offen offset:1024 sc1
v_add_u32 v248, 0x10000, v232
v_mfma_f32_16x16x32_bf16 v[80:83], v[164:167], a[8:11], v[80:83]
ds_read_b64_tr_b16 v[130:131], v234 offset:6144
ds_read_b64_tr_b16 v[132:133], v234 offset:12288
v_add_u32 v249, 0x10000, v233
v_mfma_f32_16x16x32_bf16 v[112:115], v[160:163], a[4:7], 0
ds_read_b64_tr_b16 v[134:135], v234 offset:14336
buffer_load_dwordx4 v231, s[32:35], s18 offen offset:3072 lds
v_add_u32 v250, 0x10000, v234
v_mfma_f32_16x16x32_bf16 v[112:115], v[164:167], a[12:15], v[112:115]
s_waitcnt lgkmcnt(5)
ds_read_b64_tr_b16 v[136:137], v235 offset:4096
v_mfma_f32_16x16x32_bf16 v[84:87], v[168:171], a[0:3], 0
s_waitcnt lgkmcnt(5)
ds_read_b64_tr_b16 v[138:139], v235 offset:6144
buffer_load_dwordx4 a[44:47], v225, s[36:39], s98 offen offset:1024 sc1
s_add_u32 m0, s11, 49152
s_add_u32 s18, s16, 196608
s_add_u32 s98, s17, 6144
v_mfma_f32_16x16x32_bf16 v[84:87], v[172:175], a[8:11], v[84:87]
ds_read_b64_tr_b16 v[140:141], v235 offset:12288
v_add_u32 v251, 0x10000, v235
v_mfma_f32_16x16x32_bf16 v[116:119], v[168:171], a[4:7], 0
ds_read_b64_tr_b16 v[142:143], v235 offset:14336
ds_read_b64_tr_b16 v[144:145], v232 offset:16384
v_mfma_f32_16x16x32_bf16 v[116:119], v[172:175], a[12:15], v[116:119]
s_waitcnt lgkmcnt(7)
ds_read_b64_tr_b16 v[146:147], v232 offset:18432
buffer_load_dwordx4 v228, s[32:35], s18 offen offset:0 lds
v_mfma_f32_16x16x32_bf16 v[88:91], v[128:131], a[0:3], 0
s_waitcnt lgkmcnt(6)
ds_read_b64_tr_b16 v[148:149], v232 offset:24576
v_mfma_f32_16x16x32_bf16 v[88:91], v[132:135], a[8:11], v[88:91]
buffer_load_dwordx4 a[48:51], v224, s[36:39], s98 offen offset:0 sc1
v_mfma_f32_16x16x32_bf16 v[120:123], v[128:131], a[4:7], 0
ds_read_b64_tr_b16 v[150:151], v232 offset:26624
s_lshr_b32 s75, s101, 2
v_mfma_f32_16x16x32_bf16 v[120:123], v[132:135], a[12:15], v[120:123]
s_waitcnt lgkmcnt(6)
ds_read_b64_tr_b16 v[152:153], v233 offset:16384
buffer_load_dwordx4 v229, s[32:35], s18 offen offset:1024 lds
v_mfma_f32_16x16x32_bf16 v[92:95], v[136:139], a[0:3], 0
s_waitcnt lgkmcnt(5)
ds_read_b64_tr_b16 v[154:155], v233 offset:18432
buffer_load_dwordx4 a[52:55], v225, s[36:39], s98 offen offset:0 sc1
s_and_b32 s75, s75, 7
v_mfma_f32_16x16x32_bf16 v[92:95], v[140:143], a[8:11], v[92:95]
ds_read_b64_tr_b16 v[156:157], v233 offset:24576
s_add_u32 s75, s75, s101
v_mfma_f32_16x16x32_bf16 v[124:127], v[136:139], a[4:7], 0
ds_read_b64_tr_b16 v[158:159], v233 offset:26624
s_and_b32 s75, s75, 7
buffer_load_dwordx4 v230, s[32:35], s18 offen offset:2048 lds
v_mfma_f32_16x16x32_bf16 v[124:127], v[140:143], a[12:15], v[124:127]
s_waitcnt lgkmcnt(5)
ds_read_b64_tr_b16 v[160:161], v234 offset:16384
v_mfma_f32_16x16x32_bf16 v[64:67], v[144:147], a[16:19], v[64:67]
s_waitcnt lgkmcnt(5)
ds_read_b64_tr_b16 v[162:163], v234 offset:18432
buffer_load_dwordx4 a[56:59], v224, s[36:39], s98 offen offset:1024 sc1
s_and_b32 s69, s101, 0x3c
v_mfma_f32_16x16x32_bf16 v[64:67], v[148:151], a[24:27], v[64:67]
ds_read_b64_tr_b16 v[164:165], v234 offset:24576
s_add_u32 s69, s69, s99
v_mfma_f32_16x16x32_bf16 v[96:99], v[144:147], a[20:23], v[96:99]
buffer_load_dwordx4 v231, s[32:35], s18 offen offset:3072 lds
ds_read_b64_tr_b16 v[166:167], v234 offset:26624
s_add_u32 s69, s69, 56
s_lshl_b32 s69, s69, 7
v_mfma_f32_16x16x32_bf16 v[96:99], v[148:151], a[28:31], v[96:99]
s_waitcnt lgkmcnt(6)
ds_read_b64_tr_b16 v[168:169], v235 offset:16384
buffer_load_dwordx4 a[60:63], v225, s[36:39], s98 offen offset:1024 sc1
s_add_u32 m0, s11, 65536
s_add_u32 s18, s16, 262144
s_add_u32 s98, s17, 8192
s_lshr_b32 s70, s101, 2
v_mfma_f32_16x16x32_bf16 v[68:71], v[152:155], a[16:19], v[68:71]
s_waitcnt lgkmcnt(5)
ds_read_b64_tr_b16 v[170:171], v235 offset:18432
s_lshl_b32 s70, s70, 3
s_lshl_b32 s3, s56, 1
v_mfma_f32_16x16x32_bf16 v[68:71], v[156:159], a[24:27], v[68:71]
ds_read_b64_tr_b16 v[172:173], v235 offset:24576
s_add_u32 s3, s3, s70
s_lshl_b32 s3, s3, 17
v_mfma_f32_16x16x32_bf16 v[100:103], v[152:155], a[20:23], v[100:103]
ds_read_b64_tr_b16 v[174:175], v235 offset:26624
buffer_load_dwordx4 v228, s[32:35], s18 offen offset:0 lds
v_add_u32 v252, s3, v242
v_mfma_f32_16x16x32_bf16 v[100:103], v[156:159], a[28:31], v[100:103]
s_waitcnt lgkmcnt(6)
ds_read_b64_tr_b16 v[128:129], v232 offset:20480
v_add_u32 v253, 0x20000, v252
v_mfma_f32_16x16x32_bf16 v[72:75], v[160:163], a[16:19], v[72:75]
s_waitcnt lgkmcnt(5)
ds_read_b64_tr_b16 v[130:131], v232 offset:22528
buffer_load_dwordx4 a[64:67], v224, s[36:39], s98 offen offset:0 sc1
s_lshl_b32 s12, s99, 15
v_mfma_f32_16x16x32_bf16 v[72:75], v[164:167], a[24:27], v[72:75]
ds_read_b64_tr_b16 v[132:133], v232 offset:28672
s_add_u32 s73, s58, 48
v_mfma_f32_16x16x32_bf16 v[104:107], v[160:163], a[20:23], v[104:107]
buffer_load_dwordx4 v229, s[32:35], s18 offen offset:1024 lds
ds_read_b64_tr_b16 v[134:135], v232 offset:30720
s_lshl_b32 s73, s73, 7
s_lshl_b32 s3, s101, 17
v_mfma_f32_16x16x32_bf16 v[104:107], v[164:167], a[28:31], v[104:107]
s_waitcnt lgkmcnt(6)
ds_read_b64_tr_b16 v[136:137], v233 offset:20480
s_add_u32 s3, s3, 60817408
v_mfma_f32_16x16x32_bf16 v[76:79], v[168:171], a[16:19], v[76:79]
s_waitcnt lgkmcnt(5)
ds_read_b64_tr_b16 v[138:139], v233 offset:22528
buffer_load_dwordx4 a[68:71], v225, s[36:39], s98 offen offset:0 sc1
v_mfma_f32_16x16x32_bf16 v[76:79], v[172:175], a[24:27], v[76:79]
buffer_load_dwordx4 v230, s[32:35], s18 offen offset:2048 lds
ds_read_b64_tr_b16 v[140:141], v233 offset:28672
v_mfma_f32_16x16x32_bf16 v[108:111], v[168:171], a[20:23], v[108:111]
ds_read_b64_tr_b16 v[142:143], v233 offset:30720
s_add_u32 s40, s26, s3
s_addc_u32 s41, s27, 0
s_mov_b32 s42, 8519680
s_mov_b32 s43, 0x20000
s_mov_b32 s52, s4
s_mov_b32 s53, s5
v_mfma_f32_16x16x32_bf16 v[108:111], v[172:175], a[28:31], v[108:111]
s_waitcnt lgkmcnt(6)
ds_read_b64_tr_b16 v[144:145], v234 offset:20480
buffer_load_dwordx4 a[72:75], v224, s[36:39], s98 offen offset:1024 sc1
s_mov_b32 s54, 2097152
v_mfma_f32_16x16x32_bf16 v[80:83], v[128:131], a[16:19], v[80:83]
s_waitcnt lgkmcnt(5)
buffer_load_dwordx4 v231, s[32:35], s18 offen offset:3072 lds
buffer_load_dwordx4 a[76:79], v225, s[36:39], s98 offen offset:1024 sc1
s_mov_b32 s55, 0x20000
s_lshr_b32 s3, s1, 1
v_mfma_f32_16x16x32_bf16 v[80:83], v[132:135], a[24:27], v[80:83]
s_waitcnt vmcnt(16)
s_barrier
s_cmp_lg_u32 s56, 0
s_cbranch_scc1 L_sig21
s_mov_b64 exec, 1
buffer_atomic_add v239, v238, s[48:51], s67 offen sc1
buffer_atomic_add v239, v238, s[48:51], s68 offen sc1
buffer_atomic_add v239, v238, s[48:51], s66 offen sc1
s_mov_b64 exec, -1
L_sig21:
ds_read_b64_tr_b16 v[146:147], v234 offset:22528
ds_read_b64_tr_b16 v[148:149], v234 offset:28672
s_lshl_b32 s3, s3, 2
v_mfma_f32_16x16x32_bf16 v[112:115], v[128:131], a[20:23], v[112:115]
ds_read_b64_tr_b16 v[150:151], v234 offset:30720
s_add_u32 s70, s70, s3
s_add_u32 s70, s70, s56
v_mfma_f32_16x16x32_bf16 v[112:115], v[132:135], a[28:31], v[112:115]
s_waitcnt lgkmcnt(6)
ds_read_b64_tr_b16 v[152:153], v235 offset:20480
s_lshl_b32 s60, s70, 14
s_and_b32 s3, s101, 3
v_mfma_f32_16x16x32_bf16 v[84:87], v[136:139], a[16:19], v[84:87]
s_waitcnt lgkmcnt(5)
ds_read_b64_tr_b16 v[154:155], v235 offset:22528
s_lshl_b32 s3, s3, 7
s_add_u32 m0, s11, 81920
v_mfma_f32_16x16x32_bf16 v[84:87], v[140:143], a[24:27], v[84:87]
ds_read_b64_tr_b16 v[156:157], v235 offset:28672
s_add_u32 s60, s60, s3
s_and_b32 s3, s1, 1
s_add_u32 s18, s16, 327680
v_mfma_f32_16x16x32_bf16 v[116:119], v[136:139], a[20:23], v[116:119]
ds_read_b64_tr_b16 v[158:159], v235 offset:30720
s_lshl_b32 s3, s3, 9
s_add_u32 s98, s17, 10240
s_add_u32 s60, s60, s3
v_mfma_f32_16x16x32_bf16 v[116:119], v[140:143], a[28:31], v[116:119]
s_waitcnt lgkmcnt(6)
ds_read_b64_tr_b16 v[160:161], v232 offset:32768
v_and_b32 v212, 15, v243
v_mfma_f32_16x16x32_bf16 v[88:91], v[144:147], a[16:19], v[88:91]
s_waitcnt lgkmcnt(5)
ds_read_b64_tr_b16 v[162:163], v232 offset:34816
v_lshlrev_b32 v212, 10, v212
v_mfma_f32_16x16x32_bf16 v[88:91], v[148:151], a[24:27], v[88:91]
ds_read_b64_tr_b16 v[164:165], v232 offset:40960
v_lshrrev_b32 v213, 4, v243
v_mfma_f32_16x16x32_bf16 v[120:123], v[144:147], a[20:23], v[120:123]
ds_read_b64_tr_b16 v[166:167], v232 offset:43008
v_lshl_add_u32 v254, v213, 3, v212
v_mfma_f32_16x16x32_bf16 v[120:123], v[148:151], a[28:31], v[120:123]
s_waitcnt lgkmcnt(6)
ds_read_b64_tr_b16 v[168:169], v233 offset:32768
buffer_load_dwordx4 v228, s[32:35], s18 offen offset:0 lds
v_mfma_f32_16x16x32_bf16 v[92:95], v[152:155], a[16:19], v[92:95]
s_waitcnt lgkmcnt(5)
ds_read_b64_tr_b16 v[170:171], v233 offset:34816
s_and_b32 s61, s56, 2
s_lshl_b32 s62, s61, 2
v_mfma_f32_16x16x32_bf16 v[92:95], v[156:159], a[24:27], v[92:95]
ds_read_b64_tr_b16 v[172:173], v233 offset:40960
s_add_u32 s62, s62, s99
v_mfma_f32_16x16x32_bf16 v[124:127], v[152:155], a[20:23], v[124:127]
ds_read_b64_tr_b16 v[174:175], v233 offset:43008
s_lshl_b32 s62, s62, 13
buffer_load_dwordx4 a[0:3], v224, s[36:39], s98 offen offset:0 sc1
s_and_b32 s3, s56, 1
v_mfma_f32_16x16x32_bf16 v[124:127], v[156:159], a[28:31], v[124:127]
s_waitcnt lgkmcnt(6)
ds_read_b64_tr_b16 v[128:129], v234 offset:32768
s_lshl_b32 s3, s3, 12
s_add_u32 s62, s62, s3
v_mfma_f32_16x16x32_bf16 v[64:67], v[160:163], a[32:35], v[64:67]
s_waitcnt lgkmcnt(5)
ds_read_b64_tr_b16 v[130:131], v234 offset:34816
s_lshl_b32 s3, s3, 1
v_mfma_f32_16x16x32_bf16 v[64:67], v[164:167], a[40:43], v[64:67]
ds_read_b64_tr_b16 v[132:133], v234 offset:40960
s_add_u32 s3, s3, 0x20000
v_add_u32 v255, s3, v242
v_mfma_f32_16x16x32_bf16 v[96:99], v[160:163], a[36:39], v[96:99]
buffer_load_dwordx4 v229, s[32:35], s18 offen offset:1024 lds
ds_read_b64_tr_b16 v[134:135], v234 offset:43008
v_mfma_f32_16x16x32_bf16 v[96:99], v[164:167], a[44:47], v[96:99]
s_waitcnt lgkmcnt(6)
ds_read_b64_tr_b16 v[136:137], v235 offset:32768
s_lshl_b32 s70, s1, 15
s_lshl_b32 s3, s56, 11
v_mfma_f32_16x16x32_bf16 v[68:71], v[168:171], a[32:35], v[68:71]
s_waitcnt lgkmcnt(5)
ds_read_b64_tr_b16 v[138:139], v235 offset:34816
s_add_u32 s70, s70, s3
s_lshl_b32 s3, s56, 12
v_mfma_f32_16x16x32_bf16 v[68:71], v[172:175], a[40:43], v[68:71]
buffer_load_dwordx4 a[4:7], v225, s[36:39], s98 offen offset:0 sc1
ds_read_b64_tr_b16 v[140:141], v235 offset:40960
s_add_u32 s3, s3, 0x20000
v_mfma_f32_16x16x32_bf16 v[100:103], v[168:171], a[36:39], v[100:103]
ds_read_b64_tr_b16 v[142:143], v235 offset:43008
v_add_u32 v240, s3, v242
v_mfma_f32_16x16x32_bf16 v[100:103], v[172:175], a[44:47], v[100:103]
s_waitcnt lgkmcnt(6)
ds_read_b64_tr_b16 v[144:145], v232 offset:36864
s_add_u32 s3, s99, 1
s_and_b32 s3, s3, 3
v_mfma_f32_16x16x32_bf16 v[72:75], v[128:131], a[32:35], v[72:75]
s_waitcnt lgkmcnt(5)
ds_read_b64_tr_b16 v[146:147], v232 offset:38912
buffer_load_dwordx4 v230, s[32:35], s18 offen offset:2048 lds
s_lshl_b32 s3, s3, 13
v_mfma_f32_16x16x32_bf16 v[72:75], v[132:135], a[40:43], v[72:75]
ds_read_b64_tr_b16 v[148:149], v232 offset:45056
s_add_u32 s63, s70, s3
s_add_u32 s3, s99, 2
v_mfma_f32_16x16x32_bf16 v[104:107], v[128:131], a[36:39], v[104:107]
ds_read_b64_tr_b16 v[150:151], v232 offset:47104
s_and_b32 s3, s3, 3
s_lshl_b32 s3, s3, 13
v_mfma_f32_16x16x32_bf16 v[104:107], v[132:135], a[44:47], v[104:107]
s_waitcnt lgkmcnt(6)
ds_read_b64_tr_b16 v[152:153], v233 offset:36864
s_add_u32 s64, s70, s3
v_mfma_f32_16x16x32_bf16 v[76:79], v[136:139], a[32:35], v[76:79]
s_waitcnt lgkmcnt(5)
ds_read_b64_tr_b16 v[154:155], v233 offset:38912
buffer_load_dwordx4 a[8:11], v224, s[36:39], s98 offen offset:1024 sc1
s_add_u32 s3, s99, 3
s_and_b32 s3, s3, 3
v_mfma_f32_16x16x32_bf16 v[76:79], v[140:143], a[40:43], v[76:79]
ds_read_b64_tr_b16 v[156:157], v233 offset:45056
s_lshl_b32 s3, s3, 13
s_add_u32 s65, s70, s3
v_mfma_f32_16x16x32_bf16 v[108:111], v[136:139], a[36:39], v[108:111]
ds_read_b64_tr_b16 v[158:159], v233 offset:47104
s_mov_b32 s76, 0x3f80
v_mfma_f32_16x16x32_bf16 v[108:111], v[140:143], a[44:47], v[108:111]
s_waitcnt lgkmcnt(6)
ds_read_b64_tr_b16 v[160:161], v234 offset:36864
buffer_load_dwordx4 v231, s[32:35], s18 offen offset:3072 lds
s_mov_b32 s77, 0x3f800000
s_mov_b32 s78, 0xbfb8aa3b
v_mfma_f32_16x16x32_bf16 v[80:83], v[144:147], a[32:35], v[80:83]
s_waitcnt lgkmcnt(5)
buffer_load_dwordx4 a[12:15], v225, s[36:39], s98 offen offset:1024 sc1
s_mov_b32 s79, s78
v_mfma_f32_16x16x32_bf16 v[80:83], v[148:151], a[40:43], v[80:83]
s_waitcnt vmcnt(16)
s_barrier
s_add_u32 m0, s11, 98304
ds_read_b64_tr_b16 v[162:163], v234 offset:38912
ds_read_b64_tr_b16 v[164:165], v234 offset:45056
v_mfma_f32_16x16x32_bf16 v[112:115], v[144:147], a[36:39], v[112:115]
ds_read_b64_tr_b16 v[166:167], v234 offset:47104
s_add_u32 s18, s16, 393216
v_mfma_f32_16x16x32_bf16 v[112:115], v[148:151], a[44:47], v[112:115]
s_waitcnt lgkmcnt(6)
ds_read_b64_tr_b16 v[168:169], v235 offset:36864
v_mfma_f32_16x16x32_bf16 v[84:87], v[152:155], a[32:35], v[84:87]
s_waitcnt lgkmcnt(5)
ds_read_b64_tr_b16 v[170:171], v235 offset:38912
v_mfma_f32_16x16x32_bf16 v[84:87], v[156:159], a[40:43], v[84:87]
ds_read_b64_tr_b16 v[172:173], v235 offset:45056
s_add_u32 s98, s17, 12288
v_mfma_f32_16x16x32_bf16 v[116:119], v[152:155], a[36:39], v[116:119]
ds_read_b64_tr_b16 v[174:175], v235 offset:47104
ds_read_b64_tr_b16 v[128:129], v232 offset:49152
v_mfma_f32_16x16x32_bf16 v[116:119], v[156:159], a[44:47], v[116:119]
s_waitcnt lgkmcnt(7)
ds_read_b64_tr_b16 v[130:131], v232 offset:51200
v_mfma_f32_16x16x32_bf16 v[88:91], v[160:163], a[32:35], v[88:91]
s_waitcnt lgkmcnt(6)
ds_read_b64_tr_b16 v[132:133], v232 offset:57344
v_mfma_f32_16x16x32_bf16 v[88:91], v[164:167], a[40:43], v[88:91]
ds_read_b64_tr_b16 v[134:135], v232 offset:59392
ds_read_b64_tr_b16 v[136:137], v233 offset:49152
v_mfma_f32_16x16x32_bf16 v[120:123], v[160:163], a[36:39], v[120:123]
buffer_load_dwordx4 v228, s[32:35], s18 offen offset:0 lds
v_mfma_f32_16x16x32_bf16 v[120:123], v[164:167], a[44:47], v[120:123]
s_waitcnt lgkmcnt(7)
ds_read_b64_tr_b16 v[138:139], v233 offset:51200
v_mfma_f32_16x16x32_bf16 v[92:95], v[168:171], a[32:35], v[92:95]
s_waitcnt lgkmcnt(6)
ds_read_b64_tr_b16 v[140:141], v233 offset:57344
v_mfma_f32_16x16x32_bf16 v[92:95], v[172:175], a[40:43], v[92:95]
buffer_load_dwordx4 a[16:19], v224, s[36:39], s98 offen offset:0 sc1
v_mfma_f32_16x16x32_bf16 v[124:127], v[168:171], a[36:39], v[124:127]
ds_read_b64_tr_b16 v[142:143], v233 offset:59392
ds_read_b64_tr_b16 v[144:145], v234 offset:49152
v_mfma_f32_16x16x32_bf16 v[124:127], v[172:175], a[44:47], v[124:127]
s_waitcnt lgkmcnt(6)
ds_read_b64_tr_b16 v[146:147], v234 offset:51200
v_mfma_f32_16x16x32_bf16 v[64:67], v[128:131], a[48:51], v[64:67]
s_waitcnt lgkmcnt(5)
ds_read_b64_tr_b16 v[148:149], v234 offset:57344
v_mfma_f32_16x16x32_bf16 v[64:67], v[132:135], a[56:59], v[64:67]
buffer_load_dwordx4 v229, s[32:35], s18 offen offset:1024 lds
v_mfma_f32_16x16x32_bf16 v[96:99], v[128:131], a[52:55], v[96:99]
ds_read_b64_tr_b16 v[150:151], v234 offset:59392
ds_read_b64_tr_b16 v[152:153], v235 offset:49152
v_mfma_f32_16x16x32_bf16 v[96:99], v[132:135], a[60:63], v[96:99]
s_waitcnt lgkmcnt(6)
ds_read_b64_tr_b16 v[154:155], v235 offset:51200
v_mfma_f32_16x16x32_bf16 v[68:71], v[136:139], a[48:51], v[68:71]
s_waitcnt lgkmcnt(6)
ds_read_b64_tr_b16 v[156:157], v235 offset:57344
buffer_load_dwordx4 a[20:23], v225, s[36:39], s98 offen offset:0 sc1
v_mfma_f32_16x16x32_bf16 v[68:71], v[140:143], a[56:59], v[68:71]
ds_read_b64_tr_b16 v[158:159], v235 offset:59392
ds_read_b64_tr_b16 v[160:161], v232 offset:53248
v_mfma_f32_16x16x32_bf16 v[100:103], v[136:139], a[52:55], v[100:103]
buffer_load_dwordx4 v230, s[32:35], s18 offen offset:2048 lds
v_mfma_f32_16x16x32_bf16 v[100:103], v[140:143], a[60:63], v[100:103]
s_waitcnt lgkmcnt(6)
ds_read_b64_tr_b16 v[162:163], v232 offset:55296
v_mfma_f32_16x16x32_bf16 v[72:75], v[144:147], a[48:51], v[72:75]
s_waitcnt lgkmcnt(6)
ds_read_b64_tr_b16 v[164:165], v232 offset:61440
v_mfma_f32_16x16x32_bf16 v[72:75], v[148:151], a[56:59], v[72:75]
buffer_load_dwordx4 a[24:27], v224, s[36:39], s98 offen offset:1024 sc1
v_mfma_f32_16x16x32_bf16 v[104:107], v[144:147], a[52:55], v[104:107]
ds_read_b64_tr_b16 v[166:167], v232 offset:63488
ds_read_b64_tr_b16 v[168:169], v233 offset:53248
v_mfma_f32_16x16x32_bf16 v[104:107], v[148:151], a[60:63], v[104:107]
s_waitcnt lgkmcnt(6)
ds_read_b64_tr_b16 v[170:171], v233 offset:55296
v_mfma_f32_16x16x32_bf16 v[76:79], v[152:155], a[48:51], v[76:79]
s_waitcnt lgkmcnt(5)
ds_read_b64_tr_b16 v[172:173], v233 offset:61440
v_mfma_f32_16x16x32_bf16 v[76:79], v[156:159], a[56:59], v[76:79]
buffer_load_dwordx4 v231, s[32:35], s18 offen offset:3072 lds
v_mfma_f32_16x16x32_bf16 v[108:111], v[152:155], a[52:55], v[108:111]
ds_read_b64_tr_b16 v[174:175], v233 offset:63488
ds_read_b64_tr_b16 v[128:129], v234 offset:53248
v_mfma_f32_16x16x32_bf16 v[108:111], v[156:159], a[60:63], v[108:111]
s_waitcnt lgkmcnt(6)
ds_read_b64_tr_b16 v[130:131], v234 offset:55296
v_mfma_f32_16x16x32_bf16 v[80:83], v[160:163], a[48:51], v[80:83]
s_waitcnt lgkmcnt(6)
buffer_load_dwordx4 a[28:31], v225, s[36:39], s98 offen offset:1024 sc1
buffer_load_dword v236, v238, s[48:51], s69 offen sc1
v_mfma_f32_16x16x32_bf16 v[80:83], v[164:167], a[56:59], v[80:83]
s_waitcnt vmcnt(17)
s_barrier
s_add_u32 m0, s11, 114688
ds_read_b64_tr_b16 v[132:133], v234 offset:61440
v_mfma_f32_16x16x32_bf16 v[112:115], v[160:163], a[52:55], v[112:115]
ds_read_b64_tr_b16 v[134:135], v234 offset:63488
ds_read_b64_tr_b16 v[136:137], v235 offset:53248
v_mfma_f32_16x16x32_bf16 v[112:115], v[164:167], a[60:63], v[112:115]
s_waitcnt lgkmcnt(6)
ds_read_b64_tr_b16 v[138:139], v235 offset:55296
v_mfma_f32_16x16x32_bf16 v[84:87], v[168:171], a[48:51], v[84:87]
s_waitcnt lgkmcnt(6)
ds_read_b64_tr_b16 v[140:141], v235 offset:61440
v_mfma_f32_16x16x32_bf16 v[84:87], v[172:175], a[56:59], v[84:87]
ds_read_b64_tr_b16 v[142:143], v235 offset:63488
ds_read_b64_tr_b16 v[144:145], v248 offset:0
v_mfma_f32_16x16x32_bf16 v[116:119], v[168:171], a[52:55], v[116:119]
ds_read_b64_tr_b16 v[146:147], v248 offset:2048
ds_read_b64_tr_b16 v[148:149], v248 offset:8192
v_mfma_f32_16x16x32_bf16 v[116:119], v[172:175], a[60:63], v[116:119]
s_waitcnt lgkmcnt(9)
ds_read_b64_tr_b16 v[150:151], v248 offset:10240
v_mfma_f32_16x16x32_bf16 v[88:91], v[128:131], a[48:51], v[88:91]
s_waitcnt lgkmcnt(8)
ds_read_b64_tr_b16 v[152:153], v249 offset:0
v_mfma_f32_16x16x32_bf16 v[88:91], v[132:135], a[56:59], v[88:91]
s_xor_b32 s18, s75, 0
s_lshl_b32 s18, s18, 16
s_add_u32 s18, s18, s10
v_mfma_f32_16x16x32_bf16 v[120:123], v[128:131], a[52:55], v[120:123]
ds_read_b64_tr_b16 v[154:155], v249 offset:2048
ds_read_b64_tr_b16 v[156:157], v249 offset:8192
v_mfma_f32_16x16x32_bf16 v[120:123], v[132:135], a[60:63], v[120:123]
s_waitcnt lgkmcnt(8)
ds_read_b64_tr_b16 v[158:159], v249 offset:10240
v_mfma_f32_16x16x32_bf16 v[92:95], v[136:139], a[48:51], v[92:95]
s_waitcnt lgkmcnt(7)
ds_read_b64_tr_b16 v[160:161], v250 offset:0
v_mfma_f32_16x16x32_bf16 v[92:95], v[140:143], a[56:59], v[92:95]
buffer_load_dwordx4 v228, s[28:31], s18 offen offset:0 lds
v_mfma_f32_16x16x32_bf16 v[124:127], v[136:139], a[52:55], v[124:127]
ds_read_b64_tr_b16 v[162:163], v250 offset:2048
ds_read_b64_tr_b16 v[164:165], v250 offset:8192
v_mfma_f32_16x16x32_bf16 v[124:127], v[140:143], a[60:63], v[124:127]
s_waitcnt lgkmcnt(6)
ds_read_b64_tr_b16 v[166:167], v250 offset:10240
v_mfma_f32_16x16x32_bf16 v[64:67], v[144:147], a[64:67], v[64:67]
buffer_load_dwordx4 v229, s[28:31], s18 offen offset:1024 lds
v_mfma_f32_16x16x32_bf16 v[64:67], v[148:151], a[72:75], v[64:67]
ds_read_b64_tr_b16 v[168:169], v251 offset:0
ds_read_b64_tr_b16 v[170:171], v251 offset:2048
v_mfma_f32_16x16x32_bf16 v[96:99], v[144:147], a[68:71], v[96:99]
ds_read_b64_tr_b16 v[172:173], v251 offset:8192
ds_read_b64_tr_b16 v[174:175], v251 offset:10240
v_mfma_f32_16x16x32_bf16 v[96:99], v[148:151], a[76:79], v[96:99]
s_waitcnt lgkmcnt(7)
ds_read_b64_tr_b16 v[128:129], v248 offset:4096
v_mfma_f32_16x16x32_bf16 v[68:71], v[152:155], a[64:67], v[68:71]
ds_read_b64_tr_b16 v[130:131], v248 offset:6144
v_mfma_f32_16x16x32_bf16 v[68:71], v[156:159], a[72:75], v[68:71]
ds_read_b64_tr_b16 v[132:133], v248 offset:12288
v_mfma_f32_16x16x32_bf16 v[100:103], v[152:155], a[68:71], v[100:103]
buffer_load_dwordx4 v230, s[28:31], s18 offen offset:2048 lds
v_mfma_f32_16x16x32_bf16 v[100:103], v[156:159], a[76:79], v[100:103]
s_waitcnt lgkmcnt(7)
ds_read_b64_tr_b16 v[134:135], v248 offset:14336
v_mfma_f32_16x16x32_bf16 v[72:75], v[160:163], a[64:67], v[72:75]
ds_read_b64_tr_b16 v[136:137], v249 offset:4096
v_mfma_f32_16x16x32_bf16 v[72:75], v[164:167], a[72:75], v[72:75]
ds_read_b64_tr_b16 v[138:139], v249 offset:6144
ds_read_b64_tr_b16 v[140:141], v249 offset:12288
v_mfma_f32_16x16x32_bf16 v[104:107], v[160:163], a[68:71], v[104:107]
ds_read_b64_tr_b16 v[142:143], v249 offset:14336
v_mfma_f32_16x16x32_bf16 v[104:107], v[164:167], a[76:79], v[104:107]
s_waitcnt lgkmcnt(6)
ds_read_b64_tr_b16 v[144:145], v250 offset:4096
v_mfma_f32_16x16x32_bf16 v[76:79], v[168:171], a[64:67], v[76:79]
buffer_load_dwordx4 v231, s[28:31], s18 offen offset:3072 lds
v_mfma_f32_16x16x32_bf16 v[76:79], v[172:175], a[72:75], v[76:79]
ds_read_b64_tr_b16 v[146:147], v250 offset:6144
ds_read_b64_tr_b16 v[148:149], v250 offset:12288
v_mfma_f32_16x16x32_bf16 v[108:111], v[168:171], a[68:71], v[108:111]
ds_read_b64_tr_b16 v[150:151], v250 offset:14336
v_mfma_f32_16x16x32_bf16 v[108:111], v[172:175], a[76:79], v[108:111]
ds_read_b64_tr_b16 v[152:153], v251 offset:4096
v_mfma_f32_16x16x32_bf16 v[80:83], v[128:131], a[64:67], v[80:83]
s_waitcnt lgkmcnt(6)
ds_read_b64_tr_b16 v[154:155], v251 offset:6144
v_mfma_f32_16x16x32_bf16 v[80:83], v[132:135], a[72:75], v[80:83]
s_waitcnt vmcnt(13)
s_barrier
ds_read_b64_tr_b16 v[156:157], v251 offset:12288
v_mfma_f32_16x16x32_bf16 v[112:115], v[128:131], a[68:71], v[112:115]
ds_read_b64_tr_b16 v[158:159], v251 offset:14336
v_mfma_f32_16x16x32_bf16 v[112:115], v[132:135], a[76:79], v[112:115]
ds_read_b64_tr_b16 v[160:161], v248 offset:16384
v_mfma_f32_16x16x32_bf16 v[84:87], v[136:139], a[64:67], v[84:87]
s_waitcnt lgkmcnt(6)
ds_read_b64_tr_b16 v[162:163], v248 offset:18432
v_mfma_f32_16x16x32_bf16 v[84:87], v[140:143], a[72:75], v[84:87]
ds_read_b64_tr_b16 v[164:165], v248 offset:24576
v_mfma_f32_16x16x32_bf16 v[116:119], v[136:139], a[68:71], v[116:119]
ds_read_b64_tr_b16 v[166:167], v248 offset:26624
v_mfma_f32_16x16x32_bf16 v[116:119], v[140:143], a[76:79], v[116:119]
ds_read_b64_tr_b16 v[168:169], v249 offset:16384
v_mfma_f32_16x16x32_bf16 v[88:91], v[144:147], a[64:67], v[88:91]
s_waitcnt lgkmcnt(6)
ds_read_b64_tr_b16 v[170:171], v249 offset:18432
s_waitcnt vmcnt(4)
v_readfirstlane_b32 s70, v236
s_nop 2
s_cmp_ge_u32 s70, 8
s_cbranch_scc0 L_spin22
L_got22:
v_mfma_f32_16x16x32_bf16 v[88:91], v[148:151], a[72:75], v[88:91]
s_xor_b32 s98, s75, 0
s_lshl_b32 s98, s98, 11
s_add_u32 s98, s98, s12
v_mfma_f32_16x16x32_bf16 v[120:123], v[144:147], a[68:71], v[120:123]
buffer_load_dwordx4 a[32:35], v252, s[44:47], s98 offen offset:0 sc1
v_mfma_f32_16x16x32_bf16 v[120:123], v[148:151], a[76:79], v[120:123]
ds_read_b64_tr_b16 v[172:173], v249 offset:24576
ds_read_b64_tr_b16 v[174:175], v249 offset:26624
v_mfma_f32_16x16x32_bf16 v[92:95], v[152:155], a[64:67], v[92:95]
s_waitcnt lgkmcnt(5)
ds_read_b64_tr_b16 v[128:129], v250 offset:16384
v_mfma_f32_16x16x32_bf16 v[92:95], v[156:159], a[72:75], v[92:95]
buffer_load_dwordx4 a[36:39], v253, s[44:47], s98 offen offset:0 sc1
v_mfma_f32_16x16x32_bf16 v[124:127], v[152:155], a[68:71], v[124:127]
buffer_load_dwordx4 a[40:43], v252, s[44:47], s98 offen offset:1024 sc1
v_mfma_f32_16x16x32_bf16 v[124:127], v[156:159], a[76:79], v[124:127]
ds_read_b64_tr_b16 v[130:131], v250 offset:18432
ds_read_b64_tr_b16 v[132:133], v250 offset:24576
v_mfma_f32_16x16x32_bf16 v[64:67], v[160:163], a[0:3], v[64:67]
s_waitcnt lgkmcnt(5)
ds_read_b64_tr_b16 v[134:135], v250 offset:26624
v_mfma_f32_16x16x32_bf16 v[64:67], v[164:167], a[8:11], v[64:67]
buffer_load_dwordx4 a[44:47], v253, s[44:47], s98 offen offset:1024 sc1
s_add_u32 m0, s11, 0
v_mfma_f32_16x16x32_bf16 v[96:99], v[160:163], a[4:7], v[96:99]
s_xor_b32 s18, s75, 1
s_lshl_b32 s18, s18, 16
s_add_u32 s18, s18, s10
v_mfma_f32_16x16x32_bf16 v[96:99], v[164:167], a[12:15], v[96:99]
ds_read_b64_tr_b16 v[136:137], v251 offset:16384
ds_read_b64_tr_b16 v[138:139], v251 offset:18432
v_mfma_f32_16x16x32_bf16 v[68:71], v[168:171], a[0:3], v[68:71]
s_waitcnt lgkmcnt(5)
ds_read_b64_tr_b16 v[140:141], v251 offset:24576
v_mfma_f32_16x16x32_bf16 v[68:71], v[172:175], a[8:11], v[68:71]
s_xor_b32 s98, s75, 1
s_lshl_b32 s98, s98, 11
s_add_u32 s98, s98, s12
v_mfma_f32_16x16x32_bf16 v[100:103], v[168:171], a[4:7], v[100:103]
ds_read_b64_tr_b16 v[142:143], v251 offset:26624
ds_read_b64_tr_b16 v[144:145], v248 offset:20480
v_mfma_f32_16x16x32_bf16 v[100:103], v[172:175], a[12:15], v[100:103]
s_waitcnt lgkmcnt(5)
ds_read_b64_tr_b16 v[146:147], v248 offset:22528
buffer_load_dwordx4 v228, s[28:31], s18 offen offset:0 lds
v_mfma_f32_16x16x32_bf16 v[72:75], v[128:131], a[0:3], v[72:75]
buffer_load_dwordx4 a[48:51], v252, s[44:47], s98 offen offset:0 sc1
v_mfma_f32_16x16x32_bf16 v[72:75], v[132:135], a[8:11], v[72:75]
ds_read_b64_tr_b16 v[148:149], v248 offset:28672
ds_read_b64_tr_b16 v[150:151], v248 offset:30720
v_mfma_f32_16x16x32_bf16 v[104:107], v[128:131], a[4:7], v[104:107]
buffer_load_dwordx4 v229, s[28:31], s18 offen offset:1024 lds
v_mfma_f32_16x16x32_bf16 v[104:107], v[132:135], a[12:15], v[104:107]
s_waitcnt lgkmcnt(5)
ds_read_b64_tr_b16 v[152:153], v249 offset:20480
v_mfma_f32_16x16x32_bf16 v[76:79], v[136:139], a[0:3], v[76:79]
s_waitcnt lgkmcnt(5)
ds_read_b64_tr_b16 v[154:155], v249 offset:22528
buffer_load_dwordx4 a[52:55], v253, s[44:47], s98 offen offset:0 sc1
v_mfma_f32_16x16x32_bf16 v[76:79], v[140:143], a[8:11], v[76:79]
ds_read_b64_tr_b16 v[156:157], v249 offset:28672
ds_read_b64_tr_b16 v[158:159], v249 offset:30720
v_mfma_f32_16x16x32_bf16 v[108:111], v[136:139], a[4:7], v[108:111]
buffer_load_dwordx4 v230, s[28:31], s18 offen offset:2048 lds
v_mfma_f32_16x16x32_bf16 v[108:111], v[140:143], a[12:15], v[108:111]
s_waitcnt lgkmcnt(6)
ds_read_b64_tr_b16 v[160:161], v250 offset:20480
v_mfma_f32_16x16x32_bf16 v[80:83], v[144:147], a[0:3], v[80:83]
s_waitcnt lgkmcnt(5)
buffer_load_dwordx4 a[56:59], v252, s[44:47], s98 offen offset:1024 sc1
buffer_load_dwordx4 v231, s[28:31], s18 offen offset:3072 lds
buffer_load_dwordx4 a[60:63], v253, s[44:47], s98 offen offset:1024 sc1
v_mfma_f32_16x16x32_bf16 v[80:83], v[148:151], a[8:11], v[80:83]
s_waitcnt vmcnt(17)
s_barrier
s_add_u32 m0, s11, 16384
ds_read_b64_tr_b16 v[162:163], v250 offset:22528
ds_read_b64_tr_b16 v[164:165], v250 offset:28672
v_mfma_f32_16x16x32_bf16 v[112:115], v[144:147], a[4:7], v[112:115]
ds_read_b64_tr_b16 v[166:167], v250 offset:30720
ds_read_b64_tr_b16 v[168:169], v251 offset:20480
v_mfma_f32_16x16x32_bf16 v[112:115], v[148:151], a[12:15], v[112:115]
s_waitcnt lgkmcnt(7)
ds_read_b64_tr_b16 v[170:171], v251 offset:22528
v_mfma_f32_16x16x32_bf16 v[84:87], v[152:155], a[0:3], v[84:87]
s_waitcnt lgkmcnt(6)
ds_read_b64_tr_b16 v[172:173], v251 offset:28672
v_mfma_f32_16x16x32_bf16 v[84:87], v[156:159], a[8:11], v[84:87]
ds_read_b64_tr_b16 v[174:175], v251 offset:30720
ds_read_b64_tr_b16 v[128:129], v248 offset:32768
v_mfma_f32_16x16x32_bf16 v[116:119], v[152:155], a[4:7], v[116:119]
ds_read_b64_tr_b16 v[130:131], v248 offset:34816
ds_read_b64_tr_b16 v[132:133], v248 offset:40960
v_mfma_f32_16x16x32_bf16 v[116:119], v[156:159], a[12:15], v[116:119]
s_waitcnt lgkmcnt(9)
ds_read_b64_tr_b16 v[134:135], v248 offset:43008
v_mfma_f32_16x16x32_bf16 v[88:91], v[160:163], a[0:3], v[88:91]
s_waitcnt lgkmcnt(8)
ds_read_b64_tr_b16 v[136:137], v249 offset:32768
v_mfma_f32_16x16x32_bf16 v[88:91], v[164:167], a[8:11], v[88:91]
s_xor_b32 s18, s75, 2
s_lshl_b32 s18, s18, 16
s_add_u32 s18, s18, s10
v_mfma_f32_16x16x32_bf16 v[120:123], v[160:163], a[4:7], v[120:123]
s_xor_b32 s98, s75, 2
s_lshl_b32 s98, s98, 11
s_add_u32 s98, s98, s12
v_mfma_f32_16x16x32_bf16 v[120:123], v[164:167], a[12:15], v[120:123]
s_waitcnt lgkmcnt(6)
ds_read_b64_tr_b16 v[138:139], v249 offset:34816
v_mfma_f32_16x16x32_bf16 v[92:95], v[168:171], a[0:3], v[92:95]
s_waitcnt lgkmcnt(5)
ds_read_b64_tr_b16 v[140:141], v249 offset:40960
v_mfma_f32_16x16x32_bf16 v[92:95], v[172:175], a[8:11], v[92:95]
buffer_load_dwordx4 v228, s[28:31], s18 offen offset:0 lds
v_mfma_f32_16x16x32_bf16 v[124:127], v[168:171], a[4:7], v[124:127]
ds_read_b64_tr_b16 v[142:143], v249 offset:43008
ds_read_b64_tr_b16 v[144:145], v250 offset:32768
v_mfma_f32_16x16x32_bf16 v[124:127], v[172:175], a[12:15], v[124:127]
s_waitcnt lgkmcnt(4)
ds_read_b64_tr_b16 v[146:147], v250 offset:34816
v_mfma_f32_16x16x32_bf16 v[64:67], v[128:131], a[16:19], v[64:67]
buffer_load_dwordx4 a[64:67], v252, s[44:47], s98 offen offset:0 sc1
v_mfma_f32_16x16x32_bf16 v[64:67], v[132:135], a[24:27], v[64:67]
ds_read_b64_tr_b16 v[148:149], v250 offset:40960
ds_read_b64_tr_b16 v[150:151], v250 offset:43008
v_mfma_f32_16x16x32_bf16 v[96:99], v[128:131], a[20:23], v[96:99]
buffer_load_dwordx4 v229, s[28:31], s18 offen offset:1024 lds
v_mfma_f32_16x16x32_bf16 v[96:99], v[132:135], a[28:31], v[96:99]
s_waitcnt lgkmcnt(5)
ds_read_b64_tr_b16 v[152:153], v251 offset:32768
v_mfma_f32_16x16x32_bf16 v[68:71], v[136:139], a[16:19], v[68:71]
s_waitcnt lgkmcnt(5)
ds_read_b64_tr_b16 v[154:155], v251 offset:34816
v_mfma_f32_16x16x32_bf16 v[68:71], v[140:143], a[24:27], v[68:71]
ds_read_b64_tr_b16 v[156:157], v251 offset:40960
ds_read_b64_tr_b16 v[158:159], v251 offset:43008
v_mfma_f32_16x16x32_bf16 v[100:103], v[136:139], a[20:23], v[100:103]
buffer_load_dwordx4 a[68:71], v253, s[44:47], s98 offen offset:0 sc1
v_mfma_f32_16x16x32_bf16 v[100:103], v[140:143], a[28:31], v[100:103]
s_waitcnt lgkmcnt(6)
ds_read_b64_tr_b16 v[160:161], v248 offset:36864
v_mfma_f32_16x16x32_bf16 v[72:75], v[144:147], a[16:19], v[72:75]
s_waitcnt lgkmcnt(5)
ds_read_b64_tr_b16 v[162:163], v248 offset:38912
v_mfma_f32_16x16x32_bf16 v[72:75], v[148:151], a[24:27], v[72:75]
ds_read_b64_tr_b16 v[164:165], v248 offset:45056
ds_read_b64_tr_b16 v[166:167], v248 offset:47104
v_mfma_f32_16x16x32_bf16 v[104:107], v[144:147], a[20:23], v[104:107]
buffer_load_dwordx4 v230, s[28:31], s18 offen offset:2048 lds
v_mfma_f32_16x16x32_bf16 v[104:107], v[148:151], a[28:31], v[104:107]
s_waitcnt lgkmcnt(6)
ds_read_b64_tr_b16 v[168:169], v249 offset:36864
v_mfma_f32_16x16x32_bf16 v[76:79], v[152:155], a[16:19], v[76:79]
s_waitcnt lgkmcnt(5)
ds_read_b64_tr_b16 v[170:171], v249 offset:38912
v_mfma_f32_16x16x32_bf16 v[76:79], v[156:159], a[24:27], v[76:79]
buffer_load_dwordx4 a[72:75], v252, s[44:47], s98 offen offset:1024 sc1
ds_read_b64_tr_b16 v[172:173], v249 offset:45056
v_mfma_f32_16x16x32_bf16 v[108:111], v[152:155], a[20:23], v[108:111]
ds_read_b64_tr_b16 v[174:175], v249 offset:47104
ds_read_b64_tr_b16 v[128:129], v250 offset:36864
v_mfma_f32_16x16x32_bf16 v[108:111], v[156:159], a[28:31], v[108:111]
s_waitcnt lgkmcnt(7)
ds_read_b64_tr_b16 v[130:131], v250 offset:38912
v_mfma_f32_16x16x32_bf16 v[80:83], v[160:163], a[16:19], v[80:83]
s_waitcnt lgkmcnt(6)
buffer_load_dwordx4 v231, s[28:31], s18 offen offset:3072 lds
buffer_load_dwordx4 a[76:79], v253, s[44:47], s98 offen offset:1024 sc1
v_mfma_f32_16x16x32_bf16 v[80:83], v[164:167], a[24:27], v[80:83]
s_waitcnt vmcnt(16)
s_barrier
s_add_u32 m0, s11, 32768
ds_read_b64_tr_b16 v[132:133], v250 offset:45056
v_mfma_f32_16x16x32_bf16 v[112:115], v[160:163], a[20:23], v[112:115]
ds_read_b64_tr_b16 v[134:135], v250 offset:47104
ds_read_b64_tr_b16 v[136:137], v251 offset:36864
v_mfma_f32_16x16x32_bf16 v[112:115], v[164:167], a[28:31], v[112:115]
s_waitcnt lgkmcnt(7)
ds_read_b64_tr_b16 v[138:139], v251 offset:38912
v_mfma_f32_16x16x32_bf16 v[84:87], v[168:171], a[16:19], v[84:87]
s_waitcnt lgkmcnt(6)
ds_read_b64_tr_b16 v[140:141], v251 offset:45056
v_mfma_f32_16x16x32_bf16 v[84:87], v[172:175], a[24:27], v[84:87]
ds_read_b64_tr_b16 v[142:143], v251 offset:47104
ds_read_b64_tr_b16 v[144:145], v248 offset:49152
v_mfma_f32_16x16x32_bf16 v[116:119], v[168:171], a[20:23], v[116:119]
ds_read_b64_tr_b16 v[146:147], v248 offset:51200
ds_read_b64_tr_b16 v[148:149], v248 offset:57344
v_mfma_f32_16x16x32_bf16 v[116:119], v[172:175], a[28:31], v[116:119]
s_waitcnt lgkmcnt(9)
ds_read_b64_tr_b16 v[150:151], v248 offset:59392
v_mfma_f32_16x16x32_bf16 v[88:91], v[128:131], a[16:19], v[88:91]
s_waitcnt lgkmcnt(8)
ds_read_b64_tr_b16 v[152:153], v249 offset:49152
v_mfma_f32_16x16x32_bf16 v[88:91], v[132:135], a[24:27], v[88:91]
s_xor_b32 s18, s75, 3
s_lshl_b32 s18, s18, 16
s_add_u32 s18, s18, s10
v_mfma_f32_16x16x32_bf16 v[120:123], v[128:131], a[20:23], v[120:123]
s_xor_b32 s98, s75, 3
s_lshl_b32 s98, s98, 11
s_add_u32 s98, s98, s12
v_mfma_f32_16x16x32_bf16 v[120:123], v[132:135], a[28:31], v[120:123]
s_waitcnt lgkmcnt(6)
ds_read_b64_tr_b16 v[154:155], v249 offset:51200
v_mfma_f32_16x16x32_bf16 v[92:95], v[136:139], a[16:19], v[92:95]
s_waitcnt lgkmcnt(5)
ds_read_b64_tr_b16 v[156:157], v249 offset:57344
ds_read_b64_tr_b16 v[158:159], v249 offset:59392
v_mfma_f32_16x16x32_bf16 v[92:95], v[140:143], a[24:27], v[92:95]
buffer_load_dwordx4 v228, s[28:31], s18 offen offset:0 lds
v_mfma_f32_16x16x32_bf16 v[124:127], v[136:139], a[20:23], v[124:127]
ds_read_b64_tr_b16 v[160:161], v250 offset:49152
ds_read_b64_tr_b16 v[162:163], v250 offset:51200
v_mfma_f32_16x16x32_bf16 v[124:127], v[140:143], a[28:31], v[124:127]
s_waitcnt lgkmcnt(5)
ds_read_b64_tr_b16 v[164:165], v250 offset:57344
v_mfma_f32_16x16x32_bf16 v[0:3], v[144:147], a[32:35], 0
buffer_load_dwordx4 a[0:3], v252, s[44:47], s98 offen offset:0 sc1
v_mfma_f32_16x16x32_bf16 v[0:3], v[148:151], a[40:43], v[0:3]
ds_read_b64_tr_b16 v[166:167], v250 offset:59392
ds_read_b64_tr_b16 v[168:169], v251 offset:49152
v_mfma_f32_16x16x32_bf16 v[32:35], v[144:147], a[36:39], 0
buffer_load_dwordx4 v229, s[28:31], s18 offen offset:1024 lds
v_mfma_f32_16x16x32_bf16 v[32:35], v[148:151], a[44:47], v[32:35]
s_waitcnt lgkmcnt(5)
ds_read_b64_tr_b16 v[170:171], v251 offset:51200
v_mfma_f32_16x16x32_bf16 v[4:7], v[152:155], a[32:35], 0
ds_read_b64_tr_b16 v[172:173], v251 offset:57344
ds_read_b64_tr_b16 v[174:175], v251 offset:59392
v_mfma_f32_16x16x32_bf16 v[4:7], v[156:159], a[40:43], v[4:7]
buffer_load_dwordx4 a[4:7], v253, s[44:47], s98 offen offset:0 sc1
v_mfma_f32_16x16x32_bf16 v[36:39], v[152:155], a[36:39], 0
ds_read_b64_tr_b16 v[128:129], v248 offset:53248
ds_read_b64_tr_b16 v[130:131], v248 offset:55296
v_mfma_f32_16x16x32_bf16 v[36:39], v[156:159], a[44:47], v[36:39]
s_waitcnt lgkmcnt(7)
ds_read_b64_tr_b16 v[132:133], v248 offset:61440
v_mfma_f32_16x16x32_bf16 v[8:11], v[160:163], a[32:35], 0
s_waitcnt lgkmcnt(6)
buffer_load_dwordx4 v230, s[28:31], s18 offen offset:2048 lds
v_mfma_f32_16x16x32_bf16 v[8:11], v[164:167], a[40:43], v[8:11]
ds_read_b64_tr_b16 v[134:135], v248 offset:63488
ds_read_b64_tr_b16 v[136:137], v249 offset:53248
v_mfma_f32_16x16x32_bf16 v[40:43], v[160:163], a[36:39], 0
buffer_load_dwordx4 a[8:11], v252, s[44:47], s98 offen offset:1024 sc1
v_mfma_f32_16x16x32_bf16 v[40:43], v[164:167], a[44:47], v[40:43]
s_waitcnt lgkmcnt(5)
ds_read_b64_tr_b16 v[138:139], v249 offset:55296
v_mfma_f32_16x16x32_bf16 v[12:15], v[168:171], a[32:35], 0
ds_read_b64_tr_b16 v[140:141], v249 offset:61440
ds_read_b64_tr_b16 v[142:143], v249 offset:63488
v_mfma_f32_16x16x32_bf16 v[12:15], v[172:175], a[40:43], v[12:15]
buffer_load_dwordx4 v231, s[28:31], s18 offen offset:3072 lds
v_mfma_f32_16x16x32_bf16 v[44:47], v[168:171], a[36:39], 0
ds_read_b64_tr_b16 v[144:145], v250 offset:53248
ds_read_b64_tr_b16 v[146:147], v250 offset:55296
v_mfma_f32_16x16x32_bf16 v[44:47], v[172:175], a[44:47], v[44:47]
s_waitcnt lgkmcnt(7)
ds_read_b64_tr_b16 v[148:149], v250 offset:61440
v_mfma_f32_16x16x32_bf16 v[16:19], v[128:131], a[32:35], 0
s_waitcnt lgkmcnt(6)
buffer_load_dwordx4 a[12:15], v253, s[44:47], s98 offen offset:1024 sc1
v_mfma_f32_16x16x32_bf16 v[16:19], v[132:135], a[40:43], v[16:19]
s_waitcnt vmcnt(16)
s_barrier
s_add_u32 m0, s11, 49152
v_mfma_f32_16x16x32_bf16 v[48:51], v[128:131], a[36:39], 0
ds_read_b64_tr_b16 v[150:151], v250 offset:63488
s_add_u32 s3, s61, 0
s_cmp_eq_u32 s3, s1
s_cbranch_scc1 L_owny0
s_add_u32 s3, s62, 8388608
v_cvt_pk_bf16_f32 v64, v64, v65
v_cvt_pk_bf16_f32 v65, v66, v67
v_cvt_pk_bf16_f32 v66, v68, v69
v_cvt_pk_bf16_f32 v67, v70, v71
buffer_store_dwordx4 v[64:67], v242, s[40:43], s3 offen offset:0 sc1
v_cvt_pk_bf16_f32 v96, v96, v97
v_cvt_pk_bf16_f32 v97, v98, v99
v_cvt_pk_bf16_f32 v98, v100, v101
v_cvt_pk_bf16_f32 v99, v102, v103
buffer_store_dwordx4 v[96:99], v242, s[40:43], s3 offen offset:2048 sc1
s_branch L_shy0
L_owny0:
ds_write_b128 v255, v[64:67] offset:0
ds_write_b128 v255, v[68:71] offset:1024
ds_write_b128 v255, v[96:99] offset:4096
ds_write_b128 v255, v[100:103] offset:5120
s_waitcnt lgkmcnt(0)
L_shy0:
v_mfma_f32_16x16x32_bf16 v[48:51], v[132:135], a[44:47], v[48:51]
s_waitcnt lgkmcnt(4)
ds_read_b64_tr_b16 v[152:153], v251 offset:53248
v_mfma_f32_16x16x32_bf16 v[20:23], v[136:139], a[32:35], 0
ds_read_b64_tr_b16 v[154:155], v251 offset:55296
ds_read_b64_tr_b16 v[156:157], v251 offset:61440
v_mfma_f32_16x16x32_bf16 v[20:23], v[140:143], a[40:43], v[20:23]
ds_read_b64_tr_b16 v[158:159], v251 offset:63488
ds_read_b64_tr_b16 v[160:161], v232 offset:0
v_mfma_f32_16x16x32_bf16 v[52:55], v[136:139], a[36:39], 0
ds_read_b64_tr_b16 v[162:163], v232 offset:2048
ds_read_b64_tr_b16 v[164:165], v232 offset:8192
v_mfma_f32_16x16x32_bf16 v[52:55], v[140:143], a[44:47], v[52:55]
s_waitcnt lgkmcnt(8)
ds_read_b64_tr_b16 v[166:167], v232 offset:10240
v_mfma_f32_16x16x32_bf16 v[24:27], v[144:147], a[32:35], 0
s_waitcnt lgkmcnt(8)
s_xor_b32 s18, s75, 4
s_lshl_b32 s18, s18, 16
s_add_u32 s18, s18, s10
v_mfma_f32_16x16x32_bf16 v[24:27], v[148:151], a[40:43], v[24:27]
s_xor_b32 s98, s75, 4
s_lshl_b32 s98, s98, 11
s_add_u32 s98, s98, s12
v_mfma_f32_16x16x32_bf16 v[56:59], v[144:147], a[36:39], 0
ds_read_b64_tr_b16 v[168:169], v233 offset:0
ds_read_b64_tr_b16 v[170:171], v233 offset:2048
v_mfma_f32_16x16x32_bf16 v[56:59], v[148:151], a[44:47], v[56:59]
s_waitcnt lgkmcnt(7)
ds_read_b64_tr_b16 v[172:173], v233 offset:8192
v_mfma_f32_16x16x32_bf16 v[28:31], v[152:155], a[32:35], 0
s_waitcnt lgkmcnt(6)
buffer_load_dwordx4 v228, s[28:31], s18 offen offset:0 lds
v_mfma_f32_16x16x32_bf16 v[28:31], v[156:159], a[40:43], v[28:31]
ds_read_b64_tr_b16 v[174:175], v233 offset:10240
ds_read_b64_tr_b16 v[128:129], v234 offset:0
v_mfma_f32_16x16x32_bf16 v[60:63], v[152:155], a[36:39], 0
buffer_load_dwordx4 a[16:19], v252, s[44:47], s98 offen offset:0 sc1
v_mfma_f32_16x16x32_bf16 v[60:63], v[156:159], a[44:47], v[60:63]
s_waitcnt lgkmcnt(5)
ds_read_b64_tr_b16 v[130:131], v234 offset:2048
v_mfma_f32_16x16x32_bf16 v[0:3], v[160:163], a[48:51], v[0:3]
ds_read_b64_tr_b16 v[132:133], v234 offset:8192
ds_read_b64_tr_b16 v[134:135], v234 offset:10240
v_mfma_f32_16x16x32_bf16 v[0:3], v[164:167], a[56:59], v[0:3]
buffer_load_dwordx4 v229, s[28:31], s18 offen offset:1024 lds
v_mfma_f32_16x16x32_bf16 v[32:35], v[160:163], a[52:55], v[32:35]
ds_read_b64_tr_b16 v[136:137], v235 offset:0
ds_read_b64_tr_b16 v[138:139], v235 offset:2048
v_mfma_f32_16x16x32_bf16 v[32:35], v[164:167], a[60:63], v[32:35]
s_waitcnt lgkmcnt(7)
ds_read_b64_tr_b16 v[140:141], v235 offset:8192
v_mfma_f32_16x16x32_bf16 v[4:7], v[168:171], a[48:51], v[4:7]
s_waitcnt lgkmcnt(6)
ds_read_b64_tr_b16 v[142:143], v235 offset:10240
ds_read_b64_tr_b16 v[144:145], v232 offset:4096
v_mfma_f32_16x16x32_bf16 v[4:7], v[172:175], a[56:59], v[4:7]
buffer_load_dwordx4 a[20:23], v253, s[44:47], s98 offen offset:0 sc1
v_mfma_f32_16x16x32_bf16 v[36:39], v[168:171], a[52:55], v[36:39]
ds_read_b64_tr_b16 v[146:147], v232 offset:6144
s_add_u32 s3, s61, 0
s_cmp_eq_u32 s3, s1
s_cbranch_scc1 L_owny1
s_add_u32 s3, s62, 8388608
v_cvt_pk_bf16_f32 v72, v72, v73
v_cvt_pk_bf16_f32 v73, v74, v75
v_cvt_pk_bf16_f32 v74, v76, v77
v_cvt_pk_bf16_f32 v75, v78, v79
buffer_store_dwordx4 v[72:75], v242, s[40:43], s3 offen offset:1024 sc1
v_cvt_pk_bf16_f32 v104, v104, v105
v_cvt_pk_bf16_f32 v105, v106, v107
v_cvt_pk_bf16_f32 v106, v108, v109
v_cvt_pk_bf16_f32 v107, v110, v111
buffer_store_dwordx4 v[104:107], v242, s[40:43], s3 offen offset:3072 sc1
s_branch L_shy1
L_owny1:
ds_write_b128 v255, v[72:75] offset:2048
ds_write_b128 v255, v[76:79] offset:3072
ds_write_b128 v255, v[104:107] offset:6144
ds_write_b128 v255, v[108:111] offset:7168
s_waitcnt lgkmcnt(0)
L_shy1:
v_mfma_f32_16x16x32_bf16 v[36:39], v[172:175], a[60:63], v[36:39]
s_waitcnt lgkmcnt(6)
ds_read_b64_tr_b16 v[148:149], v232 offset:12288
v_mfma_f32_16x16x32_bf16 v[8:11], v[128:131], a[48:51], v[8:11]
buffer_load_dwordx4 v230, s[28:31], s18 offen offset:2048 lds
v_mfma_f32_16x16x32_bf16 v[8:11], v[132:135], a[56:59], v[8:11]
ds_read_b64_tr_b16 v[150:151], v232 offset:14336
ds_read_b64_tr_b16 v[152:153], v233 offset:4096
v_mfma_f32_16x16x32_bf16 v[40:43], v[128:131], a[52:55], v[40:43]
buffer_load_dwordx4 a[24:27], v252, s[44:47], s98 offen offset:1024 sc1
v_mfma_f32_16x16x32_bf16 v[40:43], v[132:135], a[60:63], v[40:43]
s_waitcnt lgkmcnt(4)
ds_read_b64_tr_b16 v[154:155], v233 offset:6144
v_mfma_f32_16x16x32_bf16 v[12:15], v[136:139], a[48:51], v[12:15]
ds_read_b64_tr_b16 v[156:157], v233 offset:12288
ds_read_b64_tr_b16 v[158:159], v233 offset:14336
v_mfma_f32_16x16x32_bf16 v[12:15], v[140:143], a[56:59], v[12:15]
buffer_load_dwordx4 v231, s[28:31], s18 offen offset:3072 lds
v_mfma_f32_16x16x32_bf16 v[44:47], v[136:139], a[52:55], v[44:47]
ds_read_b64_tr_b16 v[160:161], v234 offset:4096
ds_read_b64_tr_b16 v[162:163], v234 offset:6144
v_mfma_f32_16x16x32_bf16 v[44:47], v[140:143], a[60:63], v[44:47]
s_waitcnt lgkmcnt(7)
ds_read_b64_tr_b16 v[164:165], v234 offset:12288
v_mfma_f32_16x16x32_bf16 v[16:19], v[144:147], a[48:51], v[16:19]
s_waitcnt lgkmcnt(6)
buffer_load_dwordx4 a[28:31], v253, s[44:47], s98 offen offset:1024 sc1
v_mfma_f32_16x16x32_bf16 v[16:19], v[148:151], a[56:59], v[16:19]
s_waitcnt vmcnt(16)
s_barrier
s_add_u32 m0, s11, 65536
v_mfma_f32_16x16x32_bf16 v[48:51], v[144:147], a[52:55], v[48:51]
ds_read_b64_tr_b16 v[166:167], v234 offset:14336
ds_read_b64_tr_b16 v[168:169], v235 offset:4096
v_mfma_f32_16x16x32_bf16 v[48:51], v[148:151], a[60:63], v[48:51]
s_waitcnt lgkmcnt(5)
ds_read_b64_tr_b16 v[170:171], v235 offset:6144
v_mfma_f32_16x16x32_bf16 v[20:23], v[152:155], a[48:51], v[20:23]
ds_read_b64_tr_b16 v[172:173], v235 offset:12288
ds_read_b64_tr_b16 v[174:175], v235 offset:14336
v_mfma_f32_16x16x32_bf16 v[20:23], v[156:159], a[56:59], v[20:23]
ds_read_b64_tr_b16 v[128:129], v232 offset:16384
ds_read_b64_tr_b16 v[130:131], v232 offset:18432
v_mfma_f32_16x16x32_bf16 v[52:55], v[152:155], a[52:55], v[52:55]
s_xor_b32 s18, s75, 5
s_lshl_b32 s18, s18, 16
s_add_u32 s18, s18, s10
v_mfma_f32_16x16x32_bf16 v[52:55], v[156:159], a[60:63], v[52:55]
s_waitcnt lgkmcnt(7)
ds_read_b64_tr_b16 v[132:133], v232 offset:24576
v_mfma_f32_16x16x32_bf16 v[24:27], v[160:163], a[48:51], v[24:27]
s_waitcnt lgkmcnt(7)
ds_read_b64_tr_b16 v[134:135], v232 offset:26624
ds_read_b64_tr_b16 v[136:137], v233 offset:16384
v_mfma_f32_16x16x32_bf16 v[24:27], v[164:167], a[56:59], v[24:27]
s_xor_b32 s98, s75, 5
s_lshl_b32 s98, s98, 11
s_add_u32 s98, s98, s12
v_mfma_f32_16x16x32_bf16 v[56:59], v[160:163], a[52:55], v[56:59]
ds_read_b64_tr_b16 v[138:139], v233 offset:18432
s_add_u32 s3, s61, 1
s_cmp_eq_u32 s3, s1
s_cbranch_scc1 L_owny2
s_add_u32 s3, s62, 8421376
v_cvt_pk_bf16_f32 v80, v80, v81
v_cvt_pk_bf16_f32 v81, v82, v83
v_cvt_pk_bf16_f32 v82, v84, v85
v_cvt_pk_bf16_f32 v83, v86, v87
buffer_store_dwordx4 v[80:83], v242, s[40:43], s3 offen offset:0 sc1
v_cvt_pk_bf16_f32 v112, v112, v113
v_cvt_pk_bf16_f32 v113, v114, v115
v_cvt_pk_bf16_f32 v114, v116, v117
v_cvt_pk_bf16_f32 v115, v118, v119
buffer_store_dwordx4 v[112:115], v242, s[40:43], s3 offen offset:2048 sc1
s_branch L_shy2
L_owny2:
ds_write_b128 v255, v[80:83] offset:0
ds_write_b128 v255, v[84:87] offset:1024
ds_write_b128 v255, v[112:115] offset:4096
ds_write_b128 v255, v[116:119] offset:5120
s_waitcnt lgkmcnt(0)
L_shy2:
v_mfma_f32_16x16x32_bf16 v[56:59], v[164:167], a[60:63], v[56:59]
s_waitcnt lgkmcnt(6)
ds_read_b64_tr_b16 v[140:141], v233 offset:24576
v_mfma_f32_16x16x32_bf16 v[28:31], v[168:171], a[48:51], v[28:31]
buffer_load_dwordx4 v228, s[28:31], s18 offen offset:0 lds
v_mfma_f32_16x16x32_bf16 v[28:31], v[172:175], a[56:59], v[28:31]
ds_read_b64_tr_b16 v[142:143], v233 offset:26624
ds_read_b64_tr_b16 v[144:145], v234 offset:16384
v_mfma_f32_16x16x32_bf16 v[60:63], v[168:171], a[52:55], v[60:63]
buffer_load_dwordx4 a[32:35], v252, s[44:47], s98 offen offset:0 sc1
v_mfma_f32_16x16x32_bf16 v[60:63], v[172:175], a[60:63], v[60:63]
s_waitcnt lgkmcnt(4)
ds_read_b64_tr_b16 v[146:147], v234 offset:18432
v_mfma_f32_16x16x32_bf16 v[0:3], v[128:131], a[64:67], v[0:3]
ds_read_b64_tr_b16 v[148:149], v234 offset:24576
ds_read_b64_tr_b16 v[150:151], v234 offset:26624
v_mfma_f32_16x16x32_bf16 v[0:3], v[132:135], a[72:75], v[0:3]
buffer_load_dwordx4 v229, s[28:31], s18 offen offset:1024 lds
v_mfma_f32_16x16x32_bf16 v[32:35], v[128:131], a[68:71], v[32:35]
ds_read_b64_tr_b16 v[152:153], v235 offset:16384
ds_read_b64_tr_b16 v[154:155], v235 offset:18432
v_mfma_f32_16x16x32_bf16 v[32:35], v[132:135], a[76:79], v[32:35]
s_waitcnt lgkmcnt(7)
ds_read_b64_tr_b16 v[156:157], v235 offset:24576
v_mfma_f32_16x16x32_bf16 v[4:7], v[136:139], a[64:67], v[4:7]
s_waitcnt lgkmcnt(6)
ds_read_b64_tr_b16 v[158:159], v235 offset:26624
ds_read_b64_tr_b16 v[160:161], v232 offset:20480
v_mfma_f32_16x16x32_bf16 v[4:7], v[140:143], a[72:75], v[4:7]
buffer_load_dwordx4 a[36:39], v253, s[44:47], s98 offen offset:0 sc1
v_mfma_f32_16x16x32_bf16 v[36:39], v[136:139], a[68:71], v[36:39]
ds_read_b64_tr_b16 v[162:163], v232 offset:22528
ds_read_b64_tr_b16 v[164:165], v232 offset:28672
v_mfma_f32_16x16x32_bf16 v[36:39], v[140:143], a[76:79], v[36:39]
s_waitcnt lgkmcnt(7)
ds_read_b64_tr_b16 v[166:167], v232 offset:30720
v_mfma_f32_16x16x32_bf16 v[8:11], v[144:147], a[64:67], v[8:11]
buffer_load_dwordx4 v230, s[28:31], s18 offen offset:2048 lds
v_mfma_f32_16x16x32_bf16 v[8:11], v[148:151], a[72:75], v[8:11]
ds_read_b64_tr_b16 v[168:169], v233 offset:20480
ds_read_b64_tr_b16 v[170:171], v233 offset:22528
v_mfma_f32_16x16x32_bf16 v[40:43], v[144:147], a[68:71], v[40:43]
buffer_load_dwordx4 a[40:43], v252, s[44:47], s98 offen offset:1024 sc1
v_mfma_f32_16x16x32_bf16 v[40:43], v[148:151], a[76:79], v[40:43]
s_waitcnt lgkmcnt(5)
ds_read_b64_tr_b16 v[172:173], v233 offset:28672
v_mfma_f32_16x16x32_bf16 v[12:15], v[152:155], a[64:67], v[12:15]
ds_read_b64_tr_b16 v[174:175], v233 offset:30720
ds_read_b64_tr_b16 v[128:129], v234 offset:20480
v_mfma_f32_16x16x32_bf16 v[12:15], v[156:159], a[72:75], v[12:15]
buffer_load_dwordx4 v231, s[28:31], s18 offen offset:3072 lds
v_mfma_f32_16x16x32_bf16 v[44:47], v[152:155], a[68:71], v[44:47]
ds_read_b64_tr_b16 v[130:131], v234 offset:22528
s_add_u32 s3, s61, 1
s_cmp_eq_u32 s3, s1
s_cbranch_scc1 L_owny3
s_add_u32 s3, s62, 8421376
v_cvt_pk_bf16_f32 v88, v88, v89
v_cvt_pk_bf16_f32 v89, v90, v91
v_cvt_pk_bf16_f32 v90, v92, v93
v_cvt_pk_bf16_f32 v91, v94, v95
buffer_store_dwordx4 v[88:91], v242, s[40:43], s3 offen offset:1024 sc1
v_cvt_pk_bf16_f32 v120, v120, v121
v_cvt_pk_bf16_f32 v121, v122, v123
v_cvt_pk_bf16_f32 v122, v124, v125
v_cvt_pk_bf16_f32 v123, v126, v127
buffer_store_dwordx4 v[120:123], v242, s[40:43], s3 offen offset:3072 sc1
s_branch L_shy3
L_owny3:
ds_write_b128 v255, v[88:91] offset:2048
ds_write_b128 v255, v[92:95] offset:3072
ds_write_b128 v255, v[120:123] offset:6144
ds_write_b128 v255, v[124:127] offset:7168
s_waitcnt lgkmcnt(0)
L_shy3:
v_mfma_f32_16x16x32_bf16 v[44:47], v[156:159], a[76:79], v[44:47]
s_waitcnt lgkmcnt(6)
ds_read_b64_tr_b16 v[132:133], v234 offset:28672
v_mfma_f32_16x16x32_bf16 v[16:19], v[160:163], a[64:67], v[16:19]
buffer_load_dwordx4 a[44:47], v253, s[44:47], s98 offen offset:1024 sc1
v_mfma_f32_16x16x32_bf16 v[16:19], v[164:167], a[72:75], v[16:19]
s_waitcnt vmcnt(16)
s_barrier
s_add_u32 m0, s11, 81920
v_mfma_f32_16x16x32_bf16 v[48:51], v[160:163], a[68:71], v[48:51]
ds_read_b64_tr_b16 v[134:135], v234 offset:30720
ds_read_b64_tr_b16 v[136:137], v235 offset:20480
v_mfma_f32_16x16x32_bf16 v[48:51], v[164:167], a[76:79], v[48:51]
s_waitcnt lgkmcnt(4)
ds_read_b64_tr_b16 v[138:139], v235 offset:22528
v_mfma_f32_16x16x32_bf16 v[20:23], v[168:171], a[64:67], v[20:23]
ds_read_b64_tr_b16 v[140:141], v235 offset:28672
ds_read_b64_tr_b16 v[142:143], v235 offset:30720
v_mfma_f32_16x16x32_bf16 v[20:23], v[172:175], a[72:75], v[20:23]
ds_read_b64_tr_b16 v[144:145], v232 offset:32768
ds_read_b64_tr_b16 v[146:147], v232 offset:34816
v_mfma_f32_16x16x32_bf16 v[52:55], v[168:171], a[68:71], v[52:55]
s_xor_b32 s18, s75, 6
s_lshl_b32 s18, s18, 16
s_add_u32 s18, s18, s10
v_mfma_f32_16x16x32_bf16 v[52:55], v[172:175], a[76:79], v[52:55]
s_waitcnt lgkmcnt(7)
ds_read_b64_tr_b16 v[148:149], v232 offset:40960
v_mfma_f32_16x16x32_bf16 v[24:27], v[128:131], a[64:67], v[24:27]
s_waitcnt lgkmcnt(7)
ds_read_b64_tr_b16 v[150:151], v232 offset:43008
ds_read_b64_tr_b16 v[152:153], v233 offset:32768
v_mfma_f32_16x16x32_bf16 v[24:27], v[132:135], a[72:75], v[24:27]
s_xor_b32 s98, s75, 6
s_lshl_b32 s98, s98, 11
s_add_u32 s98, s98, s12
v_mfma_f32_16x16x32_bf16 v[56:59], v[128:131], a[68:71], v[56:59]
ds_read_b64_tr_b16 v[154:155], v233 offset:34816
ds_read_b64_tr_b16 v[156:157], v233 offset:40960
v_mfma_f32_16x16x32_bf16 v[56:59], v[132:135], a[76:79], v[56:59]
s_waitcnt lgkmcnt(7)
ds_read_b64_tr_b16 v[158:159], v233 offset:43008
v_mfma_f32_16x16x32_bf16 v[28:31], v[136:139], a[64:67], v[28:31]
buffer_load_dwordx4 v228, s[28:31], s18 offen offset:0 lds
v_mfma_f32_16x16x32_bf16 v[28:31], v[140:143], a[72:75], v[28:31]
ds_read_b64_tr_b16 v[160:161], v234 offset:32768
ds_read_b64_tr_b16 v[162:163], v234 offset:34816
v_mfma_f32_16x16x32_bf16 v[60:63], v[136:139], a[68:71], v[60:63]
buffer_load_dwordx4 a[48:51], v252, s[44:47], s98 offen offset:0 sc1
v_mfma_f32_16x16x32_bf16 v[60:63], v[140:143], a[76:79], v[60:63]
s_waitcnt lgkmcnt(5)
ds_read_b64_tr_b16 v[164:165], v234 offset:40960
v_mfma_f32_16x16x32_bf16 v[0:3], v[144:147], a[0:3], v[0:3]
ds_read_b64_tr_b16 v[166:167], v234 offset:43008
ds_read_b64_tr_b16 v[168:169], v235 offset:32768
v_mfma_f32_16x16x32_bf16 v[0:3], v[148:151], a[8:11], v[0:3]
buffer_load_dwordx4 v229, s[28:31], s18 offen offset:1024 lds
v_mfma_f32_16x16x32_bf16 v[32:35], v[144:147], a[4:7], v[32:35]
ds_read_b64_tr_b16 v[170:171], v235 offset:34816
ds_read_b64_tr_b16 v[172:173], v235 offset:40960
v_mfma_f32_16x16x32_bf16 v[32:35], v[148:151], a[12:15], v[32:35]
s_waitcnt lgkmcnt(7)
ds_read_b64_tr_b16 v[174:175], v235 offset:43008
v_mfma_f32_16x16x32_bf16 v[4:7], v[152:155], a[0:3], v[4:7]
buffer_load_dwordx4 a[52:55], v253, s[44:47], s98 offen offset:0 sc1
v_mfma_f32_16x16x32_bf16 v[4:7], v[156:159], a[8:11], v[4:7]
ds_read_b64_tr_b16 v[128:129], v232 offset:36864
ds_read_b64_tr_b16 v[130:131], v232 offset:38912
v_mfma_f32_16x16x32_bf16 v[36:39], v[152:155], a[4:7], v[36:39]
ds_read_b64_tr_b16 v[132:133], v232 offset:45056
ds_read_b64_tr_b16 v[134:135], v232 offset:47104
v_mfma_f32_16x16x32_bf16 v[36:39], v[156:159], a[12:15], v[36:39]
s_waitcnt lgkmcnt(7)
ds_read_b64_tr_b16 v[136:137], v233 offset:36864
v_mfma_f32_16x16x32_bf16 v[8:11], v[160:163], a[0:3], v[8:11]
buffer_load_dwordx4 v230, s[28:31], s18 offen offset:2048 lds
v_mfma_f32_16x16x32_bf16 v[8:11], v[164:167], a[8:11], v[8:11]
buffer_load_dwordx4 a[56:59], v252, s[44:47], s98 offen offset:1024 sc1
v_mfma_f32_16x16x32_bf16 v[40:43], v[160:163], a[4:7], v[40:43]
ds_read_b64_tr_b16 v[138:139], v233 offset:38912
ds_read_b64_tr_b16 v[140:141], v233 offset:45056
v_mfma_f32_16x16x32_bf16 v[40:43], v[164:167], a[12:15], v[40:43]
s_waitcnt lgkmcnt(7)
ds_read_b64_tr_b16 v[142:143], v233 offset:47104
v_mfma_f32_16x16x32_bf16 v[12:15], v[168:171], a[0:3], v[12:15]
buffer_load_dwordx4 v231, s[28:31], s18 offen offset:3072 lds
v_mfma_f32_16x16x32_bf16 v[12:15], v[172:175], a[8:11], v[12:15]
ds_read_b64_tr_b16 v[144:145], v234 offset:36864
ds_read_b64_tr_b16 v[146:147], v234 offset:38912
v_mfma_f32_16x16x32_bf16 v[44:47], v[168:171], a[4:7], v[44:47]
ds_read_b64_tr_b16 v[148:149], v234 offset:45056
ds_read_b64_tr_b16 v[150:151], v234 offset:47104
v_mfma_f32_16x16x32_bf16 v[44:47], v[172:175], a[12:15], v[44:47]
s_waitcnt lgkmcnt(7)
ds_read_b64_tr_b16 v[152:153], v235 offset:36864
v_mfma_f32_16x16x32_bf16 v[16:19], v[128:131], a[0:3], v[16:19]
buffer_load_dwordx4 a[60:63], v253, s[44:47], s98 offen offset:1024 sc1
v_mfma_f32_16x16x32_bf16 v[16:19], v[132:135], a[8:11], v[16:19]
s_waitcnt vmcnt(16)
s_barrier
s_add_u32 m0, s11, 98304
v_mfma_f32_16x16x32_bf16 v[48:51], v[128:131], a[4:7], v[48:51]
ds_read_b64_tr_b16 v[154:155], v235 offset:38912
ds_read_b64_tr_b16 v[156:157], v235 offset:45056
v_mfma_f32_16x16x32_bf16 v[48:51], v[132:135], a[12:15], v[48:51]
s_waitcnt lgkmcnt(7)
ds_read_b64_tr_b16 v[158:159], v235 offset:47104
v_mfma_f32_16x16x32_bf16 v[20:23], v[136:139], a[0:3], v[20:23]
ds_read_b64_tr_b16 v[160:161], v232 offset:49152
v_mfma_f32_16x16x32_bf16 v[20:23], v[140:143], a[8:11], v[20:23]
ds_read_b64_tr_b16 v[162:163], v232 offset:51200
ds_read_b64_tr_b16 v[164:165], v232 offset:57344
v_mfma_f32_16x16x32_bf16 v[52:55], v[136:139], a[4:7], v[52:55]
s_xor_b32 s18, s75, 7
s_lshl_b32 s18, s18, 16
s_add_u32 s18, s18, s10
v_mfma_f32_16x16x32_bf16 v[52:55], v[140:143], a[12:15], v[52:55]
s_waitcnt lgkmcnt(6)
ds_read_b64_tr_b16 v[166:167], v232 offset:59392
v_mfma_f32_16x16x32_bf16 v[24:27], v[144:147], a[0:3], v[24:27]
s_xor_b32 s98, s75, 7
s_lshl_b32 s98, s98, 11
s_add_u32 s98, s98, s12
v_mfma_f32_16x16x32_bf16 v[24:27], v[148:151], a[8:11], v[24:27]
ds_read_b64_tr_b16 v[168:169], v233 offset:49152
ds_read_b64_tr_b16 v[170:171], v233 offset:51200
v_mfma_f32_16x16x32_bf16 v[56:59], v[144:147], a[4:7], v[56:59]
ds_read_b64_tr_b16 v[172:173], v233 offset:57344
ds_read_b64_tr_b16 v[174:175], v233 offset:59392
v_mfma_f32_16x16x32_bf16 v[56:59], v[148:151], a[12:15], v[56:59]
s_waitcnt lgkmcnt(7)
ds_read_b64_tr_b16 v[128:129], v234 offset:49152
v_mfma_f32_16x16x32_bf16 v[28:31], v[152:155], a[0:3], v[28:31]
buffer_load_dwordx4 v228, s[28:31], s18 offen offset:0 lds
v_mfma_f32_16x16x32_bf16 v[28:31], v[156:159], a[8:11], v[28:31]
buffer_load_dwordx4 a[64:67], v252, s[44:47], s98 offen offset:0 sc1
v_mfma_f32_16x16x32_bf16 v[60:63], v[152:155], a[4:7], v[60:63]
ds_read_b64_tr_b16 v[130:131], v234 offset:51200
ds_read_b64_tr_b16 v[132:133], v234 offset:57344
v_mfma_f32_16x16x32_bf16 v[60:63], v[156:159], a[12:15], v[60:63]
s_waitcnt lgkmcnt(7)
ds_read_b64_tr_b16 v[134:135], v234 offset:59392
v_mfma_f32_16x16x32_bf16 v[0:3], v[160:163], a[16:19], v[0:3]
buffer_load_dwordx4 v229, s[28:31], s18 offen offset:1024 lds
v_mfma_f32_16x16x32_bf16 v[0:3], v[164:167], a[24:27], v[0:3]
ds_read_b64_tr_b16 v[136:137], v235 offset:49152
ds_read_b64_tr_b16 v[138:139], v235 offset:51200
v_mfma_f32_16x16x32_bf16 v[32:35], v[160:163], a[20:23], v[32:35]
ds_read_b64_tr_b16 v[140:141], v235 offset:57344
ds_read_b64_tr_b16 v[142:143], v235 offset:59392
v_mfma_f32_16x16x32_bf16 v[32:35], v[164:167], a[28:31], v[32:35]
s_waitcnt lgkmcnt(7)
ds_read_b64_tr_b16 v[144:145], v232 offset:53248
v_mfma_f32_16x16x32_bf16 v[4:7], v[168:171], a[16:19], v[4:7]
buffer_load_dwordx4 a[68:71], v253, s[44:47], s98 offen offset:0 sc1
v_mfma_f32_16x16x32_bf16 v[4:7], v[172:175], a[24:27], v[4:7]
ds_read_b64_tr_b16 v[146:147], v232 offset:55296
ds_read_b64_tr_b16 v[148:149], v232 offset:61440
v_mfma_f32_16x16x32_bf16 v[36:39], v[168:171], a[20:23], v[36:39]
buffer_load_dwordx4 v230, s[28:31], s18 offen offset:2048 lds
v_mfma_f32_16x16x32_bf16 v[36:39], v[172:175], a[28:31], v[36:39]
s_waitcnt lgkmcnt(7)
ds_read_b64_tr_b16 v[150:151], v232 offset:63488
v_mfma_f32_16x16x32_bf16 v[8:11], v[128:131], a[16:19], v[8:11]
ds_read_b64_tr_b16 v[152:153], v233 offset:53248
v_mfma_f32_16x16x32_bf16 v[8:11], v[132:135], a[24:27], v[8:11]
buffer_load_dwordx4 a[72:75], v252, s[44:47], s98 offen offset:1024 sc1
v_mfma_f32_16x16x32_bf16 v[40:43], v[128:131], a[20:23], v[40:43]
ds_read_b64_tr_b16 v[154:155], v233 offset:55296
ds_read_b64_tr_b16 v[156:157], v233 offset:61440
v_mfma_f32_16x16x32_bf16 v[40:43], v[132:135], a[28:31], v[40:43]
s_waitcnt lgkmcnt(6)
ds_read_b64_tr_b16 v[158:159], v233 offset:63488
v_mfma_f32_16x16x32_bf16 v[12:15], v[136:139], a[16:19], v[12:15]
buffer_load_dwordx4 v231, s[28:31], s18 offen offset:3072 lds
v_mfma_f32_16x16x32_bf16 v[12:15], v[140:143], a[24:27], v[12:15]
ds_read_b64_tr_b16 v[160:161], v234 offset:53248
ds_read_b64_tr_b16 v[162:163], v234 offset:55296
v_mfma_f32_16x16x32_bf16 v[44:47], v[136:139], a[20:23], v[44:47]
ds_read_b64_tr_b16 v[164:165], v234 offset:61440
ds_read_b64_tr_b16 v[166:167], v234 offset:63488
v_mfma_f32_16x16x32_bf16 v[44:47], v[140:143], a[28:31], v[44:47]
s_waitcnt lgkmcnt(7)
ds_read_b64_tr_b16 v[168:169], v235 offset:53248
v_mfma_f32_16x16x32_bf16 v[16:19], v[144:147], a[16:19], v[16:19]
buffer_load_dwordx4 a[76:79], v253, s[44:47], s98 offen offset:1024 sc1
v_mfma_f32_16x16x32_bf16 v[16:19], v[148:151], a[24:27], v[16:19]
s_waitcnt vmcnt(16)
s_barrier
s_add_u32 m0, s11, 114688
v_mfma_f32_16x16x32_bf16 v[48:51], v[144:147], a[20:23], v[48:51]
ds_read_b64_tr_b16 v[170:171], v235 offset:55296
ds_read_b64_tr_b16 v[172:173], v235 offset:61440
v_mfma_f32_16x16x32_bf16 v[48:51], v[148:151], a[28:31], v[48:51]
s_waitcnt lgkmcnt(7)
ds_read_b64_tr_b16 v[174:175], v235 offset:63488
v_mfma_f32_16x16x32_bf16 v[20:23], v[152:155], a[16:19], v[20:23]
ds_read_b64_tr_b16 v[128:129], v248 offset:0
v_mfma_f32_16x16x32_bf16 v[20:23], v[156:159], a[24:27], v[20:23]
ds_read_b64_tr_b16 v[130:131], v248 offset:2048
ds_read_b64_tr_b16 v[132:133], v248 offset:8192
v_mfma_f32_16x16x32_bf16 v[52:55], v[152:155], a[20:23], v[52:55]
s_xor_b32 s18, s75, 8
s_lshl_b32 s18, s18, 16
s_add_u32 s18, s18, s10
v_mfma_f32_16x16x32_bf16 v[52:55], v[156:159], a[28:31], v[52:55]
s_waitcnt lgkmcnt(6)
ds_read_b64_tr_b16 v[134:135], v248 offset:10240
v_mfma_f32_16x16x32_bf16 v[24:27], v[160:163], a[16:19], v[24:27]
s_xor_b32 s98, s75, 8
s_lshl_b32 s98, s98, 11
s_add_u32 s98, s98, s12
v_mfma_f32_16x16x32_bf16 v[24:27], v[164:167], a[24:27], v[24:27]
ds_read_b64_tr_b16 v[136:137], v249 offset:0
ds_read_b64_tr_b16 v[138:139], v249 offset:2048
v_mfma_f32_16x16x32_bf16 v[56:59], v[160:163], a[20:23], v[56:59]
ds_read_b64_tr_b16 v[140:141], v249 offset:8192
ds_read_b64_tr_b16 v[142:143], v249 offset:10240
v_mfma_f32_16x16x32_bf16 v[56:59], v[164:167], a[28:31], v[56:59]
s_waitcnt lgkmcnt(7)
ds_read_b64_tr_b16 v[144:145], v250 offset:0
v_mfma_f32_16x16x32_bf16 v[28:31], v[168:171], a[16:19], v[28:31]
buffer_load_dwordx4 v228, s[28:31], s18 offen offset:0 lds
v_mfma_f32_16x16x32_bf16 v[28:31], v[172:175], a[24:27], v[28:31]
buffer_load_dwordx4 a[0:3], v252, s[44:47], s98 offen offset:0 sc1
v_mfma_f32_16x16x32_bf16 v[60:63], v[168:171], a[20:23], v[60:63]
ds_read_b64_tr_b16 v[146:147], v250 offset:2048
ds_read_b64_tr_b16 v[148:149], v250 offset:8192
v_mfma_f32_16x16x32_bf16 v[60:63], v[172:175], a[28:31], v[60:63]
s_waitcnt lgkmcnt(7)
ds_read_b64_tr_b16 v[150:151], v250 offset:10240
v_mfma_f32_16x16x32_bf16 v[0:3], v[128:131], a[32:35], v[0:3]
buffer_load_dwordx4 v229, s[28:31], s18 offen offset:1024 lds
v_mfma_f32_16x16x32_bf16 v[0:3], v[132:135], a[40:43], v[0:3]
ds_read_b64_tr_b16 v[152:153], v251 offset:0
ds_read_b64_tr_b16 v[154:155], v251 offset:2048
v_mfma_f32_16x16x32_bf16 v[32:35], v[128:131], a[36:39], v[32:35]
ds_read_b64_tr_b16 v[156:157], v251 offset:8192
ds_read_b64_tr_b16 v[158:159], v251 offset:10240
v_mfma_f32_16x16x32_bf16 v[32:35], v[132:135], a[44:47], v[32:35]
s_waitcnt lgkmcnt(7)
ds_read_b64_tr_b16 v[160:161], v248 offset:4096
v_mfma_f32_16x16x32_bf16 v[4:7], v[136:139], a[32:35], v[4:7]
buffer_load_dwordx4 a[4:7], v253, s[44:47], s98 offen offset:0 sc1
v_mfma_f32_16x16x32_bf16 v[4:7], v[140:143], a[40:43], v[4:7]
ds_read_b64_tr_b16 v[162:163], v248 offset:6144
ds_read_b64_tr_b16 v[164:165], v248 offset:12288
v_mfma_f32_16x16x32_bf16 v[36:39], v[136:139], a[36:39], v[36:39]
buffer_load_dwordx4 v230, s[28:31], s18 offen offset:2048 lds
v_mfma_f32_16x16x32_bf16 v[36:39], v[140:143], a[44:47], v[36:39]
s_waitcnt lgkmcnt(7)
ds_read_b64_tr_b16 v[166:167], v248 offset:14336
v_mfma_f32_16x16x32_bf16 v[8:11], v[144:147], a[32:35], v[8:11]
ds_read_b64_tr_b16 v[168:169], v249 offset:4096
v_mfma_f32_16x16x32_bf16 v[8:11], v[148:151], a[40:43], v[8:11]
buffer_load_dwordx4 a[8:11], v252, s[44:47], s98 offen offset:1024 sc1
v_mfma_f32_16x16x32_bf16 v[40:43], v[144:147], a[36:39], v[40:43]
ds_read_b64_tr_b16 v[170:171], v249 offset:6144
ds_read_b64_tr_b16 v[172:173], v249 offset:12288
v_mfma_f32_16x16x32_bf16 v[40:43], v[148:151], a[44:47], v[40:43]
s_waitcnt lgkmcnt(6)
ds_read_b64_tr_b16 v[174:175], v249 offset:14336
v_mfma_f32_16x16x32_bf16 v[12:15], v[152:155], a[32:35], v[12:15]
buffer_load_dwordx4 v231, s[28:31], s18 offen offset:3072 lds
v_mfma_f32_16x16x32_bf16 v[12:15], v[156:159], a[40:43], v[12:15]
ds_read_b64_tr_b16 v[128:129], v250 offset:4096
ds_read_b64_tr_b16 v[130:131], v250 offset:6144
v_mfma_f32_16x16x32_bf16 v[44:47], v[152:155], a[36:39], v[44:47]
ds_read_b64_tr_b16 v[132:133], v250 offset:12288
ds_read_b64_tr_b16 v[134:135], v250 offset:14336
v_mfma_f32_16x16x32_bf16 v[44:47], v[156:159], a[44:47], v[44:47]
s_waitcnt lgkmcnt(7)
ds_read_b64_tr_b16 v[136:137], v251 offset:4096
v_mfma_f32_16x16x32_bf16 v[16:19], v[160:163], a[32:35], v[16:19]
buffer_load_dwordx4 a[12:15], v253, s[44:47], s98 offen offset:1024 sc1
v_mfma_f32_16x16x32_bf16 v[16:19], v[164:167], a[40:43], v[16:19]
s_waitcnt vmcnt(16)
s_barrier
s_add_u32 m0, s11, 0
v_mfma_f32_16x16x32_bf16 v[48:51], v[160:163], a[36:39], v[48:51]
ds_read_b64_tr_b16 v[138:139], v251 offset:6144
ds_read_b64_tr_b16 v[140:141], v251 offset:12288
v_mfma_f32_16x16x32_bf16 v[48:51], v[164:167], a[44:47], v[48:51]
s_waitcnt lgkmcnt(7)
ds_read_b64_tr_b16 v[142:143], v251 offset:14336
v_mfma_f32_16x16x32_bf16 v[20:23], v[168:171], a[32:35], v[20:23]
ds_read_b64_tr_b16 v[144:145], v248 offset:16384
v_mfma_f32_16x16x32_bf16 v[20:23], v[172:175], a[40:43], v[20:23]
ds_read_b64_tr_b16 v[146:147], v248 offset:18432
ds_read_b64_tr_b16 v[148:149], v248 offset:24576
v_mfma_f32_16x16x32_bf16 v[52:55], v[168:171], a[36:39], v[52:55]
s_xor_b32 s18, s75, 9
s_lshl_b32 s18, s18, 16
s_add_u32 s18, s18, s10
v_mfma_f32_16x16x32_bf16 v[52:55], v[172:175], a[44:47], v[52:55]
s_waitcnt lgkmcnt(6)
ds_read_b64_tr_b16 v[150:151], v248 offset:26624
v_mfma_f32_16x16x32_bf16 v[24:27], v[128:131], a[32:35], v[24:27]
s_xor_b32 s98, s75, 9
s_lshl_b32 s98, s98, 11
s_add_u32 s98, s98, s12
v_mfma_f32_16x16x32_bf16 v[24:27], v[132:135], a[40:43], v[24:27]
ds_read_b64_tr_b16 v[152:153], v249 offset:16384
ds_read_b64_tr_b16 v[154:155], v249 offset:18432
v_mfma_f32_16x16x32_bf16 v[56:59], v[128:131], a[36:39], v[56:59]
ds_read_b64_tr_b16 v[156:157], v249 offset:24576
ds_read_b64_tr_b16 v[158:159], v249 offset:26624
v_mfma_f32_16x16x32_bf16 v[56:59], v[132:135], a[44:47], v[56:59]
s_waitcnt lgkmcnt(7)
ds_read_b64_tr_b16 v[160:161], v250 offset:16384
v_mfma_f32_16x16x32_bf16 v[28:31], v[136:139], a[32:35], v[28:31]
buffer_load_dwordx4 v228, s[28:31], s18 offen offset:0 lds
v_mfma_f32_16x16x32_bf16 v[28:31], v[140:143], a[40:43], v[28:31]
buffer_load_dwordx4 a[16:19], v252, s[44:47], s98 offen offset:0 sc1
v_mfma_f32_16x16x32_bf16 v[60:63], v[136:139], a[36:39], v[60:63]
ds_read_b64_tr_b16 v[162:163], v250 offset:18432
ds_read_b64_tr_b16 v[164:165], v250 offset:24576
v_mfma_f32_16x16x32_bf16 v[60:63], v[140:143], a[44:47], v[60:63]
s_waitcnt lgkmcnt(7)
ds_read_b64_tr_b16 v[166:167], v250 offset:26624
v_mfma_f32_16x16x32_bf16 v[0:3], v[144:147], a[48:51], v[0:3]
buffer_load_dwordx4 v229, s[28:31], s18 offen offset:1024 lds
v_mfma_f32_16x16x32_bf16 v[0:3], v[148:151], a[56:59], v[0:3]
ds_read_b64_tr_b16 v[168:169], v251 offset:16384
ds_read_b64_tr_b16 v[170:171], v251 offset:18432
v_mfma_f32_16x16x32_bf16 v[32:35], v[144:147], a[52:55], v[32:35]
ds_read_b64_tr_b16 v[172:173], v251 offset:24576
ds_read_b64_tr_b16 v[174:175], v251 offset:26624
v_mfma_f32_16x16x32_bf16 v[32:35], v[148:151], a[60:63], v[32:35]
s_waitcnt lgkmcnt(7)
ds_read_b64_tr_b16 v[128:129], v248 offset:20480
v_mfma_f32_16x16x32_bf16 v[4:7], v[152:155], a[48:51], v[4:7]
buffer_load_dwordx4 a[20:23], v253, s[44:47], s98 offen offset:0 sc1
v_mfma_f32_16x16x32_bf16 v[4:7], v[156:159], a[56:59], v[4:7]
ds_read_b64_tr_b16 v[130:131], v248 offset:22528
ds_read_b64_tr_b16 v[132:133], v248 offset:28672
v_mfma_f32_16x16x32_bf16 v[36:39], v[152:155], a[52:55], v[36:39]
buffer_load_dwordx4 v230, s[28:31], s18 offen offset:2048 lds
v_mfma_f32_16x16x32_bf16 v[36:39], v[156:159], a[60:63], v[36:39]
s_waitcnt lgkmcnt(7)
ds_read_b64_tr_b16 v[134:135], v248 offset:30720
v_mfma_f32_16x16x32_bf16 v[8:11], v[160:163], a[48:51], v[8:11]
ds_read_b64_tr_b16 v[136:137], v249 offset:20480
v_mfma_f32_16x16x32_bf16 v[8:11], v[164:167], a[56:59], v[8:11]
buffer_load_dwordx4 a[24:27], v252, s[44:47], s98 offen offset:1024 sc1
v_mfma_f32_16x16x32_bf16 v[40:43], v[160:163], a[52:55], v[40:43]
ds_read_b64_tr_b16 v[138:139], v249 offset:22528
ds_read_b64_tr_b16 v[140:141], v249 offset:28672
v_mfma_f32_16x16x32_bf16 v[40:43], v[164:167], a[60:63], v[40:43]
s_waitcnt lgkmcnt(6)
ds_read_b64_tr_b16 v[142:143], v249 offset:30720
v_mfma_f32_16x16x32_bf16 v[12:15], v[168:171], a[48:51], v[12:15]
buffer_load_dwordx4 v231, s[28:31], s18 offen offset:3072 lds
v_mfma_f32_16x16x32_bf16 v[12:15], v[172:175], a[56:59], v[12:15]
ds_read_b64_tr_b16 v[144:145], v250 offset:20480
ds_read_b64_tr_b16 v[146:147], v250 offset:22528
v_mfma_f32_16x16x32_bf16 v[44:47], v[168:171], a[52:55], v[44:47]
ds_read_b64_tr_b16 v[148:149], v250 offset:28672
ds_read_b64_tr_b16 v[150:151], v250 offset:30720
v_mfma_f32_16x16x32_bf16 v[44:47], v[172:175], a[60:63], v[44:47]
s_waitcnt lgkmcnt(7)
ds_read_b64_tr_b16 v[152:153], v251 offset:20480
v_mfma_f32_16x16x32_bf16 v[16:19], v[128:131], a[48:51], v[16:19]
buffer_load_dwordx4 a[28:31], v253, s[44:47], s98 offen offset:1024 sc1
v_mfma_f32_16x16x32_bf16 v[16:19], v[132:135], a[56:59], v[16:19]
s_waitcnt vmcnt(16)
s_barrier
s_cmp_lg_u32 s56, 0
s_cbranch_scc1 L_sig23
s_mov_b64 exec, 1
buffer_atomic_add v239, v238, s[48:51], s66 offen sc1
s_mov_b64 exec, -1
L_sig23:
v_mfma_f32_16x16x32_bf16 v[48:51], v[128:131], a[52:55], v[48:51]
ds_read_b64_tr_b16 v[154:155], v251 offset:22528
s_add_u32 m0, s11, 16384
v_mfma_f32_16x16x32_bf16 v[48:51], v[132:135], a[60:63], v[48:51]
s_waitcnt lgkmcnt(6)
ds_read_b64_tr_b16 v[156:157], v251 offset:28672
v_mfma_f32_16x16x32_bf16 v[20:23], v[136:139], a[48:51], v[20:23]
ds_read_b64_tr_b16 v[158:159], v251 offset:30720
ds_read_b64_tr_b16 v[160:161], v248 offset:32768
v_mfma_f32_16x16x32_bf16 v[20:23], v[140:143], a[56:59], v[20:23]
ds_read_b64_tr_b16 v[162:163], v248 offset:34816
ds_read_b64_tr_b16 v[164:165], v248 offset:40960
v_mfma_f32_16x16x32_bf16 v[52:55], v[136:139], a[52:55], v[52:55]
s_xor_b32 s18, s75, 10
s_lshl_b32 s18, s18, 16
s_add_u32 s18, s18, s10
v_mfma_f32_16x16x32_bf16 v[52:55], v[140:143], a[60:63], v[52:55]
s_waitcnt lgkmcnt(6)
ds_read_b64_tr_b16 v[166:167], v248 offset:43008
v_mfma_f32_16x16x32_bf16 v[24:27], v[144:147], a[48:51], v[24:27]
s_xor_b32 s98, s75, 10
s_lshl_b32 s98, s98, 11
s_add_u32 s98, s98, s12
v_mfma_f32_16x16x32_bf16 v[24:27], v[148:151], a[56:59], v[24:27]
ds_read_b64_tr_b16 v[168:169], v249 offset:32768
ds_read_b64_tr_b16 v[170:171], v249 offset:34816
v_mfma_f32_16x16x32_bf16 v[56:59], v[144:147], a[52:55], v[56:59]
ds_read_b64_tr_b16 v[172:173], v249 offset:40960
ds_read_b64_tr_b16 v[174:175], v249 offset:43008
v_mfma_f32_16x16x32_bf16 v[56:59], v[148:151], a[60:63], v[56:59]
s_waitcnt lgkmcnt(7)
ds_read_b64_tr_b16 v[128:129], v250 offset:32768
v_mfma_f32_16x16x32_bf16 v[28:31], v[152:155], a[48:51], v[28:31]
buffer_load_dwordx4 v228, s[28:31], s18 offen offset:0 lds
v_mfma_f32_16x16x32_bf16 v[28:31], v[156:159], a[56:59], v[28:31]
buffer_load_dwordx4 a[32:35], v252, s[44:47], s98 offen offset:0 sc1
v_mfma_f32_16x16x32_bf16 v[60:63], v[152:155], a[52:55], v[60:63]
ds_read_b64_tr_b16 v[130:131], v250 offset:34816
ds_read_b64_tr_b16 v[132:133], v250 offset:40960
v_mfma_f32_16x16x32_bf16 v[60:63], v[156:159], a[60:63], v[60:63]
s_waitcnt lgkmcnt(7)
ds_read_b64_tr_b16 v[134:135], v250 offset:43008
v_mfma_f32_16x16x32_bf16 v[0:3], v[160:163], a[64:67], v[0:3]
buffer_load_dwordx4 v229, s[28:31], s18 offen offset:1024 lds
v_mfma_f32_16x16x32_bf16 v[0:3], v[164:167], a[72:75], v[0:3]
ds_read_b64_tr_b16 v[136:137], v251 offset:32768
ds_read_b64_tr_b16 v[138:139], v251 offset:34816
v_mfma_f32_16x16x32_bf16 v[32:35], v[160:163], a[68:71], v[32:35]
ds_read_b64_tr_b16 v[140:141], v251 offset:40960
ds_read_b64_tr_b16 v[142:143], v251 offset:43008
v_mfma_f32_16x16x32_bf16 v[32:35], v[164:167], a[76:79], v[32:35]
s_waitcnt lgkmcnt(7)
ds_read_b64_tr_b16 v[144:145], v248 offset:36864
v_mfma_f32_16x16x32_bf16 v[4:7], v[168:171], a[64:67], v[4:7]
buffer_load_dwordx4 a[36:39], v253, s[44:47], s98 offen offset:0 sc1
v_mfma_f32_16x16x32_bf16 v[4:7], v[172:175], a[72:75], v[4:7]
ds_read_b64_tr_b16 v[146:147], v248 offset:38912
ds_read_b64_tr_b16 v[148:149], v248 offset:45056
v_mfma_f32_16x16x32_bf16 v[36:39], v[168:171], a[68:71], v[36:39]
buffer_load_dwordx4 v230, s[28:31], s18 offen offset:2048 lds
v_mfma_f32_16x16x32_bf16 v[36:39], v[172:175], a[76:79], v[36:39]
s_waitcnt lgkmcnt(7)
ds_read_b64_tr_b16 v[150:151], v248 offset:47104
v_mfma_f32_16x16x32_bf16 v[8:11], v[128:131], a[64:67], v[8:11]
ds_read_b64_tr_b16 v[152:153], v249 offset:36864
v_mfma_f32_16x16x32_bf16 v[8:11], v[132:135], a[72:75], v[8:11]
buffer_load_dwordx4 a[40:43], v252, s[44:47], s98 offen offset:1024 sc1
v_mfma_f32_16x16x32_bf16 v[40:43], v[128:131], a[68:71], v[40:43]
ds_read_b64_tr_b16 v[154:155], v249 offset:38912
ds_read_b64_tr_b16 v[156:157], v249 offset:45056
v_mfma_f32_16x16x32_bf16 v[40:43], v[132:135], a[76:79], v[40:43]
s_waitcnt lgkmcnt(6)
ds_read_b64_tr_b16 v[158:159], v249 offset:47104
v_mfma_f32_16x16x32_bf16 v[12:15], v[136:139], a[64:67], v[12:15]
buffer_load_dwordx4 v231, s[28:31], s18 offen offset:3072 lds
v_mfma_f32_16x16x32_bf16 v[12:15], v[140:143], a[72:75], v[12:15]
ds_read_b64_tr_b16 v[160:161], v250 offset:36864
ds_read_b64_tr_b16 v[162:163], v250 offset:38912
v_mfma_f32_16x16x32_bf16 v[44:47], v[136:139], a[68:71], v[44:47]
ds_read_b64_tr_b16 v[164:165], v250 offset:45056
ds_read_b64_tr_b16 v[166:167], v250 offset:47104
v_mfma_f32_16x16x32_bf16 v[44:47], v[140:143], a[76:79], v[44:47]
s_waitcnt lgkmcnt(7)
ds_read_b64_tr_b16 v[168:169], v251 offset:36864
v_mfma_f32_16x16x32_bf16 v[16:19], v[144:147], a[64:67], v[16:19]
buffer_load_dwordx4 a[44:47], v253, s[44:47], s98 offen offset:1024 sc1
v_mfma_f32_16x16x32_bf16 v[16:19], v[148:151], a[72:75], v[16:19]
s_waitcnt vmcnt(16)
s_barrier
s_add_u32 m0, s11, 32768
v_mfma_f32_16x16x32_bf16 v[48:51], v[144:147], a[68:71], v[48:51]
ds_read_b64_tr_b16 v[170:171], v251 offset:38912
ds_read_b64_tr_b16 v[172:173], v251 offset:45056
v_mfma_f32_16x16x32_bf16 v[48:51], v[148:151], a[76:79], v[48:51]
s_waitcnt lgkmcnt(7)
ds_read_b64_tr_b16 v[174:175], v251 offset:47104
v_mfma_f32_16x16x32_bf16 v[20:23], v[152:155], a[64:67], v[20:23]
ds_read_b64_tr_b16 v[128:129], v248 offset:49152
v_mfma_f32_16x16x32_bf16 v[20:23], v[156:159], a[72:75], v[20:23]
ds_read_b64_tr_b16 v[130:131], v248 offset:51200
ds_read_b64_tr_b16 v[132:133], v248 offset:57344
v_mfma_f32_16x16x32_bf16 v[52:55], v[152:155], a[68:71], v[52:55]
s_xor_b32 s18, s75, 11
s_lshl_b32 s18, s18, 16
s_add_u32 s18, s18, s10
v_mfma_f32_16x16x32_bf16 v[52:55], v[156:159], a[76:79], v[52:55]
s_waitcnt lgkmcnt(6)
ds_read_b64_tr_b16 v[134:135], v248 offset:59392
v_mfma_f32_16x16x32_bf16 v[24:27], v[160:163], a[64:67], v[24:27]
s_xor_b32 s98, s75, 11
s_lshl_b32 s98, s98, 11
s_add_u32 s98, s98, s12
v_mfma_f32_16x16x32_bf16 v[24:27], v[164:167], a[72:75], v[24:27]
ds_read_b64_tr_b16 v[136:137], v249 offset:49152
ds_read_b64_tr_b16 v[138:139], v249 offset:51200
v_mfma_f32_16x16x32_bf16 v[56:59], v[160:163], a[68:71], v[56:59]
ds_read_b64_tr_b16 v[140:141], v249 offset:57344
ds_read_b64_tr_b16 v[142:143], v249 offset:59392
v_mfma_f32_16x16x32_bf16 v[56:59], v[164:167], a[76:79], v[56:59]
s_waitcnt lgkmcnt(7)
ds_read_b64_tr_b16 v[144:145], v250 offset:49152
v_mfma_f32_16x16x32_bf16 v[28:31], v[168:171], a[64:67], v[28:31]
buffer_load_dwordx4 v228, s[28:31], s18 offen offset:0 lds
v_mfma_f32_16x16x32_bf16 v[28:31], v[172:175], a[72:75], v[28:31]
buffer_load_dwordx4 a[48:51], v252, s[44:47], s98 offen offset:0 sc1
v_mfma_f32_16x16x32_bf16 v[60:63], v[168:171], a[68:71], v[60:63]
ds_read_b64_tr_b16 v[146:147], v250 offset:51200
ds_read_b64_tr_b16 v[148:149], v250 offset:57344
v_mfma_f32_16x16x32_bf16 v[60:63], v[172:175], a[76:79], v[60:63]
s_waitcnt lgkmcnt(7)
ds_read_b64_tr_b16 v[150:151], v250 offset:59392
v_mfma_f32_16x16x32_bf16 v[0:3], v[128:131], a[0:3], v[0:3]
buffer_load_dwordx4 v229, s[28:31], s18 offen offset:1024 lds
v_mfma_f32_16x16x32_bf16 v[0:3], v[132:135], a[8:11], v[0:3]
ds_read_b64_tr_b16 v[152:153], v251 offset:49152
ds_read_b64_tr_b16 v[154:155], v251 offset:51200
v_mfma_f32_16x16x32_bf16 v[32:35], v[128:131], a[4:7], v[32:35]
ds_read_b64_tr_b16 v[156:157], v251 offset:57344
ds_read_b64_tr_b16 v[158:159], v251 offset:59392
v_mfma_f32_16x16x32_bf16 v[32:35], v[132:135], a[12:15], v[32:35]
s_waitcnt lgkmcnt(7)
ds_read_b64_tr_b16 v[160:161], v248 offset:53248
v_mfma_f32_16x16x32_bf16 v[4:7], v[136:139], a[0:3], v[4:7]
buffer_load_dwordx4 a[52:55], v253, s[44:47], s98 offen offset:0 sc1
v_mfma_f32_16x16x32_bf16 v[4:7], v[140:143], a[8:11], v[4:7]
ds_read_b64_tr_b16 v[162:163], v248 offset:55296
ds_read_b64_tr_b16 v[164:165], v248 offset:61440
v_mfma_f32_16x16x32_bf16 v[36:39], v[136:139], a[4:7], v[36:39]
buffer_load_dwordx4 v230, s[28:31], s18 offen offset:2048 lds
v_mfma_f32_16x16x32_bf16 v[36:39], v[140:143], a[12:15], v[36:39]
s_waitcnt lgkmcnt(7)
ds_read_b64_tr_b16 v[166:167], v248 offset:63488
v_mfma_f32_16x16x32_bf16 v[8:11], v[144:147], a[0:3], v[8:11]
ds_read_b64_tr_b16 v[168:169], v249 offset:53248
v_mfma_f32_16x16x32_bf16 v[8:11], v[148:151], a[8:11], v[8:11]
buffer_load_dwordx4 a[56:59], v252, s[44:47], s98 offen offset:1024 sc1
v_mfma_f32_16x16x32_bf16 v[40:43], v[144:147], a[4:7], v[40:43]
ds_read_b64_tr_b16 v[170:171], v249 offset:55296
ds_read_b64_tr_b16 v[172:173], v249 offset:61440
v_mfma_f32_16x16x32_bf16 v[40:43], v[148:151], a[12:15], v[40:43]
s_waitcnt lgkmcnt(6)
ds_read_b64_tr_b16 v[174:175], v249 offset:63488
v_mfma_f32_16x16x32_bf16 v[12:15], v[152:155], a[0:3], v[12:15]
buffer_load_dwordx4 v231, s[28:31], s18 offen offset:3072 lds
v_mfma_f32_16x16x32_bf16 v[12:15], v[156:159], a[8:11], v[12:15]
ds_read_b64_tr_b16 v[128:129], v250 offset:53248
ds_read_b64_tr_b16 v[130:131], v250 offset:55296
v_mfma_f32_16x16x32_bf16 v[44:47], v[152:155], a[4:7], v[44:47]
ds_read_b64_tr_b16 v[132:133], v250 offset:61440
ds_read_b64_tr_b16 v[134:135], v250 offset:63488
v_mfma_f32_16x16x32_bf16 v[44:47], v[156:159], a[12:15], v[44:47]
s_waitcnt lgkmcnt(7)
ds_read_b64_tr_b16 v[136:137], v251 offset:53248
v_mfma_f32_16x16x32_bf16 v[16:19], v[160:163], a[0:3], v[16:19]
buffer_load_dwordx4 a[60:63], v253, s[44:47], s98 offen offset:1024 sc1
v_mfma_f32_16x16x32_bf16 v[16:19], v[164:167], a[8:11], v[16:19]
s_waitcnt vmcnt(16)
s_barrier
s_add_u32 m0, s11, 49152
v_mfma_f32_16x16x32_bf16 v[48:51], v[160:163], a[4:7], v[48:51]
ds_read_b64_tr_b16 v[138:139], v251 offset:55296
ds_read_b64_tr_b16 v[140:141], v251 offset:61440
v_mfma_f32_16x16x32_bf16 v[48:51], v[164:167], a[12:15], v[48:51]
s_waitcnt lgkmcnt(7)
ds_read_b64_tr_b16 v[142:143], v251 offset:63488
v_mfma_f32_16x16x32_bf16 v[20:23], v[168:171], a[0:3], v[20:23]
ds_read_b64_tr_b16 v[144:145], v232 offset:0
v_mfma_f32_16x16x32_bf16 v[20:23], v[172:175], a[8:11], v[20:23]
ds_read_b64_tr_b16 v[146:147], v232 offset:2048
ds_read_b64_tr_b16 v[148:149], v232 offset:8192
v_mfma_f32_16x16x32_bf16 v[52:55], v[168:171], a[4:7], v[52:55]
s_xor_b32 s18, s75, 12
s_lshl_b32 s18, s18, 16
s_add_u32 s18, s18, s10
v_mfma_f32_16x16x32_bf16 v[52:55], v[172:175], a[12:15], v[52:55]
s_waitcnt lgkmcnt(6)
ds_read_b64_tr_b16 v[150:151], v232 offset:10240
v_mfma_f32_16x16x32_bf16 v[24:27], v[128:131], a[0:3], v[24:27]
s_xor_b32 s98, s75, 12
s_lshl_b32 s98, s98, 11
s_add_u32 s98, s98, s12
v_mfma_f32_16x16x32_bf16 v[24:27], v[132:135], a[8:11], v[24:27]
ds_read_b64_tr_b16 v[152:153], v233 offset:0
ds_read_b64_tr_b16 v[154:155], v233 offset:2048
v_mfma_f32_16x16x32_bf16 v[56:59], v[128:131], a[4:7], v[56:59]
ds_read_b64_tr_b16 v[156:157], v233 offset:8192
ds_read_b64_tr_b16 v[158:159], v233 offset:10240
v_mfma_f32_16x16x32_bf16 v[56:59], v[132:135], a[12:15], v[56:59]
s_waitcnt lgkmcnt(7)
ds_read_b64_tr_b16 v[160:161], v234 offset:0
v_mfma_f32_16x16x32_bf16 v[28:31], v[136:139], a[0:3], v[28:31]
buffer_load_dwordx4 v228, s[28:31], s18 offen offset:0 lds
v_mfma_f32_16x16x32_bf16 v[28:31], v[140:143], a[8:11], v[28:31]
buffer_load_dwordx4 a[64:67], v252, s[44:47], s98 offen offset:0 sc1
v_mfma_f32_16x16x32_bf16 v[60:63], v[136:139], a[4:7], v[60:63]
ds_read_b64_tr_b16 v[162:163], v234 offset:2048
ds_read_b64_tr_b16 v[164:165], v234 offset:8192
v_mfma_f32_16x16x32_bf16 v[60:63], v[140:143], a[12:15], v[60:63]
s_waitcnt lgkmcnt(7)
ds_read_b64_tr_b16 v[166:167], v234 offset:10240
v_mfma_f32_16x16x32_bf16 v[0:3], v[144:147], a[16:19], v[0:3]
buffer_load_dwordx4 v229, s[28:31], s18 offen offset:1024 lds
v_mfma_f32_16x16x32_bf16 v[0:3], v[148:151], a[24:27], v[0:3]
ds_read_b64_tr_b16 v[168:169], v235 offset:0
ds_read_b64_tr_b16 v[170:171], v235 offset:2048
v_mfma_f32_16x16x32_bf16 v[32:35], v[144:147], a[20:23], v[32:35]
ds_read_b64_tr_b16 v[172:173], v235 offset:8192
ds_read_b64_tr_b16 v[174:175], v235 offset:10240
v_mfma_f32_16x16x32_bf16 v[32:35], v[148:151], a[28:31], v[32:35]
s_waitcnt lgkmcnt(7)
ds_read_b64_tr_b16 v[128:129], v232 offset:4096
v_mfma_f32_16x16x32_bf16 v[4:7], v[152:155], a[16:19], v[4:7]
buffer_load_dwordx4 a[68:71], v253, s[44:47], s98 offen offset:0 sc1
v_mfma_f32_16x16x32_bf16 v[4:7], v[156:159], a[24:27], v[4:7]
ds_read_b64_tr_b16 v[130:131], v232 offset:6144
ds_read_b64_tr_b16 v[132:133], v232 offset:12288
v_mfma_f32_16x16x32_bf16 v[36:39], v[152:155], a[20:23], v[36:39]
buffer_load_dwordx4 v230, s[28:31], s18 offen offset:2048 lds
v_mfma_f32_16x16x32_bf16 v[36:39], v[156:159], a[28:31], v[36:39]
s_waitcnt lgkmcnt(7)
ds_read_b64_tr_b16 v[134:135], v232 offset:14336
v_mfma_f32_16x16x32_bf16 v[8:11], v[160:163], a[16:19], v[8:11]
ds_read_b64_tr_b16 v[136:137], v233 offset:4096
v_mfma_f32_16x16x32_bf16 v[8:11], v[164:167], a[24:27], v[8:11]
buffer_load_dwordx4 a[72:75], v252, s[44:47], s98 offen offset:1024 sc1
v_mfma_f32_16x16x32_bf16 v[40:43], v[160:163], a[20:23], v[40:43]
ds_read_b64_tr_b16 v[138:139], v233 offset:6144
ds_read_b64_tr_b16 v[140:141], v233 offset:12288
v_mfma_f32_16x16x32_bf16 v[40:43], v[164:167], a[28:31], v[40:43]
s_waitcnt lgkmcnt(6)
ds_read_b64_tr_b16 v[142:143], v233 offset:14336
v_mfma_f32_16x16x32_bf16 v[12:15], v[168:171], a[16:19], v[12:15]
buffer_load_dwordx4 v231, s[28:31], s18 offen offset:3072 lds
v_mfma_f32_16x16x32_bf16 v[12:15], v[172:175], a[24:27], v[12:15]
ds_read_b64_tr_b16 v[144:145], v234 offset:4096
ds_read_b64_tr_b16 v[146:147], v234 offset:6144
v_mfma_f32_16x16x32_bf16 v[44:47], v[168:171], a[20:23], v[44:47]
ds_read_b64_tr_b16 v[148:149], v234 offset:12288
ds_read_b64_tr_b16 v[150:151], v234 offset:14336
v_mfma_f32_16x16x32_bf16 v[44:47], v[172:175], a[28:31], v[44:47]
s_waitcnt lgkmcnt(7)
ds_read_b64_tr_b16 v[152:153], v235 offset:4096
v_mfma_f32_16x16x32_bf16 v[16:19], v[128:131], a[16:19], v[16:19]
buffer_load_dwordx4 a[76:79], v253, s[44:47], s98 offen offset:1024 sc1
v_mfma_f32_16x16x32_bf16 v[16:19], v[132:135], a[24:27], v[16:19]
s_waitcnt vmcnt(16)
s_barrier
s_add_u32 m0, s11, 65536
v_mfma_f32_16x16x32_bf16 v[48:51], v[128:131], a[20:23], v[48:51]
ds_read_b64_tr_b16 v[154:155], v235 offset:6144
ds_read_b64_tr_b16 v[156:157], v235 offset:12288
v_mfma_f32_16x16x32_bf16 v[48:51], v[132:135], a[28:31], v[48:51]
s_waitcnt lgkmcnt(7)
ds_read_b64_tr_b16 v[158:159], v235 offset:14336
v_mfma_f32_16x16x32_bf16 v[20:23], v[136:139], a[16:19], v[20:23]
ds_read_b64_tr_b16 v[160:161], v232 offset:16384
v_mfma_f32_16x16x32_bf16 v[20:23], v[140:143], a[24:27], v[20:23]
ds_read_b64_tr_b16 v[162:163], v232 offset:18432
ds_read_b64_tr_b16 v[164:165], v232 offset:24576
v_mfma_f32_16x16x32_bf16 v[52:55], v[136:139], a[20:23], v[52:55]
s_xor_b32 s18, s75, 13
s_lshl_b32 s18, s18, 16
s_add_u32 s18, s18, s10
v_mfma_f32_16x16x32_bf16 v[52:55], v[140:143], a[28:31], v[52:55]
s_waitcnt lgkmcnt(6)
ds_read_b64_tr_b16 v[166:167], v232 offset:26624
v_mfma_f32_16x16x32_bf16 v[24:27], v[144:147], a[16:19], v[24:27]
s_xor_b32 s98, s75, 13
s_lshl_b32 s98, s98, 11
s_add_u32 s98, s98, s12
v_mfma_f32_16x16x32_bf16 v[24:27], v[148:151], a[24:27], v[24:27]
ds_read_b64_tr_b16 v[168:169], v233 offset:16384
ds_read_b64_tr_b16 v[170:171], v233 offset:18432
v_mfma_f32_16x16x32_bf16 v[56:59], v[144:147], a[20:23], v[56:59]
buffer_load_dwordx4 v228, s[28:31], s18 offen offset:0 lds
v_mfma_f32_16x16x32_bf16 v[56:59], v[148:151], a[28:31], v[56:59]
s_waitcnt lgkmcnt(5)
ds_read_b64_tr_b16 v[172:173], v233 offset:24576
v_mfma_f32_16x16x32_bf16 v[28:31], v[152:155], a[16:19], v[28:31]
ds_read_b64_tr_b16 v[174:175], v233 offset:26624
ds_read_b64_tr_b16 v[128:129], v234 offset:16384
v_mfma_f32_16x16x32_bf16 v[28:31], v[156:159], a[24:27], v[28:31]
buffer_load_dwordx4 a[0:3], v252, s[44:47], s98 offen offset:0 sc1
v_mfma_f32_16x16x32_bf16 v[60:63], v[152:155], a[20:23], v[60:63]
ds_read_b64_tr_b16 v[130:131], v234 offset:18432
ds_read_b64_tr_b16 v[132:133], v234 offset:24576
v_mfma_f32_16x16x32_bf16 v[60:63], v[156:159], a[28:31], v[60:63]
s_waitcnt lgkmcnt(7)
ds_read_b64_tr_b16 v[134:135], v234 offset:26624
v_mfma_f32_16x16x32_bf16 v[0:3], v[160:163], a[32:35], v[0:3]
buffer_load_dwordx4 v229, s[28:31], s18 offen offset:1024 lds
v_mfma_f32_16x16x32_bf16 v[0:3], v[164:167], a[40:43], v[0:3]
ds_read_b64_tr_b16 v[136:137], v235 offset:16384
ds_read_b64_tr_b16 v[138:139], v235 offset:18432
v_mfma_f32_16x16x32_bf16 v[32:35], v[160:163], a[36:39], v[32:35]
buffer_load_dwordx4 a[4:7], v253, s[44:47], s98 offen offset:0 sc1
v_mfma_f32_16x16x32_bf16 v[32:35], v[164:167], a[44:47], v[32:35]
s_waitcnt lgkmcnt(5)
ds_read_b64_tr_b16 v[140:141], v235 offset:24576
v_mfma_f32_16x16x32_bf16 v[4:7], v[168:171], a[32:35], v[4:7]
ds_read_b64_tr_b16 v[142:143], v235 offset:26624
ds_read_b64_tr_b16 v[144:145], v232 offset:20480
v_mfma_f32_16x16x32_bf16 v[4:7], v[172:175], a[40:43], v[4:7]
buffer_load_dwordx4 v230, s[28:31], s18 offen offset:2048 lds
v_mfma_f32_16x16x32_bf16 v[36:39], v[168:171], a[36:39], v[36:39]
ds_read_b64_tr_b16 v[146:147], v232 offset:22528
ds_read_b64_tr_b16 v[148:149], v232 offset:28672
v_mfma_f32_16x16x32_bf16 v[36:39], v[172:175], a[44:47], v[36:39]
s_waitcnt lgkmcnt(7)
ds_read_b64_tr_b16 v[150:151], v232 offset:30720
v_mfma_f32_16x16x32_bf16 v[8:11], v[128:131], a[32:35], v[8:11]
buffer_load_dwordx4 a[8:11], v252, s[44:47], s98 offen offset:1024 sc1
v_mfma_f32_16x16x32_bf16 v[8:11], v[132:135], a[40:43], v[8:11]
ds_read_b64_tr_b16 v[152:153], v233 offset:20480
ds_read_b64_tr_b16 v[154:155], v233 offset:22528
v_mfma_f32_16x16x32_bf16 v[40:43], v[128:131], a[36:39], v[40:43]
buffer_load_dwordx4 v231, s[28:31], s18 offen offset:3072 lds
v_mfma_f32_16x16x32_bf16 v[40:43], v[132:135], a[44:47], v[40:43]
s_waitcnt lgkmcnt(5)
ds_read_b64_tr_b16 v[156:157], v233 offset:28672
v_mfma_f32_16x16x32_bf16 v[12:15], v[136:139], a[32:35], v[12:15]
ds_read_b64_tr_b16 v[158:159], v233 offset:30720
ds_read_b64_tr_b16 v[160:161], v234 offset:20480
v_mfma_f32_16x16x32_bf16 v[12:15], v[140:143], a[40:43], v[12:15]
buffer_load_dwordx4 a[12:15], v253, s[44:47], s98 offen offset:1024 sc1
v_mfma_f32_16x16x32_bf16 v[44:47], v[136:139], a[36:39], v[44:47]
ds_read_b64_tr_b16 v[162:163], v234 offset:22528
ds_read_b64_tr_b16 v[164:165], v234 offset:28672
v_mfma_f32_16x16x32_bf16 v[44:47], v[140:143], a[44:47], v[44:47]
s_waitcnt lgkmcnt(7)
ds_read_b64_tr_b16 v[166:167], v234 offset:30720
v_mfma_f32_16x16x32_bf16 v[16:19], v[144:147], a[32:35], v[16:19]
buffer_load_dword v237, v238, s[48:51], s66 offen sc1
v_mfma_f32_16x16x32_bf16 v[16:19], v[148:151], a[40:43], v[16:19]
s_waitcnt vmcnt(17)
s_barrier
s_add_u32 m0, s11, 81920
v_mfma_f32_16x16x32_bf16 v[48:51], v[144:147], a[36:39], v[48:51]
ds_read_b64_tr_b16 v[168:169], v235 offset:20480
ds_read_b64_tr_b16 v[170:171], v235 offset:22528
v_mfma_f32_16x16x32_bf16 v[48:51], v[148:151], a[44:47], v[48:51]
s_waitcnt lgkmcnt(5)
ds_read_b64_tr_b16 v[172:173], v235 offset:28672
v_mfma_f32_16x16x32_bf16 v[20:23], v[152:155], a[32:35], v[20:23]
ds_read_b64_tr_b16 v[174:175], v235 offset:30720
ds_read_b64_tr_b16 v[128:129], v232 offset:32768
v_mfma_f32_16x16x32_bf16 v[20:23], v[156:159], a[40:43], v[20:23]
ds_read_b64_tr_b16 v[130:131], v232 offset:34816
ds_read_b64_tr_b16 v[132:133], v232 offset:40960
v_mfma_f32_16x16x32_bf16 v[52:55], v[152:155], a[36:39], v[52:55]
s_xor_b32 s18, s75, 14
s_lshl_b32 s18, s18, 16
s_add_u32 s18, s18, s10
v_mfma_f32_16x16x32_bf16 v[52:55], v[156:159], a[44:47], v[52:55]
s_waitcnt lgkmcnt(7)
ds_read_b64_tr_b16 v[134:135], v232 offset:43008
v_mfma_f32_16x16x32_bf16 v[24:27], v[160:163], a[32:35], v[24:27]
s_xor_b32 s98, s75, 14
s_lshl_b32 s98, s98, 11
s_add_u32 s98, s98, s12
v_mfma_f32_16x16x32_bf16 v[24:27], v[164:167], a[40:43], v[24:27]
ds_read_b64_tr_b16 v[136:137], v233 offset:32768
ds_read_b64_tr_b16 v[138:139], v233 offset:34816
v_mfma_f32_16x16x32_bf16 v[56:59], v[160:163], a[36:39], v[56:59]
ds_read_b64_tr_b16 v[140:141], v233 offset:40960
ds_read_b64_tr_b16 v[142:143], v233 offset:43008
v_mfma_f32_16x16x32_bf16 v[56:59], v[164:167], a[44:47], v[56:59]
s_waitcnt lgkmcnt(7)
ds_read_b64_tr_b16 v[144:145], v234 offset:32768
v_mfma_f32_16x16x32_bf16 v[28:31], v[168:171], a[32:35], v[28:31]
buffer_load_dwordx4 v228, s[28:31], s18 offen offset:0 lds
v_mfma_f32_16x16x32_bf16 v[28:31], v[172:175], a[40:43], v[28:31]
buffer_load_dwordx4 a[16:19], v252, s[44:47], s98 offen offset:0 sc1
v_mfma_f32_16x16x32_bf16 v[60:63], v[168:171], a[36:39], v[60:63]
ds_read_b64_tr_b16 v[146:147], v234 offset:34816
ds_read_b64_tr_b16 v[148:149], v234 offset:40960
v_mfma_f32_16x16x32_bf16 v[60:63], v[172:175], a[44:47], v[60:63]
s_waitcnt lgkmcnt(7)
ds_read_b64_tr_b16 v[150:151], v234 offset:43008
v_mfma_f32_16x16x32_bf16 v[0:3], v[128:131], a[48:51], v[0:3]
buffer_load_dwordx4 v229, s[28:31], s18 offen offset:1024 lds
v_mfma_f32_16x16x32_bf16 v[0:3], v[132:135], a[56:59], v[0:3]
ds_read_b64_tr_b16 v[152:153], v235 offset:32768
ds_read_b64_tr_b16 v[154:155], v235 offset:34816
v_mfma_f32_16x16x32_bf16 v[32:35], v[128:131], a[52:55], v[32:35]
ds_read_b64_tr_b16 v[156:157], v235 offset:40960
ds_read_b64_tr_b16 v[158:159], v235 offset:43008
v_mfma_f32_16x16x32_bf16 v[32:35], v[132:135], a[60:63], v[32:35]
s_waitcnt lgkmcnt(7)
ds_read_b64_tr_b16 v[160:161], v232 offset:36864
v_mfma_f32_16x16x32_bf16 v[4:7], v[136:139], a[48:51], v[4:7]
buffer_load_dwordx4 a[20:23], v253, s[44:47], s98 offen offset:0 sc1
v_mfma_f32_16x16x32_bf16 v[4:7], v[140:143], a[56:59], v[4:7]
ds_read_b64_tr_b16 v[162:163], v232 offset:38912
ds_read_b64_tr_b16 v[164:165], v232 offset:45056
v_mfma_f32_16x16x32_bf16 v[36:39], v[136:139], a[52:55], v[36:39]
buffer_load_dwordx4 v230, s[28:31], s18 offen offset:2048 lds
v_mfma_f32_16x16x32_bf16 v[36:39], v[140:143], a[60:63], v[36:39]
s_waitcnt lgkmcnt(7)
ds_read_b64_tr_b16 v[166:167], v232 offset:47104
v_mfma_f32_16x16x32_bf16 v[8:11], v[144:147], a[48:51], v[8:11]
ds_read_b64_tr_b16 v[168:169], v233 offset:36864
v_mfma_f32_16x16x32_bf16 v[8:11], v[148:151], a[56:59], v[8:11]
buffer_load_dwordx4 a[24:27], v252, s[44:47], s98 offen offset:1024 sc1
v_mfma_f32_16x16x32_bf16 v[40:43], v[144:147], a[52:55], v[40:43]
ds_read_b64_tr_b16 v[170:171], v233 offset:38912
ds_read_b64_tr_b16 v[172:173], v233 offset:45056
v_mfma_f32_16x16x32_bf16 v[40:43], v[148:151], a[60:63], v[40:43]
s_waitcnt lgkmcnt(6)
ds_read_b64_tr_b16 v[174:175], v233 offset:47104
v_mfma_f32_16x16x32_bf16 v[12:15], v[152:155], a[48:51], v[12:15]
buffer_load_dwordx4 v231, s[28:31], s18 offen offset:3072 lds
v_mfma_f32_16x16x32_bf16 v[12:15], v[156:159], a[56:59], v[12:15]
ds_read_b64_tr_b16 v[128:129], v234 offset:36864
ds_read_b64_tr_b16 v[130:131], v234 offset:38912
v_mfma_f32_16x16x32_bf16 v[44:47], v[152:155], a[52:55], v[44:47]
ds_read_b64_tr_b16 v[132:133], v234 offset:45056
ds_read_b64_tr_b16 v[134:135], v234 offset:47104
v_mfma_f32_16x16x32_bf16 v[44:47], v[156:159], a[60:63], v[44:47]
s_waitcnt lgkmcnt(7)
ds_read_b64_tr_b16 v[136:137], v235 offset:36864
v_mfma_f32_16x16x32_bf16 v[16:19], v[160:163], a[48:51], v[16:19]
buffer_load_dwordx4 a[28:31], v253, s[44:47], s98 offen offset:1024 sc1
v_mfma_f32_16x16x32_bf16 v[16:19], v[164:167], a[56:59], v[16:19]
s_waitcnt vmcnt(17)
s_barrier
s_add_u32 m0, s11, 98304
v_mfma_f32_16x16x32_bf16 v[48:51], v[160:163], a[52:55], v[48:51]
ds_read_b64_tr_b16 v[138:139], v235 offset:38912
ds_read_b64_tr_b16 v[140:141], v235 offset:45056
v_mfma_f32_16x16x32_bf16 v[48:51], v[164:167], a[60:63], v[48:51]
s_waitcnt lgkmcnt(7)
ds_read_b64_tr_b16 v[142:143], v235 offset:47104
v_mfma_f32_16x16x32_bf16 v[20:23], v[168:171], a[48:51], v[20:23]
ds_read_b64_tr_b16 v[144:145], v232 offset:49152
v_mfma_f32_16x16x32_bf16 v[20:23], v[172:175], a[56:59], v[20:23]
ds_read_b64_tr_b16 v[146:147], v232 offset:51200
ds_read_b64_tr_b16 v[148:149], v232 offset:57344
v_mfma_f32_16x16x32_bf16 v[52:55], v[168:171], a[52:55], v[52:55]
s_xor_b32 s18, s75, 15
s_lshl_b32 s18, s18, 16
s_add_u32 s18, s18, s10
v_mfma_f32_16x16x32_bf16 v[52:55], v[172:175], a[60:63], v[52:55]
s_waitcnt lgkmcnt(6)
ds_read_b64_tr_b16 v[150:151], v232 offset:59392
v_mfma_f32_16x16x32_bf16 v[24:27], v[128:131], a[48:51], v[24:27]
s_xor_b32 s98, s75, 15
s_lshl_b32 s98, s98, 11
s_add_u32 s98, s98, s12
v_mfma_f32_16x16x32_bf16 v[24:27], v[132:135], a[56:59], v[24:27]
ds_read_b64_tr_b16 v[152:153], v233 offset:49152
ds_read_b64_tr_b16 v[154:155], v233 offset:51200
v_mfma_f32_16x16x32_bf16 v[56:59], v[128:131], a[52:55], v[56:59]
buffer_load_dwordx4 v228, s[28:31], s18 offen offset:0 lds
v_mfma_f32_16x16x32_bf16 v[56:59], v[132:135], a[60:63], v[56:59]
s_waitcnt lgkmcnt(5)
ds_read_b64_tr_b16 v[156:157], v233 offset:57344
v_mfma_f32_16x16x32_bf16 v[28:31], v[136:139], a[48:51], v[28:31]
ds_read_b64_tr_b16 v[158:159], v233 offset:59392
ds_read_b64_tr_b16 v[160:161], v234 offset:49152
v_mfma_f32_16x16x32_bf16 v[28:31], v[140:143], a[56:59], v[28:31]
buffer_load_dwordx4 a[32:35], v252, s[44:47], s98 offen offset:0 sc1
v_mfma_f32_16x16x32_bf16 v[60:63], v[136:139], a[52:55], v[60:63]
ds_read_b64_tr_b16 v[162:163], v234 offset:51200
ds_read_b64_tr_b16 v[164:165], v234 offset:57344
v_mfma_f32_16x16x32_bf16 v[60:63], v[140:143], a[60:63], v[60:63]
s_waitcnt lgkmcnt(7)
ds_read_b64_tr_b16 v[166:167], v234 offset:59392
v_mfma_f32_16x16x32_bf16 v[0:3], v[144:147], a[64:67], v[0:3]
buffer_load_dwordx4 v229, s[28:31], s18 offen offset:1024 lds
v_mfma_f32_16x16x32_bf16 v[0:3], v[148:151], a[72:75], v[0:3]
ds_read_b64_tr_b16 v[168:169], v235 offset:49152
ds_read_b64_tr_b16 v[170:171], v235 offset:51200
v_mfma_f32_16x16x32_bf16 v[32:35], v[144:147], a[68:71], v[32:35]
buffer_load_dwordx4 a[36:39], v253, s[44:47], s98 offen offset:0 sc1
v_mfma_f32_16x16x32_bf16 v[32:35], v[148:151], a[76:79], v[32:35]
s_waitcnt lgkmcnt(5)
ds_read_b64_tr_b16 v[172:173], v235 offset:57344
v_mfma_f32_16x16x32_bf16 v[4:7], v[152:155], a[64:67], v[4:7]
ds_read_b64_tr_b16 v[174:175], v235 offset:59392
ds_read_b64_tr_b16 v[128:129], v232 offset:53248
v_mfma_f32_16x16x32_bf16 v[4:7], v[156:159], a[72:75], v[4:7]
buffer_load_dwordx4 v230, s[28:31], s18 offen offset:2048 lds
v_mfma_f32_16x16x32_bf16 v[36:39], v[152:155], a[68:71], v[36:39]
ds_read_b64_tr_b16 v[130:131], v232 offset:55296
ds_read_b64_tr_b16 v[132:133], v232 offset:61440
v_mfma_f32_16x16x32_bf16 v[36:39], v[156:159], a[76:79], v[36:39]
s_waitcnt lgkmcnt(7)
ds_read_b64_tr_b16 v[134:135], v232 offset:63488
v_mfma_f32_16x16x32_bf16 v[8:11], v[160:163], a[64:67], v[8:11]
buffer_load_dwordx4 a[40:43], v252, s[44:47], s98 offen offset:1024 sc1
v_mfma_f32_16x16x32_bf16 v[8:11], v[164:167], a[72:75], v[8:11]
buffer_load_dwordx4 v231, s[28:31], s18 offen offset:3072 lds
v_mfma_f32_16x16x32_bf16 v[40:43], v[160:163], a[68:71], v[40:43]
ds_read_b64_tr_b16 v[136:137], v233 offset:53248
ds_read_b64_tr_b16 v[138:139], v233 offset:55296
v_mfma_f32_16x16x32_bf16 v[40:43], v[164:167], a[76:79], v[40:43]
s_waitcnt lgkmcnt(5)
ds_read_b64_tr_b16 v[140:141], v233 offset:61440
v_mfma_f32_16x16x32_bf16 v[12:15], v[168:171], a[64:67], v[12:15]
ds_read_b64_tr_b16 v[142:143], v233 offset:63488
ds_read_b64_tr_b16 v[144:145], v234 offset:53248
v_mfma_f32_16x16x32_bf16 v[12:15], v[172:175], a[72:75], v[12:15]
buffer_load_dwordx4 a[44:47], v253, s[44:47], s98 offen offset:1024 sc1
v_mfma_f32_16x16x32_bf16 v[44:47], v[168:171], a[68:71], v[44:47]
ds_read_b64_tr_b16 v[146:147], v234 offset:55296
ds_read_b64_tr_b16 v[148:149], v234 offset:61440
v_mfma_f32_16x16x32_bf16 v[44:47], v[172:175], a[76:79], v[44:47]
s_waitcnt lgkmcnt(7)
ds_read_b64_tr_b16 v[150:151], v234 offset:63488
v_mfma_f32_16x16x32_bf16 v[16:19], v[128:131], a[64:67], v[16:19]
s_waitcnt vmcnt(16)
v_readfirstlane_b32 s70, v237
s_nop 2
s_cmp_ge_u32 s70, 8
s_cbranch_scc0 L_spin24
L_got24:
v_mfma_f32_16x16x32_bf16 v[16:19], v[132:135], a[72:75], v[16:19]
s_waitcnt vmcnt(17)
s_barrier
v_add_u32 v214, s60, v254
v_mfma_f32_16x16x32_bf16 v[48:51], v[128:131], a[68:71], v[48:51]
ds_read_b64_tr_b16 v[152:153], v235 offset:53248
ds_read_b64_tr_b16 v[154:155], v235 offset:55296
v_mfma_f32_16x16x32_bf16 v[48:51], v[132:135], a[76:79], v[48:51]
s_waitcnt lgkmcnt(5)
ds_read_b64_tr_b16 v[156:157], v235 offset:61440
v_mfma_f32_16x16x32_bf16 v[20:23], v[136:139], a[64:67], v[20:23]
ds_read_b64_tr_b16 v[158:159], v235 offset:63488
ds_read_b64_tr_b16 v[160:161], v248 offset:0
v_mfma_f32_16x16x32_bf16 v[20:23], v[140:143], a[72:75], v[20:23]
ds_read_b64_tr_b16 v[162:163], v248 offset:2048
ds_read_b64_tr_b16 v[164:165], v248 offset:8192
v_mfma_f32_16x16x32_bf16 v[52:55], v[136:139], a[68:71], v[52:55]
ds_read_b64_tr_b16 v[166:167], v248 offset:10240
v_mfma_f32_16x16x32_bf16 v[52:55], v[140:143], a[76:79], v[52:55]
s_waitcnt lgkmcnt(8)
ds_read_b64_tr_b16 v[168:169], v249 offset:0
v_mfma_f32_16x16x32_bf16 v[24:27], v[144:147], a[64:67], v[24:27]
global_load_dword v215, v214, s[22:23]
v_mfma_f32_16x16x32_bf16 v[24:27], v[148:151], a[72:75], v[24:27]
ds_read_b64_tr_b16 v[170:171], v249 offset:2048
ds_read_b64_tr_b16 v[172:173], v249 offset:8192
v_mfma_f32_16x16x32_bf16 v[56:59], v[144:147], a[68:71], v[56:59]
ds_read_b64_tr_b16 v[174:175], v249 offset:10240
v_mfma_f32_16x16x32_bf16 v[56:59], v[148:151], a[76:79], v[56:59]
s_waitcnt lgkmcnt(7)
ds_read_b64_tr_b16 v[128:129], v250 offset:0
v_mfma_f32_16x16x32_bf16 v[28:31], v[152:155], a[64:67], v[28:31]
buffer_load_dwordx2 v[216:217], v254, s[52:55], s60 offen offset:0
v_mfma_f32_16x16x32_bf16 v[28:31], v[156:159], a[72:75], v[28:31]
ds_read_b64_tr_b16 v[130:131], v250 offset:2048
ds_read_b64_tr_b16 v[132:133], v250 offset:8192
v_mfma_f32_16x16x32_bf16 v[60:63], v[152:155], a[68:71], v[60:63]
ds_read_b64_tr_b16 v[134:135], v250 offset:10240
v_mfma_f32_16x16x32_bf16 v[60:63], v[156:159], a[76:79], v[60:63]
s_waitcnt lgkmcnt(7)
ds_read_b64_tr_b16 v[136:137], v251 offset:0
v_mfma_f32_16x16x32_bf16 v[0:3], v[160:163], a[0:3], v[0:3]
buffer_load_dwordx2 v[218:219], v254, s[52:55], s60 offen offset:32
v_mfma_f32_16x16x32_bf16 v[0:3], v[164:167], a[8:11], v[0:3]
ds_read_b64_tr_b16 v[138:139], v251 offset:2048
ds_read_b64_tr_b16 v[140:141], v251 offset:8192
v_mfma_f32_16x16x32_bf16 v[32:35], v[160:163], a[4:7], v[32:35]
ds_read_b64_tr_b16 v[142:143], v251 offset:10240
v_mfma_f32_16x16x32_bf16 v[32:35], v[164:167], a[12:15], v[32:35]
s_waitcnt lgkmcnt(7)
ds_read_b64_tr_b16 v[144:145], v248 offset:4096
v_mfma_f32_16x16x32_bf16 v[4:7], v[168:171], a[0:3], v[4:7]
ds_read_b64_tr_b16 v[146:147], v248 offset:6144
v_mfma_f32_16x16x32_bf16 v[4:7], v[172:175], a[8:11], v[4:7]
buffer_load_dwordx2 v[220:221], v254, s[52:55], s60 offen offset:64
v_mfma_f32_16x16x32_bf16 v[36:39], v[168:171], a[4:7], v[36:39]
ds_read_b64_tr_b16 v[148:149], v248 offset:12288
ds_read_b64_tr_b16 v[150:151], v248 offset:14336
v_mfma_f32_16x16x32_bf16 v[36:39], v[172:175], a[12:15], v[36:39]
s_waitcnt lgkmcnt(7)
ds_read_b64_tr_b16 v[152:153], v249 offset:4096
v_mfma_f32_16x16x32_bf16 v[8:11], v[128:131], a[0:3], v[8:11]
ds_read_b64_tr_b16 v[154:155], v249 offset:6144
v_mfma_f32_16x16x32_bf16 v[8:11], v[132:135], a[8:11], v[8:11]
ds_read_b64_tr_b16 v[156:157], v249 offset:12288
v_mfma_f32_16x16x32_bf16 v[40:43], v[128:131], a[4:7], v[40:43]
ds_read_b64_tr_b16 v[158:159], v249 offset:14336
v_mfma_f32_16x16x32_bf16 v[40:43], v[132:135], a[12:15], v[40:43]
s_waitcnt lgkmcnt(6)
ds_read_b64_tr_b16 v[160:161], v250 offset:4096
v_mfma_f32_16x16x32_bf16 v[12:15], v[136:139], a[0:3], v[12:15]
buffer_load_dwordx2 v[222:223], v254, s[52:55], s60 offen offset:96
v_mfma_f32_16x16x32_bf16 v[12:15], v[140:143], a[8:11], v[12:15]
ds_read_b64_tr_b16 v[162:163], v250 offset:6144
s_mov_b32 s52, s22
v_mfma_f32_16x16x32_bf16 v[44:47], v[136:139], a[4:7], v[44:47]
ds_read_b64_tr_b16 v[164:165], v250 offset:12288
s_mov_b32 s53, s23
v_mfma_f32_16x16x32_bf16 v[44:47], v[140:143], a[12:15], v[44:47]
ds_read_b64_tr_b16 v[166:167], v250 offset:14336
v_mfma_f32_16x16x32_bf16 v[16:19], v[144:147], a[0:3], v[16:19]
s_waitcnt lgkmcnt(5)
ds_read_b64_tr_b16 v[168:169], v251 offset:4096
v_mfma_f32_16x16x32_bf16 v[16:19], v[148:151], a[8:11], v[16:19]
s_waitcnt vmcnt(5)
s_barrier
ds_read_b64_tr_b16 v[170:171], v251 offset:6144
v_mfma_f32_16x16x32_bf16 v[48:51], v[144:147], a[4:7], v[48:51]
ds_read_b64_tr_b16 v[172:173], v251 offset:12288
ds_read_b64_tr_b16 v[174:175], v251 offset:14336
v_mfma_f32_16x16x32_bf16 v[48:51], v[148:151], a[12:15], v[48:51]
ds_read_b64_tr_b16 v[128:129], v248 offset:16384
v_mfma_f32_16x16x32_bf16 v[20:23], v[152:155], a[0:3], v[20:23]
s_waitcnt lgkmcnt(7)
ds_read_b64_tr_b16 v[130:131], v248 offset:18432
v_mfma_f32_16x16x32_bf16 v[20:23], v[156:159], a[8:11], v[20:23]
ds_read_b64_tr_b16 v[132:133], v248 offset:24576
v_mfma_f32_16x16x32_bf16 v[52:55], v[152:155], a[4:7], v[52:55]
ds_read_b64_tr_b16 v[134:135], v248 offset:26624
ds_read_b64_tr_b16 v[136:137], v248 offset:32768
v_mfma_f32_16x16x32_bf16 v[52:55], v[156:159], a[12:15], v[52:55]
ds_read_b64_tr_b16 v[138:139], v248 offset:34816
ds_read_b64_tr_b16 v[140:141], v248 offset:40960
v_mfma_f32_16x16x32_bf16 v[24:27], v[160:163], a[0:3], v[24:27]
s_waitcnt lgkmcnt(9)
ds_read_b64_tr_b16 v[142:143], v248 offset:43008
v_mfma_f32_16x16x32_bf16 v[24:27], v[164:167], a[8:11], v[24:27]
ds_read_b64_tr_b16 v[144:145], v249 offset:16384
v_mfma_f32_16x16x32_bf16 v[56:59], v[160:163], a[4:7], v[56:59]
ds_read_b64_tr_b16 v[146:147], v249 offset:18432
v_mfma_f32_16x16x32_bf16 v[56:59], v[164:167], a[12:15], v[56:59]
ds_read_b64_tr_b16 v[148:149], v249 offset:24576
v_mfma_f32_16x16x32_bf16 v[28:31], v[168:171], a[0:3], v[28:31]
s_waitcnt lgkmcnt(8)
ds_read_b64_tr_b16 v[150:151], v249 offset:26624
v_mfma_f32_16x16x32_bf16 v[28:31], v[172:175], a[8:11], v[28:31]
ds_read_b64_tr_b16 v[152:153], v249 offset:32768
v_mfma_f32_16x16x32_bf16 v[60:63], v[168:171], a[4:7], v[60:63]
ds_read_b64_tr_b16 v[154:155], v249 offset:34816
v_mfma_f32_16x16x32_bf16 v[60:63], v[172:175], a[12:15], v[60:63]
ds_read_b64_tr_b16 v[156:157], v249 offset:40960
v_mfma_f32_16x16x32_bf16 v[0:3], v[128:131], a[16:19], v[0:3]
s_waitcnt lgkmcnt(6)
ds_read_b64_tr_b16 v[158:159], v249 offset:43008
v_mfma_f32_16x16x32_bf16 v[0:3], v[132:135], a[24:27], v[0:3]
ds_read_b64_tr_b16 v[160:161], v250 offset:16384
v_mfma_f32_16x16x32_bf16 v[0:3], v[136:139], a[32:35], v[0:3]
ds_read_b64_tr_b16 v[162:163], v250 offset:18432
v_mfma_f32_16x16x32_bf16 v[0:3], v[140:143], a[40:43], v[0:3]
ds_read_b64_tr_b16 v[164:165], v250 offset:24576
v_mfma_f32_16x16x32_bf16 v[32:35], v[128:131], a[20:23], v[32:35]
ds_read_b64_tr_b16 v[166:167], v250 offset:26624
v_mfma_f32_16x16x32_bf16 v[32:35], v[132:135], a[28:31], v[32:35]
ds_read_b64_tr_b16 v[168:169], v250 offset:32768
v_mfma_f32_16x16x32_bf16 v[32:35], v[136:139], a[36:39], v[32:35]
ds_read_b64_tr_b16 v[170:171], v250 offset:34816
v_mfma_f32_16x16x32_bf16 v[32:35], v[140:143], a[44:47], v[32:35]
s_waitcnt lgkmcnt(6)
ds_read_b64_tr_b16 v[172:173], v250 offset:40960
v_mfma_f32_16x16x32_bf16 v[4:7], v[144:147], a[16:19], v[4:7]
ds_read_b64_tr_b16 v[174:175], v250 offset:43008
s_add_u32 s72, s63, 8388608
v_mfma_f32_16x16x32_bf16 v[4:7], v[148:151], a[24:27], v[4:7]
ds_read_b64_tr_b16 v[128:129], v251 offset:16384
v_mfma_f32_16x16x32_bf16 v[4:7], v[152:155], a[32:35], v[4:7]
buffer_load_dwordx4 v[176:179], v242, s[40:43], s72 offen offset:0 sc1
v_mfma_f32_16x16x32_bf16 v[4:7], v[156:159], a[40:43], v[4:7]
ds_read_b64_tr_b16 v[130:131], v251 offset:18432
v_mfma_f32_16x16x32_bf16 v[36:39], v[144:147], a[20:23], v[36:39]
ds_read_b64_tr_b16 v[132:133], v251 offset:24576
v_mfma_f32_16x16x32_bf16 v[36:39], v[148:151], a[28:31], v[36:39]
ds_read_b64_tr_b16 v[134:135], v251 offset:26624
v_mfma_f32_16x16x32_bf16 v[36:39], v[152:155], a[36:39], v[36:39]
ds_read_b64_tr_b16 v[136:137], v251 offset:32768
v_mfma_f32_16x16x32_bf16 v[36:39], v[156:159], a[44:47], v[36:39]
s_waitcnt lgkmcnt(5)
ds_read_b64_tr_b16 v[138:139], v251 offset:34816
v_mfma_f32_16x16x32_bf16 v[8:11], v[160:163], a[16:19], v[8:11]
buffer_load_dwordx4 v[180:183], v242, s[40:43], s72 offen offset:1024 sc1
s_add_u32 s72, s64, 8388608
v_mfma_f32_16x16x32_bf16 v[8:11], v[164:167], a[24:27], v[8:11]
ds_read_b64_tr_b16 v[140:141], v251 offset:40960
ds_read_b64_tr_b16 v[142:143], v251 offset:43008
v_mfma_f32_16x16x32_bf16 v[8:11], v[168:171], a[32:35], v[8:11]
buffer_load_dwordx4 v[184:187], v242, s[40:43], s72 offen offset:0 sc1
v_mfma_f32_16x16x32_bf16 v[8:11], v[172:175], a[40:43], v[8:11]
buffer_load_dwordx4 v[188:191], v242, s[40:43], s72 offen offset:1024 sc1
v_mfma_f32_16x16x32_bf16 v[40:43], v[160:163], a[20:23], v[40:43]
ds_read_b64_tr_b16 v[144:145], v248 offset:20480
s_add_u32 s72, s65, 8388608
v_mfma_f32_16x16x32_bf16 v[40:43], v[164:167], a[28:31], v[40:43]
buffer_load_dwordx4 v[192:195], v242, s[40:43], s72 offen offset:0 sc1
v_mfma_f32_16x16x32_bf16 v[40:43], v[168:171], a[36:39], v[40:43]
ds_read_b64_tr_b16 v[146:147], v248 offset:22528
ds_read_b64_tr_b16 v[148:149], v248 offset:28672
v_mfma_f32_16x16x32_bf16 v[40:43], v[172:175], a[44:47], v[40:43]
s_waitcnt lgkmcnt(5)
ds_read_b64_tr_b16 v[150:151], v248 offset:30720
v_mfma_f32_16x16x32_bf16 v[12:15], v[128:131], a[16:19], v[12:15]
ds_read_b64_tr_b16 v[152:153], v248 offset:36864
ds_read_b64_tr_b16 v[154:155], v248 offset:38912
v_mfma_f32_16x16x32_bf16 v[12:15], v[132:135], a[24:27], v[12:15]
buffer_load_dwordx4 v[196:199], v242, s[40:43], s72 offen offset:1024 sc1
v_mfma_f32_16x16x32_bf16 v[12:15], v[136:139], a[32:35], v[12:15]
s_waitcnt lgkmcnt(6)
ds_read_b64_tr_b16 v[156:157], v248 offset:45056
v_mfma_f32_16x16x32_bf16 v[12:15], v[140:143], a[40:43], v[12:15]
ds_read_b64_tr_b16 v[158:159], v248 offset:47104
v_mfma_f32_16x16x32_bf16 v[44:47], v[128:131], a[20:23], v[44:47]
ds_read_b64_tr_b16 v[160:161], v249 offset:20480
v_mfma_f32_16x16x32_bf16 v[44:47], v[132:135], a[28:31], v[44:47]
ds_read_b64_tr_b16 v[162:163], v249 offset:22528
ds_read_b64_tr_b16 v[164:165], v249 offset:28672
v_mfma_f32_16x16x32_bf16 v[44:47], v[136:139], a[36:39], v[44:47]
ds_read_b64_tr_b16 v[166:167], v249 offset:30720
s_add_u32 s3, s61, 0
s_cmp_eq_u32 s3, s1
s_cbranch_scc1 L_owns0
s_add_u32 s3, s62, 0
v_cvt_pk_bf16_f32 v0, v0, v1
v_cvt_pk_bf16_f32 v1, v2, v3
v_cvt_pk_bf16_f32 v2, v4, v5
v_cvt_pk_bf16_f32 v3, v6, v7
buffer_store_dwordx4 v[0:3], v242, s[40:43], s3 offen offset:0 sc1
v_cvt_pk_bf16_f32 v32, v32, v33
v_cvt_pk_bf16_f32 v33, v34, v35
v_cvt_pk_bf16_f32 v34, v36, v37
v_cvt_pk_bf16_f32 v35, v38, v39
buffer_store_dwordx4 v[32:35], v242, s[40:43], s3 offen offset:2048 sc1
s_branch L_shs0
L_owns0:
ds_write_b128 v255, v[0:3] offset:16384
ds_write_b128 v255, v[4:7] offset:17408
ds_write_b128 v255, v[32:35] offset:20480
ds_write_b128 v255, v[36:39] offset:21504
s_waitcnt lgkmcnt(0)
L_shs0:
v_mfma_f32_16x16x32_bf16 v[44:47], v[140:143], a[44:47], v[44:47]
s_waitcnt lgkmcnt(6)
ds_read_b64_tr_b16 v[168:169], v249 offset:36864
v_mfma_f32_16x16x32_bf16 v[16:19], v[144:147], a[16:19], v[16:19]
ds_read_b64_tr_b16 v[170:171], v249 offset:38912
ds_read_b64_tr_b16 v[172:173], v249 offset:45056
v_mfma_f32_16x16x32_bf16 v[16:19], v[148:151], a[24:27], v[16:19]
ds_read_b64_tr_b16 v[174:175], v249 offset:47104
v_mfma_f32_16x16x32_bf16 v[16:19], v[152:155], a[32:35], v[16:19]
s_waitcnt lgkmcnt(8)
ds_read_b64_tr_b16 v[128:129], v250 offset:20480
v_mfma_f32_16x16x32_bf16 v[16:19], v[156:159], a[40:43], v[16:19]
ds_read_b64_tr_b16 v[130:131], v250 offset:22528
v_mfma_f32_16x16x32_bf16 v[48:51], v[144:147], a[20:23], v[48:51]
ds_read_b64_tr_b16 v[132:133], v250 offset:28672
v_mfma_f32_16x16x32_bf16 v[48:51], v[148:151], a[28:31], v[48:51]
ds_read_b64_tr_b16 v[134:135], v250 offset:30720
v_mfma_f32_16x16x32_bf16 v[48:51], v[152:155], a[36:39], v[48:51]
ds_read_b64_tr_b16 v[136:137], v250 offset:36864
v_mfma_f32_16x16x32_bf16 v[48:51], v[156:159], a[44:47], v[48:51]
s_waitcnt lgkmcnt(6)
ds_read_b64_tr_b16 v[138:139], v250 offset:38912
v_mfma_f32_16x16x32_bf16 v[20:23], v[160:163], a[16:19], v[20:23]
ds_read_b64_tr_b16 v[140:141], v250 offset:45056
ds_read_b64_tr_b16 v[142:143], v250 offset:47104
v_mfma_f32_16x16x32_bf16 v[20:23], v[164:167], a[24:27], v[20:23]
ds_read_b64_tr_b16 v[144:145], v251 offset:20480
v_mfma_f32_16x16x32_bf16 v[20:23], v[168:171], a[32:35], v[20:23]
s_waitcnt lgkmcnt(7)
ds_read_b64_tr_b16 v[146:147], v251 offset:22528
v_mfma_f32_16x16x32_bf16 v[20:23], v[172:175], a[40:43], v[20:23]
ds_read_b64_tr_b16 v[148:149], v251 offset:28672
v_mfma_f32_16x16x32_bf16 v[52:55], v[160:163], a[20:23], v[52:55]
ds_read_b64_tr_b16 v[150:151], v251 offset:30720
v_mfma_f32_16x16x32_bf16 v[52:55], v[164:167], a[28:31], v[52:55]
ds_read_b64_tr_b16 v[152:153], v251 offset:36864
v_mfma_f32_16x16x32_bf16 v[52:55], v[168:171], a[36:39], v[52:55]
ds_read_b64_tr_b16 v[154:155], v251 offset:38912
s_add_u32 s3, s61, 0
s_cmp_eq_u32 s3, s1
s_cbranch_scc1 L_owns1
s_add_u32 s3, s62, 0
v_cvt_pk_bf16_f32 v8, v8, v9
v_cvt_pk_bf16_f32 v9, v10, v11
v_cvt_pk_bf16_f32 v10, v12, v13
v_cvt_pk_bf16_f32 v11, v14, v15
buffer_store_dwordx4 v[8:11], v242, s[40:43], s3 offen offset:1024 sc1
v_cvt_pk_bf16_f32 v40, v40, v41
v_cvt_pk_bf16_f32 v41, v42, v43
v_cvt_pk_bf16_f32 v42, v44, v45
v_cvt_pk_bf16_f32 v43, v46, v47
buffer_store_dwordx4 v[40:43], v242, s[40:43], s3 offen offset:3072 sc1
s_branch L_shs1
L_owns1:
ds_write_b128 v255, v[8:11] offset:18432
ds_write_b128 v255, v[12:15] offset:19456
ds_write_b128 v255, v[40:43] offset:22528
ds_write_b128 v255, v[44:47] offset:23552
s_waitcnt lgkmcnt(0)
L_shs1:
v_mfma_f32_16x16x32_bf16 v[52:55], v[172:175], a[44:47], v[52:55]
ds_read_b64_tr_b16 v[156:157], v251 offset:45056
v_mfma_f32_16x16x32_bf16 v[24:27], v[128:131], a[16:19], v[24:27]
s_waitcnt lgkmcnt(6)
ds_read_b64_tr_b16 v[158:159], v251 offset:47104
v_mfma_f32_16x16x32_bf16 v[24:27], v[132:135], a[24:27], v[24:27]
v_mfma_f32_16x16x32_bf16 v[24:27], v[136:139], a[32:35], v[24:27]
v_mfma_f32_16x16x32_bf16 v[24:27], v[140:143], a[40:43], v[24:27]
v_mfma_f32_16x16x32_bf16 v[56:59], v[128:131], a[20:23], v[56:59]
v_mfma_f32_16x16x32_bf16 v[56:59], v[132:135], a[28:31], v[56:59]
v_mfma_f32_16x16x32_bf16 v[56:59], v[136:139], a[36:39], v[56:59]
v_mfma_f32_16x16x32_bf16 v[56:59], v[140:143], a[44:47], v[56:59]
s_waitcnt lgkmcnt(0)
v_mfma_f32_16x16x32_bf16 v[28:31], v[144:147], a[16:19], v[28:31]
v_mfma_f32_16x16x32_bf16 v[28:31], v[148:151], a[24:27], v[28:31]
v_mfma_f32_16x16x32_bf16 v[28:31], v[152:155], a[32:35], v[28:31]
v_mfma_f32_16x16x32_bf16 v[28:31], v[156:159], a[40:43], v[28:31]
v_mfma_f32_16x16x32_bf16 v[60:63], v[144:147], a[20:23], v[60:63]
v_mfma_f32_16x16x32_bf16 v[60:63], v[148:151], a[28:31], v[60:63]
v_mfma_f32_16x16x32_bf16 v[60:63], v[152:155], a[36:39], v[60:63]
s_add_u32 s3, s61, 1
s_cmp_eq_u32 s3, s1
s_cbranch_scc1 L_owns2
s_add_u32 s3, s62, 32768
v_cvt_pk_bf16_f32 v16, v16, v17
v_cvt_pk_bf16_f32 v17, v18, v19
v_cvt_pk_bf16_f32 v18, v20, v21
v_cvt_pk_bf16_f32 v19, v22, v23
buffer_store_dwordx4 v[16:19], v242, s[40:43], s3 offen offset:0 sc1
v_cvt_pk_bf16_f32 v48, v48, v49
v_cvt_pk_bf16_f32 v49, v50, v51
v_cvt_pk_bf16_f32 v50, v52, v53
v_cvt_pk_bf16_f32 v51, v54, v55
buffer_store_dwordx4 v[48:51], v242, s[40:43], s3 offen offset:2048 sc1
s_branch L_shs2
L_owns2:
ds_write_b128 v255, v[16:19] offset:16384
ds_write_b128 v255, v[20:23] offset:17408
ds_write_b128 v255, v[48:51] offset:20480
ds_write_b128 v255, v[52:55] offset:21504
s_waitcnt lgkmcnt(0)
L_shs2:
v_mfma_f32_16x16x32_bf16 v[60:63], v[156:159], a[44:47], v[60:63]
s_nop 7
s_add_u32 s3, s61, 1
s_cmp_eq_u32 s3, s1
s_cbranch_scc1 L_owns3
s_add_u32 s3, s62, 32768
v_cvt_pk_bf16_f32 v24, v24, v25
v_cvt_pk_bf16_f32 v25, v26, v27
v_cvt_pk_bf16_f32 v26, v28, v29
v_cvt_pk_bf16_f32 v27, v30, v31
buffer_store_dwordx4 v[24:27], v242, s[40:43], s3 offen offset:1024 sc1
v_cvt_pk_bf16_f32 v56, v56, v57
v_cvt_pk_bf16_f32 v57, v58, v59
v_cvt_pk_bf16_f32 v58, v60, v61
v_cvt_pk_bf16_f32 v59, v62, v63
buffer_store_dwordx4 v[56:59], v242, s[40:43], s3 offen offset:3072 sc1
s_branch L_shs3
L_owns3:
ds_write_b128 v255, v[24:27] offset:18432
ds_write_b128 v255, v[28:31] offset:19456
ds_write_b128 v255, v[56:59] offset:22528
ds_write_b128 v255, v[60:63] offset:23552
s_waitcnt lgkmcnt(0)
L_shs3:
s_mov_b32 s74, 0x80000
s_waitcnt lgkmcnt(0)
s_barrier
ds_read_b128 v[144:147], v240 offset:0
ds_read_b128 v[148:151], v240 offset:1024
ds_read_b128 v[152:155], v240 offset:2048
ds_read_b128 v[156:159], v240 offset:3072
ds_read_b128 v[128:131], v240 offset:16384
ds_read_b128 v[132:135], v240 offset:17408
ds_read_b128 v[136:139], v240 offset:18432
ds_read_b128 v[140:143], v240 offset:19456
buffer_load_dwordx4 v[64:67], v242, s[40:43], s63 offen offset:0 sc1
buffer_load_dwordx4 v[68:71], v242, s[40:43], s63 offen offset:1024 sc1
buffer_load_dwordx4 v[72:75], v242, s[40:43], s64 offen offset:0 sc1
buffer_load_dwordx4 v[76:79], v242, s[40:43], s64 offen offset:1024 sc1
buffer_load_dwordx4 v[80:83], v242, s[40:43], s65 offen offset:0 sc1
buffer_load_dwordx4 v[84:87], v242, s[40:43], s65 offen offset:1024 sc1
s_and_b32 s3, s1, 2
s_cmp_eq_u32 s3, s61
s_cbranch_scc1 L_w4
s_waitcnt vmcnt(14)
s_branch L_w8
L_w4:
s_waitcnt vmcnt(10)
L_w8:
v_lshlrev_b32 v96, 16, v216
v_and_b32 v97, 0xffff0000, v216
v_lshlrev_b32 v98, 16, v217
v_and_b32 v99, 0xffff0000, v217
v_lshlrev_b32 v100, 16, v218
v_and_b32 v101, 0xffff0000, v218
v_lshlrev_b32 v102, 16, v219
v_and_b32 v103, 0xffff0000, v219
v_lshlrev_b32 v104, 16, v220
v_and_b32 v105, 0xffff0000, v220
v_lshlrev_b32 v106, 16, v221
v_and_b32 v107, 0xffff0000, v221
v_lshlrev_b32 v108, 16, v222
v_and_b32 v109, 0xffff0000, v222
v_lshlrev_b32 v110, 16, v223
v_and_b32 v111, 0xffff0000, v223
s_waitcnt lgkmcnt(0)
v_dot2_f32_bf16 v144, v176, s76, v144
v_dot2_f32_bf16 v145, v176, s77, v145
v_dot2_f32_bf16 v146, v177, s76, v146
v_dot2_f32_bf16 v147, v177, s77, v147
v_dot2_f32_bf16 v148, v178, s76, v148
v_dot2_f32_bf16 v149, v178, s77, v149
v_dot2_f32_bf16 v150, v179, s76, v150
v_dot2_f32_bf16 v151, v179, s77, v151
v_dot2_f32_bf16 v152, v180, s76, v152
v_dot2_f32_bf16 v153, v180, s77, v153
v_dot2_f32_bf16 v154, v181, s76, v154
v_dot2_f32_bf16 v155, v181, s77, v155
v_dot2_f32_bf16 v156, v182, s76, v156
v_dot2_f32_bf16 v157, v182, s77, v157
v_dot2_f32_bf16 v158, v183, s76, v158
v_dot2_f32_bf16 v159, v183, s77, v159
v_dot2_f32_bf16 v144, v184, s76, v144
v_dot2_f32_bf16 v145, v184, s77, v145
v_dot2_f32_bf16 v146, v185, s76, v146
v_dot2_f32_bf16 v147, v185, s77, v147
v_dot2_f32_bf16 v148, v186, s76, v148
v_dot2_f32_bf16 v149, v186, s77, v149
v_dot2_f32_bf16 v150, v187, s76, v150
v_dot2_f32_bf16 v151, v187, s77, v151
v_dot2_f32_bf16 v152, v188, s76, v152
v_dot2_f32_bf16 v153, v188, s77, v153
v_dot2_f32_bf16 v154, v189, s76, v154
v_dot2_f32_bf16 v155, v189, s77, v155
v_dot2_f32_bf16 v156, v190, s76, v156
v_dot2_f32_bf16 v157, v190, s77, v157
v_dot2_f32_bf16 v158, v191, s76, v158
v_dot2_f32_bf16 v159, v191, s77, v159
v_dot2_f32_bf16 v144, v192, s76, v144
v_dot2_f32_bf16 v145, v192, s77, v145
v_dot2_f32_bf16 v146, v193, s76, v146
v_dot2_f32_bf16 v147, v193, s77, v147
v_dot2_f32_bf16 v148, v194, s76, v148
v_dot2_f32_bf16 v149, v194, s77, v149
v_dot2_f32_bf16 v150, v195, s76, v150
v_dot2_f32_bf16 v151, v195, s77, v151
v_dot2_f32_bf16 v152, v196, s76, v152
v_dot2_f32_bf16 v153, v196, s77, v153
v_dot2_f32_bf16 v154, v197, s76, v154
v_dot2_f32_bf16 v155, v197, s77, v155
v_dot2_f32_bf16 v156, v198, s76, v156
v_dot2_f32_bf16 v157, v198, s77, v157
v_dot2_f32_bf16 v158, v199, s76, v158
v_dot2_f32_bf16 v159, v199, s77, v159
s_nop 2
v_pk_mul_f32 v[160:161], v[144:145], s[78:79]
v_pk_mul_f32 v[162:163], v[146:147], s[78:79]
v_pk_mul_f32 v[164:165], v[148:149], s[78:79]
v_pk_mul_f32 v[166:167], v[150:151], s[78:79]
v_pk_mul_f32 v[168:169], v[152:153], s[78:79]
v_pk_mul_f32 v[170:171], v[154:155], s[78:79]
v_pk_mul_f32 v[172:173], v[156:157], s[78:79]
v_pk_mul_f32 v[174:175], v[158:159], s[78:79]
v_exp_f32 v160, v160
v_exp_f32 v161, v161
v_exp_f32 v162, v162
v_exp_f32 v163, v163
v_exp_f32 v164, v164
v_exp_f32 v165, v165
v_exp_f32 v166, v166
v_exp_f32 v167, v167
v_exp_f32 v168, v168
v_exp_f32 v169, v169
v_exp_f32 v170, v170
v_exp_f32 v171, v171
v_exp_f32 v172, v172
v_exp_f32 v173, v173
v_exp_f32 v174, v174
v_exp_f32 v175, v175
v_add_f32 v160, 1.0, v160
v_add_f32 v161, 1.0, v161
v_add_f32 v162, 1.0, v162
v_add_f32 v163, 1.0, v163
v_add_f32 v164, 1.0, v164
v_add_f32 v165, 1.0, v165
v_add_f32 v166, 1.0, v166
v_add_f32 v167, 1.0, v167
v_add_f32 v168, 1.0, v168
v_add_f32 v169, 1.0, v169
v_add_f32 v170, 1.0, v170
v_add_f32 v171, 1.0, v171
v_add_f32 v172, 1.0, v172
v_add_f32 v173, 1.0, v173
v_add_f32 v174, 1.0, v174
v_add_f32 v175, 1.0, v175
v_rcp_f32 v160, v160
v_rcp_f32 v161, v161
v_rcp_f32 v162, v162
v_rcp_f32 v163, v163
v_rcp_f32 v164, v164
v_rcp_f32 v165, v165
v_rcp_f32 v166, v166
v_rcp_f32 v167, v167
v_rcp_f32 v168, v168
v_rcp_f32 v169, v169
v_rcp_f32 v170, v170
v_rcp_f32 v171, v171
v_rcp_f32 v172, v172
v_rcp_f32 v173, v173
v_rcp_f32 v174, v174
v_rcp_f32 v175, v175
v_pk_mul_f32 v[144:145], v[144:145], v[160:161]
v_pk_mul_f32 v[146:147], v[146:147], v[162:163]
v_pk_mul_f32 v[148:149], v[148:149], v[164:165]
v_pk_mul_f32 v[150:151], v[150:151], v[166:167]
v_pk_mul_f32 v[152:153], v[152:153], v[168:169]
v_pk_mul_f32 v[154:155], v[154:155], v[170:171]
v_pk_mul_f32 v[156:157], v[156:157], v[172:173]
v_pk_mul_f32 v[158:159], v[158:159], v[174:175]
s_waitcnt vmcnt(0)
v_max3_u32 v200, v64, v65, v66
v_max3_u32 v201, v67, v68, v69
v_max3_u32 v200, v200, v70, v71
v_max3_u32 v201, v201, v72, v73
v_max3_u32 v200, v200, v74, v75
v_max3_u32 v201, v201, v76, v77
v_max3_u32 v200, v200, v78, v79
v_max3_u32 v201, v201, v80, v81
v_max3_u32 v200, v200, v82, v83
v_max3_u32 v201, v201, v84, v85
v_max3_u32 v200, v200, v86, v87
v_max_u32 v200, v200, v201
v_cmp_eq_u32 vcc, -1, v200
s_sub_u32 s74, s74, 1
s_cselect_b64 s[70:71], 0, -1
s_and_b64 vcc, vcc, s[70:71]
s_cmp_lg_u64 vcc, 0
s_cbranch_scc1 L_pws
L_pks:
v_dot2_f32_bf16 v128, v64, s76, v128
v_dot2_f32_bf16 v129, v64, s77, v129
v_dot2_f32_bf16 v130, v65, s76, v130
v_dot2_f32_bf16 v131, v65, s77, v131
v_dot2_f32_bf16 v132, v66, s76, v132
v_dot2_f32_bf16 v133, v66, s77, v133
v_dot2_f32_bf16 v134, v67, s76, v134
v_dot2_f32_bf16 v135, v67, s77, v135
v_dot2_f32_bf16 v136, v68, s76, v136
v_dot2_f32_bf16 v137, v68, s77, v137
v_dot2_f32_bf16 v138, v69, s76, v138
v_dot2_f32_bf16 v139, v69, s77, v139
v_dot2_f32_bf16 v140, v70, s76, v140
v_dot2_f32_bf16 v141, v70, s77, v141
v_dot2_f32_bf16 v142, v71, s76, v142
v_dot2_f32_bf16 v143, v71, s77, v143
v_dot2_f32_bf16 v128, v72, s76, v128
v_dot2_f32_bf16 v129, v72, s77, v129
v_dot2_f32_bf16 v130, v73, s76, v130
v_dot2_f32_bf16 v131, v73, s77, v131
v_dot2_f32_bf16 v132, v74, s76, v132
v_dot2_f32_bf16 v133, v74, s77, v133
v_dot2_f32_bf16 v134, v75, s76, v134
v_dot2_f32_bf16 v135, v75, s77, v135
v_dot2_f32_bf16 v136, v76, s76, v136
v_dot2_f32_bf16 v137, v76, s77, v137
v_dot2_f32_bf16 v138, v77, s76, v138
v_dot2_f32_bf16 v139, v77, s77, v139
v_dot2_f32_bf16 v140, v78, s76, v140
v_dot2_f32_bf16 v141, v78, s77, v141
v_dot2_f32_bf16 v142, v79, s76, v142
v_dot2_f32_bf16 v143, v79, s77, v143
v_dot2_f32_bf16 v128, v80, s76, v128
v_dot2_f32_bf16 v129, v80, s77, v129
v_dot2_f32_bf16 v130, v81, s76, v130
v_dot2_f32_bf16 v131, v81, s77, v131
v_dot2_f32_bf16 v132, v82, s76, v132
v_dot2_f32_bf16 v133, v82, s77, v133
v_dot2_f32_bf16 v134, v83, s76, v134
v_dot2_f32_bf16 v135, v83, s77, v135
v_dot2_f32_bf16 v136, v84, s76, v136
v_dot2_f32_bf16 v137, v84, s77, v137
v_dot2_f32_bf16 v138, v85, s76, v138
v_dot2_f32_bf16 v139, v85, s77, v139
v_dot2_f32_bf16 v140, v86, s76, v140
v_dot2_f32_bf16 v141, v86, s77, v141
v_dot2_f32_bf16 v142, v87, s76, v142
v_dot2_f32_bf16 v143, v87, s77, v143
s_nop 2
v_pk_fma_f32 v[160:161], v[128:129], v[144:145], v[96:97]
v_pk_fma_f32 v[162:163], v[130:131], v[146:147], v[98:99]
v_cvt_pk_bf16_f32 v112, v160, v161
v_cvt_pk_bf16_f32 v113, v162, v163
buffer_store_dwordx2 v[112:113], v254, s[52:55], s60 offen offset:0
v_pk_fma_f32 v[164:165], v[132:133], v[148:149], v[100:101]
v_pk_fma_f32 v[166:167], v[134:135], v[150:151], v[102:103]
v_cvt_pk_bf16_f32 v114, v164, v165
v_cvt_pk_bf16_f32 v115, v166, v167
buffer_store_dwordx2 v[114:115], v254, s[52:55], s60 offen offset:32
v_pk_fma_f32 v[168:169], v[136:137], v[152:153], v[104:105]
v_pk_fma_f32 v[170:171], v[138:139], v[154:155], v[106:107]
v_cvt_pk_bf16_f32 v116, v168, v169
v_cvt_pk_bf16_f32 v117, v170, v171
buffer_store_dwordx2 v[116:117], v254, s[52:55], s60 offen offset:64
v_pk_fma_f32 v[172:173], v[140:141], v[156:157], v[108:109]
v_pk_fma_f32 v[174:175], v[142:143], v[158:159], v[110:111]
v_cvt_pk_bf16_f32 v118, v172, v173
v_cvt_pk_bf16_f32 v119, v174, v175
buffer_store_dwordx2 v[118:119], v254, s[52:55], s60 offen offset:96
s_endpgm
L_fallback:
s_mov_b32 s7, 1
s_mov_b32 s96, 0
s_lshl_b32 s97, s56, 11
v_and_b32 v40, 15, v243
v_lshrrev_b32 v2, 4, v243
v_lshlrev_b32 v2, 2, v2
v_sub_u32 v40, v40, v2
s_lshr_b32 s3, s76, 17
s_lshl_b32 s3, s3, 4
v_add_u32 v44, s3, v40
v_mov_b32 v48, v244
s_lshr_b32 s3, s77, 17
s_lshl_b32 s3, s3, 4
v_add_u32 v45, s3, v40
v_mov_b32 v49, v244
s_lshr_b32 s3, s78, 17
s_lshl_b32 s3, s3, 4
v_add_u32 v46, s3, v40
v_mov_b32 v50, v244
s_lshr_b32 s3, s79, 17
s_lshl_b32 s3, s3, 4
v_add_u32 v47, s3, v40
v_mov_b32 v51, v244
v_mov_b32 v41, v242
L_mx:
s_waitcnt vmcnt(0) lgkmcnt(0)
s_barrier
s_mov_b32 m0, s97
s_mul_i32 s3, s96, 16384
s_add_u32 s3, s3, s97
buffer_load_dwordx4 v242, s[40:43], s3 offen sc1 lds
buffer_load_dwordx4 v242, s[40:43], s3 offen offset:1024 sc1 lds
s_waitcnt vmcnt(0)
s_barrier
ds_read_b128 a[144:147], v41 offset:0
ds_read_b128 a[148:151], v41 offset:1024
ds_read_b128 a[152:155], v41 offset:2048
ds_read_b128 a[156:159], v41 offset:3072
ds_read_b128 a[160:163], v41 offset:4096
ds_read_b128 a[164:167], v41 offset:5120
ds_read_b128 a[168:171], v41 offset:6144
ds_read_b128 a[172:175], v41 offset:7168
s_waitcnt lgkmcnt(0)
v_mfma_f32_16x16x32_bf16 v[0:3], a[144:147], v[96:99], 0
v_mfma_f32_16x16x32_bf16 v[0:3], a[148:151], v[112:115], v[0:3]
v_mfma_f32_16x16x32_bf16 v[0:3], a[152:155], v[128:131], v[0:3]
v_mfma_f32_16x16x32_bf16 v[0:3], a[156:159], v[144:147], v[0:3]
v_mfma_f32_16x16x32_bf16 v[4:7], a[160:163], v[96:99], 0
v_mfma_f32_16x16x32_bf16 v[4:7], a[164:167], v[112:115], v[4:7]
v_mfma_f32_16x16x32_bf16 v[4:7], a[168:171], v[128:131], v[4:7]
v_mfma_f32_16x16x32_bf16 v[4:7], a[172:175], v[144:147], v[4:7]
v_mfma_f32_16x16x32_bf16 v[8:11], a[144:147], v[100:103], 0
v_mfma_f32_16x16x32_bf16 v[8:11], a[148:151], v[116:119], v[8:11]
v_mfma_f32_16x16x32_bf16 v[8:11], a[152:155], v[132:135], v[8:11]
v_mfma_f32_16x16x32_bf16 v[8:11], a[156:159], v[148:151], v[8:11]
v_mfma_f32_16x16x32_bf16 v[12:15], a[160:163], v[100:103], 0
v_mfma_f32_16x16x32_bf16 v[12:15], a[164:167], v[116:119], v[12:15]
v_mfma_f32_16x16x32_bf16 v[12:15], a[168:171], v[132:135], v[12:15]
v_mfma_f32_16x16x32_bf16 v[12:15], a[172:175], v[148:151], v[12:15]
v_mfma_f32_16x16x32_bf16 v[16:19], a[144:147], v[104:107], 0
v_mfma_f32_16x16x32_bf16 v[16:19], a[148:151], v[120:123], v[16:19]
v_mfma_f32_16x16x32_bf16 v[16:19], a[152:155], v[136:139], v[16:19]
v_mfma_f32_16x16x32_bf16 v[16:19], a[156:159], v[152:155], v[16:19]
v_mfma_f32_16x16x32_bf16 v[20:23], a[160:163], v[104:107], 0
v_mfma_f32_16x16x32_bf16 v[20:23], a[164:167], v[120:123], v[20:23]
v_mfma_f32_16x16x32_bf16 v[20:23], a[168:171], v[136:139], v[20:23]
v_mfma_f32_16x16x32_bf16 v[20:23], a[172:175], v[152:155], v[20:23]
v_mfma_f32_16x16x32_bf16 v[24:27], a[144:147], v[108:111], 0
v_mfma_f32_16x16x32_bf16 v[24:27], a[148:151], v[124:127], v[24:27]
v_mfma_f32_16x16x32_bf16 v[24:27], a[152:155], v[140:143], v[24:27]
v_mfma_f32_16x16x32_bf16 v[24:27], a[156:159], v[156:159], v[24:27]
v_mfma_f32_16x16x32_bf16 v[28:31], a[160:163], v[108:111], 0
v_mfma_f32_16x16x32_bf16 v[28:31], a[164:167], v[124:127], v[28:31]
v_mfma_f32_16x16x32_bf16 v[28:31], a[168:171], v[140:143], v[28:31]
v_mfma_f32_16x16x32_bf16 v[28:31], a[172:175], v[156:159], v[28:31]
s_nop 7
s_lshl_b32 s3, s96, 5
v_subrev_u32 v42, s3, v44
v_cmp_le_i32 vcc, 0, v42
s_nop 1
v_cndmask_b32 v43, v244, v0, vcc
v_max_f32 v48, v48, v43
v_cmp_le_i32 vcc, 1, v42
s_nop 1
v_cndmask_b32 v43, v244, v1, vcc
v_max_f32 v48, v48, v43
v_cmp_le_i32 vcc, 2, v42
s_nop 1
v_cndmask_b32 v43, v244, v2, vcc
v_max_f32 v48, v48, v43
v_cmp_le_i32 vcc, 3, v42
s_nop 1
v_cndmask_b32 v43, v244, v3, vcc
v_max_f32 v48, v48, v43
v_cmp_le_i32 vcc, 16, v42
s_nop 1
v_cndmask_b32 v43, v244, v4, vcc
v_max_f32 v48, v48, v43
v_cmp_le_i32 vcc, 17, v42
s_nop 1
v_cndmask_b32 v43, v244, v5, vcc
v_max_f32 v48, v48, v43
v_cmp_le_i32 vcc, 18, v42
s_nop 1
v_cndmask_b32 v43, v244, v6, vcc
v_max_f32 v48, v48, v43
v_cmp_le_i32 vcc, 19, v42
s_nop 1
v_cndmask_b32 v43, v244, v7, vcc
v_max_f32 v48, v48, v43
v_subrev_u32 v42, s3, v45
v_cmp_le_i32 vcc, 0, v42
s_nop 1
v_cndmask_b32 v43, v244, v8, vcc
v_max_f32 v49, v49, v43
v_cmp_le_i32 vcc, 1, v42
s_nop 1
v_cndmask_b32 v43, v244, v9, vcc
v_max_f32 v49, v49, v43
v_cmp_le_i32 vcc, 2, v42
s_nop 1
v_cndmask_b32 v43, v244, v10, vcc
v_max_f32 v49, v49, v43
v_cmp_le_i32 vcc, 3, v42
s_nop 1
v_cndmask_b32 v43, v244, v11, vcc
v_max_f32 v49, v49, v43
v_cmp_le_i32 vcc, 16, v42
s_nop 1
v_cndmask_b32 v43, v244, v12, vcc
v_max_f32 v49, v49, v43
v_cmp_le_i32 vcc, 17, v42
s_nop 1
v_cndmask_b32 v43, v244, v13, vcc
v_max_f32 v49, v49, v43
v_cmp_le_i32 vcc, 18, v42
s_nop 1
v_cndmask_b32 v43, v244, v14, vcc
v_max_f32 v49, v49, v43
v_cmp_le_i32 vcc, 19, v42
s_nop 1
v_cndmask_b32 v43, v244, v15, vcc
v_max_f32 v49, v49, v43
v_subrev_u32 v42, s3, v46
v_cmp_le_i32 vcc, 0, v42
s_nop 1
v_cndmask_b32 v43, v244, v16, vcc
v_max_f32 v50, v50, v43
v_cmp_le_i32 vcc, 1, v42
s_nop 1
v_cndmask_b32 v43, v244, v17, vcc
v_max_f32 v50, v50, v43
v_cmp_le_i32 vcc, 2, v42
s_nop 1
v_cndmask_b32 v43, v244, v18, vcc
v_max_f32 v50, v50, v43
v_cmp_le_i32 vcc, 3, v42
s_nop 1
v_cndmask_b32 v43, v244, v19, vcc
v_max_f32 v50, v50, v43
v_cmp_le_i32 vcc, 16, v42
s_nop 1
v_cndmask_b32 v43, v244, v20, vcc
v_max_f32 v50, v50, v43
v_cmp_le_i32 vcc, 17, v42
s_nop 1
v_cndmask_b32 v43, v244, v21, vcc
v_max_f32 v50, v50, v43
v_cmp_le_i32 vcc, 18, v42
s_nop 1
v_cndmask_b32 v43, v244, v22, vcc
v_max_f32 v50, v50, v43
v_cmp_le_i32 vcc, 19, v42
s_nop 1
v_cndmask_b32 v43, v244, v23, vcc
v_max_f32 v50, v50, v43
v_subrev_u32 v42, s3, v47
v_cmp_le_i32 vcc, 0, v42
s_nop 1
v_cndmask_b32 v43, v244, v24, vcc
v_max_f32 v51, v51, v43
v_cmp_le_i32 vcc, 1, v42
s_nop 1
v_cndmask_b32 v43, v244, v25, vcc
v_max_f32 v51, v51, v43
v_cmp_le_i32 vcc, 2, v42
s_nop 1
v_cndmask_b32 v43, v244, v26, vcc
v_max_f32 v51, v51, v43
v_cmp_le_i32 vcc, 3, v42
s_nop 1
v_cndmask_b32 v43, v244, v27, vcc
v_max_f32 v51, v51, v43
v_cmp_le_i32 vcc, 16, v42
s_nop 1
v_cndmask_b32 v43, v244, v28, vcc
v_max_f32 v51, v51, v43
v_cmp_le_i32 vcc, 17, v42
s_nop 1
v_cndmask_b32 v43, v244, v29, vcc
v_max_f32 v51, v51, v43
v_cmp_le_i32 vcc, 18, v42
s_nop 1
v_cndmask_b32 v43, v244, v30, vcc
v_max_f32 v51, v51, v43
v_cmp_le_i32 vcc, 19, v42
s_nop 1
v_cndmask_b32 v43, v244, v31, vcc
v_max_f32 v51, v51, v43
s_add_u32 s96, s96, 1
s_cmp_lt_u32 s96, s62
s_cbranch_scc1 L_mx
v_mov_b32 v43, v48
s_nop 1
v_permlane16_swap_b32 v48, v43
s_nop 1
v_max_f32 v48, v48, v43
v_mov_b32 v43, v48
s_nop 1
v_permlane32_swap_b32 v48, v43
s_nop 1
v_max_f32 v48, v48, v43
v_sub_f32 v192, 0, v48
v_sub_f32 v208, v252, v48
v_sub_f32 v193, 0, v48
v_sub_f32 v209, v253, v48
v_sub_f32 v194, 0, v48
v_sub_f32 v210, v254, v48
v_sub_f32 v195, 0, v48
v_sub_f32 v211, v255, v48
v_mov_b32 v43, v49
s_nop 1
v_permlane16_swap_b32 v49, v43
s_nop 1
v_max_f32 v49, v49, v43
v_mov_b32 v43, v49
s_nop 1
v_permlane32_swap_b32 v49, v43
s_nop 1
v_max_f32 v49, v49, v43
v_sub_f32 v196, 0, v49
v_sub_f32 v212, v252, v49
v_sub_f32 v197, 0, v49
v_sub_f32 v213, v253, v49
v_sub_f32 v198, 0, v49
v_sub_f32 v214, v254, v49
v_sub_f32 v199, 0, v49
v_sub_f32 v215, v255, v49
v_mov_b32 v43, v50
s_nop 1
v_permlane16_swap_b32 v50, v43
s_nop 1
v_max_f32 v50, v50, v43
v_mov_b32 v43, v50
s_nop 1
v_permlane32_swap_b32 v50, v43
s_nop 1
v_max_f32 v50, v50, v43
v_sub_f32 v200, 0, v50
v_sub_f32 v216, v252, v50
v_sub_f32 v201, 0, v50
v_sub_f32 v217, v253, v50
v_sub_f32 v202, 0, v50
v_sub_f32 v218, v254, v50
v_sub_f32 v203, 0, v50
v_sub_f32 v219, v255, v50
v_mov_b32 v43, v51
s_nop 1
v_permlane16_swap_b32 v51, v43
s_nop 1
v_max_f32 v51, v51, v43
v_mov_b32 v43, v51
s_nop 1
v_permlane32_swap_b32 v51, v43
s_nop 1
v_max_f32 v51, v51, v43
v_sub_f32 v204, 0, v51
v_sub_f32 v220, v252, v51
v_sub_f32 v205, 0, v51
v_sub_f32 v221, v253, v51
v_sub_f32 v206, 0, v51
v_sub_f32 v222, v254, v51
v_sub_f32 v207, 0, v51
v_sub_f32 v223, v255, v51
s_barrier
s_add_u32 m0, s6, 0
s_add_u32 s3, s63, 0
buffer_load_dwordx4 v242, s[40:43], s3 offen offset:0 sc1 lds
buffer_load_dwordx4 v242, s[40:43], s3 offen offset:1024 sc1 lds
buffer_load_dwordx4 v242, s[40:43], s3 offen offset:2048 sc1 lds
buffer_load_dwordx4 v242, s[40:43], s3 offen offset:3072 sc1 lds
s_add_u32 m0, s6, 8192
s_add_u32 s3, s63, 16384
buffer_load_dwordx4 v242, s[40:43], s3 offen offset:0 sc1 lds
buffer_load_dwordx4 v242, s[40:43], s3 offen offset:1024 sc1 lds
buffer_load_dwordx4 v242, s[40:43], s3 offen offset:2048 sc1 lds
buffer_load_dwordx4 v242, s[40:43], s3 offen offset:3072 sc1 lds
s_add_u32 m0, s6, 16384
s_add_u32 s3, s63, 32768
buffer_load_dwordx4 v242, s[40:43], s3 offen offset:0 sc1 lds
buffer_load_dwordx4 v242, s[40:43], s3 offen offset:1024 sc1 lds
buffer_load_dwordx4 v242, s[40:43], s3 offen offset:2048 sc1 lds
buffer_load_dwordx4 v242, s[40:43], s3 offen offset:3072 sc1 lds
s_add_u32 m0, s6, 24576
s_add_u32 s3, s63, 49152
buffer_load_dwordx4 v242, s[40:43], s3 offen offset:0 sc1 lds
buffer_load_dwordx4 v242, s[40:43], s3 offen offset:1024 sc1 lds
buffer_load_dwordx4 v242, s[40:43], s3 offen offset:2048 sc1 lds
buffer_load_dwordx4 v242, s[40:43], s3 offen offset:3072 sc1 lds
s_add_u32 m0, s100, 98304
s_mul_i32 s3, s56, 16384
s_add_u32 s3, s3, 65536
buffer_load_dwordx4 v242, s[40:43], s3 offen offset:0 sc1 lds
buffer_load_dwordx4 v242, s[40:43], s3 offen offset:1024 sc1 lds
buffer_load_dwordx4 v242, s[40:43], s3 offen offset:2048 sc1 lds
buffer_load_dwordx4 v242, s[40:43], s3 offen offset:3072 sc1 lds
s_add_u32 m0, s100, 102400
s_mul_i32 s3, s56, 16384
s_add_u32 s3, s3, 69632
buffer_load_dwordx4 v242, s[40:43], s3 offen offset:0 sc1 lds
buffer_load_dwordx4 v242, s[40:43], s3 offen offset:1024 sc1 lds
buffer_load_dwordx4 v242, s[40:43], s3 offen offset:2048 sc1 lds
buffer_load_dwordx4 v242, s[40:43], s3 offen offset:3072 sc1 lds
s_mov_b32 s65, s64
s_mov_b32 s68, 32768
s_cmp_lt_u32 s56, 2
s_cselect_b32 s67, s68, 32768
s_mov_b32 s70, 0
v_add_u32 v240, 131072, v242
v_add_u32 v241, 32768, v242
s_waitcnt vmcnt(0)
s_barrier
ds_read_b128 a[144:147], v240 offset:0
ds_read_b128 a[148:151], v240 offset:1024
ds_read_b128 a[152:155], v240 offset:2048
ds_read_b128 a[156:159], v240 offset:3072
ds_read_b128 a[160:163], v240 offset:4096
ds_read_b128 a[164:167], v240 offset:5120
s_waitcnt lgkmcnt(1)
s_cmp_ge_u32 s60, 2
s_cbranch_scc0 L_alt16_1
v_mfma_f32_16x16x32_bf16 v[0:3], a[144:147], v[96:99], v[192:195]
v_mfma_f32_16x16x32_bf16 v[4:7], a[160:163], v[96:99], v[192:195]
L_ret16:
ds_read_b128 a[168:171], v240 offset:6144
s_add_u32 s68, s68, 8192
v_mfma_f32_16x16x32_bf16 v[16:19], a[144:147], v[104:107], v[200:203]
ds_read_b128 a[172:175], v240 offset:7168
s_and_b32 s68, s68, 0xffff
v_mfma_f32_16x16x32_bf16 v[16:19], a[148:151], v[120:123], v[16:19]
v_mfma_f32_16x16x32_bf16 v[16:19], a[152:155], v[136:139], v[16:19]
v_mfma_f32_16x16x32_bf16 v[16:19], a[156:159], v[152:155], v[16:19]
s_add_u32 s69, s68, 98304
v_mfma_f32_16x16x32_bf16 v[24:27], a[144:147], v[108:111], v[204:207]
v_mfma_f32_16x16x32_bf16 v[24:27], a[148:151], v[124:127], v[24:27]
v_mfma_f32_16x16x32_bf16 v[24:27], a[152:155], v[140:143], v[24:27]
v_mfma_f32_16x16x32_bf16 v[24:27], a[156:159], v[156:159], v[24:27]
v_mfma_f32_16x16x32_bf16 v[8:11], a[144:147], v[100:103], v[196:199]
v_mfma_f32_16x16x32_bf16 v[8:11], a[148:151], v[116:119], v[8:11]
v_mfma_f32_16x16x32_bf16 v[8:11], a[152:155], v[132:135], v[8:11]
v_mfma_f32_16x16x32_bf16 v[8:11], a[156:159], v[148:151], v[8:11]
v_add_u32 v240, s69, v242
v_mfma_f32_16x16x32_bf16 v[0:3], a[148:151], v[112:115], v[0:3]
v_mfma_f32_16x16x32_bf16 v[0:3], a[152:155], v[128:131], v[0:3]
v_mfma_f32_16x16x32_bf16 v[0:3], a[156:159], v[144:147], v[0:3]
v_mfma_f32_16x16x32_bf16 v[20:23], a[160:163], v[104:107], v[200:203]
s_waitcnt lgkmcnt(0)
v_mfma_f32_16x16x32_bf16 v[20:23], a[164:167], v[120:123], v[20:23]
s_waitcnt vmcnt(0) lgkmcnt(0)
s_barrier
v_mfma_f32_16x16x32_bf16 v[20:23], a[168:171], v[136:139], v[20:23]
ds_read_b128 a[144:147], v240 offset:0
v_mfma_f32_16x16x32_bf16 v[20:23], a[172:175], v[152:155], v[20:23]
ds_read_b128 a[148:151], v240 offset:1024
v_mfma_f32_16x16x32_bf16 v[28:31], a[160:163], v[108:111], v[204:207]
ds_read_b128 a[152:155], v240 offset:2048
v_mfma_f32_16x16x32_bf16 v[28:31], a[164:167], v[124:127], v[28:31]
ds_read_b128 a[156:159], v240 offset:3072
v_mfma_f32_16x16x32_bf16 v[28:31], a[168:171], v[140:143], v[28:31]
v_mfma_f32_16x16x32_bf16 v[28:31], a[172:175], v[156:159], v[28:31]
v_mfma_f32_16x16x32_bf16 v[12:15], a[160:163], v[100:103], v[196:199]
ds_read_b128 a[160:163], v240 offset:4096
v_mfma_f32_16x16x32_bf16 v[12:15], a[164:167], v[116:119], v[12:15]
v_mfma_f32_16x16x32_bf16 v[12:15], a[168:171], v[132:135], v[12:15]
v_mfma_f32_16x16x32_bf16 v[12:15], a[172:175], v[148:151], v[12:15]
v_mfma_f32_16x16x32_bf16 v[4:7], a[164:167], v[112:115], v[4:7]
ds_read_b128 a[164:167], v240 offset:5120
v_mfma_f32_16x16x32_bf16 v[4:7], a[168:171], v[128:131], v[4:7]
v_mfma_f32_16x16x32_bf16 v[4:7], a[172:175], v[144:147], v[4:7]
s_branch L_p1
L_ool:
L_spin5:
s_mov_b32 s70, 0x80000
L_spinl5:
s_sleep 1
buffer_load_dword v219, v222, s[52:55], 0 offen sc1
s_waitcnt vmcnt(0)
v_readfirstlane_b32 s79, v219
s_sub_u32 s70, s70, 1
s_cmp_eq_u32 s70, 0
s_cbranch_scc1 L_got5
s_cmp_ge_u32 s79, 1
s_cbranch_scc0 L_spinl5
s_branch L_got5
L_spin6:
s_mov_b32 s77, 0x80000
L_spinl6:
s_sleep 1
buffer_load_dword v245, v222, s[48:51], s70 offen sc1
s_waitcnt vmcnt(0)
v_readfirstlane_b32 s79, v245
s_sub_u32 s77, s77, 1
s_cmp_eq_u32 s77, 0
s_cbranch_scc1 L_got6
s_cmp_ge_u32 s79, 16
s_cbranch_scc0 L_spinl6
s_branch L_got6
L_spin7:
s_mov_b32 s77, 0x80000
L_spinl7:
s_sleep 1
buffer_load_dword v244, v222, s[48:51], s71 offen sc1
s_waitcnt vmcnt(0)
v_readfirstlane_b32 s79, v244
s_sub_u32 s77, s77, 1
s_cmp_eq_u32 s77, 0
s_cbranch_scc1 L_got7
s_cmp_ge_u32 s79, 16
s_cbranch_scc0 L_spinl7
s_branch L_got7
L_spin9:
s_mov_b32 s9, 0x80000
L_spinl9:
s_sleep 1
buffer_load_dword v220, v222, s[48:51], s97 offen sc1
s_waitcnt vmcnt(0)
v_readfirstlane_b32 s8, v220
s_sub_u32 s9, s9, 1
s_cmp_eq_u32 s9, 0
s_cbranch_scc1 L_got9
s_cmp_ge_u32 s8, 8
s_cbranch_scc0 L_spinl9
s_branch L_got9
L_alt0_1:
s_cmp_eq_u32 s60, 1
s_cbranch_scc0 L_alt0_2
v_mfma_f32_16x16x32_bf16 v[0:3], a[144:147], v[96:99], v[192:195]
v_mfma_f32_16x16x32_bf16 v[4:7], a[160:163], v[96:99], v[208:211]
s_branch L_ret0
L_alt0_2:
v_mfma_f32_16x16x32_bf16 v[0:3], a[144:147], v[96:99], v[208:211]
v_mfma_f32_16x16x32_bf16 v[4:7], a[160:163], v[96:99], v[244:247]
s_branch L_ret0
L_alt1_1:
s_cmp_eq_u32 s60, 3
s_cbranch_scc0 L_alt1_2
v_mfma_f32_16x16x32_bf16 v[32:35], a[144:147], v[96:99], v[192:195]
v_mfma_f32_16x16x32_bf16 v[36:39], a[160:163], v[96:99], v[208:211]
s_branch L_ret1
L_alt1_2:
s_cmp_eq_u32 s60, 2
s_cbranch_scc0 L_alt1_3
v_mfma_f32_16x16x32_bf16 v[32:35], a[144:147], v[96:99], v[208:211]
v_mfma_f32_16x16x32_bf16 v[36:39], a[160:163], v[96:99], v[244:247]
s_branch L_ret1
L_alt1_3:
v_mfma_f32_16x16x32_bf16 v[32:35], a[144:147], v[96:99], v[244:247]
v_mfma_f32_16x16x32_bf16 v[36:39], a[160:163], v[96:99], v[244:247]
s_branch L_ret1
L_alt2_1:
s_cmp_ge_u32 s60, 2
s_cbranch_scc0 L_alt2_2
v_mfma_f32_16x16x32_bf16 v[0:3], a[144:147], v[96:99], v[244:247]
v_mfma_f32_16x16x32_bf16 v[4:7], a[160:163], v[96:99], v[244:247]
v_mfma_f32_16x16x32_bf16 v[8:11], a[144:147], v[100:103], v[196:199]
v_mfma_f32_16x16x32_bf16 v[12:15], a[160:163], v[100:103], v[196:199]
s_branch L_ret2
L_alt2_2:
s_cmp_eq_u32 s60, 1
s_cbranch_scc0 L_alt2_3
v_mfma_f32_16x16x32_bf16 v[0:3], a[144:147], v[96:99], v[244:247]
v_mfma_f32_16x16x32_bf16 v[4:7], a[160:163], v[96:99], v[244:247]
v_mfma_f32_16x16x32_bf16 v[8:11], a[144:147], v[100:103], v[196:199]
v_mfma_f32_16x16x32_bf16 v[12:15], a[160:163], v[100:103], v[212:215]
s_branch L_ret2
L_alt2_3:
v_mfma_f32_16x16x32_bf16 v[0:3], a[144:147], v[96:99], v[244:247]
v_mfma_f32_16x16x32_bf16 v[4:7], a[160:163], v[96:99], v[244:247]
v_mfma_f32_16x16x32_bf16 v[8:11], a[144:147], v[100:103], v[212:215]
v_mfma_f32_16x16x32_bf16 v[12:15], a[160:163], v[100:103], v[244:247]
s_branch L_ret2
L_alt3_1:
s_cmp_eq_u32 s60, 3
s_cbranch_scc0 L_alt3_2
v_mfma_f32_16x16x32_bf16 v[32:35], a[144:147], v[96:99], v[244:247]
v_mfma_f32_16x16x32_bf16 v[36:39], a[160:163], v[96:99], v[244:247]
v_mfma_f32_16x16x32_bf16 v[40:43], a[144:147], v[100:103], v[196:199]
v_mfma_f32_16x16x32_bf16 v[44:47], a[160:163], v[100:103], v[212:215]
s_branch L_ret3
L_alt3_2:
s_cmp_eq_u32 s60, 2
s_cbranch_scc0 L_alt3_3
v_mfma_f32_16x16x32_bf16 v[32:35], a[144:147], v[96:99], v[244:247]
v_mfma_f32_16x16x32_bf16 v[36:39], a[160:163], v[96:99], v[244:247]
v_mfma_f32_16x16x32_bf16 v[40:43], a[144:147], v[100:103], v[212:215]
v_mfma_f32_16x16x32_bf16 v[44:47], a[160:163], v[100:103], v[244:247]
s_branch L_ret3
L_alt3_3:
v_mfma_f32_16x16x32_bf16 v[32:35], a[144:147], v[96:99], v[244:247]
v_mfma_f32_16x16x32_bf16 v[36:39], a[160:163], v[96:99], v[244:247]
v_mfma_f32_16x16x32_bf16 v[40:43], a[144:147], v[100:103], v[244:247]
v_mfma_f32_16x16x32_bf16 v[44:47], a[160:163], v[100:103], v[244:247]
s_branch L_ret3
L_alt4_1:
s_cmp_eq_u32 s56, 1
s_cbranch_scc0 L_alt4_2
v_mfma_f32_16x16x32_bf16 v[0:3], a[144:147], v[96:99], v[192:195]
v_mfma_f32_16x16x32_bf16 v[4:7], a[160:163], v[96:99], v[208:211]
s_branch L_ret4
L_alt4_2:
v_mfma_f32_16x16x32_bf16 v[0:3], a[144:147], v[96:99], v[208:211]
v_mfma_f32_16x16x32_bf16 v[4:7], a[160:163], v[96:99], v[244:247]
s_branch L_ret4
L_alt5_1:
s_cmp_eq_u32 s56, 2
s_cbranch_scc0 L_alt5_2
v_mfma_f32_16x16x32_bf16 v[32:35], a[144:147], v[96:99], v[208:211]
v_mfma_f32_16x16x32_bf16 v[36:39], a[160:163], v[96:99], v[244:247]
s_branch L_ret5
L_alt5_2:
v_mfma_f32_16x16x32_bf16 v[32:35], a[144:147], v[96:99], v[244:247]
v_mfma_f32_16x16x32_bf16 v[36:39], a[160:163], v[96:99], v[244:247]
s_branch L_ret5
L_alt6_1:
s_cmp_eq_u32 s56, 1
s_cbranch_scc0 L_alt6_2
v_mfma_f32_16x16x32_bf16 v[8:11], a[144:147], v[100:103], v[196:199]
v_mfma_f32_16x16x32_bf16 v[12:15], a[160:163], v[100:103], v[212:215]
s_branch L_ret6
L_alt6_2:
v_mfma_f32_16x16x32_bf16 v[8:11], a[144:147], v[100:103], v[212:215]
v_mfma_f32_16x16x32_bf16 v[12:15], a[160:163], v[100:103], v[244:247]
s_branch L_ret6
L_alt7_1:
s_cmp_eq_u32 s56, 2
s_cbranch_scc0 L_alt7_2
v_mfma_f32_16x16x32_bf16 v[40:43], a[144:147], v[100:103], v[212:215]
v_mfma_f32_16x16x32_bf16 v[44:47], a[160:163], v[100:103], v[244:247]
s_branch L_ret7
L_alt7_2:
v_mfma_f32_16x16x32_bf16 v[40:43], a[144:147], v[100:103], v[244:247]
v_mfma_f32_16x16x32_bf16 v[44:47], a[160:163], v[100:103], v[244:247]
s_branch L_ret7
L_alt8_1:
s_cmp_eq_u32 s61, 1
s_cbranch_scc0 L_alt8_2
v_mfma_f32_16x16x32_bf16 v[0:3], a[144:147], v[104:107], v[200:203]
v_mfma_f32_16x16x32_bf16 v[4:7], a[160:163], v[104:107], v[216:219]
s_branch L_ret8
L_alt8_2:
v_mfma_f32_16x16x32_bf16 v[0:3], a[144:147], v[104:107], v[216:219]
v_mfma_f32_16x16x32_bf16 v[4:7], a[160:163], v[104:107], v[244:247]
s_branch L_ret8
L_alt9_1:
s_cmp_eq_u32 s61, 3
s_cbranch_scc0 L_alt9_2
v_mfma_f32_16x16x32_bf16 v[8:11], a[176:179], v[104:107], v[200:203]
v_mfma_f32_16x16x32_bf16 v[12:15], a[192:195], v[104:107], v[216:219]
s_branch L_ret9
L_alt9_2:
s_cmp_eq_u32 s61, 2
s_cbranch_scc0 L_alt9_3
v_mfma_f32_16x16x32_bf16 v[8:11], a[176:179], v[104:107], v[216:219]
v_mfma_f32_16x16x32_bf16 v[12:15], a[192:195], v[104:107], v[244:247]
s_branch L_ret9
L_alt9_3:
v_mfma_f32_16x16x32_bf16 v[8:11], a[176:179], v[104:107], v[244:247]
v_mfma_f32_16x16x32_bf16 v[12:15], a[192:195], v[104:107], v[244:247]
s_branch L_ret9
L_alt10_1:
s_cmp_ge_u32 s61, 2
s_cbranch_scc0 L_alt10_2
v_mfma_f32_16x16x32_bf16 v[32:35], a[144:147], v[104:107], v[244:247]
v_mfma_f32_16x16x32_bf16 v[36:39], a[160:163], v[104:107], v[244:247]
v_mfma_f32_16x16x32_bf16 v[48:51], a[144:147], v[108:111], v[204:207]
v_mfma_f32_16x16x32_bf16 v[52:55], a[160:163], v[108:111], v[204:207]
s_branch L_ret10
L_alt10_2:
s_cmp_eq_u32 s61, 1
s_cbranch_scc0 L_alt10_3
v_mfma_f32_16x16x32_bf16 v[32:35], a[144:147], v[104:107], v[244:247]
v_mfma_f32_16x16x32_bf16 v[36:39], a[160:163], v[104:107], v[244:247]
v_mfma_f32_16x16x32_bf16 v[48:51], a[144:147], v[108:111], v[204:207]
v_mfma_f32_16x16x32_bf16 v[52:55], a[160:163], v[108:111], v[220:223]
s_branch L_ret10
L_alt10_3:
v_mfma_f32_16x16x32_bf16 v[32:35], a[144:147], v[104:107], v[244:247]
v_mfma_f32_16x16x32_bf16 v[36:39], a[160:163], v[104:107], v[244:247]
v_mfma_f32_16x16x32_bf16 v[48:51], a[144:147], v[108:111], v[220:223]
v_mfma_f32_16x16x32_bf16 v[52:55], a[160:163], v[108:111], v[244:247]
s_branch L_ret10
L_alt11_1:
s_cmp_eq_u32 s61, 3
s_cbranch_scc0 L_alt11_2
v_mfma_f32_16x16x32_bf16 v[40:43], a[176:179], v[104:107], v[244:247]
v_mfma_f32_16x16x32_bf16 v[44:47], a[192:195], v[104:107], v[244:247]
v_mfma_f32_16x16x32_bf16 v[56:59], a[176:179], v[108:111], v[204:207]
v_mfma_f32_16x16x32_bf16 v[60:63], a[192:195], v[108:111], v[220:223]
s_branch L_ret11
L_alt11_2:
s_cmp_eq_u32 s61, 2
s_cbranch_scc0 L_alt11_3
v_mfma_f32_16x16x32_bf16 v[40:43], a[176:179], v[104:107], v[244:247]
v_mfma_f32_16x16x32_bf16 v[44:47], a[192:195], v[104:107], v[244:247]
v_mfma_f32_16x16x32_bf16 v[56:59], a[176:179], v[108:111], v[220:223]
v_mfma_f32_16x16x32_bf16 v[60:63], a[192:195], v[108:111], v[244:247]
s_branch L_ret11
L_alt11_3:
v_mfma_f32_16x16x32_bf16 v[40:43], a[176:179], v[104:107], v[244:247]
v_mfma_f32_16x16x32_bf16 v[44:47], a[192:195], v[104:107], v[244:247]
v_mfma_f32_16x16x32_bf16 v[56:59], a[176:179], v[108:111], v[244:247]
v_mfma_f32_16x16x32_bf16 v[60:63], a[192:195], v[108:111], v[244:247]
s_branch L_ret11
L_alt12_1:
s_cmp_eq_u32 s56, 1
s_cbranch_scc0 L_alt12_2
v_mfma_f32_16x16x32_bf16 v[0:3], a[144:147], v[104:107], v[200:203]
v_mfma_f32_16x16x32_bf16 v[4:7], a[160:163], v[104:107], v[216:219]
s_branch L_ret12
L_alt12_2:
v_mfma_f32_16x16x32_bf16 v[0:3], a[144:147], v[104:107], v[216:219]
v_mfma_f32_16x16x32_bf16 v[4:7], a[160:163], v[104:107], v[244:247]
s_branch L_ret12
L_alt13_1:
s_cmp_eq_u32 s56, 2
s_cbranch_scc0 L_alt13_2
v_mfma_f32_16x16x32_bf16 v[8:11], a[176:179], v[104:107], v[216:219]
v_mfma_f32_16x16x32_bf16 v[12:15], a[192:195], v[104:107], v[244:247]
s_branch L_ret13
L_alt13_2:
v_mfma_f32_16x16x32_bf16 v[8:11], a[176:179], v[104:107], v[244:247]
v_mfma_f32_16x16x32_bf16 v[12:15], a[192:195], v[104:107], v[244:247]
s_branch L_ret13
L_alt14_1:
s_cmp_eq_u32 s56, 1
s_cbranch_scc0 L_alt14_2
v_mfma_f32_16x16x32_bf16 v[48:51], a[144:147], v[108:111], v[204:207]
v_mfma_f32_16x16x32_bf16 v[52:55], a[160:163], v[108:111], v[220:223]
s_branch L_ret14
L_alt14_2:
v_mfma_f32_16x16x32_bf16 v[48:51], a[144:147], v[108:111], v[220:223]
v_mfma_f32_16x16x32_bf16 v[52:55], a[160:163], v[108:111], v[244:247]
s_branch L_ret14
L_alt15_1:
s_cmp_eq_u32 s56, 2
s_cbranch_scc0 L_alt15_2
v_mfma_f32_16x16x32_bf16 v[56:59], a[176:179], v[108:111], v[220:223]
v_mfma_f32_16x16x32_bf16 v[60:63], a[192:195], v[108:111], v[244:247]
s_branch L_ret15
L_alt15_2:
v_mfma_f32_16x16x32_bf16 v[56:59], a[176:179], v[108:111], v[244:247]
v_mfma_f32_16x16x32_bf16 v[60:63], a[192:195], v[108:111], v[244:247]
s_branch L_ret15
L_z0:
ds_read_b128 a[144:147], v241 offset:0
ds_read_b128 a[148:151], v241 offset:8192
ds_read_b128 a[152:155], v241 offset:1024
ds_read_b128 a[156:159], v241 offset:9216
ds_read_b128 a[160:163], v241 offset:2048
ds_read_b128 a[164:167], v241 offset:10240
s_branch L_z1
L_spin20:
s_mov_b32 s98, 0x80000
L_spinl20:
s_sleep 1
buffer_load_dword v236, v238, s[48:51], s19 offen sc1
s_waitcnt vmcnt(0)
v_readfirstlane_b32 s18, v236
s_sub_u32 s98, s98, 1
s_cmp_eq_u32 s98, 0
s_cbranch_scc1 L_got20
s_cmp_ge_u32 s18, 32
s_cbranch_scc0 L_spinl20
s_branch L_got20
L_spin22:
s_mov_b32 s71, 0x80000
L_spinl22:
s_sleep 1
buffer_load_dword v236, v238, s[48:51], s69 offen sc1
s_waitcnt vmcnt(0)
v_readfirstlane_b32 s70, v236
s_sub_u32 s71, s71, 1
s_cmp_eq_u32 s71, 0
s_cbranch_scc1 L_got22
s_cmp_ge_u32 s70, 8
s_cbranch_scc0 L_spinl22
s_branch L_got22
L_spin24:
s_mov_b32 s71, 0x80000
L_spinl24:
s_sleep 1
buffer_load_dword v237, v238, s[48:51], s66 offen sc1
s_waitcnt vmcnt(0)
v_readfirstlane_b32 s70, v237
s_sub_u32 s71, s71, 1
s_cmp_eq_u32 s71, 0
s_cbranch_scc1 L_got24
s_cmp_ge_u32 s70, 8
s_cbranch_scc0 L_spinl24
s_branch L_got24
L_pws:
buffer_load_dwordx4 v[64:67], v242, s[40:43], s63 offen offset:0 sc1
buffer_load_dwordx4 v[68:71], v242, s[40:43], s63 offen offset:1024 sc1
buffer_load_dwordx4 v[72:75], v242, s[40:43], s64 offen offset:0 sc1
buffer_load_dwordx4 v[76:79], v242, s[40:43], s64 offen offset:1024 sc1
buffer_load_dwordx4 v[80:83], v242, s[40:43], s65 offen offset:0 sc1
buffer_load_dwordx4 v[84:87], v242, s[40:43], s65 offen offset:1024 sc1
s_waitcnt vmcnt(0)
v_max3_u32 v200, v64, v65, v66
v_max3_u32 v201, v67, v68, v69
v_max3_u32 v200, v200, v70, v71
v_max3_u32 v201, v201, v72, v73
v_max3_u32 v200, v200, v74, v75
v_max3_u32 v201, v201, v76, v77
v_max3_u32 v200, v200, v78, v79
v_max3_u32 v201, v201, v80, v81
v_max3_u32 v200, v200, v82, v83
v_max3_u32 v201, v201, v84, v85
v_max3_u32 v200, v200, v86, v87
v_max_u32 v200, v200, v201
v_cmp_eq_u32 vcc, -1, v200
s_sub_u32 s74, s74, 1
s_cselect_b64 s[70:71], 0, -1
s_and_b64 vcc, vcc, s[70:71]
s_cmp_lg_u64 vcc, 0
s_cbranch_scc1 L_pws
s_branch L_pks
L_alt16_1:
s_cmp_eq_u32 s60, 1
s_cbranch_scc0 L_alt16_2
v_mfma_f32_16x16x32_bf16 v[0:3], a[144:147], v[96:99], v[192:195]
v_mfma_f32_16x16x32_bf16 v[4:7], a[160:163], v[96:99], v[208:211]
s_branch L_ret16
L_alt16_2:
v_mfma_f32_16x16x32_bf16 v[0:3], a[144:147], v[96:99], v[208:211]
v_mfma_f32_16x16x32_bf16 v[4:7], a[160:163], v[96:99], v[244:247]
s_branch L_ret16
L_end:
s_endpgm
.section .rodata,"a"
.p2align 6
.amdhsa_kernel recurrent_scan__compressed_kv_cla__glu_gated_bilinear__prompt_kernel
  .amdhsa_next_free_vgpr 512
  .amdhsa_next_free_sgpr 102
  .amdhsa_accum_offset 256
  .amdhsa_group_segment_fixed_size 0
  .amdhsa_kernarg_size 104
  .amdhsa_user_sgpr_count 2
  .amdhsa_user_sgpr_kernarg_segment_ptr 1
  .amdhsa_system_sgpr_workgroup_id_x 1
  .amdhsa_float_denorm_mode_32 3
.end_amdhsa_kernel
.text
```
